```python
import torch

def _softmax(x, axis=-1):
    return torch.softmax(x, dim=axis)

def _gelu(x):
    return torch.nn.functional.gelu(x, approximate='tanh')

def _silu(x):
    return torch.nn.functional.silu(x)

def _sigmoid(x):
    return torch.sigmoid(x)

def _layernorm(x, axis=-1, eps=1e-05):
    m = x.mean(dim=axis, keepdim=True)
    v = x.var(dim=axis, keepdim=True, unbiased=False)
    return (x - m) / torch.sqrt(v + eps)

def _scatter_add(tgt, idx, src, axis=0):
    return tgt.clone().index_add_(axis, idx, src)

def _segment_sum(src, seg, n):
    out = torch.zeros((n,) + src.shape[1:], dtype=src.dtype)
    return out.index_add_(0, seg, src)

def _pad(x, pw):
    flat = tuple((v for pair in reversed(pw) for v in pair))
    return torch.nn.functional.pad(x, flat)
kernel_name = 'recurrent_scan__memory_aug_recurrent_mem_tr__dense_activation_relu__prompt'

def setup_inputs():

    _w = lambda a: (lambda t: t.to(torch.bfloat16) if t.is_floating_point() else t)(torch.as_tensor(a))

    def _A_setup():
        B, S, Dm = (1, 2048, 640)
        H, Dh = (32, 192)
        M, seg = (8, 32)
        seg = min(seg, S)
        S = S // seg * seg
        return {'x': _w((lambda *s: torch.randn(*s, dtype=torch.bfloat16) * 0.05)(B, S, Dm)), 'mem0': _w((lambda *s: torch.randn(*s, dtype=torch.bfloat16) * 0.2)(B, M, Dm)), 'Wq': _w((lambda *s: torch.randn(*s, dtype=torch.bfloat16) * 0.8)(Dm, H, Dh) * Dm ** (-0.5)), 'Wk': _w((lambda *s: torch.randn(*s, dtype=torch.bfloat16) * 0.8)(Dm, H, Dh) * Dm ** (-0.5)), 'Wv': _w((lambda *s: torch.randn(*s, dtype=torch.bfloat16) * 0.2)(Dm, H, Dh) * Dm ** (-0.5)), 'Wo': _w((lambda *s: torch.randn(*s, dtype=torch.bfloat16) * 0.2)(H, Dh, Dm) * (H * Dh) ** (-0.5)), 'seg_len': seg}
    _A_in = _A_setup()

    def _B_setup():
        B, S, D, Dff = (1, 2048, 640, 1536)
        return {'x': _w((lambda *s: torch.randn(*s, dtype=torch.bfloat16) * 0.05)(B, S, D)), 'w1': _w((lambda *s: torch.randn(*s, dtype=torch.bfloat16) * 0.1)(D, Dff)), 'w2': _w((lambda *s: torch.randn(*s, dtype=torch.bfloat16) * 0.1)(Dff, D))}
    _B_in = _B_setup()
    return {'A_x': _A_in['x'], 'A_mem0': _A_in['mem0'], 'A_Wq': _A_in['Wq'], 'A_Wk': _A_in['Wk'], 'A_Wv': _A_in['Wv'], 'A_Wo': _A_in['Wo'], 'A_seg_len': _A_in['seg_len'], 'B_x': _B_in['x'], 'B_w1': _B_in['w1'], 'B_w2': _B_in['w2']}

def reference(A_x, A_mem0, A_Wq, A_Wk, A_Wv, A_Wo, A_seg_len, B_x, B_w1, B_w2):

    def _A_ref(x, mem0, Wq, Wk, Wv, Wo, seg_len):
        B, S, Dm = x.shape
        H, Dh = (Wq.shape[1], Wq.shape[2])
        M = mem0.shape[1]
        scale = Dh ** (-0.5)
        n_seg = S // seg_len
        L = M + seg_len
        idx = torch.arange(L)
        mask = (idx[:, None] < M) | (idx[:, None] >= idx[None, :])
        mem = mem0
        outs = []
        for s in range(n_seg):
            xs = x[:, s * seg_len:(s + 1) * seg_len, :].clone()
            h = torch.concatenate([mem, xs], axis=1)
            q = torch.einsum('btd,dhe->bhte', h, Wq)
            k = torch.einsum('btd,dhe->bhte', h, Wk)
            v = torch.einsum('btd,dhe->bhte', h, Wv)
            scores = torch.einsum('bhqe,bhke->bhqk', q, k) * scale
            scores = torch.where(mask[None, None], scores, -1000000000.0)
            p = _softmax(scores, axis=-1)
            o = torch.einsum('bhqk,bhke->bhqe', p, v)
            o = torch.einsum('bhte,hed->btd', o, Wo)
            mem = o[:, :M, :].clone()
            outs.append(o[:, M:, :])
        return torch.concatenate(outs, axis=1)

    def _B_ref(x, w1, w2):
        h = torch.einsum('bsd,df->bsf', x, w1)
        zero = torch.zeros_like(h)
        h = torch.maximum(h, zero)
        return torch.einsum('bsf,fd->bsd', h, w2)
    x = A_x
    xn = _layernorm(x, axis=-1)
    s = _A_ref(xn, A_mem0, A_Wq, A_Wk, A_Wv, A_Wo, A_seg_len)
    g = _silu(_B_ref(xn, B_w1, B_w2))
    return x + s * g
```

```asm
; @launch grid=(256,1,1) block=(256,1,1) lds=163840
.amdgcn_target "amdgcn-amd-amdhsa--gfx950"
.text
.globl recurrent_scan__memory_aug_recurrent_mem_tr__dense_activation_relu__prompt_kernel
.p2align 8
.type recurrent_scan__memory_aug_recurrent_mem_tr__dense_activation_relu__prompt_kernel,@function
recurrent_scan__memory_aug_recurrent_mem_tr__dense_activation_relu__prompt_kernel:
s_cmp_ge_u32 s2, 256
s_cbranch_scc1 L_end
v_lshrrev_b32 v1, 6, v0
v_and_b32 v0, 63, v0
v_readfirstlane_b32 s3, v1
s_getreg_b32 s4, hwreg(HW_REG_XCC_ID)
s_and_b32 s4, s4, 7
s_sub_u32 s34, s4, s2
s_and_b32 s34, s34, 7
s_cmp_lg_u32 s3, 1
s_cbranch_scc1 Lcw_1
s_getpc_b64 s[6:7]
L_pc:
s_lshr_b32 s8, s2, 3
s_lshl_b32 s8, s8, 13
v_lshlrev_b32 v1, 7, v0
v_add_u32 v1, s8, v1
v_min_u32 v1, L_end-L_pc, v1
v_mov_b32 v3, s7
v_add_co_u32 v2, vcc, s6, v1
s_nop 1
v_addc_co_u32 v3, vcc, 0, v3, vcc
global_load_dword v255, v[2:3], off
Lcw_1:
L_restart:
s_load_dwordx16 s[36:51], s[0:1], 0
s_load_dwordx8 s[52:59], s[0:1], 64
s_load_dwordx2 s[60:61], s[0:1], 96
s_add_u32 s5, s2, s34
s_and_b32 s5, s5, 7
s_lshl_b32 s5, s5, 5
s_lshr_b32 s6, s2, 3
s_add_u32 s5, s5, s6
s_waitcnt lgkmcnt(0)
s_mov_b32 s8, s60
s_mov_b32 s9, s61
s_mov_b32 s10, 268435456
s_mov_b32 s11, 0x20000
s_mov_b32 s12, s58
s_mov_b32 s13, s59
s_mov_b32 s14, 256
s_mov_b32 s15, 0x20000
s_or_b32 s6, s2, s3
s_cmp_lg_u32 s6, 0
s_cbranch_scc1 Lz_2
s_add_u32 s6, s34, 1
v_mov_b32 v1, s6
v_mov_b32 v2, 176
buffer_store_dword v1, v2, s[12:15], 0 offen sc1
Lz_2:
s_cmp_ge_u32 s5, 64
s_cbranch_scc1 L_gemm
s_lshr_b32 s64, s5, 5
s_and_b32 s67, s5, 15
s_lshl_b32 s63, s64, 4
s_add_u32 s63, s63, s67
s_mov_b32 s65, 2097152
s_mov_b32 s62, 0
s_mov_b32 s24, s38
s_mov_b32 s25, s39
s_mov_b32 s26, 10240
s_mov_b32 s27, 0x20000
s_add_u32 s59, s60, 237502463
s_and_b32 s59, s59, 0xfff80000
s_sub_u32 s59, s59, s60
s_mul_i32 s58, s3, 3072
s_lshl_b32 s67, s3, 11
s_add_u32 s67, s67, 28672
s_cmp_ge_u32 s3, 2
s_cselect_b32 s58, s67, s58
s_mov_b32 s100, 0x00003f80
s_mov_b32 s101, 0x3f800000
s_bitcmp1_b32 s5, 4
s_cbranch_scc1 Lrole_vo_3
s_mov_b32 s16, s40
s_mov_b32 s17, s41
s_mov_b32 s18, 7864320
s_mov_b32 s19, 0x20000
s_mov_b32 s20, s42
s_mov_b32 s21, s43
s_mov_b32 s22, 7864320
s_mov_b32 s23, 0x20000
v_lshlrev_b32 v1, 4, v0
s_mul_i32 s6, s3, 3
s_lshl_b32 s7, s3, 1
s_add_u32 s7, s7, 2
s_min_u32 s6, s6, s7
s_lshl_b32 s80, s6, 10
v_add_u32 v3, 147456, v1
v_add_u32 v2, s80, v3
s_mul_i32 s67, s3, 36864
s_add_u32 s67, s67, 0
v_mov_b32 v4, s67
v_bfe_u32 v160, v0, 0, 6
s_mov_b32 s67, 16
v_mad_i32_i24 v4, v160, s67, v4
v_mov_b32 v8, 17476
v_bfe_u32 v160, v0, 1, 1
s_mov_b32 s67, 43690
v_mad_i32_i24 v8, v160, s67, v8
v_and_b32 v160, 8, v0
v_cmp_ne_u32 s[70:71], 0, v160
s_mul_i32 s67, s3, 256
s_add_u32 s67, s67, 147456
v_mov_b32 v5, s67
v_bfe_u32 v160, v0, 0, 4
s_mov_b32 s67, 16
v_mad_i32_i24 v5, v160, s67, v5
v_bfe_u32 v160, v0, 4, 2
s_mov_b32 s67, 4
v_mad_i32_i24 v5, v160, s67, v5
v_mov_b32 v7, 147456
v_bfe_u32 v160, v0, 0, 1
s_mov_b32 s67, 8
v_mad_i32_i24 v7, v160, s67, v7
v_bfe_u32 v160, v0, 2, 4
s_mov_b32 s67, 16
v_mad_i32_i24 v7, v160, s67, v7
v_mov_b32 v9, 0
v_bfe_u32 v160, v0, 0, 1
s_mov_b32 s67, 16
v_mad_i32_i24 v9, v160, s67, v9
v_bfe_u32 v160, v0, 1, 2
s_mov_b32 s67, 64
v_mad_i32_i24 v9, v160, s67, v9
v_bfe_u32 v160, v0, 3, 1
s_mov_b32 s67, 32
v_mad_i32_i24 v9, v160, s67, v9
v_bfe_u32 v160, v0, 4, 1
s_mov_b32 s67, 8
v_mad_i32_i24 v9, v160, s67, v9
v_bfe_u32 v160, v0, 5, 1
s_mov_b32 s67, 256
v_mad_i32_i24 v9, v160, s67, v9
v_mov_b32 v10, 0
v_bfe_u32 v160, v0, 0, 1
s_mov_b32 s67, 16
v_mad_i32_i24 v10, v160, s67, v10
v_bfe_u32 v160, v0, 1, 2
s_mov_b32 s67, 64
v_mad_i32_i24 v10, v160, s67, v10
v_bfe_u32 v160, v0, 3, 1
s_mov_b32 s67, 32
v_mad_i32_i24 v10, v160, s67, v10
v_bfe_u32 v160, v0, 4, 1
s_mov_b32 s67, 4
v_mad_i32_i24 v10, v160, s67, v10
v_mov_b32 v11, 150528
v_bfe_u32 v160, v0, 0, 6
s_mov_b32 s67, 16
v_mad_i32_i24 v11, v160, s67, v11
v_mov_b32 v12, 147456
v_bfe_u32 v160, v0, 0, 1
s_mov_b32 s67, 16
v_mad_i32_i24 v12, v160, s67, v12
v_bfe_u32 v160, v0, 1, 2
s_mov_b32 s67, 64
v_mad_i32_i24 v12, v160, s67, v12
v_bfe_u32 v160, v0, 3, 1
s_mov_b32 s67, 512
v_mad_i32_i24 v12, v160, s67, v12
v_bfe_u32 v160, v0, 4, 1
s_mov_b32 s67, 8
v_mad_i32_i24 v12, v160, s67, v12
v_bfe_u32 v160, v0, 5, 1
s_mov_b32 s67, 32
v_mad_i32_i24 v12, v160, s67, v12
s_and_b32 s68, s63, 15
s_min_u32 s68, s68, 9
s_lshl_b32 s68, s68, 10
v_add_u32 v12, s68, v12
v_mov_b32 v6, 0
v_bfe_u32 v160, v0, 0, 3
s_mov_b32 s67, 16
v_mad_i32_i24 v6, v160, s67, v6
v_bfe_u32 v160, v0, 3, 1
s_mov_b32 s67, 1024
v_mad_i32_i24 v6, v160, s67, v6
v_bfe_u32 v160, v0, 4, 2
s_mov_b32 s67, 256
v_mad_i32_i24 v6, v160, s67, v6
s_mul_i32 s67, s64, 12288
s_add_u32 s67, s67, 192053248
s_and_b32 s68, s63, 15
s_lshl_b32 s76, s68, 9
s_add_u32 s76, s76, s67
s_lshr_b32 s77, s68, 1
s_lshl_b32 s77, s77, 8
s_add_u32 s77, s77, s67
s_and_b32 s68, s68, 1
s_lshl_b32 s68, s68, 3
s_add_u32 s77, s77, s68
s_add_u32 s77, s77, 8192
s_mov_b32 s60, 0
s_cmp_lg_u32 s3, 0
s_cbranch_scc1 Ls_5
v_mov_b32 v18, 0
v_bfe_u32 v16, v0, 0, 3
s_mov_b32 s67, 1280
v_mad_i32_i24 v18, v16, s67, v18
v_bfe_u32 v16, v0, 3, 3
s_mov_b32 s67, 16
v_mad_i32_i24 v18, v16, s67, v18
v_mov_b32 v19, 147456
v_bfe_u32 v16, v0, 0, 1
s_mov_b32 s67, 16
v_mad_i32_i24 v19, v16, s67, v19
v_bfe_u32 v16, v0, 1, 2
s_mov_b32 s67, 64
v_mad_i32_i24 v19, v16, s67, v19
v_bfe_u32 v16, v0, 3, 1
s_mov_b32 s67, 32
v_mad_i32_i24 v19, v16, s67, v19
v_bfe_u32 v16, v0, 4, 2
s_mov_b32 s67, 256
v_mad_i32_i24 v19, v16, s67, v19
buffer_load_dwordx4 v[24:27], v18, s[24:27], 0 offen offset:0
buffer_load_dwordx4 v[28:31], v18, s[24:27], 0 offen offset:128
buffer_load_dwordx4 v[32:35], v18, s[24:27], 0 offen offset:256
buffer_load_dwordx4 v[36:39], v18, s[24:27], 0 offen offset:384
buffer_load_dwordx4 v[40:43], v18, s[24:27], 0 offen offset:512
buffer_load_dwordx4 v[44:47], v18, s[24:27], 0 offen offset:640
buffer_load_dwordx4 v[48:51], v18, s[24:27], 0 offen offset:768
buffer_load_dwordx4 v[52:55], v18, s[24:27], 0 offen offset:896
buffer_load_dwordx4 v[56:59], v18, s[24:27], 0 offen offset:1024
buffer_load_dwordx4 v[60:63], v18, s[24:27], 0 offen offset:1152
Ls_5:
v_lshrrev_b32 v168, 3, v0
v_and_b32 v169, 6, v168
v_and_b32 v160, 7, v0
v_xor_b32 v160, v160, v169
v_lshlrev_b32 v160, 4, v160
s_mov_b32 s67, 12288
v_mad_u32_u24 v160, v168, s67, v160
v_lshrrev_b32 v168, 3, v0
v_and_b32 v169, 6, v168
v_and_b32 v161, 7, v0
v_xor_b32 v161, v161, v169
v_lshlrev_b32 v161, 4, v161
s_mov_b32 s67, 1280
v_mad_u32_u24 v161, v168, s67, v161
v_mov_b32 v168, 0
v_bfe_u32 v170, v0, 4, 1
s_mov_b32 s67, 4
v_mad_i32_i24 v168, v170, s67, v168
s_mul_i32 s67, s3, 2
s_add_u32 s67, s67, 0
v_mov_b32 v169, s67
v_bfe_u32 v170, v0, 1, 1
s_mov_b32 s67, 1
v_mad_i32_i24 v169, v170, s67, v169
v_xor_b32 v169, v169, v168
v_mov_b32 v162, 0
v_bfe_u32 v170, v0, 0, 1
s_mov_b32 s67, 8
v_mad_i32_i24 v162, v170, s67, v162
v_bfe_u32 v170, v0, 2, 1
s_mov_b32 s67, 128
v_mad_i32_i24 v162, v170, s67, v162
v_bfe_u32 v170, v0, 3, 1
s_mov_b32 s67, 1024
v_mad_i32_i24 v162, v170, s67, v162
v_bfe_u32 v170, v0, 4, 1
s_mov_b32 s67, 512
v_mad_i32_i24 v162, v170, s67, v162
v_bfe_u32 v170, v0, 5, 1
s_mov_b32 s67, 2048
v_mad_i32_i24 v162, v170, s67, v162
v_lshl_add_u32 v162, v169, 4, v162
v_add_u32 v163, 49152, v162
v_add_u32 v164, 98304, v162
v_mov_b32 v168, 2
v_bfe_u32 v170, v0, 4, 1
s_mov_b32 s67, 4
v_mad_i32_i24 v168, v170, s67, v168
s_mul_i32 s67, s3, 2
s_add_u32 s67, s67, 0
v_mov_b32 v169, s67
v_bfe_u32 v170, v0, 1, 1
s_mov_b32 s67, 1
v_mad_i32_i24 v169, v170, s67, v169
v_xor_b32 v169, v169, v168
v_mov_b32 v165, 256
v_bfe_u32 v170, v0, 0, 1
s_mov_b32 s67, 8
v_mad_i32_i24 v165, v170, s67, v165
v_bfe_u32 v170, v0, 2, 1
s_mov_b32 s67, 128
v_mad_i32_i24 v165, v170, s67, v165
v_bfe_u32 v170, v0, 3, 1
s_mov_b32 s67, 1024
v_mad_i32_i24 v165, v170, s67, v165
v_bfe_u32 v170, v0, 4, 1
s_mov_b32 s67, 512
v_mad_i32_i24 v165, v170, s67, v165
v_bfe_u32 v170, v0, 5, 1
s_mov_b32 s67, 2048
v_mad_i32_i24 v165, v170, s67, v165
v_lshl_add_u32 v165, v169, 4, v165
v_add_u32 v166, 49152, v165
v_add_u32 v167, 98304, v165
s_mul_i32 s68, s63, 384
s_mul_i32 s67, s3, 98304
s_add_u32 s68, s68, s67
s_mul_i32 s69, s63, 245760
s_mul_i32 s67, s3, 10240
s_add_u32 s69, s69, s67
s_lshl_b32 s7, s3, 10
s_add_u32 m0, s7, 0
s_add_u32 s67, s68, 0
buffer_load_dwordx4 v160, s[16:19], s67 offen lds
s_add_u32 m0, s7, 4096
s_add_u32 s67, s68, 128
buffer_load_dwordx4 v160, s[16:19], s67 offen lds
s_add_u32 m0, s7, 8192
s_add_u32 s67, s68, 256
buffer_load_dwordx4 v160, s[16:19], s67 offen lds
s_add_u32 m0, s7, 12288
s_add_u32 s67, s68, 393216
buffer_load_dwordx4 v160, s[16:19], s67 offen lds
s_add_u32 m0, s7, 16384
s_add_u32 s67, s68, 393344
buffer_load_dwordx4 v160, s[16:19], s67 offen lds
s_add_u32 m0, s7, 20480
s_add_u32 s67, s68, 393472
buffer_load_dwordx4 v160, s[16:19], s67 offen lds
s_add_u32 m0, s7, 24576
s_add_u32 s67, s68, 786432
buffer_load_dwordx4 v160, s[16:19], s67 offen lds
s_add_u32 m0, s7, 28672
s_add_u32 s67, s68, 786560
buffer_load_dwordx4 v160, s[16:19], s67 offen lds
s_add_u32 m0, s7, 32768
s_add_u32 s67, s68, 786688
buffer_load_dwordx4 v160, s[16:19], s67 offen lds
s_add_u32 m0, s7, 36864
s_add_u32 s67, s68, 1179648
buffer_load_dwordx4 v160, s[16:19], s67 offen lds
s_add_u32 m0, s7, 40960
s_add_u32 s67, s68, 1179776
buffer_load_dwordx4 v160, s[16:19], s67 offen lds
s_add_u32 m0, s7, 45056
s_add_u32 s67, s68, 1179904
buffer_load_dwordx4 v160, s[16:19], s67 offen lds
s_add_u32 m0, s7, 49152
s_add_u32 s67, s68, 2359296
buffer_load_dwordx4 v160, s[16:19], s67 offen lds
s_add_u32 m0, s7, 53248
s_add_u32 s67, s68, 2359424
buffer_load_dwordx4 v160, s[16:19], s67 offen lds
s_add_u32 m0, s7, 57344
s_add_u32 s67, s68, 2359552
buffer_load_dwordx4 v160, s[16:19], s67 offen lds
s_add_u32 m0, s7, 61440
s_add_u32 s67, s68, 2752512
buffer_load_dwordx4 v160, s[16:19], s67 offen lds
s_add_u32 m0, s7, 65536
s_add_u32 s67, s68, 2752640
buffer_load_dwordx4 v160, s[16:19], s67 offen lds
s_add_u32 m0, s7, 69632
s_add_u32 s67, s68, 2752768
buffer_load_dwordx4 v160, s[16:19], s67 offen lds
s_waitcnt vmcnt(15)
s_waitcnt lgkmcnt(0)
s_barrier
s_add_u32 m0, s7, 73728
s_add_u32 s67, s68, 3145728
buffer_load_dwordx4 v160, s[16:19], s67 offen lds
s_add_u32 m0, s7, 77824
s_add_u32 s67, s68, 3145856
buffer_load_dwordx4 v160, s[16:19], s67 offen lds
s_add_u32 m0, s7, 81920
s_add_u32 s67, s68, 3145984
buffer_load_dwordx4 v160, s[16:19], s67 offen lds
ds_read_b64_tr_b16 a[0:1], v162 offset:0
ds_read_b64_tr_b16 a[2:3], v165 offset:0
ds_read_b64_tr_b16 a[56:57], v162 offset:4096
ds_read_b64_tr_b16 a[58:59], v165 offset:4096
ds_read_b64_tr_b16 a[112:113], v162 offset:8192
ds_read_b64_tr_b16 a[114:115], v165 offset:8192
s_cmp_lg_u32 s3, 0
s_cbranch_scc1 Ls_6
ds_write_b128 v19, v[24:27] offset:0
ds_write_b128 v19, v[28:31] offset:1024
ds_write_b128 v19, v[32:35] offset:2048
ds_write_b128 v19, v[36:39] offset:3072
ds_write_b128 v19, v[40:43] offset:4096
ds_write_b128 v19, v[44:47] offset:5120
ds_write_b128 v19, v[48:51] offset:6144
ds_write_b128 v19, v[52:55] offset:7168
ds_write_b128 v19, v[56:59] offset:8192
ds_write_b128 v19, v[60:63] offset:9216
Ls_6:
s_waitcnt vmcnt(15)
s_waitcnt lgkmcnt(0)
s_barrier
s_add_u32 m0, s7, 86016
s_add_u32 s67, s68, 3538944
buffer_load_dwordx4 v160, s[16:19], s67 offen lds
s_add_u32 m0, s7, 90112
s_add_u32 s67, s68, 3539072
buffer_load_dwordx4 v160, s[16:19], s67 offen lds
s_add_u32 m0, s7, 94208
s_add_u32 s67, s68, 3539200
buffer_load_dwordx4 v160, s[16:19], s67 offen lds
ds_read_b64_tr_b16 a[4:5], v162 offset:12288
ds_read_b64_tr_b16 a[6:7], v165 offset:12288
ds_read_b64_tr_b16 a[60:61], v162 offset:16384
ds_read_b64_tr_b16 a[62:63], v165 offset:16384
ds_read_b64_tr_b16 a[116:117], v162 offset:20480
ds_read_b64_tr_b16 a[118:119], v165 offset:20480
v_mov_b32 v173, 176
buffer_load_dword v172, v173, s[12:15], 0 offen sc1
s_waitcnt vmcnt(16)
s_waitcnt lgkmcnt(0)
s_barrier
s_add_u32 m0, s7, 98304
s_add_u32 s67, s68, 4718592
buffer_load_dwordx4 v160, s[16:19], s67 offen lds
s_add_u32 m0, s7, 102400
s_add_u32 s67, s68, 4718720
buffer_load_dwordx4 v160, s[16:19], s67 offen lds
s_add_u32 m0, s7, 106496
s_add_u32 s67, s68, 4718848
buffer_load_dwordx4 v160, s[16:19], s67 offen lds
ds_read_b64_tr_b16 a[8:9], v162 offset:24576
ds_read_b64_tr_b16 a[10:11], v165 offset:24576
ds_read_b64_tr_b16 a[64:65], v162 offset:28672
ds_read_b64_tr_b16 a[66:67], v165 offset:28672
ds_read_b64_tr_b16 a[120:121], v162 offset:32768
ds_read_b64_tr_b16 a[122:123], v165 offset:32768
s_waitcnt vmcnt(16)
s_waitcnt lgkmcnt(0)
s_barrier
s_add_u32 m0, s7, 110592
s_add_u32 s67, s68, 5111808
buffer_load_dwordx4 v160, s[16:19], s67 offen lds
s_add_u32 m0, s7, 114688
s_add_u32 s67, s68, 5111936
buffer_load_dwordx4 v160, s[16:19], s67 offen lds
s_add_u32 m0, s7, 118784
s_add_u32 s67, s68, 5112064
buffer_load_dwordx4 v160, s[16:19], s67 offen lds
ds_read_b64_tr_b16 a[12:13], v162 offset:36864
ds_read_b64_tr_b16 a[14:15], v165 offset:36864
ds_read_b64_tr_b16 a[68:69], v162 offset:40960
ds_read_b64_tr_b16 a[70:71], v165 offset:40960
ds_read_b64_tr_b16 a[124:125], v162 offset:45056
ds_read_b64_tr_b16 a[126:127], v165 offset:45056
s_waitcnt vmcnt(16)
s_waitcnt lgkmcnt(0)
s_barrier
s_add_u32 m0, s7, 122880
s_add_u32 s67, s68, 5505024
buffer_load_dwordx4 v160, s[16:19], s67 offen lds
s_add_u32 m0, s7, 126976
s_add_u32 s67, s68, 5505152
buffer_load_dwordx4 v160, s[16:19], s67 offen lds
s_add_u32 m0, s7, 131072
s_add_u32 s67, s68, 5505280
buffer_load_dwordx4 v160, s[16:19], s67 offen lds
ds_read_b64_tr_b16 a[16:17], v163 offset:0
ds_read_b64_tr_b16 a[18:19], v166 offset:0
ds_read_b64_tr_b16 a[72:73], v163 offset:4096
ds_read_b64_tr_b16 a[74:75], v166 offset:4096
ds_read_b64_tr_b16 a[128:129], v163 offset:8192
ds_read_b64_tr_b16 a[130:131], v166 offset:8192
s_waitcnt vmcnt(16)
s_waitcnt lgkmcnt(0)
s_barrier
s_add_u32 m0, s7, 135168
s_add_u32 s67, s68, 5898240
buffer_load_dwordx4 v160, s[16:19], s67 offen lds
s_add_u32 m0, s7, 139264
s_add_u32 s67, s68, 5898368
buffer_load_dwordx4 v160, s[16:19], s67 offen lds
s_add_u32 m0, s7, 143360
s_add_u32 s67, s68, 5898496
buffer_load_dwordx4 v160, s[16:19], s67 offen lds
ds_read_b64_tr_b16 a[20:21], v163 offset:12288
ds_read_b64_tr_b16 a[22:23], v166 offset:12288
ds_read_b64_tr_b16 a[76:77], v163 offset:16384
ds_read_b64_tr_b16 a[78:79], v166 offset:16384
ds_read_b64_tr_b16 a[132:133], v163 offset:20480
ds_read_b64_tr_b16 a[134:135], v166 offset:20480
s_waitcnt vmcnt(16)
s_waitcnt lgkmcnt(0)
s_barrier
s_add_u32 m0, s7, 0
s_add_u32 s67, s68, 6291456
buffer_load_dwordx4 v160, s[16:19], s67 offen lds
s_add_u32 m0, s7, 4096
s_add_u32 s67, s68, 6291584
buffer_load_dwordx4 v160, s[16:19], s67 offen lds
s_add_u32 m0, s7, 8192
s_add_u32 s67, s68, 6291712
buffer_load_dwordx4 v160, s[16:19], s67 offen lds
ds_read_b64_tr_b16 a[24:25], v163 offset:24576
ds_read_b64_tr_b16 a[26:27], v166 offset:24576
ds_read_b64_tr_b16 a[80:81], v163 offset:28672
ds_read_b64_tr_b16 a[82:83], v166 offset:28672
ds_read_b64_tr_b16 a[136:137], v163 offset:32768
ds_read_b64_tr_b16 a[138:139], v166 offset:32768
s_waitcnt vmcnt(16)
s_waitcnt lgkmcnt(0)
s_barrier
s_add_u32 m0, s7, 12288
s_add_u32 s67, s68, 6684672
buffer_load_dwordx4 v160, s[16:19], s67 offen lds
s_add_u32 m0, s7, 16384
s_add_u32 s67, s68, 6684800
buffer_load_dwordx4 v160, s[16:19], s67 offen lds
s_add_u32 m0, s7, 20480
s_add_u32 s67, s68, 6684928
buffer_load_dwordx4 v160, s[16:19], s67 offen lds
ds_read_b64_tr_b16 a[28:29], v163 offset:36864
ds_read_b64_tr_b16 a[30:31], v166 offset:36864
ds_read_b64_tr_b16 a[84:85], v163 offset:40960
ds_read_b64_tr_b16 a[86:87], v166 offset:40960
ds_read_b64_tr_b16 a[140:141], v163 offset:45056
ds_read_b64_tr_b16 a[142:143], v166 offset:45056
s_waitcnt vmcnt(15)
s_waitcnt lgkmcnt(0)
s_barrier
s_add_u32 m0, s7, 24576
s_add_u32 s67, s68, 0
buffer_load_dwordx4 v160, s[20:23], s67 offen lds
s_add_u32 m0, s7, 28672
s_add_u32 s67, s68, 128
buffer_load_dwordx4 v160, s[20:23], s67 offen lds
s_add_u32 m0, s7, 32768
s_add_u32 s67, s68, 256
buffer_load_dwordx4 v160, s[20:23], s67 offen lds
ds_read_b64_tr_b16 a[32:33], v164 offset:0
ds_read_b64_tr_b16 a[34:35], v167 offset:0
ds_read_b64_tr_b16 a[88:89], v164 offset:4096
ds_read_b64_tr_b16 a[90:91], v167 offset:4096
ds_read_b64_tr_b16 a[144:145], v164 offset:8192
ds_read_b64_tr_b16 a[146:147], v167 offset:8192
s_waitcnt vmcnt(15)
s_waitcnt lgkmcnt(0)
s_barrier
s_add_u32 m0, s7, 36864
s_add_u32 s67, s68, 393216
buffer_load_dwordx4 v160, s[20:23], s67 offen lds
s_add_u32 m0, s7, 40960
s_add_u32 s67, s68, 393344
buffer_load_dwordx4 v160, s[20:23], s67 offen lds
s_add_u32 m0, s7, 45056
s_add_u32 s67, s68, 393472
buffer_load_dwordx4 v160, s[20:23], s67 offen lds
ds_read_b64_tr_b16 a[36:37], v164 offset:12288
ds_read_b64_tr_b16 a[38:39], v167 offset:12288
ds_read_b64_tr_b16 a[92:93], v164 offset:16384
ds_read_b64_tr_b16 a[94:95], v167 offset:16384
ds_read_b64_tr_b16 a[148:149], v164 offset:20480
ds_read_b64_tr_b16 a[150:151], v167 offset:20480
s_waitcnt vmcnt(15)
s_waitcnt lgkmcnt(0)
s_barrier
s_add_u32 m0, s7, 49152
s_add_u32 s67, s68, 786432
buffer_load_dwordx4 v160, s[20:23], s67 offen lds
s_add_u32 m0, s7, 53248
s_add_u32 s67, s68, 786560
buffer_load_dwordx4 v160, s[20:23], s67 offen lds
s_add_u32 m0, s7, 57344
s_add_u32 s67, s68, 786688
buffer_load_dwordx4 v160, s[20:23], s67 offen lds
ds_read_b64_tr_b16 a[40:41], v164 offset:24576
ds_read_b64_tr_b16 a[42:43], v167 offset:24576
ds_read_b64_tr_b16 a[96:97], v164 offset:28672
ds_read_b64_tr_b16 a[98:99], v167 offset:28672
ds_read_b64_tr_b16 a[152:153], v164 offset:32768
ds_read_b64_tr_b16 a[154:155], v167 offset:32768
s_waitcnt vmcnt(15)
s_waitcnt lgkmcnt(0)
s_barrier
s_add_u32 m0, s7, 61440
s_add_u32 s67, s68, 1179648
buffer_load_dwordx4 v160, s[20:23], s67 offen lds
s_add_u32 m0, s7, 65536
s_add_u32 s67, s68, 1179776
buffer_load_dwordx4 v160, s[20:23], s67 offen lds
s_add_u32 m0, s7, 69632
s_add_u32 s67, s68, 1179904
buffer_load_dwordx4 v160, s[20:23], s67 offen lds
ds_read_b64_tr_b16 a[44:45], v164 offset:36864
ds_read_b64_tr_b16 a[46:47], v167 offset:36864
ds_read_b64_tr_b16 a[100:101], v164 offset:40960
ds_read_b64_tr_b16 a[102:103], v167 offset:40960
ds_read_b64_tr_b16 a[156:157], v164 offset:45056
ds_read_b64_tr_b16 a[158:159], v167 offset:45056
s_waitcnt vmcnt(15)
s_waitcnt lgkmcnt(0)
s_barrier
s_add_u32 m0, s7, 73728
s_add_u32 s67, s68, 2359296
buffer_load_dwordx4 v160, s[20:23], s67 offen lds
s_add_u32 m0, s7, 77824
s_add_u32 s67, s68, 2359424
buffer_load_dwordx4 v160, s[20:23], s67 offen lds
s_add_u32 m0, s7, 81920
s_add_u32 s67, s68, 2359552
buffer_load_dwordx4 v160, s[20:23], s67 offen lds
ds_read_b64_tr_b16 a[48:49], v162 offset:0
ds_read_b64_tr_b16 a[50:51], v165 offset:0
ds_read_b64_tr_b16 a[104:105], v162 offset:4096
ds_read_b64_tr_b16 a[106:107], v165 offset:4096
ds_read_b64_tr_b16 a[160:161], v162 offset:8192
ds_read_b64_tr_b16 a[162:163], v165 offset:8192
s_waitcnt vmcnt(15)
s_waitcnt lgkmcnt(0)
s_barrier
s_add_u32 m0, s7, 86016
s_add_u32 s67, s68, 2752512
buffer_load_dwordx4 v160, s[20:23], s67 offen lds
s_add_u32 m0, s7, 90112
s_add_u32 s67, s68, 2752640
buffer_load_dwordx4 v160, s[20:23], s67 offen lds
s_add_u32 m0, s7, 94208
s_add_u32 s67, s68, 2752768
buffer_load_dwordx4 v160, s[20:23], s67 offen lds
ds_read_b64_tr_b16 a[52:53], v162 offset:12288
ds_read_b64_tr_b16 a[54:55], v165 offset:12288
ds_read_b64_tr_b16 a[108:109], v162 offset:16384
ds_read_b64_tr_b16 a[110:111], v165 offset:16384
ds_read_b64_tr_b16 a[164:165], v162 offset:20480
ds_read_b64_tr_b16 a[166:167], v165 offset:20480
s_branch Lrc_8
Lrp_7:
v_mov_b32 v173, 176
buffer_load_dword v172, v173, s[12:15], 0 offen sc1
s_waitcnt vmcnt(0)
Lrc_8:
v_readfirstlane_b32 s67, v172
s_nop 0
s_sub_u32 s67, s67, 1
s_cmp_eq_u32 s67, s34
s_cbranch_scc1 Lro_9
s_sub_u32 s65, s65, 1
s_cmp_eq_u32 s65, 0
s_cbranch_scc1 Lro_9
s_cmp_gt_u32 s67, 7
s_cbranch_scc1 Lrp_7
s_mov_b32 s34, s67
s_waitcnt vmcnt(0) lgkmcnt(0)
s_barrier
s_branch L_restart
Lro_9:
s_cmp_lg_u32 s3, 0
s_cbranch_scc1 Ls_4
v_mov_b32 v32, -1
v_mov_b32 v33, -1
buffer_store_dwordx2 v[32:33], v9, s[8:11], s76 offen sc1
buffer_store_dword v32, v10, s[8:11], s77 offen sc1
s_lshl_b32 s67, 1, s4
v_mov_b32 v13, s67
s_lshl_b32 s67, s64, 2
v_mov_b32 v14, s67
s_mov_b64 exec, 1
buffer_atomic_or v13, v14, s[12:15], 0 offen sc1
s_mov_b64 exec, -1
Ls_4:
s_waitcnt vmcnt(15)
s_waitcnt lgkmcnt(0)
s_barrier
s_add_u32 m0, s7, 98304
s_add_u32 s67, s68, 3145728
buffer_load_dwordx4 v160, s[20:23], s67 offen lds
s_add_u32 m0, s7, 102400
s_add_u32 s67, s68, 3145856
buffer_load_dwordx4 v160, s[20:23], s67 offen lds
s_add_u32 m0, s7, 106496
s_add_u32 s67, s68, 3145984
buffer_load_dwordx4 v160, s[20:23], s67 offen lds
ds_read_b64_tr_b16 a[168:169], v162 offset:24576
ds_read_b64_tr_b16 a[170:171], v165 offset:24576
ds_read_b64_tr_b16 a[224:225], v162 offset:28672
ds_read_b64_tr_b16 a[226:227], v165 offset:28672
ds_read_b64_tr_b16 v[200:201], v162 offset:32768
ds_read_b64_tr_b16 v[202:203], v165 offset:32768
s_waitcnt vmcnt(15)
s_waitcnt lgkmcnt(0)
s_barrier
s_add_u32 m0, s7, 110592
s_add_u32 s67, s68, 3538944
buffer_load_dwordx4 v160, s[20:23], s67 offen lds
s_add_u32 m0, s7, 114688
s_add_u32 s67, s68, 3539072
buffer_load_dwordx4 v160, s[20:23], s67 offen lds
s_add_u32 m0, s7, 118784
s_add_u32 s67, s68, 3539200
buffer_load_dwordx4 v160, s[20:23], s67 offen lds
ds_read_b64_tr_b16 a[172:173], v162 offset:36864
ds_read_b64_tr_b16 a[174:175], v165 offset:36864
ds_read_b64_tr_b16 a[228:229], v162 offset:40960
ds_read_b64_tr_b16 a[230:231], v165 offset:40960
ds_read_b64_tr_b16 v[204:205], v162 offset:45056
ds_read_b64_tr_b16 v[206:207], v165 offset:45056
s_waitcnt vmcnt(15)
s_waitcnt lgkmcnt(0)
s_barrier
s_add_u32 m0, s7, 122880
s_add_u32 s67, s68, 4718592
buffer_load_dwordx4 v160, s[20:23], s67 offen lds
s_add_u32 m0, s7, 126976
s_add_u32 s67, s68, 4718720
buffer_load_dwordx4 v160, s[20:23], s67 offen lds
s_add_u32 m0, s7, 131072
s_add_u32 s67, s68, 4718848
buffer_load_dwordx4 v160, s[20:23], s67 offen lds
ds_read_b64_tr_b16 a[176:177], v163 offset:0
ds_read_b64_tr_b16 a[178:179], v166 offset:0
ds_read_b64_tr_b16 a[232:233], v163 offset:4096
ds_read_b64_tr_b16 a[234:235], v166 offset:4096
ds_read_b64_tr_b16 v[208:209], v163 offset:8192
ds_read_b64_tr_b16 v[210:211], v166 offset:8192
s_waitcnt vmcnt(15)
s_waitcnt lgkmcnt(0)
s_barrier
s_add_u32 m0, s7, 135168
s_add_u32 s67, s68, 5111808
buffer_load_dwordx4 v160, s[20:23], s67 offen lds
s_add_u32 m0, s7, 139264
s_add_u32 s67, s68, 5111936
buffer_load_dwordx4 v160, s[20:23], s67 offen lds
s_add_u32 m0, s7, 143360
s_add_u32 s67, s68, 5112064
buffer_load_dwordx4 v160, s[20:23], s67 offen lds
ds_read_b64_tr_b16 a[180:181], v163 offset:12288
ds_read_b64_tr_b16 a[182:183], v166 offset:12288
ds_read_b64_tr_b16 a[236:237], v163 offset:16384
ds_read_b64_tr_b16 a[238:239], v166 offset:16384
ds_read_b64_tr_b16 v[212:213], v163 offset:20480
ds_read_b64_tr_b16 v[214:215], v166 offset:20480
s_waitcnt vmcnt(15)
s_waitcnt lgkmcnt(0)
s_barrier
s_add_u32 m0, s7, 0
s_add_u32 s67, s68, 5505024
buffer_load_dwordx4 v160, s[20:23], s67 offen lds
s_add_u32 m0, s7, 4096
s_add_u32 s67, s68, 5505152
buffer_load_dwordx4 v160, s[20:23], s67 offen lds
s_add_u32 m0, s7, 8192
s_add_u32 s67, s68, 5505280
buffer_load_dwordx4 v160, s[20:23], s67 offen lds
ds_read_b64_tr_b16 a[184:185], v163 offset:24576
ds_read_b64_tr_b16 a[186:187], v166 offset:24576
ds_read_b64_tr_b16 a[240:241], v163 offset:28672
ds_read_b64_tr_b16 a[242:243], v166 offset:28672
ds_read_b64_tr_b16 v[216:217], v163 offset:32768
ds_read_b64_tr_b16 v[218:219], v166 offset:32768
s_waitcnt vmcnt(15)
s_waitcnt lgkmcnt(0)
s_barrier
s_add_u32 m0, s7, 12288
s_add_u32 s67, s68, 5898240
buffer_load_dwordx4 v160, s[20:23], s67 offen lds
s_add_u32 m0, s7, 16384
s_add_u32 s67, s68, 5898368
buffer_load_dwordx4 v160, s[20:23], s67 offen lds
s_add_u32 m0, s7, 20480
s_add_u32 s67, s68, 5898496
buffer_load_dwordx4 v160, s[20:23], s67 offen lds
ds_read_b64_tr_b16 a[188:189], v163 offset:36864
ds_read_b64_tr_b16 a[190:191], v166 offset:36864
ds_read_b64_tr_b16 a[244:245], v163 offset:40960
ds_read_b64_tr_b16 a[246:247], v166 offset:40960
ds_read_b64_tr_b16 v[220:221], v163 offset:45056
ds_read_b64_tr_b16 v[222:223], v166 offset:45056
s_waitcnt vmcnt(15)
s_waitcnt lgkmcnt(0)
s_barrier
s_add_u32 m0, s7, 24576
s_add_u32 s67, s68, 6291456
buffer_load_dwordx4 v160, s[20:23], s67 offen lds
s_add_u32 m0, s7, 28672
s_add_u32 s67, s68, 6291584
buffer_load_dwordx4 v160, s[20:23], s67 offen lds
s_add_u32 m0, s7, 32768
s_add_u32 s67, s68, 6291712
buffer_load_dwordx4 v160, s[20:23], s67 offen lds
ds_read_b64_tr_b16 a[192:193], v164 offset:0
ds_read_b64_tr_b16 a[194:195], v167 offset:0
ds_read_b64_tr_b16 a[248:249], v164 offset:4096
ds_read_b64_tr_b16 a[250:251], v167 offset:4096
ds_read_b64_tr_b16 v[224:225], v164 offset:8192
ds_read_b64_tr_b16 v[226:227], v167 offset:8192
s_cmp_lg_u32 s3, 0
s_cbranch_scc1 Ls_10
v_mov_b32 v13, 1
v_mov_b32 v14, 36
s_mov_b64 exec, 1
buffer_atomic_add v13, v14, s[12:15], 0 offen sc1
s_mov_b64 exec, -1
Ls_10:
s_waitcnt vmcnt(15)
s_waitcnt lgkmcnt(0)
s_barrier
s_add_u32 m0, s7, 36864
s_add_u32 s67, s68, 6684672
buffer_load_dwordx4 v160, s[20:23], s67 offen lds
s_add_u32 m0, s7, 40960
s_add_u32 s67, s68, 6684800
buffer_load_dwordx4 v160, s[20:23], s67 offen lds
s_add_u32 m0, s7, 45056
s_add_u32 s67, s68, 6684928
buffer_load_dwordx4 v160, s[20:23], s67 offen lds
ds_read_b64_tr_b16 a[196:197], v164 offset:12288
ds_read_b64_tr_b16 a[198:199], v167 offset:12288
ds_read_b64_tr_b16 a[252:253], v164 offset:16384
ds_read_b64_tr_b16 a[254:255], v167 offset:16384
ds_read_b64_tr_b16 v[228:229], v164 offset:20480
ds_read_b64_tr_b16 v[230:231], v167 offset:20480
s_waitcnt vmcnt(15)
s_waitcnt lgkmcnt(0)
s_barrier
s_add_u32 m0, s7, 49152
s_add_u32 s67, s68, 1572864
buffer_load_dwordx4 v160, s[16:19], s67 offen lds
s_add_u32 m0, s7, 53248
s_add_u32 s67, s68, 1572992
buffer_load_dwordx4 v160, s[16:19], s67 offen lds
s_add_u32 m0, s7, 57344
s_add_u32 s67, s68, 1573120
buffer_load_dwordx4 v160, s[16:19], s67 offen lds
ds_read_b64_tr_b16 a[200:201], v164 offset:24576
ds_read_b64_tr_b16 a[202:203], v167 offset:24576
ds_read_b64_tr_b16 v[176:177], v164 offset:28672
ds_read_b64_tr_b16 v[178:179], v167 offset:28672
ds_read_b64_tr_b16 v[232:233], v164 offset:32768
ds_read_b64_tr_b16 v[234:235], v167 offset:32768
s_waitcnt vmcnt(15)
s_waitcnt lgkmcnt(0)
s_barrier
s_add_u32 m0, s7, 61440
s_add_u32 s67, s68, 1966080
buffer_load_dwordx4 v160, s[16:19], s67 offen lds
s_add_u32 m0, s7, 65536
s_add_u32 s67, s68, 1966208
buffer_load_dwordx4 v160, s[16:19], s67 offen lds
s_add_u32 m0, s7, 69632
s_add_u32 s67, s68, 1966336
buffer_load_dwordx4 v160, s[16:19], s67 offen lds
ds_read_b64_tr_b16 a[204:205], v164 offset:36864
ds_read_b64_tr_b16 a[206:207], v167 offset:36864
ds_read_b64_tr_b16 v[180:181], v164 offset:40960
ds_read_b64_tr_b16 v[182:183], v167 offset:40960
ds_read_b64_tr_b16 v[236:237], v164 offset:45056
ds_read_b64_tr_b16 v[238:239], v167 offset:45056
s_waitcnt vmcnt(15)
s_waitcnt lgkmcnt(0)
s_barrier
s_add_u32 m0, s7, 73728
s_add_u32 s67, s68, 3932160
buffer_load_dwordx4 v160, s[16:19], s67 offen lds
s_add_u32 m0, s7, 77824
s_add_u32 s67, s68, 3932288
buffer_load_dwordx4 v160, s[16:19], s67 offen lds
s_add_u32 m0, s7, 81920
s_add_u32 s67, s68, 3932416
buffer_load_dwordx4 v160, s[16:19], s67 offen lds
ds_read_b64_tr_b16 a[208:209], v162 offset:0
ds_read_b64_tr_b16 a[210:211], v165 offset:0
ds_read_b64_tr_b16 v[184:185], v162 offset:4096
ds_read_b64_tr_b16 v[186:187], v165 offset:4096
ds_read_b64_tr_b16 v[240:241], v162 offset:8192
ds_read_b64_tr_b16 v[242:243], v165 offset:8192
s_waitcnt vmcnt(15)
s_waitcnt lgkmcnt(0)
s_barrier
s_add_u32 m0, s7, 86016
s_add_u32 s67, s68, 4325376
buffer_load_dwordx4 v160, s[16:19], s67 offen lds
s_add_u32 m0, s7, 90112
s_add_u32 s67, s68, 4325504
buffer_load_dwordx4 v160, s[16:19], s67 offen lds
s_add_u32 m0, s7, 94208
s_add_u32 s67, s68, 4325632
buffer_load_dwordx4 v160, s[16:19], s67 offen lds
ds_read_b64_tr_b16 a[212:213], v162 offset:12288
ds_read_b64_tr_b16 a[214:215], v165 offset:12288
ds_read_b64_tr_b16 v[188:189], v162 offset:16384
ds_read_b64_tr_b16 v[190:191], v165 offset:16384
ds_read_b64_tr_b16 v[244:245], v162 offset:20480
ds_read_b64_tr_b16 v[246:247], v165 offset:20480
s_waitcnt vmcnt(15)
s_waitcnt lgkmcnt(0)
s_barrier
s_add_u32 m0, s7, 98304
s_add_u32 s67, s68, 7077888
buffer_load_dwordx4 v160, s[16:19], s67 offen lds
s_add_u32 m0, s7, 102400
s_add_u32 s67, s68, 7078016
buffer_load_dwordx4 v160, s[16:19], s67 offen lds
s_add_u32 m0, s7, 106496
s_add_u32 s67, s68, 7078144
buffer_load_dwordx4 v160, s[16:19], s67 offen lds
ds_read_b64_tr_b16 a[216:217], v162 offset:24576
ds_read_b64_tr_b16 a[218:219], v165 offset:24576
ds_read_b64_tr_b16 v[192:193], v162 offset:28672
ds_read_b64_tr_b16 v[194:195], v165 offset:28672
ds_read_b64_tr_b16 v[248:249], v162 offset:32768
ds_read_b64_tr_b16 v[250:251], v165 offset:32768
s_waitcnt vmcnt(15)
s_waitcnt lgkmcnt(0)
s_barrier
s_add_u32 m0, s7, 110592
s_add_u32 s67, s68, 7471104
buffer_load_dwordx4 v160, s[16:19], s67 offen lds
s_add_u32 m0, s7, 114688
s_add_u32 s67, s68, 7471232
buffer_load_dwordx4 v160, s[16:19], s67 offen lds
s_add_u32 m0, s7, 118784
s_add_u32 s67, s68, 7471360
buffer_load_dwordx4 v160, s[16:19], s67 offen lds
ds_read_b64_tr_b16 a[220:221], v162 offset:36864
ds_read_b64_tr_b16 a[222:223], v165 offset:36864
ds_read_b64_tr_b16 v[196:197], v162 offset:40960
ds_read_b64_tr_b16 v[198:199], v165 offset:40960
ds_read_b64_tr_b16 v[252:253], v162 offset:45056
ds_read_b64_tr_b16 v[254:255], v165 offset:45056
s_waitcnt vmcnt(15)
s_waitcnt lgkmcnt(0)
s_barrier
s_add_u32 m0, s7, 122880
s_add_u32 s67, s68, 1572864
buffer_load_dwordx4 v160, s[20:23], s67 offen lds
s_add_u32 m0, s7, 126976
s_add_u32 s67, s68, 1572992
buffer_load_dwordx4 v160, s[20:23], s67 offen lds
s_add_u32 m0, s7, 131072
s_add_u32 s67, s68, 1573120
buffer_load_dwordx4 v160, s[20:23], s67 offen lds
ds_read_b64_tr_b16 v[16:17], v163 offset:0
ds_read_b64_tr_b16 v[18:19], v166 offset:0
ds_read_b64_tr_b16 v[24:25], v163 offset:4096
ds_read_b64_tr_b16 v[26:27], v166 offset:4096
ds_read_b64_tr_b16 v[32:33], v163 offset:8192
ds_read_b64_tr_b16 v[34:35], v166 offset:8192
s_waitcnt vmcnt(15)
s_waitcnt lgkmcnt(0)
s_barrier
s_add_u32 m0, s7, 135168
s_add_u32 s67, s68, 1966080
buffer_load_dwordx4 v160, s[20:23], s67 offen lds
s_add_u32 m0, s7, 139264
s_add_u32 s67, s68, 1966208
buffer_load_dwordx4 v160, s[20:23], s67 offen lds
s_add_u32 m0, s7, 143360
s_add_u32 s67, s68, 1966336
buffer_load_dwordx4 v160, s[20:23], s67 offen lds
ds_read_b64_tr_b16 v[20:21], v163 offset:12288
ds_read_b64_tr_b16 v[22:23], v166 offset:12288
ds_read_b64_tr_b16 v[28:29], v163 offset:16384
ds_read_b64_tr_b16 v[30:31], v166 offset:16384
ds_read_b64_tr_b16 v[36:37], v163 offset:20480
ds_read_b64_tr_b16 v[38:39], v166 offset:20480
s_waitcnt vmcnt(15)
s_waitcnt lgkmcnt(0)
s_barrier
s_add_u32 m0, s7, 0
s_add_u32 s67, s68, 3932160
buffer_load_dwordx4 v160, s[20:23], s67 offen lds
s_add_u32 m0, s7, 4096
s_add_u32 s67, s68, 3932288
buffer_load_dwordx4 v160, s[20:23], s67 offen lds
s_add_u32 m0, s7, 8192
s_add_u32 s67, s68, 3932416
buffer_load_dwordx4 v160, s[20:23], s67 offen lds
ds_read_b64_tr_b16 v[40:41], v163 offset:24576
ds_read_b64_tr_b16 v[42:43], v166 offset:24576
ds_read_b64_tr_b16 v[48:49], v163 offset:28672
ds_read_b64_tr_b16 v[50:51], v166 offset:28672
ds_read_b64_tr_b16 v[56:57], v163 offset:32768
ds_read_b64_tr_b16 v[58:59], v166 offset:32768
s_waitcnt vmcnt(15)
s_waitcnt lgkmcnt(0)
s_barrier
s_add_u32 m0, s7, 12288
s_add_u32 s67, s68, 4325376
buffer_load_dwordx4 v160, s[20:23], s67 offen lds
s_add_u32 m0, s7, 16384
s_add_u32 s67, s68, 4325504
buffer_load_dwordx4 v160, s[20:23], s67 offen lds
s_add_u32 m0, s7, 20480
s_add_u32 s67, s68, 4325632
buffer_load_dwordx4 v160, s[20:23], s67 offen lds
ds_read_b64_tr_b16 v[44:45], v163 offset:36864
ds_read_b64_tr_b16 v[46:47], v166 offset:36864
ds_read_b64_tr_b16 v[52:53], v163 offset:40960
ds_read_b64_tr_b16 v[54:55], v166 offset:40960
ds_read_b64_tr_b16 v[60:61], v163 offset:45056
ds_read_b64_tr_b16 v[62:63], v166 offset:45056
v_lshlrev_b32 v173, 2, v0
buffer_load_dword v172, v173, s[12:15], 0 offen sc1
s_waitcnt vmcnt(16)
s_waitcnt lgkmcnt(0)
s_barrier
s_add_u32 m0, s7, 24576
s_add_u32 s67, s68, 7077888
buffer_load_dwordx4 v160, s[20:23], s67 offen lds
s_add_u32 m0, s7, 28672
s_add_u32 s67, s68, 7078016
buffer_load_dwordx4 v160, s[20:23], s67 offen lds
s_add_u32 m0, s7, 32768
s_add_u32 s67, s68, 7078144
buffer_load_dwordx4 v160, s[20:23], s67 offen lds
ds_read_b64_tr_b16 v[64:65], v164 offset:0
ds_read_b64_tr_b16 v[66:67], v167 offset:0
ds_read_b64_tr_b16 v[72:73], v164 offset:4096
ds_read_b64_tr_b16 v[74:75], v167 offset:4096
ds_read_b64_tr_b16 v[80:81], v164 offset:8192
ds_read_b64_tr_b16 v[82:83], v167 offset:8192
s_waitcnt vmcnt(16)
s_waitcnt lgkmcnt(0)
s_barrier
s_add_u32 m0, s7, 36864
s_add_u32 s67, s68, 7471104
buffer_load_dwordx4 v160, s[20:23], s67 offen lds
s_add_u32 m0, s7, 40960
s_add_u32 s67, s68, 7471232
buffer_load_dwordx4 v160, s[20:23], s67 offen lds
s_add_u32 m0, s7, 45056
s_add_u32 s67, s68, 7471360
buffer_load_dwordx4 v160, s[20:23], s67 offen lds
ds_read_b64_tr_b16 v[68:69], v164 offset:12288
ds_read_b64_tr_b16 v[70:71], v167 offset:12288
ds_read_b64_tr_b16 v[76:77], v164 offset:16384
ds_read_b64_tr_b16 v[78:79], v167 offset:16384
ds_read_b64_tr_b16 v[84:85], v164 offset:20480
ds_read_b64_tr_b16 v[86:87], v167 offset:20480
s_waitcnt vmcnt(16)
s_waitcnt lgkmcnt(0)
s_barrier
ds_read_b64_tr_b16 v[88:89], v164 offset:24576
ds_read_b64_tr_b16 v[90:91], v167 offset:24576
ds_read_b64_tr_b16 v[96:97], v164 offset:28672
ds_read_b64_tr_b16 v[98:99], v167 offset:28672
ds_read_b64_tr_b16 v[104:105], v164 offset:32768
ds_read_b64_tr_b16 v[106:107], v167 offset:32768
s_waitcnt vmcnt(13)
s_waitcnt lgkmcnt(0)
s_barrier
ds_read_b64_tr_b16 v[92:93], v164 offset:36864
ds_read_b64_tr_b16 v[94:95], v167 offset:36864
ds_read_b64_tr_b16 v[100:101], v164 offset:40960
ds_read_b64_tr_b16 v[102:103], v167 offset:40960
ds_read_b64_tr_b16 v[108:109], v164 offset:45056
ds_read_b64_tr_b16 v[110:111], v167 offset:45056
s_waitcnt vmcnt(10)
s_waitcnt lgkmcnt(0)
s_barrier
ds_read_b64_tr_b16 v[112:113], v162 offset:0
ds_read_b64_tr_b16 v[114:115], v165 offset:0
ds_read_b64_tr_b16 v[120:121], v162 offset:4096
ds_read_b64_tr_b16 v[122:123], v165 offset:4096
ds_read_b64_tr_b16 v[128:129], v162 offset:8192
ds_read_b64_tr_b16 v[130:131], v165 offset:8192
s_waitcnt vmcnt(7)
s_waitcnt lgkmcnt(0)
s_barrier
ds_read_b64_tr_b16 v[116:117], v162 offset:12288
ds_read_b64_tr_b16 v[118:119], v165 offset:12288
ds_read_b64_tr_b16 v[124:125], v162 offset:16384
ds_read_b64_tr_b16 v[126:127], v165 offset:16384
ds_read_b64_tr_b16 v[132:133], v162 offset:20480
ds_read_b64_tr_b16 v[134:135], v165 offset:20480
s_waitcnt vmcnt(3)
s_waitcnt lgkmcnt(0)
s_barrier
ds_read_b64_tr_b16 v[136:137], v162 offset:24576
ds_read_b64_tr_b16 v[138:139], v165 offset:24576
ds_read_b64_tr_b16 v[144:145], v162 offset:28672
ds_read_b64_tr_b16 v[146:147], v165 offset:28672
ds_read_b64_tr_b16 v[152:153], v162 offset:32768
ds_read_b64_tr_b16 v[154:155], v165 offset:32768
v_and_b32 v175, 15, v0
v_min_u32 v175, 2, v175
s_mul_i32 s81, s63, 384
s_add_u32 s81, s81, 192950272
v_lshlrev_b32 v175, 7, v175
buffer_load_dword v174, v175, s[8:11], s81 offen sc1
s_waitcnt vmcnt(1)
s_waitcnt lgkmcnt(0)
s_barrier
ds_read_b64_tr_b16 v[140:141], v162 offset:36864
ds_read_b64_tr_b16 v[142:143], v165 offset:36864
ds_read_b64_tr_b16 v[148:149], v162 offset:40960
ds_read_b64_tr_b16 v[150:151], v165 offset:40960
ds_read_b64_tr_b16 v[156:157], v162 offset:45056
ds_read_b64_tr_b16 v[158:159], v165 offset:45056
s_waitcnt lgkmcnt(0)
s_barrier
ds_write_b128 v4, v[16:19] offset:0
ds_write_b128 v4, v[20:23] offset:1024
ds_write_b128 v4, v[24:27] offset:2048
ds_write_b128 v4, v[28:31] offset:3072
ds_write_b128 v4, v[32:35] offset:4096
ds_write_b128 v4, v[36:39] offset:5120
ds_write_b128 v4, v[40:43] offset:6144
ds_write_b128 v4, v[44:47] offset:7168
ds_write_b128 v4, v[48:51] offset:8192
ds_write_b128 v4, v[52:55] offset:9216
ds_write_b128 v4, v[56:59] offset:10240
ds_write_b128 v4, v[60:63] offset:11264
ds_write_b128 v4, v[64:67] offset:12288
ds_write_b128 v4, v[68:71] offset:13312
ds_write_b128 v4, v[72:75] offset:14336
ds_write_b128 v4, v[76:79] offset:15360
ds_write_b128 v4, v[80:83] offset:16384
ds_write_b128 v4, v[84:87] offset:17408
ds_write_b128 v4, v[88:91] offset:18432
ds_write_b128 v4, v[92:95] offset:19456
ds_write_b128 v4, v[96:99] offset:20480
ds_write_b128 v4, v[100:103] offset:21504
ds_write_b128 v4, v[104:107] offset:22528
ds_write_b128 v4, v[108:111] offset:23552
ds_write_b128 v4, v[112:115] offset:24576
ds_write_b128 v4, v[116:119] offset:25600
ds_write_b128 v4, v[120:123] offset:26624
ds_write_b128 v4, v[124:127] offset:27648
ds_write_b128 v4, v[128:131] offset:28672
ds_write_b128 v4, v[132:135] offset:29696
ds_write_b128 v4, v[136:139] offset:30720
ds_write_b128 v4, v[140:143] offset:31744
ds_write_b128 v4, v[144:147] offset:32768
ds_write_b128 v4, v[148:151] offset:33792
ds_write_b128 v4, v[152:155] offset:34816
ds_write_b128 v4, v[156:159] offset:35840
s_waitcnt lgkmcnt(0)
s_waitcnt vmcnt(0)
v_min_u32_dpp v174, v174, v174 row_ror:8 row_mask:0xf bank_mask:0xf
s_nop 1
v_min_u32_dpp v174, v174, v174 row_ror:4 row_mask:0xf bank_mask:0xf
s_nop 1
v_min_u32_dpp v174, v174, v174 row_ror:2 row_mask:0xf bank_mask:0xf
s_nop 1
v_min_u32_dpp v174, v174, v174 row_ror:1 row_mask:0xf bank_mask:0xf
s_nop 0
v_readfirstlane_b32 s60, v174
v_lshlrev_b32 v14, 2, v0
v_mov_b32 v13, v172
s_branch Lrc_14
Lr_11:
s_mov_b32 s60, 0
buffer_load_dword v13, v14, s[12:15], 0 offen sc1
s_waitcnt vmcnt(0)
Lrc_14:
v_readlane_b32 s67, v13, 9
v_readlane_b32 s68, v13, 10
s_nop 0
s_cmp_lt_u32 s68, 2560
s_cselect_b32 s67, 0, s67
v_readlane_b32 s68, v13, 40
s_nop 0
s_cmp_lt_u32 s68, 10
s_cselect_b32 s67, 0, s67
s_cmp_eq_u32 s65, 0
s_cbranch_scc1 Lrd_12
s_sub_u32 s65, s65, 1
s_cmp_lt_u32 s67, 64
s_cbranch_scc1 Lr_11
Lrd_12:
v_readlane_b32 s69, v13, 10
s_nop 0
s_and_b32 s67, s69, 15
s_cmp_gt_u32 s67, 5
s_cselect_b32 s67, 1, 0
v_readlane_b32 s68, v13, 0
s_nop 0
s_cmp_gt_u32 s68, 15
s_cselect_b32 s68, 1, 0
s_xor_b32 s67, s67, s68
s_lshl_b32 s67, s67, 13
s_add_u32 s59, s59, s67
s_bfe_u32 s69, s69, 0x40004
s_cmp_gt_u32 s69, 5
s_cselect_b32 s69, 1, 0
v_readlane_b32 s68, v13, 1
s_nop 0
s_and_b32 s68, s68, 0xaa
s_cselect_b32 s68, 1, 0
s_xor_b32 s69, s69, s68
s_xor_b32 s69, s69, s64
s_lshl_b32 s69, s69, 14
s_add_u32 s58, s58, s59
s_add_u32 s59, s59, s69
s_xor_b32 s69, s69, 16384
s_add_u32 s58, s58, s69
v_readlane_b32 s67, v13, 0
v_readlane_b32 s68, v13, 1
s_bcnt1_i32_b32 s67, s67
s_bcnt1_i32_b32 s68, s68
s_max_u32 s67, s67, s68
s_cmp_lg_u32 s67, 1
s_cbranch_scc1 Lslow_13
s_cmp_eq_u32 s3, 1
s_cbranch_scc1 Lw_16
s_cmp_eq_u32 s3, 2
s_cbranch_scc1 Lw_17
s_cmp_eq_u32 s3, 3
s_cbranch_scc1 Lw_18
Lw_15:
s_mov_b32 s62, 0
s_mov_b32 s52, 0x3dd53b95
s_mov_b32 s53, s52
s_mov_b32 s79, 0x42700000
s_mul_i32 s81, s63, 384
s_add_u32 s81, s81, 192950272
s_mov_b32 s45, 536870912
v_lshlrev_b32 v12, 7, v0
v_add_u32 v6, 8192, v12
v_min_u32 v6, 12160, v6
v_and_b32 v15, 15, v0
v_min_u32 v15, 2, v15
v_lshlrev_b32 v15, 7, v15
s_mov_b32 s54, s81
ds_read_b128 v[80:83], v4 offset:0
ds_read_b128 v[84:87], v4 offset:1024
ds_read_b128 v[88:91], v4 offset:2048
ds_read_b128 v[92:95], v4 offset:3072
ds_read_b128 v[96:99], v4 offset:4096
ds_read_b128 v[100:103], v4 offset:5120
ds_read_b128 v[104:107], v4 offset:6144
ds_read_b128 v[108:111], v4 offset:7168
v_mov_b64 v[56:57], 0
v_mov_b64 v[58:59], 0
v_mov_b64 v[60:61], 0
v_mov_b64 v[62:63], 0
v_mov_b64 v[64:65], 0
v_mov_b64 v[66:67], 0
v_mov_b64 v[68:69], 0
v_mov_b64 v[70:71], 0
v_mov_b64 v[72:73], 0
v_mov_b64 v[74:75], 0
v_mov_b64 v[76:77], 0
v_mov_b64 v[78:79], 0
s_bitcmp1_b32 s62, 0
s_cselect_b32 s78, -1.0, 1.0
s_lshl_b32 s55, s5, 7
s_add_u32 s55, s55, 193026048
s_cmp_gt_u32 s62, 60
s_cselect_b32 s55, s55, 536870912
v_mov_b32 v14, s62
v_min_u32 v13, 1, v0
v_lshlrev_b32 v13, 30, v13
ds_read_b128 v[16:19], v3 offset:0
ds_read_b128 v[24:27], v3 offset:1024
ds_read_b128 v[32:35], v3 offset:2048
s_waitcnt lgkmcnt(0)
s_branch Lqkent_20
Lqk_19:
s_barrier
s_sub_u32 s75, s62, 1
s_cmp_gt_u32 s62, 60
s_cbranch_scc1 Lkc_24
Lkb_23:
s_add_u32 s82, s62, 1
s_mov_b32 s45, 536870912
s_cmp_ge_u32 s82, 63
s_cbranch_scc1 Lnp_25
s_sub_u32 s61, s82, 12
s_max_i32 s61, s61, 0
s_lshr_b32 s61, s61, 2
s_add_u32 s61, s61, s82
s_cmp_gt_u32 s60, s61
s_cbranch_scc1 Lfd_27
v_and_b32 v14, 15, v0
v_min_u32 v14, 2, v14
v_lshlrev_b32 v14, 7, v14
Lf_26:
buffer_load_dword v13, v14, s[8:11], s81 offen sc1
s_waitcnt vmcnt(0)
v_min_u32_dpp v13, v13, v13 row_ror:8 row_mask:0xf bank_mask:0xf
s_nop 1
v_min_u32_dpp v13, v13, v13 row_ror:4 row_mask:0xf bank_mask:0xf
s_nop 1
v_min_u32_dpp v13, v13, v13 row_ror:2 row_mask:0xf bank_mask:0xf
s_nop 1
v_min_u32_dpp v13, v13, v13 row_ror:1 row_mask:0xf bank_mask:0xf
s_nop 0
v_readfirstlane_b32 s60, v13
s_nop 0
s_cmp_gt_u32 s60, s61
s_cbranch_scc1 Lfd_27
s_cmp_lt_u32 s82, 3
s_cbranch_scc1 Lnp_25
s_cmp_eq_u32 s65, 0
s_cbranch_scc1 Lfd_27
s_sub_u32 s65, s65, 1
s_branch Lf_26
Lfd_27:
s_lshl_b32 s45, s82, 5
s_add_u32 s45, s45, s63
s_mul_i32 s45, s45, 12288
s_add_u32 s45, s45, 29360128
Lnp_25:
ds_read_b128 v[80:83], v4 offset:0
ds_read_b128 v[84:87], v4 offset:1024
ds_read_b128 v[88:91], v4 offset:2048
ds_read_b128 v[92:95], v4 offset:3072
ds_read_b128 v[96:99], v4 offset:4096
ds_read_b128 v[100:103], v4 offset:5120
ds_read_b128 v[104:107], v4 offset:6144
ds_read_b128 v[108:111], v4 offset:7168
v_mov_b64 v[56:57], 0
v_mov_b64 v[58:59], 0
v_mov_b64 v[60:61], 0
v_mov_b64 v[62:63], 0
v_mov_b64 v[64:65], 0
v_mov_b64 v[66:67], 0
v_mov_b64 v[68:69], 0
v_mov_b64 v[70:71], 0
v_mov_b64 v[72:73], 0
v_mov_b64 v[74:75], 0
v_mov_b64 v[76:77], 0
v_mov_b64 v[78:79], 0
s_bitcmp1_b32 s62, 0
s_cselect_b32 s78, -1.0, 1.0
s_lshl_b32 s55, s5, 7
s_add_u32 s55, s55, 193026048
s_cmp_gt_u32 s62, 60
s_cselect_b32 s55, s55, 536870912
v_mov_b32 v14, s62
v_min_u32 v13, 1, v0
v_lshlrev_b32 v13, 30, v13
s_add_u32 s67, s62, 0
s_and_b32 s67, s67, 3
s_lshl_b32 s67, s67, 1
s_lshl_b32 s68, s67, 15
s_add_u32 s67, s67, s64
s_mul_i32 s67, s67, 10240
s_add_u32 s33, s68, s58
s_add_u32 s32, s67, s80
s_add_u32 s32, s32, 191889408
s_sleep 11
v_mov_b32 v175, 0
s_waitcnt lgkmcnt(0)
buffer_load_dwordx4 v[160:163], v1, s[8:11], s32 offen offset:0 sc1
buffer_load_dwordx4 v[164:167], v1, s[8:11], s32 offen offset:1024 sc1
buffer_load_dwordx4 v[168:171], v1, s[8:11], s32 offen offset:2048 sc1
s_waitcnt vmcnt(0)
v_max3_u32 v172, v160, v161, v162
v_max3_u32 v173, v164, v165, v166
v_max3_u32 v174, v168, v169, v170
v_max_u32 v172, v172, v163
v_max_u32 v173, v173, v167
v_max_u32 v174, v174, v171
v_cmp_eq_u32 s[16:17], -1, v172
v_cmp_eq_u32 s[18:19], -1, v173
v_cmp_eq_u32 s[20:21], -1, v174
s_or_b64 s[28:29], s[16:17], s[18:19]
s_or_b64 s[28:29], s[28:29], s[20:21]
s_cbranch_scc1 Lg_28
Lg_29:
buffer_load_dwordx4 v[136:139], v1, s[8:11], s33 offen offset:0 sc1
buffer_load_dwordx4 v[140:143], v1, s[8:11], s33 offen offset:1024 sc1
buffer_load_dwordx4 v[144:147], v1, s[8:11], s33 offen offset:2048 sc1
v_lshlrev_b32 v16, 16, v160
v_and_b32 v17, 0xffff0000, v160
v_lshlrev_b32 v18, 16, v161
v_and_b32 v19, 0xffff0000, v161
v_lshlrev_b32 v20, 16, v162
v_and_b32 v21, 0xffff0000, v162
v_lshlrev_b32 v22, 16, v163
v_and_b32 v23, 0xffff0000, v163
v_lshlrev_b32 v24, 16, v164
v_and_b32 v25, 0xffff0000, v164
v_lshlrev_b32 v26, 16, v165
v_and_b32 v27, 0xffff0000, v165
v_lshlrev_b32 v28, 16, v166
v_and_b32 v29, 0xffff0000, v166
v_lshlrev_b32 v30, 16, v167
v_and_b32 v31, 0xffff0000, v167
v_lshlrev_b32 v32, 16, v168
v_and_b32 v33, 0xffff0000, v168
v_lshlrev_b32 v34, 16, v169
v_and_b32 v35, 0xffff0000, v169
v_lshlrev_b32 v36, 16, v170
v_and_b32 v37, 0xffff0000, v170
v_lshlrev_b32 v38, 16, v171
v_and_b32 v39, 0xffff0000, v171
s_waitcnt vmcnt(0)
v_max3_u32 v172, v136, v137, v138
v_max3_u32 v173, v140, v141, v142
v_max3_u32 v174, v144, v145, v146
v_max_u32 v172, v172, v139
v_max_u32 v173, v173, v143
v_max_u32 v174, v174, v147
v_cmp_eq_u32 s[22:23], -1, v172
v_cmp_eq_u32 s[24:25], -1, v173
v_cmp_eq_u32 s[26:27], -1, v174
s_or_b64 s[28:29], s[22:23], s[24:25]
s_or_b64 s[28:29], s[28:29], s[26:27]
s_cbranch_scc1 Lg_30
Lg_32:
v_dot2c_f32_bf16 v16, s100, v136
v_dot2c_f32_bf16 v17, s101, v136
v_dot2c_f32_bf16 v18, s100, v137
v_dot2c_f32_bf16 v19, s101, v137
v_dot2c_f32_bf16 v20, s100, v138
v_dot2c_f32_bf16 v21, s101, v138
v_dot2c_f32_bf16 v22, s100, v139
v_dot2c_f32_bf16 v23, s101, v139
v_cvt_pk_bf16_f32 v16, v16, v17
v_cvt_pk_bf16_f32 v17, v18, v19
v_cvt_pk_bf16_f32 v18, v20, v21
v_cvt_pk_bf16_f32 v19, v22, v23
ds_write_b128 v2, v[16:19] offset:0
v_dot2c_f32_bf16 v24, s100, v140
v_dot2c_f32_bf16 v25, s101, v140
v_dot2c_f32_bf16 v26, s100, v141
v_dot2c_f32_bf16 v27, s101, v141
v_dot2c_f32_bf16 v28, s100, v142
v_dot2c_f32_bf16 v29, s101, v142
v_dot2c_f32_bf16 v30, s100, v143
v_dot2c_f32_bf16 v31, s101, v143
v_cvt_pk_bf16_f32 v24, v24, v25
v_cvt_pk_bf16_f32 v25, v26, v27
v_cvt_pk_bf16_f32 v26, v28, v29
v_cvt_pk_bf16_f32 v27, v30, v31
ds_write_b128 v2, v[24:27] offset:1024
v_dot2c_f32_bf16 v32, s100, v144
v_dot2c_f32_bf16 v33, s101, v144
v_dot2c_f32_bf16 v34, s100, v145
v_dot2c_f32_bf16 v35, s101, v145
v_dot2c_f32_bf16 v36, s100, v146
v_dot2c_f32_bf16 v37, s101, v146
v_dot2c_f32_bf16 v38, s100, v147
v_dot2c_f32_bf16 v39, s101, v147
v_cvt_pk_bf16_f32 v32, v32, v33
v_cvt_pk_bf16_f32 v33, v34, v35
v_cvt_pk_bf16_f32 v34, v36, v37
v_cvt_pk_bf16_f32 v35, v38, v39
ds_write_b128 v2, v[32:35] offset:2048
Lqkent_20:
v_smfmac_f32_16x16x64_bf16 v[56:59], v[16:19], a[0:7], v8
v_smfmac_f32_16x16x64_bf16 v[60:63], v[16:19], a[56:63], v8
buffer_load_dword v173, v12, s[8:11], s45 offen sc1
v_smfmac_f32_16x16x64_bf16 v[64:67], v[16:19], a[112:119], v8
v_smfmac_f32_16x16x64_bf16 v[56:59], v[24:27], a[8:15], v8
s_waitcnt lgkmcnt(0)
s_barrier
ds_read_b128 v[20:23], v3 offset:3072
v_smfmac_f32_16x16x64_bf16 v[60:63], v[24:27], a[64:71], v8
ds_read_b128 v[28:31], v3 offset:4096
v_smfmac_f32_16x16x64_bf16 v[64:67], v[24:27], a[120:127], v8
ds_read_b128 v[36:39], v3 offset:5120
buffer_load_dword v173, v6, s[8:11], s45 offen sc1
v_smfmac_f32_16x16x64_bf16 v[56:59], v[32:35], v[80:87], v8
ds_read_b128 v[40:43], v3 offset:6144
v_smfmac_f32_16x16x64_bf16 v[60:63], v[32:35], v[88:95], v8
ds_read_b128 v[44:47], v3 offset:7168
v_smfmac_f32_16x16x64_bf16 v[64:67], v[32:35], v[96:103], v8
ds_read_b128 v[48:51], v3 offset:9216
s_waitcnt lgkmcnt(5)
v_smfmac_f32_16x16x64_bf16 v[56:59], v[20:23], a[16:23], v8
ds_read_b128 v[52:55], v3 offset:8192
buffer_store_dword v14, v13, s[8:11], s55 offen sc1
v_smfmac_f32_16x16x64_bf16 v[60:63], v[20:23], a[72:79], v8
ds_read_b128 v[80:83], v4 offset:8192
ds_read_b128 v[84:87], v4 offset:9216
v_smfmac_f32_16x16x64_bf16 v[64:67], v[20:23], a[128:135], v8
ds_read_b128 v[88:91], v4 offset:10240
ds_read_b128 v[92:95], v4 offset:11264
s_waitcnt lgkmcnt(9)
v_smfmac_f32_16x16x64_bf16 v[56:59], v[28:31], a[24:31], v8
ds_read_b128 v[96:99], v4 offset:12288
v_smfmac_f32_16x16x64_bf16 v[60:63], v[28:31], a[80:87], v8
ds_read_b128 v[100:103], v4 offset:13312
v_smfmac_f32_16x16x64_bf16 v[64:67], v[28:31], a[136:143], v8
s_waitcnt lgkmcnt(10)
v_smfmac_f32_16x16x64_bf16 v[56:59], v[36:39], v[104:111], v8
ds_read_b128 v[104:107], v4 offset:14336
s_waitcnt lgkmcnt(5)
v_smfmac_f32_16x16x64_bf16 v[60:63], v[36:39], v[80:87], v8
ds_read_b128 v[108:111], v4 offset:15360
s_waitcnt lgkmcnt(4)
v_smfmac_f32_16x16x64_bf16 v[64:67], v[36:39], v[88:95], v8
ds_read_b128 v[80:83], v4 offset:16384
v_smfmac_f32_16x16x64_bf16 v[56:59], v[40:43], a[32:39], v8
ds_read_b128 v[84:87], v4 offset:17408
v_smfmac_f32_16x16x64_bf16 v[56:59], v[44:47], a[40:47], v8
ds_read_b128 v[88:91], v4 offset:18432
s_waitcnt lgkmcnt(5)
v_smfmac_f32_16x16x64_bf16 v[56:59], v[48:51], v[96:103], v8
ds_read_b128 v[92:95], v4 offset:19456
v_smfmac_f32_16x16x64_bf16 v[56:59], v[52:55], a[48:55], v8
ds_read_b128 v[96:99], v4 offset:24576
v_smfmac_f32_16x16x64_bf16 v[60:63], v[40:43], a[88:95], v8
ds_read_b128 v[100:103], v4 offset:25600
v_smfmac_f32_16x16x64_bf16 v[60:63], v[44:47], a[96:103], v8
s_waitcnt lgkmcnt(6)
v_add_f32 v56, v56, v58
v_smfmac_f32_16x16x64_bf16 v[60:63], v[48:51], v[104:111], v8
ds_read_b128 v[104:107], v4 offset:30720
v_add_f32 v57, v57, v59
v_smfmac_f32_16x16x64_bf16 v[60:63], v[52:55], a[104:111], v8
ds_read_b128 v[108:111], v4 offset:31744
v_cvt_pk_bf16_f32 v56, v56, v57
v_smfmac_f32_16x16x64_bf16 v[64:67], v[40:43], a[144:151], v8
ds_write_b32 v5, v56 offset:12736
v_smfmac_f32_16x16x64_bf16 v[64:67], v[44:47], a[152:159], v8
s_waitcnt lgkmcnt(7)
v_add_f32 v60, v60, v62
v_smfmac_f32_16x16x64_bf16 v[64:67], v[48:51], v[80:87], v8
ds_read_b128 v[80:83], v4 offset:20480
v_add_f32 v61, v61, v63
v_smfmac_f32_16x16x64_bf16 v[64:67], v[52:55], a[160:167], v8
ds_read_b128 v[84:87], v4 offset:21504
v_cvt_pk_bf16_f32 v60, v60, v61
v_smfmac_f32_16x16x64_bf16 v[68:71], v[16:19], a[168:175], v8
ds_write_b32 v5, v60 offset:13760
s_waitcnt lgkmcnt(8)
v_smfmac_f32_16x16x64_bf16 v[68:71], v[32:35], v[88:95], v8
ds_read_b128 v[88:91], v4 offset:26624
v_add_f32 v64, v64, v66
v_add_f32 v65, v65, v67
v_smfmac_f32_16x16x64_bf16 v[68:71], v[24:27], a[176:183], v8
ds_read_b128 v[92:95], v4 offset:27648
v_cvt_pk_bf16_f32 v64, v64, v65
v_smfmac_f32_16x16x64_bf16 v[68:71], v[20:23], a[184:191], v8
ds_write_b32 v5, v64 offset:14784
s_waitcnt lgkmcnt(9)
v_smfmac_f32_16x16x64_bf16 v[68:71], v[36:39], v[96:103], v8
ds_read_b128 v[96:99], v4 offset:32768
v_smfmac_f32_16x16x64_bf16 v[68:71], v[28:31], a[192:199], v8
ds_read_b128 v[100:103], v4 offset:33792
v_smfmac_f32_16x16x64_bf16 v[68:71], v[40:43], a[200:207], v8
s_waitcnt lgkmcnt(9)
v_smfmac_f32_16x16x64_bf16 v[68:71], v[48:51], v[104:111], v8
s_waitcnt vmcnt(3)
s_waitcnt lgkmcnt(2)
s_barrier
ds_read_b128 v[104:107], v4 offset:22528
v_smfmac_f32_16x16x64_bf16 v[68:71], v[44:47], a[208:215], v8
ds_read_b128 v[108:111], v4 offset:23552
v_smfmac_f32_16x16x64_bf16 v[68:71], v[52:55], a[216:223], v8
ds_read_b64_tr_b16 v[136:137], v7 offset:12736
v_smfmac_f32_16x16x64_bf16 v[72:75], v[16:19], a[224:231], v8
ds_read_b64_tr_b16 v[138:139], v7 offset:12992
v_smfmac_f32_16x16x64_bf16 v[72:75], v[32:35], v[80:87], v8
ds_read_b128 v[80:83], v4 offset:28672
v_add_f32 v68, v68, v70
v_smfmac_f32_16x16x64_bf16 v[72:75], v[24:27], a[232:239], v8
ds_read_b128 v[84:87], v4 offset:29696
v_add_f32 v69, v69, v71
v_smfmac_f32_16x16x64_bf16 v[72:75], v[20:23], a[240:247], v8
ds_read_b64_tr_b16 v[140:141], v7 offset:13248
v_cvt_pk_bf16_f32 v68, v68, v69
v_smfmac_f32_16x16x64_bf16 v[72:75], v[36:39], v[88:95], v8
ds_write_b32 v5, v68 offset:0
v_smfmac_f32_16x16x64_bf16 v[72:75], v[28:31], a[248:255], v8
ds_read_b128 v[88:91], v4 offset:34816
v_smfmac_f32_16x16x64_bf16 v[72:75], v[40:43], v[176:183], v8
ds_read_b128 v[92:95], v4 offset:35840
s_waitcnt lgkmcnt(10)
v_smfmac_f32_16x16x64_bf16 v[72:75], v[48:51], v[96:103], v8
ds_read_b64_tr_b16 v[142:143], v7 offset:13504
v_smfmac_f32_16x16x64_bf16 v[72:75], v[44:47], v[184:191], v8
ds_read_b64_tr_b16 v[144:145], v7 offset:13760
v_smfmac_f32_16x16x64_bf16 v[72:75], v[52:55], v[192:199], v8
ds_read_b64_tr_b16 v[146:147], v7 offset:14016
v_smfmac_f32_16x16x64_bf16 v[76:79], v[16:19], v[200:207], v8
ds_read_b64_tr_b16 v[148:149], v7 offset:14272
s_waitcnt lgkmcnt(12)
v_smfmac_f32_16x16x64_bf16 v[76:79], v[32:35], v[104:111], v8
ds_read_b64_tr_b16 v[150:151], v7 offset:14528
ds_read_b64_tr_b16 v[158:159], v7 offset:15552
v_add_f32 v72, v72, v74
v_smfmac_f32_16x16x64_bf16 v[76:79], v[24:27], v[208:215], v8
ds_read_b64_tr_b16 v[152:153], v7 offset:14784
ds_read_b64_tr_b16 v[156:157], v7 offset:15296
v_add_f32 v73, v73, v75
v_smfmac_f32_16x16x64_bf16 v[76:79], v[20:23], v[216:223], v8
ds_read_b64_tr_b16 v[154:155], v7 offset:15040
s_waitcnt lgkmcnt(13)
v_cvt_pk_bf16_f32 v72, v72, v73
v_smfmac_f32_16x16x64_bf16 v[76:79], v[36:39], v[80:87], v8
ds_write_b32 v5, v72 offset:1024
v_smfmac_f32_16x16x64_bf16 v[76:79], v[28:31], v[224:231], v8
v_smfmac_f32_16x16x64_bf16 v[76:79], v[40:43], v[232:239], v8
s_waitcnt lgkmcnt(0)
s_barrier
ds_read_b64_tr_b16 v[112:113], v7 offset:0
ds_read_b64_tr_b16 v[114:115], v7 offset:256
ds_read_b64_tr_b16 v[116:117], v7 offset:512
v_smfmac_f32_16x16x64_bf16 v[76:79], v[48:51], v[88:95], v8
ds_read_b64_tr_b16 v[118:119], v7 offset:768
ds_read_b64_tr_b16 v[120:121], v7 offset:1024
ds_read_b64_tr_b16 v[122:123], v7 offset:1280
v_smfmac_f32_16x16x64_bf16 v[76:79], v[44:47], v[240:247], v8
ds_read_b64_tr_b16 v[124:125], v7 offset:1536
ds_read_b64_tr_b16 v[126:127], v7 offset:1792
v_smfmac_f32_16x16x64_bf16 v[76:79], v[52:55], v[248:255], v8
s_waitcnt lgkmcnt(6)
v_mfma_f32_16x16x32_bf16 v[164:167], v[112:115], v[136:139], 0
s_waitcnt lgkmcnt(4)
v_mfma_f32_16x16x32_bf16 v[164:167], v[116:119], v[140:143], v[164:167]
s_waitcnt lgkmcnt(2)
v_add_f32 v76, v76, v78
v_mfma_f32_16x16x32_bf16 v[164:167], v[120:123], v[144:147], v[164:167]
s_waitcnt lgkmcnt(0)
v_add_f32 v77, v77, v79
v_mfma_f32_16x16x32_bf16 v[164:167], v[124:127], v[148:151], v[164:167]
v_cvt_pk_bf16_f32 v76, v76, v77
ds_write_b32 v5, v76 offset:2048
s_waitcnt lgkmcnt(0)
s_barrier
ds_read_b64_tr_b16 v[128:129], v7 offset:2048
ds_read_b64_tr_b16 v[130:131], v7 offset:2304
ds_read_b64_tr_b16 v[132:133], v7 offset:2560
ds_read_b64_tr_b16 v[134:135], v7 offset:2816
ds_read_b128 v[80:83], v11
ds_read_b128 v[84:87], v11 offset:1024
s_cmp_eq_u32 s62, 63
s_cbranch_scc1 Lkm_22
s_waitcnt lgkmcnt(4)
v_mfma_f32_16x16x32_bf16 v[164:167], v[128:131], v[152:155], v[164:167]
s_waitcnt lgkmcnt(2)
v_mfma_f32_16x16x32_bf16 v[164:167], v[132:135], v[156:159], v[164:167]
s_waitcnt lgkmcnt(0)
v_add_f32 v92, v83, v87
v_max_f32 v88, |v82|, |v86|
v_mul_f32 v88, 0x71800000, v88
v_add_f32_dpp v92, v92, v92 row_ror:8 row_mask:0xf bank_mask:0xf
v_mov_b32 v172, v92
s_nop 1
v_cndmask_b32 v164, v164, v166, s[70:71]
v_cndmask_b32 v165, v165, v167, s[70:71]
v_mul_f32 v164, s52, v164
v_mul_f32 v165, s52, v165
v_exp_f32 v166, v164
v_exp_f32 v167, v165
v_permlane16_swap_b32 v92, v172
v_max3_f32 v88, |v164|, |v165|, v88
v_add_f32 v92, v92, v172
v_add_f32 v89, v166, v167
v_mov_b32 v172, v92
v_cmp_lt_f32 vcc, s79, v88
v_add_f32_dpp v89, v89, v89 row_ror:8 row_mask:0xf bank_mask:0xf
v_permlane32_swap_b32 v92, v172
v_mov_b32 v93, v89
v_add_f32 v92, v92, v172
v_mul_f32 v92, s78, v92
v_permlane16_swap_b32 v89, v93
v_add_f32 v89, v89, v93
v_fma_f32 v89, v89, s78, v92
v_rcp_f32 v89, v89
s_nop 0
v_pk_mul_f32 v[96:97], v[80:81], v[88:89] op_sel:[0,1]
v_pk_mul_f32 v[98:99], v[84:85], v[88:89] op_sel:[0,1]
v_cvt_pk_bf16_f32 v96, v96, v97
v_cvt_pk_bf16_f32 v97, v98, v99
s_cbranch_vccnz Lsm_33
Lsb_34:
buffer_store_dwordx2 v[96:97], v9, s[8:11], s76 offen
v_pk_mul_f32 v[166:167], v[166:167], v[88:89] op_sel:[0,1]
v_cvt_pk_bf16_f32 v164, v166, v167
buffer_store_dword v164, v10, s[8:11], s77 offen
s_add_u32 s62, s62, 1
s_cmp_lt_u32 s62, 64
s_cbranch_scc1 Lqk_19
s_waitcnt vmcnt(0)
s_endpgm
Lg_28:
s_mov_b64 exec, s[16:17]
buffer_load_dwordx4 v[160:163], v1, s[8:11], s32 offen offset:0 sc1
s_mov_b64 exec, s[18:19]
buffer_load_dwordx4 v[164:167], v1, s[8:11], s32 offen offset:1024 sc1
s_mov_b64 exec, s[20:21]
buffer_load_dwordx4 v[168:171], v1, s[8:11], s32 offen offset:2048 sc1
s_mov_b64 exec, -1
s_waitcnt vmcnt(0)
v_max3_u32 v172, v160, v161, v162
v_max3_u32 v173, v164, v165, v166
v_max3_u32 v174, v168, v169, v170
v_max_u32 v172, v172, v163
v_max_u32 v173, v173, v167
v_max_u32 v174, v174, v171
v_cmp_eq_u32 s[16:17], -1, v172
v_cmp_eq_u32 s[18:19], -1, v173
v_cmp_eq_u32 s[20:21], -1, v174
s_or_b64 s[28:29], s[16:17], s[18:19]
s_or_b64 s[28:29], s[28:29], s[20:21]
s_cbranch_scc0 Lg_29
s_cmp_eq_u32 s65, 0
s_cbranch_scc1 Lg_29
s_sub_u32 s65, s65, 1
s_branch Lg_28
Lg_30:
Lg_31:
s_mov_b64 exec, s[22:23]
buffer_load_dwordx4 v[136:139], v1, s[8:11], s33 offen offset:0 sc1
s_mov_b64 exec, s[24:25]
buffer_load_dwordx4 v[140:143], v1, s[8:11], s33 offen offset:1024 sc1
s_mov_b64 exec, s[26:27]
buffer_load_dwordx4 v[144:147], v1, s[8:11], s33 offen offset:2048 sc1
s_mov_b64 exec, -1
s_waitcnt vmcnt(0)
v_max3_u32 v172, v136, v137, v138
v_max3_u32 v173, v140, v141, v142
v_max3_u32 v174, v144, v145, v146
v_max_u32 v172, v172, v139
v_max_u32 v173, v173, v143
v_max_u32 v174, v174, v147
v_cmp_eq_u32 s[22:23], -1, v172
v_cmp_eq_u32 s[24:25], -1, v173
v_cmp_eq_u32 s[26:27], -1, v174
s_or_b64 s[28:29], s[22:23], s[24:25]
s_or_b64 s[28:29], s[28:29], s[26:27]
s_cbranch_scc0 Lg_32
s_cmp_eq_u32 s65, 0
s_cbranch_scc1 Lg_32
s_sub_u32 s65, s65, 1
s_branch Lg_31
Lkm_22:
s_mov_b32 s75, 63
Lkc_24:
s_mul_i32 s72, s63, 12288
s_bfe_u32 s67, s75, 0x10001
s_mul_i32 s67, s67, 6144
s_add_u32 s72, s72, s67
s_lshr_b32 s67, s75, 2
s_mul_i32 s67, s67, 393216
s_add_u32 s72, s72, s67
s_add_u32 s72, s72, 54525952
s_add_u32 s73, s72, 4096
s_bitcmp1_b32 s75, 0
s_cselect_b32 s74, 8, 0
s_lshl_b32 s74, 0x00ff00ff, s74
s_mov_b32 exec_lo, s74
s_mov_b32 exec_hi, s74
s_waitcnt lgkmcnt(0)
buffer_store_dwordx4 v[112:115], v1, s[8:11], s72 offen offset:0 sc1
buffer_store_dwordx4 v[116:119], v1, s[8:11], s72 offen offset:1024 sc1
buffer_store_dwordx4 v[120:123], v1, s[8:11], s72 offen offset:2048 sc1
buffer_store_dwordx4 v[124:127], v1, s[8:11], s72 offen offset:3072 sc1
buffer_store_dwordx4 v[128:131], v1, s[8:11], s73 offen offset:0 sc1
buffer_store_dwordx4 v[132:135], v1, s[8:11], s73 offen offset:1024 sc1
s_mov_b64 exec, -1
s_cmp_lt_u32 s75, 63
s_cbranch_scc1 Lkb_23
s_waitcnt vmcnt(0)
s_lshl_b32 s67, s5, 7
s_add_u32 s67, s67, 193026048
s_add_u32 s68, s62, 1
v_mov_b32 v13, s68
v_mov_b32 v14, 0
s_mov_b64 exec, 1
buffer_store_dword v13, v14, s[8:11], s67 offen sc1
s_mov_b64 exec, -1
s_waitcnt vmcnt(0)
s_endpgm
Lsm_33:
v_max_f32 v88, v164, v165
s_nop 1
v_max_f32_dpp v88, v88, v88 row_ror:8 row_mask:0xf bank_mask:0xf
v_mov_b32 v172, v88
s_nop 1
v_permlane16_swap_b32 v88, v172
v_max_f32 v88, v88, v172
v_max3_f32 v88, v88, v82, v86
v_sub_f32 v164, v164, v88
v_sub_f32 v165, v165, v88
v_sub_f32 v90, v82, v88
v_sub_f32 v91, v86, v88
v_exp_f32 v166, v164
v_exp_f32 v167, v165
v_exp_f32 v90, v90
v_exp_f32 v91, v91
v_mul_f32 v92, v83, v90
v_fmac_f32 v92, v87, v91
s_nop 1
v_add_f32_dpp v92, v92, v92 row_ror:8 row_mask:0xf bank_mask:0xf
v_mov_b32 v172, v92
s_nop 1
v_permlane16_swap_b32 v92, v172
v_add_f32 v92, v92, v172
v_mov_b32 v172, v92
s_nop 1
v_permlane32_swap_b32 v92, v172
v_add_f32 v92, v92, v172
v_mul_f32 v92, s78, v92
v_mul_f32 v80, v80, v90
v_mul_f32 v84, v84, v91
v_mul_f32 v81, v81, v90
v_mul_f32 v85, v85, v91
v_add_f32 v89, v166, v167
s_nop 1
v_add_f32_dpp v89, v89, v89 row_ror:8 row_mask:0xf bank_mask:0xf
v_mov_b32 v93, v89
s_nop 1
v_permlane16_swap_b32 v89, v93
v_add_f32 v89, v89, v93
v_fma_f32 v89, v89, s78, v92
v_rcp_f32 v89, v89
s_nop 0
v_pk_mul_f32 v[96:97], v[80:81], v[88:89] op_sel:[0,1]
v_pk_mul_f32 v[98:99], v[84:85], v[88:89] op_sel:[0,1]
v_cvt_pk_bf16_f32 v96, v96, v97
v_cvt_pk_bf16_f32 v97, v98, v99
s_branch Lsb_34
Lw_16:
s_mov_b32 s62, 0
s_mov_b32 s52, 0x3dd53b95
s_mov_b32 s53, s52
s_mov_b32 s79, 0x42700000
v_lshlrev_b32 v9, 7, v0
v_and_b32 v10, 15, v0
v_lshlrev_b32 v10, 7, v10
v_cmp_eq_u32 vcc, 0, v0
v_mov_b32 v15, 0x40000000
s_nop 0
v_cndmask_b32 v15, v15, 0, vcc
s_lshl_b32 s81, s64, 11
s_bfe_u32 s67, s63, 0x20002
s_mul_i32 s67, s67, 5120
s_add_u32 s81, s81, s67
s_add_u32 s81, s81, 192978944
s_and_b32 s50, s63, 15
s_mul_i32 s50, s50, 40960
s_lshl_b32 s67, s64, 14
s_add_u32 s50, s50, s67
s_add_u32 s50, s50, 60817408
s_lshl_b32 s46, s63, 7
s_add_u32 s46, s46, 193024000
s_lshl_b32 s47, s63, 11
s_add_u32 s47, s47, 2621440
s_cmp_ge_u32 s63, 10
s_cselect_b32 s46, 536870912, s46
s_cselect_b32 s47, 536870912, s47
s_mov_b32 s45, 536870912
s_mov_b32 s48, 536870912
s_mov_b32 s49, 536870912
s_mov_b32 s54, s81
s_mov_b32 s60, 0
ds_read_b128 v[80:83], v4 offset:6144
ds_read_b128 v[84:87], v4 offset:7168
ds_read_b128 v[88:91], v4 offset:8192
ds_read_b128 v[92:95], v4 offset:9216
ds_read_b128 v[96:99], v4 offset:10240
ds_read_b128 v[100:103], v4 offset:11264
ds_read_b128 v[104:107], v4 offset:0
ds_read_b128 v[108:111], v4 offset:1024
v_mov_b64 v[56:57], 0
v_mov_b64 v[58:59], 0
v_mov_b64 v[60:61], 0
v_mov_b64 v[62:63], 0
v_mov_b64 v[64:65], 0
v_mov_b64 v[66:67], 0
v_mov_b64 v[68:69], 0
v_mov_b64 v[70:71], 0
v_mov_b64 v[72:73], 0
v_mov_b64 v[74:75], 0
v_mov_b64 v[76:77], 0
v_mov_b64 v[78:79], 0
v_mov_b32 v14, s62
s_lshr_b32 s67, s62, 2
s_mul_i32 s44, s67, 40960
s_bfe_u32 s67, s62, 0x10001
s_mul_i32 s67, s67, 20480
s_add_u32 s44, s44, s67
s_and_b32 s67, s62, 1
s_lshl_b32 s67, s67, 7
s_add_u32 s44, s44, s67
s_add_u32 s44, s44, s47
ds_read_b128 v[16:19], v3 offset:3072
ds_read_b128 v[24:27], v3 offset:4096
ds_read_b128 v[32:35], v3 offset:5120
s_waitcnt lgkmcnt(0)
s_branch Lqkent_36
Lqk_35:
s_barrier
s_add_u32 s82, s62, 1
s_mov_b32 s45, 536870912
s_cmp_ge_u32 s82, 63
s_cbranch_scc1 Lnp_41
s_sub_u32 s61, s82, 12
s_max_i32 s61, s61, 0
s_lshr_b32 s61, s61, 2
s_add_u32 s61, s61, s82
s_cmp_gt_u32 s60, s61
s_cbranch_scc1 Lfd_43
v_and_b32 v14, 15, v0
v_lshlrev_b32 v14, 7, v14
Lf_42:
buffer_load_dword v13, v14, s[8:11], s81 offen sc1
s_waitcnt vmcnt(0)
v_min_u32_dpp v13, v13, v13 row_ror:8 row_mask:0xf bank_mask:0xf
s_nop 1
v_min_u32_dpp v13, v13, v13 row_ror:4 row_mask:0xf bank_mask:0xf
s_nop 1
v_min_u32_dpp v13, v13, v13 row_ror:2 row_mask:0xf bank_mask:0xf
s_nop 1
v_min_u32_dpp v13, v13, v13 row_ror:1 row_mask:0xf bank_mask:0xf
s_nop 0
v_readfirstlane_b32 s60, v13
s_nop 0
s_cmp_gt_u32 s60, s61
s_cbranch_scc1 Lfd_43
s_cmp_lt_u32 s82, 3
s_cbranch_scc1 Lnp_41
s_cmp_eq_u32 s65, 0
s_cbranch_scc1 Lfd_43
s_sub_u32 s65, s65, 1
s_branch Lf_42
Lfd_43:
s_mul_i32 s45, s82, 1638400
s_add_u32 s45, s45, s50
Lnp_41:
s_add_u32 s48, s45, 655360
s_add_u32 s49, s45, 1310720
s_bitcmp1_b32 s63, 3
s_cselect_b32 s49, 536870912, s49
ds_read_b128 v[80:83], v4 offset:6144
ds_read_b128 v[84:87], v4 offset:7168
ds_read_b128 v[88:91], v4 offset:8192
ds_read_b128 v[92:95], v4 offset:9216
ds_read_b128 v[96:99], v4 offset:10240
ds_read_b128 v[100:103], v4 offset:11264
ds_read_b128 v[104:107], v4 offset:0
ds_read_b128 v[108:111], v4 offset:1024
v_mov_b64 v[56:57], 0
v_mov_b64 v[58:59], 0
v_mov_b64 v[60:61], 0
v_mov_b64 v[62:63], 0
v_mov_b64 v[64:65], 0
v_mov_b64 v[66:67], 0
v_mov_b64 v[68:69], 0
v_mov_b64 v[70:71], 0
v_mov_b64 v[72:73], 0
v_mov_b64 v[74:75], 0
v_mov_b64 v[76:77], 0
v_mov_b64 v[78:79], 0
v_mov_b32 v14, s62
s_lshr_b32 s67, s62, 2
s_mul_i32 s44, s67, 40960
s_bfe_u32 s67, s62, 0x10001
s_mul_i32 s67, s67, 20480
s_add_u32 s44, s44, s67
s_and_b32 s67, s62, 1
s_lshl_b32 s67, s67, 7
s_add_u32 s44, s44, s67
s_add_u32 s44, s44, s47
s_add_u32 s67, s62, 0
s_and_b32 s67, s67, 3
s_lshl_b32 s67, s67, 1
s_lshl_b32 s68, s67, 15
s_add_u32 s67, s67, s64
s_mul_i32 s67, s67, 10240
s_add_u32 s33, s68, s58
s_add_u32 s32, s67, s80
s_add_u32 s32, s32, 191889408
s_sleep 11
v_mov_b32 v175, 0
s_waitcnt lgkmcnt(0)
buffer_load_dwordx4 v[160:163], v1, s[8:11], s32 offen offset:0 sc1
buffer_load_dwordx4 v[164:167], v1, s[8:11], s32 offen offset:1024 sc1
buffer_load_dwordx4 v[168:171], v1, s[8:11], s32 offen offset:2048 sc1
s_waitcnt vmcnt(0)
v_max3_u32 v172, v160, v161, v162
v_max3_u32 v173, v164, v165, v166
v_max3_u32 v174, v168, v169, v170
v_max_u32 v172, v172, v163
v_max_u32 v173, v173, v167
v_max_u32 v174, v174, v171
v_cmp_eq_u32 s[16:17], -1, v172
v_cmp_eq_u32 s[18:19], -1, v173
v_cmp_eq_u32 s[20:21], -1, v174
s_or_b64 s[28:29], s[16:17], s[18:19]
s_or_b64 s[28:29], s[28:29], s[20:21]
s_cbranch_scc1 Lg_44
Lg_45:
buffer_load_dwordx4 v[136:139], v1, s[8:11], s33 offen offset:0 sc1
buffer_load_dwordx4 v[140:143], v1, s[8:11], s33 offen offset:1024 sc1
buffer_load_dwordx4 v[144:147], v1, s[8:11], s33 offen offset:2048 sc1
v_lshlrev_b32 v16, 16, v160
v_and_b32 v17, 0xffff0000, v160
v_lshlrev_b32 v18, 16, v161
v_and_b32 v19, 0xffff0000, v161
v_lshlrev_b32 v20, 16, v162
v_and_b32 v21, 0xffff0000, v162
v_lshlrev_b32 v22, 16, v163
v_and_b32 v23, 0xffff0000, v163
v_lshlrev_b32 v24, 16, v164
v_and_b32 v25, 0xffff0000, v164
v_lshlrev_b32 v26, 16, v165
v_and_b32 v27, 0xffff0000, v165
v_lshlrev_b32 v28, 16, v166
v_and_b32 v29, 0xffff0000, v166
v_lshlrev_b32 v30, 16, v167
v_and_b32 v31, 0xffff0000, v167
v_lshlrev_b32 v32, 16, v168
v_and_b32 v33, 0xffff0000, v168
v_lshlrev_b32 v34, 16, v169
v_and_b32 v35, 0xffff0000, v169
v_lshlrev_b32 v36, 16, v170
v_and_b32 v37, 0xffff0000, v170
v_lshlrev_b32 v38, 16, v171
v_and_b32 v39, 0xffff0000, v171
s_waitcnt vmcnt(0)
v_max3_u32 v172, v136, v137, v138
v_max3_u32 v173, v140, v141, v142
v_max3_u32 v174, v144, v145, v146
v_max_u32 v172, v172, v139
v_max_u32 v173, v173, v143
v_max_u32 v174, v174, v147
v_cmp_eq_u32 s[22:23], -1, v172
v_cmp_eq_u32 s[24:25], -1, v173
v_cmp_eq_u32 s[26:27], -1, v174
s_or_b64 s[28:29], s[22:23], s[24:25]
s_or_b64 s[28:29], s[28:29], s[26:27]
s_cbranch_scc1 Lg_46
Lg_48:
v_dot2c_f32_bf16 v16, s100, v136
v_dot2c_f32_bf16 v17, s101, v136
v_dot2c_f32_bf16 v18, s100, v137
v_dot2c_f32_bf16 v19, s101, v137
v_dot2c_f32_bf16 v20, s100, v138
v_dot2c_f32_bf16 v21, s101, v138
v_dot2c_f32_bf16 v22, s100, v139
v_dot2c_f32_bf16 v23, s101, v139
v_cvt_pk_bf16_f32 v16, v16, v17
v_cvt_pk_bf16_f32 v17, v18, v19
v_cvt_pk_bf16_f32 v18, v20, v21
v_cvt_pk_bf16_f32 v19, v22, v23
ds_write_b128 v2, v[16:19] offset:0
v_dot2c_f32_bf16 v24, s100, v140
v_dot2c_f32_bf16 v25, s101, v140
v_dot2c_f32_bf16 v26, s100, v141
v_dot2c_f32_bf16 v27, s101, v141
v_dot2c_f32_bf16 v28, s100, v142
v_dot2c_f32_bf16 v29, s101, v142
v_dot2c_f32_bf16 v30, s100, v143
v_dot2c_f32_bf16 v31, s101, v143
v_cvt_pk_bf16_f32 v24, v24, v25
v_cvt_pk_bf16_f32 v25, v26, v27
v_cvt_pk_bf16_f32 v26, v28, v29
v_cvt_pk_bf16_f32 v27, v30, v31
ds_write_b128 v2, v[24:27] offset:1024
v_dot2c_f32_bf16 v32, s100, v144
v_dot2c_f32_bf16 v33, s101, v144
v_dot2c_f32_bf16 v34, s100, v145
v_dot2c_f32_bf16 v35, s101, v145
v_dot2c_f32_bf16 v36, s100, v146
v_dot2c_f32_bf16 v37, s101, v146
v_dot2c_f32_bf16 v38, s100, v147
v_dot2c_f32_bf16 v39, s101, v147
v_cvt_pk_bf16_f32 v32, v32, v33
v_cvt_pk_bf16_f32 v33, v34, v35
v_cvt_pk_bf16_f32 v34, v36, v37
v_cvt_pk_bf16_f32 v35, v38, v39
ds_write_b128 v2, v[32:35] offset:2048
Lqkent_36:
v_smfmac_f32_16x16x64_bf16 v[56:59], v[16:19], a[16:23], v8
buffer_store_dword v14, v15, s[8:11], s46 offen sc1
v_smfmac_f32_16x16x64_bf16 v[60:63], v[16:19], a[72:79], v8
buffer_load_dword v116, v9, s[8:11], s45 offen sc1
v_smfmac_f32_16x16x64_bf16 v[64:67], v[16:19], a[128:135], v8
s_add_u32 s45, s45, 8192
v_smfmac_f32_16x16x64_bf16 v[56:59], v[24:27], a[24:31], v8
s_waitcnt lgkmcnt(0)
s_barrier
ds_read_b128 v[20:23], v3 offset:0
v_smfmac_f32_16x16x64_bf16 v[60:63], v[24:27], a[80:87], v8
ds_read_b128 v[28:31], v3 offset:1024
buffer_load_dword v117, v9, s[8:11], s45 offen sc1
v_smfmac_f32_16x16x64_bf16 v[64:67], v[24:27], a[136:143], v8
ds_read_b128 v[36:39], v3 offset:2048
v_smfmac_f32_16x16x64_bf16 v[56:59], v[32:35], v[80:87], v8
ds_read_b128 v[40:43], v3 offset:6144
v_smfmac_f32_16x16x64_bf16 v[60:63], v[32:35], v[88:95], v8
ds_read_b128 v[44:47], v3 offset:7168
buffer_load_dword v118, v9, s[8:11], s48 offen sc1
v_smfmac_f32_16x16x64_bf16 v[64:67], v[32:35], v[96:103], v8
ds_read_b128 v[48:51], v3 offset:9216
s_add_u32 s48, s48, 8192
s_waitcnt lgkmcnt(5)
v_smfmac_f32_16x16x64_bf16 v[56:59], v[20:23], a[0:7], v8
ds_read_b128 v[52:55], v3 offset:8192
v_smfmac_f32_16x16x64_bf16 v[60:63], v[20:23], a[56:63], v8
buffer_load_dword v119, v9, s[8:11], s48 offen sc1
ds_read_b128 v[80:83], v4 offset:2048
ds_read_b128 v[84:87], v4 offset:3072
v_smfmac_f32_16x16x64_bf16 v[64:67], v[20:23], a[112:119], v8
ds_read_b128 v[88:91], v4 offset:4096
ds_read_b128 v[92:95], v4 offset:5120
s_waitcnt lgkmcnt(9)
v_smfmac_f32_16x16x64_bf16 v[56:59], v[28:31], a[8:15], v8
ds_read_b128 v[96:99], v4 offset:12288
v_smfmac_f32_16x16x64_bf16 v[60:63], v[28:31], a[64:71], v8
buffer_load_dword v120, v9, s[8:11], s49 offen sc1
ds_read_b128 v[100:103], v4 offset:13312
v_smfmac_f32_16x16x64_bf16 v[64:67], v[28:31], a[120:127], v8
s_add_u32 s49, s49, 8192
s_waitcnt lgkmcnt(10)
v_smfmac_f32_16x16x64_bf16 v[56:59], v[36:39], v[104:111], v8
ds_read_b128 v[104:107], v4 offset:14336
s_waitcnt lgkmcnt(5)
v_smfmac_f32_16x16x64_bf16 v[60:63], v[36:39], v[80:87], v8
buffer_load_dword v121, v9, s[8:11], s49 offen sc1
ds_read_b128 v[108:111], v4 offset:15360
s_waitcnt lgkmcnt(4)
v_smfmac_f32_16x16x64_bf16 v[64:67], v[36:39], v[88:95], v8
ds_read_b128 v[80:83], v4 offset:16384
v_smfmac_f32_16x16x64_bf16 v[56:59], v[40:43], a[32:39], v8
ds_read_b64 v[112:113], v12 offset:0
v_smfmac_f32_16x16x64_bf16 v[56:59], v[44:47], a[40:47], v8
ds_read_b64 v[114:115], v12 offset:256
s_waitcnt lgkmcnt(5)
v_smfmac_f32_16x16x64_bf16 v[56:59], v[48:51], v[96:103], v8
ds_read_b128 v[84:87], v4 offset:17408
v_smfmac_f32_16x16x64_bf16 v[56:59], v[52:55], a[48:55], v8
ds_read_b128 v[88:91], v4 offset:18432
v_smfmac_f32_16x16x64_bf16 v[60:63], v[40:43], a[88:95], v8
ds_read_b128 v[92:95], v4 offset:19456
v_smfmac_f32_16x16x64_bf16 v[60:63], v[44:47], a[96:103], v8
ds_read_b128 v[96:99], v4 offset:24576
s_waitcnt lgkmcnt(7)
v_add_f32 v56, v56, v58
v_smfmac_f32_16x16x64_bf16 v[60:63], v[48:51], v[104:111], v8
ds_read_b128 v[100:103], v4 offset:25600
v_add_f32 v57, v57, v59
v_smfmac_f32_16x16x64_bf16 v[60:63], v[52:55], a[104:111], v8
s_waitcnt lgkmcnt(5)
buffer_store_dwordx4 v[112:115], v6, s[8:11], s44 offen sc1
ds_read_b128 v[104:107], v4 offset:30720
v_cvt_pk_bf16_f32 v56, v56, v57
v_smfmac_f32_16x16x64_bf16 v[64:67], v[40:43], a[144:151], v8
ds_write_b32 v5, v56 offset:12736
v_smfmac_f32_16x16x64_bf16 v[64:67], v[44:47], a[152:159], v8
ds_read_b128 v[108:111], v4 offset:31744
s_waitcnt lgkmcnt(7)
v_add_f32 v60, v60, v62
v_smfmac_f32_16x16x64_bf16 v[64:67], v[48:51], v[80:87], v8
ds_read_b128 v[80:83], v4 offset:20480
v_add_f32 v61, v61, v63
v_smfmac_f32_16x16x64_bf16 v[64:67], v[52:55], a[160:167], v8
ds_read_b128 v[84:87], v4 offset:21504
v_cvt_pk_bf16_f32 v60, v60, v61
v_smfmac_f32_16x16x64_bf16 v[68:71], v[20:23], a[168:175], v8
ds_write_b32 v5, v60 offset:13760
s_waitcnt lgkmcnt(8)
v_smfmac_f32_16x16x64_bf16 v[68:71], v[36:39], v[88:95], v8
ds_read_b128 v[88:91], v4 offset:26624
v_add_f32 v64, v64, v66
v_add_f32 v65, v65, v67
v_smfmac_f32_16x16x64_bf16 v[68:71], v[28:31], a[176:183], v8
ds_read_b128 v[92:95], v4 offset:27648
v_cvt_pk_bf16_f32 v64, v64, v65
v_smfmac_f32_16x16x64_bf16 v[68:71], v[16:19], a[184:191], v8
ds_write_b32 v5, v64 offset:14784
s_waitcnt lgkmcnt(9)
v_smfmac_f32_16x16x64_bf16 v[68:71], v[32:35], v[96:103], v8
ds_read_b128 v[96:99], v4 offset:32768
v_smfmac_f32_16x16x64_bf16 v[68:71], v[24:27], a[192:199], v8
s_waitcnt lgkmcnt(1)
s_barrier
ds_read_b128 v[100:103], v4 offset:33792
v_smfmac_f32_16x16x64_bf16 v[68:71], v[40:43], a[200:207], v8
v_smfmac_f32_16x16x64_bf16 v[68:71], v[48:51], v[104:111], v8
ds_read_b128 v[104:107], v4 offset:22528
v_smfmac_f32_16x16x64_bf16 v[68:71], v[44:47], a[208:215], v8
ds_read_b128 v[108:111], v4 offset:23552
v_smfmac_f32_16x16x64_bf16 v[68:71], v[52:55], a[216:223], v8
v_smfmac_f32_16x16x64_bf16 v[72:75], v[20:23], a[224:231], v8
v_smfmac_f32_16x16x64_bf16 v[72:75], v[36:39], v[80:87], v8
ds_read_b128 v[80:83], v4 offset:28672
v_add_f32 v68, v68, v70
v_smfmac_f32_16x16x64_bf16 v[72:75], v[28:31], a[232:239], v8
ds_read_b128 v[84:87], v4 offset:29696
v_add_f32 v69, v69, v71
v_smfmac_f32_16x16x64_bf16 v[72:75], v[16:19], a[240:247], v8
v_cvt_pk_bf16_f32 v68, v68, v69
v_smfmac_f32_16x16x64_bf16 v[72:75], v[32:35], v[88:95], v8
ds_write_b32 v5, v68 offset:0
v_smfmac_f32_16x16x64_bf16 v[72:75], v[24:27], a[248:255], v8
ds_read_b128 v[88:91], v4 offset:34816
v_smfmac_f32_16x16x64_bf16 v[72:75], v[40:43], v[176:183], v8
ds_read_b128 v[92:95], v4 offset:35840
s_waitcnt lgkmcnt(7)
v_smfmac_f32_16x16x64_bf16 v[72:75], v[48:51], v[96:103], v8
v_smfmac_f32_16x16x64_bf16 v[72:75], v[44:47], v[184:191], v8
v_smfmac_f32_16x16x64_bf16 v[72:75], v[52:55], v[192:199], v8
v_smfmac_f32_16x16x64_bf16 v[76:79], v[20:23], v[200:207], v8
s_waitcnt lgkmcnt(5)
v_smfmac_f32_16x16x64_bf16 v[76:79], v[36:39], v[104:111], v8
v_add_f32 v72, v72, v74
v_smfmac_f32_16x16x64_bf16 v[76:79], v[28:31], v[208:215], v8
v_add_f32 v73, v73, v75
v_smfmac_f32_16x16x64_bf16 v[76:79], v[16:19], v[216:223], v8
s_waitcnt lgkmcnt(3)
v_cvt_pk_bf16_f32 v72, v72, v73
v_smfmac_f32_16x16x64_bf16 v[76:79], v[32:35], v[80:87], v8
ds_write_b32 v5, v72 offset:1024
v_smfmac_f32_16x16x64_bf16 v[76:79], v[24:27], v[224:231], v8
v_smfmac_f32_16x16x64_bf16 v[76:79], v[40:43], v[232:239], v8
s_waitcnt lgkmcnt(0)
s_barrier
v_smfmac_f32_16x16x64_bf16 v[76:79], v[48:51], v[88:95], v8
v_smfmac_f32_16x16x64_bf16 v[76:79], v[44:47], v[240:247], v8
v_smfmac_f32_16x16x64_bf16 v[76:79], v[52:55], v[248:255], v8
s_nop 7
v_pk_add_f32 v[76:77], v[76:77], v[78:79]
v_cvt_pk_bf16_f32 v76, v76, v77
ds_write_b32 v5, v76 offset:2048
s_waitcnt lgkmcnt(0)
s_barrier
s_add_u32 s62, s62, 1
s_cmp_lt_u32 s62, 64
s_cbranch_scc1 Lqk_35
s_waitcnt vmcnt(0)
s_endpgm
Lg_44:
s_mov_b64 exec, s[16:17]
buffer_load_dwordx4 v[160:163], v1, s[8:11], s32 offen offset:0 sc1
s_mov_b64 exec, s[18:19]
buffer_load_dwordx4 v[164:167], v1, s[8:11], s32 offen offset:1024 sc1
s_mov_b64 exec, s[20:21]
buffer_load_dwordx4 v[168:171], v1, s[8:11], s32 offen offset:2048 sc1
s_mov_b64 exec, -1
s_waitcnt vmcnt(0)
v_max3_u32 v172, v160, v161, v162
v_max3_u32 v173, v164, v165, v166
v_max3_u32 v174, v168, v169, v170
v_max_u32 v172, v172, v163
v_max_u32 v173, v173, v167
v_max_u32 v174, v174, v171
v_cmp_eq_u32 s[16:17], -1, v172
v_cmp_eq_u32 s[18:19], -1, v173
v_cmp_eq_u32 s[20:21], -1, v174
s_or_b64 s[28:29], s[16:17], s[18:19]
s_or_b64 s[28:29], s[28:29], s[20:21]
s_cbranch_scc0 Lg_45
s_cmp_eq_u32 s65, 0
s_cbranch_scc1 Lg_45
s_sub_u32 s65, s65, 1
s_branch Lg_44
Lg_46:
Lg_47:
s_mov_b64 exec, s[22:23]
buffer_load_dwordx4 v[136:139], v1, s[8:11], s33 offen offset:0 sc1
s_mov_b64 exec, s[24:25]
buffer_load_dwordx4 v[140:143], v1, s[8:11], s33 offen offset:1024 sc1
s_mov_b64 exec, s[26:27]
buffer_load_dwordx4 v[144:147], v1, s[8:11], s33 offen offset:2048 sc1
s_mov_b64 exec, -1
s_waitcnt vmcnt(0)
v_max3_u32 v172, v136, v137, v138
v_max3_u32 v173, v140, v141, v142
v_max3_u32 v174, v144, v145, v146
v_max_u32 v172, v172, v139
v_max_u32 v173, v173, v143
v_max_u32 v174, v174, v147
v_cmp_eq_u32 s[22:23], -1, v172
v_cmp_eq_u32 s[24:25], -1, v173
v_cmp_eq_u32 s[26:27], -1, v174
s_or_b64 s[28:29], s[22:23], s[24:25]
s_or_b64 s[28:29], s[28:29], s[26:27]
s_cbranch_scc0 Lg_48
s_cmp_eq_u32 s65, 0
s_cbranch_scc1 Lg_48
s_sub_u32 s65, s65, 1
s_branch Lg_47
Lw_17:
s_mov_b32 s62, 0
s_mov_b32 s52, 0x3dd53b95
s_mov_b32 s53, s52
s_mov_b32 s79, 0x42700000
s_mul_i32 s81, s63, 384
s_add_u32 s81, s81, 192950272
s_mov_b32 s82, 0
s_cmp_ge_u32 s82, 63
s_cbranch_scc1 Lnp_54
s_cmp_ge_u32 s82, 3
s_cbranch_scc1 Lk_55
s_sub_u32 s61, s82, 12
s_max_i32 s61, s61, 0
s_lshr_b32 s61, s61, 2
s_add_u32 s61, s61, s82
s_cmp_gt_u32 s60, s61
s_cbranch_scc1 Lfd_57
v_and_b32 v14, 15, v0
v_min_u32 v14, 2, v14
v_lshlrev_b32 v14, 7, v14
Lf_56:
buffer_load_dword v13, v14, s[8:11], s81 offen sc1
s_waitcnt vmcnt(0)
v_min_u32_dpp v13, v13, v13 row_ror:8 row_mask:0xf bank_mask:0xf
s_nop 1
v_min_u32_dpp v13, v13, v13 row_ror:4 row_mask:0xf bank_mask:0xf
s_nop 1
v_min_u32_dpp v13, v13, v13 row_ror:2 row_mask:0xf bank_mask:0xf
s_nop 1
v_min_u32_dpp v13, v13, v13 row_ror:1 row_mask:0xf bank_mask:0xf
s_nop 0
v_readfirstlane_b32 s60, v13
s_nop 0
s_cmp_gt_u32 s60, s61
s_cbranch_scc1 Lfd_57
s_cmp_eq_u32 s65, 0
s_cbranch_scc1 Lfd_57
s_sub_u32 s65, s65, 1
s_branch Lf_56
Lfd_57:
Lk_55:
s_lshl_b32 s67, s82, 5
s_add_u32 s67, s67, s63
s_mul_i32 s67, s67, 12288
s_add_u32 s67, s67, 29360128
s_add_u32 s68, s67, 4096
buffer_load_dwordx4 v[112:115], v1, s[8:11], s67 offen offset:0 sc1
buffer_load_dwordx4 v[116:119], v1, s[8:11], s67 offen offset:1024 sc1
buffer_load_dwordx4 v[120:123], v1, s[8:11], s67 offen offset:2048 sc1
buffer_load_dwordx4 v[124:127], v1, s[8:11], s67 offen offset:3072 sc1
buffer_load_dwordx4 v[128:131], v1, s[8:11], s68 offen offset:0 sc1
buffer_load_dwordx4 v[132:135], v1, s[8:11], s68 offen offset:1024 sc1
Lnp_54:
ds_read_b128 v[80:83], v4 offset:0
ds_read_b128 v[84:87], v4 offset:1024
ds_read_b128 v[88:91], v4 offset:2048
ds_read_b128 v[92:95], v4 offset:3072
ds_read_b128 v[96:99], v4 offset:4096
ds_read_b128 v[100:103], v4 offset:5120
ds_read_b128 v[104:107], v4 offset:6144
ds_read_b128 v[108:111], v4 offset:7168
v_mov_b64 v[56:57], 0
v_mov_b64 v[58:59], 0
v_mov_b64 v[60:61], 0
v_mov_b64 v[62:63], 0
v_mov_b64 v[64:65], 0
v_mov_b64 v[66:67], 0
v_mov_b64 v[68:69], 0
v_mov_b64 v[70:71], 0
v_mov_b64 v[72:73], 0
v_mov_b64 v[74:75], 0
v_mov_b64 v[76:77], 0
v_mov_b64 v[78:79], 0
ds_read_b128 v[16:19], v3 offset:6144
ds_read_b128 v[24:27], v3 offset:7168
s_waitcnt lgkmcnt(0)
s_branch Lqkent_50
Lqk_49:
s_barrier
s_add_u32 s82, s62, 0
s_cmp_ge_u32 s82, 63
s_cbranch_scc1 Lnp_61
s_cmp_ge_u32 s82, 3
s_cbranch_scc1 Lk_62
s_sub_u32 s61, s82, 12
s_max_i32 s61, s61, 0
s_lshr_b32 s61, s61, 2
s_add_u32 s61, s61, s82
s_cmp_gt_u32 s60, s61
s_cbranch_scc1 Lfd_64
v_and_b32 v14, 15, v0
v_min_u32 v14, 2, v14
v_lshlrev_b32 v14, 7, v14
Lf_63:
buffer_load_dword v13, v14, s[8:11], s81 offen sc1
s_waitcnt vmcnt(0)
v_min_u32_dpp v13, v13, v13 row_ror:8 row_mask:0xf bank_mask:0xf
s_nop 1
v_min_u32_dpp v13, v13, v13 row_ror:4 row_mask:0xf bank_mask:0xf
s_nop 1
v_min_u32_dpp v13, v13, v13 row_ror:2 row_mask:0xf bank_mask:0xf
s_nop 1
v_min_u32_dpp v13, v13, v13 row_ror:1 row_mask:0xf bank_mask:0xf
s_nop 0
v_readfirstlane_b32 s60, v13
s_nop 0
s_cmp_gt_u32 s60, s61
s_cbranch_scc1 Lfd_64
s_cmp_eq_u32 s65, 0
s_cbranch_scc1 Lfd_64
s_sub_u32 s65, s65, 1
s_branch Lf_63
Lfd_64:
Lk_62:
s_lshl_b32 s67, s82, 5
s_add_u32 s67, s67, s63
s_mul_i32 s67, s67, 12288
s_add_u32 s67, s67, 29360128
s_add_u32 s68, s67, 4096
buffer_load_dwordx4 v[112:115], v1, s[8:11], s67 offen offset:0 sc1
buffer_load_dwordx4 v[116:119], v1, s[8:11], s67 offen offset:1024 sc1
buffer_load_dwordx4 v[120:123], v1, s[8:11], s67 offen offset:2048 sc1
buffer_load_dwordx4 v[124:127], v1, s[8:11], s67 offen offset:3072 sc1
buffer_load_dwordx4 v[128:131], v1, s[8:11], s68 offen offset:0 sc1
buffer_load_dwordx4 v[132:135], v1, s[8:11], s68 offen offset:1024 sc1
Lnp_61:
ds_read_b128 v[80:83], v4 offset:0
ds_read_b128 v[84:87], v4 offset:1024
ds_read_b128 v[88:91], v4 offset:2048
ds_read_b128 v[92:95], v4 offset:3072
ds_read_b128 v[96:99], v4 offset:4096
ds_read_b128 v[100:103], v4 offset:5120
ds_read_b128 v[104:107], v4 offset:6144
ds_read_b128 v[108:111], v4 offset:7168
v_mov_b64 v[56:57], 0
v_mov_b64 v[58:59], 0
v_mov_b64 v[60:61], 0
v_mov_b64 v[62:63], 0
v_mov_b64 v[64:65], 0
v_mov_b64 v[66:67], 0
v_mov_b64 v[68:69], 0
v_mov_b64 v[70:71], 0
v_mov_b64 v[72:73], 0
v_mov_b64 v[74:75], 0
v_mov_b64 v[76:77], 0
v_mov_b64 v[78:79], 0
s_add_u32 s67, s62, 0
s_and_b32 s67, s67, 3
s_lshl_b32 s67, s67, 1
s_lshl_b32 s68, s67, 15
s_add_u32 s67, s67, s64
s_mul_i32 s67, s67, 10240
s_add_u32 s33, s68, s58
s_add_u32 s32, s67, s80
s_add_u32 s32, s32, 191889408
s_sleep 9
v_mov_b32 v175, 0
s_waitcnt lgkmcnt(0)
buffer_load_dwordx4 v[160:163], v1, s[8:11], s32 offen offset:0 sc1
buffer_load_dwordx4 v[164:167], v1, s[8:11], s32 offen offset:1024 sc1
s_waitcnt vmcnt(0)
v_max3_u32 v172, v160, v161, v162
v_max3_u32 v173, v164, v165, v166
v_max_u32 v172, v172, v163
v_max_u32 v173, v173, v167
v_cmp_eq_u32 s[16:17], -1, v172
v_cmp_eq_u32 s[18:19], -1, v173
s_nop 0
s_or_b64 s[28:29], s[16:17], s[18:19]
s_cbranch_scc1 Lg_65
Lg_66:
buffer_load_dwordx4 v[136:139], v1, s[8:11], s33 offen offset:0 sc1
buffer_load_dwordx4 v[140:143], v1, s[8:11], s33 offen offset:1024 sc1
v_lshlrev_b32 v16, 16, v160
v_and_b32 v17, 0xffff0000, v160
v_lshlrev_b32 v18, 16, v161
v_and_b32 v19, 0xffff0000, v161
v_lshlrev_b32 v20, 16, v162
v_and_b32 v21, 0xffff0000, v162
v_lshlrev_b32 v22, 16, v163
v_and_b32 v23, 0xffff0000, v163
v_lshlrev_b32 v24, 16, v164
v_and_b32 v25, 0xffff0000, v164
v_lshlrev_b32 v26, 16, v165
v_and_b32 v27, 0xffff0000, v165
v_lshlrev_b32 v28, 16, v166
v_and_b32 v29, 0xffff0000, v166
v_lshlrev_b32 v30, 16, v167
v_and_b32 v31, 0xffff0000, v167
s_waitcnt vmcnt(0)
v_max3_u32 v172, v136, v137, v138
v_max3_u32 v173, v140, v141, v142
v_max_u32 v172, v172, v139
v_max_u32 v173, v173, v143
v_cmp_eq_u32 s[22:23], -1, v172
v_cmp_eq_u32 s[24:25], -1, v173
s_nop 0
s_or_b64 s[28:29], s[22:23], s[24:25]
s_cbranch_scc1 Lg_67
Lg_69:
v_dot2c_f32_bf16 v16, s100, v136
v_dot2c_f32_bf16 v17, s101, v136
v_dot2c_f32_bf16 v18, s100, v137
v_dot2c_f32_bf16 v19, s101, v137
v_dot2c_f32_bf16 v20, s100, v138
v_dot2c_f32_bf16 v21, s101, v138
v_dot2c_f32_bf16 v22, s100, v139
v_dot2c_f32_bf16 v23, s101, v139
v_cvt_pk_bf16_f32 v16, v16, v17
v_cvt_pk_bf16_f32 v17, v18, v19
v_cvt_pk_bf16_f32 v18, v20, v21
v_cvt_pk_bf16_f32 v19, v22, v23
ds_write_b128 v2, v[16:19] offset:0
v_dot2c_f32_bf16 v24, s100, v140
v_dot2c_f32_bf16 v25, s101, v140
v_dot2c_f32_bf16 v26, s100, v141
v_dot2c_f32_bf16 v27, s101, v141
v_dot2c_f32_bf16 v28, s100, v142
v_dot2c_f32_bf16 v29, s101, v142
v_dot2c_f32_bf16 v30, s100, v143
v_dot2c_f32_bf16 v31, s101, v143
v_cvt_pk_bf16_f32 v24, v24, v25
v_cvt_pk_bf16_f32 v25, v26, v27
v_cvt_pk_bf16_f32 v26, v28, v29
v_cvt_pk_bf16_f32 v27, v30, v31
ds_write_b128 v2, v[24:27] offset:1024
Lqkent_50:
v_smfmac_f32_16x16x64_bf16 v[56:59], v[16:19], a[32:39], v8
v_smfmac_f32_16x16x64_bf16 v[60:63], v[16:19], a[88:95], v8
v_smfmac_f32_16x16x64_bf16 v[64:67], v[16:19], a[144:151], v8
v_smfmac_f32_16x16x64_bf16 v[56:59], v[24:27], a[40:47], v8
s_waitcnt lgkmcnt(0)
s_barrier
ds_read_b128 v[20:23], v3 offset:2048
v_smfmac_f32_16x16x64_bf16 v[60:63], v[24:27], a[96:103], v8
ds_read_b128 v[28:31], v3 offset:0
v_smfmac_f32_16x16x64_bf16 v[64:67], v[24:27], a[152:159], v8
ds_read_b128 v[32:35], v3 offset:1024
s_waitcnt lgkmcnt(2)
v_mov_b32 v170, 0
v_smfmac_f32_16x16x64_bf16 v[56:59], v[20:23], v[80:87], v8
ds_read_b128 v[36:39], v3 offset:5120
v_smfmac_f32_16x16x64_bf16 v[60:63], v[20:23], v[88:95], v8
ds_read_b128 v[40:43], v3 offset:3072
ds_read_b128 v[80:83], v4 offset:8192
v_smfmac_f32_16x16x64_bf16 v[64:67], v[20:23], v[96:103], v8
ds_read_b128 v[44:47], v3 offset:4096
ds_read_b128 v[84:87], v4 offset:9216
s_waitcnt lgkmcnt(6)
v_smfmac_f32_16x16x64_bf16 v[56:59], v[28:31], a[0:7], v8
ds_read_b128 v[48:51], v3 offset:9216
v_smfmac_f32_16x16x64_bf16 v[60:63], v[28:31], a[56:63], v8
ds_read_b128 v[52:55], v3 offset:8192
v_smfmac_f32_16x16x64_bf16 v[64:67], v[28:31], a[112:119], v8
ds_read_b128 v[88:91], v4 offset:10240
ds_read_b128 v[92:95], v4 offset:11264
s_waitcnt lgkmcnt(9)
v_smfmac_f32_16x16x64_bf16 v[56:59], v[32:35], a[8:15], v8
ds_read_b128 v[96:99], v4 offset:12288
v_smfmac_f32_16x16x64_bf16 v[60:63], v[32:35], a[64:71], v8
ds_read_b128 v[100:103], v4 offset:13312
v_smfmac_f32_16x16x64_bf16 v[64:67], v[32:35], a[120:127], v8
s_waitcnt lgkmcnt(10)
v_smfmac_f32_16x16x64_bf16 v[56:59], v[36:39], v[104:111], v8
ds_read_b128 v[104:107], v4 offset:14336
s_waitcnt lgkmcnt(7)
v_smfmac_f32_16x16x64_bf16 v[60:63], v[36:39], v[80:87], v8
ds_read_b128 v[108:111], v4 offset:15360
s_waitcnt lgkmcnt(4)
v_smfmac_f32_16x16x64_bf16 v[64:67], v[36:39], v[88:95], v8
ds_read_b128 v[80:83], v4 offset:16384
v_smfmac_f32_16x16x64_bf16 v[56:59], v[40:43], a[16:23], v8
ds_read_b128 v[84:87], v4 offset:17408
v_smfmac_f32_16x16x64_bf16 v[56:59], v[44:47], a[24:31], v8
ds_read_b128 v[88:91], v4 offset:18432
s_waitcnt lgkmcnt(5)
v_smfmac_f32_16x16x64_bf16 v[56:59], v[48:51], v[96:103], v8
ds_read_b128 v[92:95], v4 offset:19456
v_smfmac_f32_16x16x64_bf16 v[56:59], v[52:55], a[48:55], v8
ds_read_b128 v[96:99], v4 offset:24576
v_smfmac_f32_16x16x64_bf16 v[60:63], v[40:43], a[72:79], v8
ds_read_b128 v[100:103], v4 offset:25600
v_smfmac_f32_16x16x64_bf16 v[60:63], v[44:47], a[80:87], v8
s_waitcnt lgkmcnt(6)
v_add_f32 v56, v56, v58
v_smfmac_f32_16x16x64_bf16 v[60:63], v[48:51], v[104:111], v8
ds_read_b128 v[104:107], v4 offset:30720
v_add_f32 v57, v57, v59
v_smfmac_f32_16x16x64_bf16 v[60:63], v[52:55], a[104:111], v8
ds_read_b128 v[108:111], v4 offset:31744
v_cvt_pk_bf16_f32 v56, v56, v57
v_smfmac_f32_16x16x64_bf16 v[64:67], v[40:43], a[128:135], v8
ds_write_b32 v5, v56 offset:12736
v_smfmac_f32_16x16x64_bf16 v[64:67], v[44:47], a[136:143], v8
s_waitcnt lgkmcnt(7)
v_add_f32 v60, v60, v62
v_smfmac_f32_16x16x64_bf16 v[64:67], v[48:51], v[80:87], v8
ds_read_b128 v[80:83], v4 offset:20480
v_add_f32 v61, v61, v63
v_smfmac_f32_16x16x64_bf16 v[64:67], v[52:55], a[160:167], v8
ds_read_b128 v[84:87], v4 offset:21504
v_cvt_pk_bf16_f32 v60, v60, v61
v_smfmac_f32_16x16x64_bf16 v[68:71], v[28:31], a[168:175], v8
ds_write_b32 v5, v60 offset:13760
s_waitcnt lgkmcnt(8)
v_smfmac_f32_16x16x64_bf16 v[68:71], v[20:23], v[88:95], v8
ds_read_b128 v[88:91], v4 offset:26624
v_add_f32 v64, v64, v66
v_add_f32 v65, v65, v67
v_smfmac_f32_16x16x64_bf16 v[68:71], v[32:35], a[176:183], v8
ds_read_b128 v[92:95], v4 offset:27648
v_cvt_pk_bf16_f32 v64, v64, v65
v_smfmac_f32_16x16x64_bf16 v[68:71], v[40:43], a[184:191], v8
ds_write_b32 v5, v64 offset:14784
s_waitcnt lgkmcnt(9)
v_smfmac_f32_16x16x64_bf16 v[68:71], v[36:39], v[96:103], v8
ds_read_b128 v[96:99], v4 offset:32768
v_smfmac_f32_16x16x64_bf16 v[68:71], v[44:47], a[192:199], v8
ds_read_b128 v[100:103], v4 offset:33792
v_smfmac_f32_16x16x64_bf16 v[68:71], v[16:19], a[200:207], v8
s_waitcnt lgkmcnt(9)
v_smfmac_f32_16x16x64_bf16 v[68:71], v[48:51], v[104:111], v8
ds_read_b128 v[104:107], v4 offset:22528
v_smfmac_f32_16x16x64_bf16 v[68:71], v[24:27], a[208:215], v8
s_waitcnt vmcnt(0)
s_waitcnt lgkmcnt(3)
s_barrier
ds_read_b64_tr_b16 v[136:137], v7 offset:12736
ds_read_b64_tr_b16 v[138:139], v7 offset:12992
v_smfmac_f32_16x16x64_bf16 v[68:71], v[52:55], a[216:223], v8
ds_read_b64_tr_b16 v[140:141], v7 offset:13248
v_smfmac_f32_16x16x64_bf16 v[72:75], v[28:31], a[224:231], v8
ds_read_b64_tr_b16 v[142:143], v7 offset:13504
v_smfmac_f32_16x16x64_bf16 v[72:75], v[20:23], v[80:87], v8
ds_read_b64_tr_b16 v[144:145], v7 offset:13760
v_add_f32 v68, v68, v70
v_smfmac_f32_16x16x64_bf16 v[72:75], v[32:35], a[232:239], v8
ds_read_b64_tr_b16 v[146:147], v7 offset:14016
v_add_f32 v69, v69, v71
v_smfmac_f32_16x16x64_bf16 v[72:75], v[40:43], a[240:247], v8
ds_read_b64_tr_b16 v[148:149], v7 offset:14272
ds_read_b64_tr_b16 v[150:151], v7 offset:14528
v_cvt_pk_bf16_f32 v68, v68, v69
v_smfmac_f32_16x16x64_bf16 v[72:75], v[36:39], v[88:95], v8
ds_read_b64_tr_b16 v[152:153], v7 offset:14784
ds_write_b32 v5, v68 offset:0
v_smfmac_f32_16x16x64_bf16 v[72:75], v[44:47], a[248:255], v8
ds_read_b64_tr_b16 v[154:155], v7 offset:15040
v_smfmac_f32_16x16x64_bf16 v[72:75], v[16:19], v[176:183], v8
ds_read_b64_tr_b16 v[156:157], v7 offset:15296
s_waitcnt lgkmcnt(13)
v_smfmac_f32_16x16x64_bf16 v[72:75], v[48:51], v[96:103], v8
ds_read_b64_tr_b16 v[158:159], v7 offset:15552
v_smfmac_f32_16x16x64_bf16 v[72:75], v[24:27], v[184:191], v8
ds_read_b128 v[108:111], v4 offset:23552
v_smfmac_f32_16x16x64_bf16 v[72:75], v[52:55], v[192:199], v8
ds_read_b128 v[80:83], v4 offset:28672
s_waitcnt lgkmcnt(13)
v_mfma_f32_16x16x32_bf16 v[160:163], v[112:115], v[136:139], 0
ds_read_b128 v[84:87], v4 offset:29696
s_waitcnt lgkmcnt(12)
v_mfma_f32_16x16x32_bf16 v[160:163], v[116:119], v[140:143], v[160:163]
ds_read_b128 v[88:91], v4 offset:34816
s_waitcnt lgkmcnt(11)
v_add_f32 v72, v72, v74
v_mfma_f32_16x16x32_bf16 v[160:163], v[120:123], v[144:147], v[160:163]
ds_read_b128 v[92:95], v4 offset:35840
s_waitcnt lgkmcnt(10)
v_add_f32 v73, v73, v75
v_mfma_f32_16x16x32_bf16 v[160:163], v[124:127], v[148:151], v[160:163]
s_waitcnt lgkmcnt(7)
v_cvt_pk_bf16_f32 v72, v72, v73
v_mfma_f32_16x16x32_bf16 v[160:163], v[128:131], v[152:155], v[160:163]
ds_write_b32 v5, v72 offset:1024
s_waitcnt lgkmcnt(6)
v_mfma_f32_16x16x32_bf16 v[160:163], v[132:135], v[156:159], v[160:163]
v_smfmac_f32_16x16x64_bf16 v[76:79], v[28:31], v[200:207], v8
s_waitcnt lgkmcnt(5)
v_smfmac_f32_16x16x64_bf16 v[76:79], v[20:23], v[104:111], v8
v_cndmask_b32 v164, v160, v162, s[70:71]
v_cndmask_b32 v165, v161, v163, s[70:71]
v_smfmac_f32_16x16x64_bf16 v[76:79], v[32:35], v[208:215], v8
s_waitcnt lgkmcnt(0)
s_barrier
v_mul_f32 v164, s52, v164
v_mul_f32 v165, s52, v165
v_smfmac_f32_16x16x64_bf16 v[76:79], v[40:43], v[216:223], v8
v_exp_f32 v168, v164
v_smfmac_f32_16x16x64_bf16 v[76:79], v[36:39], v[80:87], v8
v_exp_f32 v169, v165
v_smfmac_f32_16x16x64_bf16 v[76:79], v[44:47], v[224:231], v8
v_max_f32 v172, |v164|, |v165|
v_smfmac_f32_16x16x64_bf16 v[76:79], v[16:19], v[232:239], v8
v_add_f32 v171, v168, v169
v_smfmac_f32_16x16x64_bf16 v[76:79], v[48:51], v[88:95], v8
v_cmp_lt_f32 vcc, s79, v172
v_smfmac_f32_16x16x64_bf16 v[76:79], v[24:27], v[240:247], v8
s_cbranch_vccnz Lsx_52
Lsxb_53:
ds_write_b128 v11, v[168:171] offset:0
v_smfmac_f32_16x16x64_bf16 v[76:79], v[52:55], v[248:255], v8
s_nop 7
v_pk_add_f32 v[76:77], v[76:77], v[78:79]
v_cvt_pk_bf16_f32 v76, v76, v77
ds_write_b32 v5, v76 offset:2048
s_waitcnt lgkmcnt(0)
s_barrier
s_add_u32 s62, s62, 1
s_cmp_lt_u32 s62, 64
s_cbranch_scc1 Lqk_49
s_waitcnt vmcnt(0)
s_endpgm
Lg_65:
s_mov_b64 exec, s[16:17]
buffer_load_dwordx4 v[160:163], v1, s[8:11], s32 offen offset:0 sc1
s_mov_b64 exec, s[18:19]
buffer_load_dwordx4 v[164:167], v1, s[8:11], s32 offen offset:1024 sc1
s_mov_b64 exec, -1
s_waitcnt vmcnt(0)
v_max3_u32 v172, v160, v161, v162
v_max3_u32 v173, v164, v165, v166
v_max_u32 v172, v172, v163
v_max_u32 v173, v173, v167
v_cmp_eq_u32 s[16:17], -1, v172
v_cmp_eq_u32 s[18:19], -1, v173
s_nop 0
s_or_b64 s[28:29], s[16:17], s[18:19]
s_cbranch_scc0 Lg_66
s_cmp_eq_u32 s65, 0
s_cbranch_scc1 Lg_66
s_sub_u32 s65, s65, 1
s_branch Lg_65
Lg_67:
Lg_68:
s_mov_b64 exec, s[22:23]
buffer_load_dwordx4 v[136:139], v1, s[8:11], s33 offen offset:0 sc1
s_mov_b64 exec, s[24:25]
buffer_load_dwordx4 v[140:143], v1, s[8:11], s33 offen offset:1024 sc1
s_mov_b64 exec, -1
s_waitcnt vmcnt(0)
v_max3_u32 v172, v136, v137, v138
v_max3_u32 v173, v140, v141, v142
v_max_u32 v172, v172, v139
v_max_u32 v173, v173, v143
v_cmp_eq_u32 s[22:23], -1, v172
v_cmp_eq_u32 s[24:25], -1, v173
s_nop 0
s_or_b64 s[28:29], s[22:23], s[24:25]
s_cbranch_scc0 Lg_69
s_cmp_eq_u32 s65, 0
s_cbranch_scc1 Lg_69
s_sub_u32 s65, s65, 1
s_branch Lg_68
Lsx_52:
v_max_f32 v170, v164, v165
s_nop 1
v_max_f32_dpp v170, v170, v170 row_ror:8 row_mask:0xf bank_mask:0xf
v_mov_b32 v172, v170
s_nop 1
v_permlane16_swap_b32 v170, v172
v_max_f32 v170, v170, v172
v_mov_b32 v172, v170
s_nop 1
v_permlane32_swap_b32 v170, v172
v_max_f32 v170, v170, v172
v_sub_f32 v168, v164, v170
v_sub_f32 v169, v165, v170
v_exp_f32 v168, v168
v_exp_f32 v169, v169
s_nop 0
v_add_f32 v171, v168, v169
s_branch Lsxb_53
Lw_18:
s_mov_b32 s62, 0
s_mov_b32 s52, 0x3dd53b95
s_mov_b32 s53, s52
s_mov_b32 s79, 0x42700000
s_mul_i32 s81, s63, 384
s_add_u32 s81, s81, 192950272
s_mov_b32 s82, 0
s_cmp_ge_u32 s82, 63
s_cbranch_scc1 Lnp_75
s_cmp_ge_u32 s82, 3
s_cbranch_scc1 Lk_76
s_sub_u32 s61, s82, 12
s_max_i32 s61, s61, 0
s_lshr_b32 s61, s61, 2
s_add_u32 s61, s61, s82
s_cmp_gt_u32 s60, s61
s_cbranch_scc1 Lfd_78
v_and_b32 v14, 15, v0
v_min_u32 v14, 2, v14
v_lshlrev_b32 v14, 7, v14
Lf_77:
buffer_load_dword v13, v14, s[8:11], s81 offen sc1
s_waitcnt vmcnt(0)
v_min_u32_dpp v13, v13, v13 row_ror:8 row_mask:0xf bank_mask:0xf
s_nop 1
v_min_u32_dpp v13, v13, v13 row_ror:4 row_mask:0xf bank_mask:0xf
s_nop 1
v_min_u32_dpp v13, v13, v13 row_ror:2 row_mask:0xf bank_mask:0xf
s_nop 1
v_min_u32_dpp v13, v13, v13 row_ror:1 row_mask:0xf bank_mask:0xf
s_nop 0
v_readfirstlane_b32 s60, v13
s_nop 0
s_cmp_gt_u32 s60, s61
s_cbranch_scc1 Lfd_78
s_cmp_eq_u32 s65, 0
s_cbranch_scc1 Lfd_78
s_sub_u32 s65, s65, 1
s_branch Lf_77
Lfd_78:
Lk_76:
s_lshl_b32 s67, s82, 5
s_add_u32 s67, s67, s63
s_mul_i32 s67, s67, 12288
s_add_u32 s67, s67, 29366272
s_add_u32 s68, s67, 4096
buffer_load_dwordx4 v[112:115], v1, s[8:11], s67 offen offset:0 sc1
buffer_load_dwordx4 v[116:119], v1, s[8:11], s67 offen offset:1024 sc1
buffer_load_dwordx4 v[120:123], v1, s[8:11], s67 offen offset:2048 sc1
buffer_load_dwordx4 v[124:127], v1, s[8:11], s67 offen offset:3072 sc1
buffer_load_dwordx4 v[128:131], v1, s[8:11], s68 offen offset:0 sc1
buffer_load_dwordx4 v[132:135], v1, s[8:11], s68 offen offset:1024 sc1
Lnp_75:
ds_read_b128 v[80:83], v4 offset:12288
ds_read_b128 v[84:87], v4 offset:13312
ds_read_b128 v[88:91], v4 offset:14336
ds_read_b128 v[92:95], v4 offset:15360
ds_read_b128 v[96:99], v4 offset:16384
ds_read_b128 v[100:103], v4 offset:17408
ds_read_b128 v[104:107], v4 offset:0
ds_read_b128 v[108:111], v4 offset:1024
v_mov_b64 v[56:57], 0
v_mov_b64 v[58:59], 0
v_mov_b64 v[60:61], 0
v_mov_b64 v[62:63], 0
v_mov_b64 v[64:65], 0
v_mov_b64 v[66:67], 0
v_mov_b64 v[68:69], 0
v_mov_b64 v[70:71], 0
v_mov_b64 v[72:73], 0
v_mov_b64 v[74:75], 0
v_mov_b64 v[76:77], 0
v_mov_b64 v[78:79], 0
ds_read_b128 v[16:19], v3 offset:8192
ds_read_b128 v[24:27], v3 offset:9216
s_waitcnt lgkmcnt(0)
s_branch Lqkent_71
Lqk_70:
s_barrier
s_add_u32 s82, s62, 0
s_cmp_ge_u32 s82, 63
s_cbranch_scc1 Lnp_82
s_cmp_ge_u32 s82, 3
s_cbranch_scc1 Lk_83
s_sub_u32 s61, s82, 12
s_max_i32 s61, s61, 0
s_lshr_b32 s61, s61, 2
s_add_u32 s61, s61, s82
s_cmp_gt_u32 s60, s61
s_cbranch_scc1 Lfd_85
v_and_b32 v14, 15, v0
v_min_u32 v14, 2, v14
v_lshlrev_b32 v14, 7, v14
Lf_84:
buffer_load_dword v13, v14, s[8:11], s81 offen sc1
s_waitcnt vmcnt(0)
v_min_u32_dpp v13, v13, v13 row_ror:8 row_mask:0xf bank_mask:0xf
s_nop 1
v_min_u32_dpp v13, v13, v13 row_ror:4 row_mask:0xf bank_mask:0xf
s_nop 1
v_min_u32_dpp v13, v13, v13 row_ror:2 row_mask:0xf bank_mask:0xf
s_nop 1
v_min_u32_dpp v13, v13, v13 row_ror:1 row_mask:0xf bank_mask:0xf
s_nop 0
v_readfirstlane_b32 s60, v13
s_nop 0
s_cmp_gt_u32 s60, s61
s_cbranch_scc1 Lfd_85
s_cmp_eq_u32 s65, 0
s_cbranch_scc1 Lfd_85
s_sub_u32 s65, s65, 1
s_branch Lf_84
Lfd_85:
Lk_83:
s_lshl_b32 s67, s82, 5
s_add_u32 s67, s67, s63
s_mul_i32 s67, s67, 12288
s_add_u32 s67, s67, 29366272
s_add_u32 s68, s67, 4096
buffer_load_dwordx4 v[112:115], v1, s[8:11], s67 offen offset:0 sc1
buffer_load_dwordx4 v[116:119], v1, s[8:11], s67 offen offset:1024 sc1
buffer_load_dwordx4 v[120:123], v1, s[8:11], s67 offen offset:2048 sc1
buffer_load_dwordx4 v[124:127], v1, s[8:11], s67 offen offset:3072 sc1
buffer_load_dwordx4 v[128:131], v1, s[8:11], s68 offen offset:0 sc1
buffer_load_dwordx4 v[132:135], v1, s[8:11], s68 offen offset:1024 sc1
Lnp_82:
ds_read_b128 v[80:83], v4 offset:12288
ds_read_b128 v[84:87], v4 offset:13312
ds_read_b128 v[88:91], v4 offset:14336
ds_read_b128 v[92:95], v4 offset:15360
ds_read_b128 v[96:99], v4 offset:16384
ds_read_b128 v[100:103], v4 offset:17408
ds_read_b128 v[104:107], v4 offset:0
ds_read_b128 v[108:111], v4 offset:1024
v_mov_b64 v[56:57], 0
v_mov_b64 v[58:59], 0
v_mov_b64 v[60:61], 0
v_mov_b64 v[62:63], 0
v_mov_b64 v[64:65], 0
v_mov_b64 v[66:67], 0
v_mov_b64 v[68:69], 0
v_mov_b64 v[70:71], 0
v_mov_b64 v[72:73], 0
v_mov_b64 v[74:75], 0
v_mov_b64 v[76:77], 0
v_mov_b64 v[78:79], 0
s_add_u32 s67, s62, 0
s_and_b32 s67, s67, 3
s_lshl_b32 s67, s67, 1
s_lshl_b32 s68, s67, 15
s_add_u32 s67, s67, s64
s_mul_i32 s67, s67, 10240
s_add_u32 s33, s68, s58
s_add_u32 s32, s67, s80
s_add_u32 s32, s32, 191889408
s_sleep 9
v_mov_b32 v175, 0
s_waitcnt lgkmcnt(0)
buffer_load_dwordx4 v[160:163], v1, s[8:11], s32 offen offset:0 sc1
buffer_load_dwordx4 v[164:167], v1, s[8:11], s32 offen offset:1024 sc1
s_waitcnt vmcnt(0)
v_max3_u32 v172, v160, v161, v162
v_max3_u32 v173, v164, v165, v166
v_max_u32 v172, v172, v163
v_max_u32 v173, v173, v167
v_cmp_eq_u32 s[16:17], -1, v172
v_cmp_eq_u32 s[18:19], -1, v173
s_nop 0
s_or_b64 s[28:29], s[16:17], s[18:19]
s_cbranch_scc1 Lg_86
Lg_87:
buffer_load_dwordx4 v[136:139], v1, s[8:11], s33 offen offset:0 sc1
buffer_load_dwordx4 v[140:143], v1, s[8:11], s33 offen offset:1024 sc1
v_lshlrev_b32 v16, 16, v160
v_and_b32 v17, 0xffff0000, v160
v_lshlrev_b32 v18, 16, v161
v_and_b32 v19, 0xffff0000, v161
v_lshlrev_b32 v20, 16, v162
v_and_b32 v21, 0xffff0000, v162
v_lshlrev_b32 v22, 16, v163
v_and_b32 v23, 0xffff0000, v163
v_lshlrev_b32 v24, 16, v164
v_and_b32 v25, 0xffff0000, v164
v_lshlrev_b32 v26, 16, v165
v_and_b32 v27, 0xffff0000, v165
v_lshlrev_b32 v28, 16, v166
v_and_b32 v29, 0xffff0000, v166
v_lshlrev_b32 v30, 16, v167
v_and_b32 v31, 0xffff0000, v167
s_waitcnt vmcnt(0)
v_max3_u32 v172, v136, v137, v138
v_max3_u32 v173, v140, v141, v142
v_max_u32 v172, v172, v139
v_max_u32 v173, v173, v143
v_cmp_eq_u32 s[22:23], -1, v172
v_cmp_eq_u32 s[24:25], -1, v173
s_nop 0
s_or_b64 s[28:29], s[22:23], s[24:25]
s_cbranch_scc1 Lg_88
Lg_90:
v_dot2c_f32_bf16 v16, s100, v136
v_dot2c_f32_bf16 v17, s101, v136
v_dot2c_f32_bf16 v18, s100, v137
v_dot2c_f32_bf16 v19, s101, v137
v_dot2c_f32_bf16 v20, s100, v138
v_dot2c_f32_bf16 v21, s101, v138
v_dot2c_f32_bf16 v22, s100, v139
v_dot2c_f32_bf16 v23, s101, v139
v_cvt_pk_bf16_f32 v16, v16, v17
v_cvt_pk_bf16_f32 v17, v18, v19
v_cvt_pk_bf16_f32 v18, v20, v21
v_cvt_pk_bf16_f32 v19, v22, v23
ds_write_b128 v2, v[16:19] offset:0
v_dot2c_f32_bf16 v24, s100, v140
v_dot2c_f32_bf16 v25, s101, v140
v_dot2c_f32_bf16 v26, s100, v141
v_dot2c_f32_bf16 v27, s101, v141
v_dot2c_f32_bf16 v28, s100, v142
v_dot2c_f32_bf16 v29, s101, v142
v_dot2c_f32_bf16 v30, s100, v143
v_dot2c_f32_bf16 v31, s101, v143
v_cvt_pk_bf16_f32 v24, v24, v25
v_cvt_pk_bf16_f32 v25, v26, v27
v_cvt_pk_bf16_f32 v26, v28, v29
v_cvt_pk_bf16_f32 v27, v30, v31
ds_write_b128 v2, v[24:27] offset:1024
Lqkent_71:
v_smfmac_f32_16x16x64_bf16 v[56:59], v[16:19], a[48:55], v8
v_smfmac_f32_16x16x64_bf16 v[60:63], v[16:19], a[104:111], v8
v_smfmac_f32_16x16x64_bf16 v[64:67], v[16:19], a[160:167], v8
v_smfmac_f32_16x16x64_bf16 v[56:59], v[24:27], v[80:87], v8
s_waitcnt lgkmcnt(0)
s_barrier
ds_read_b128 v[20:23], v3 offset:0
v_smfmac_f32_16x16x64_bf16 v[60:63], v[24:27], v[88:95], v8
ds_read_b128 v[28:31], v3 offset:1024
ds_read_b128 v[80:83], v4 offset:2048
v_smfmac_f32_16x16x64_bf16 v[64:67], v[24:27], v[96:103], v8
ds_read_b128 v[32:35], v3 offset:2048
ds_read_b128 v[84:87], v4 offset:3072
ds_read_b128 v[88:91], v4 offset:4096
s_waitcnt lgkmcnt(5)
v_mov_b32 v170, 0
v_smfmac_f32_16x16x64_bf16 v[56:59], v[20:23], a[0:7], v8
ds_read_b128 v[36:39], v3 offset:3072
ds_read_b128 v[92:95], v4 offset:5120
v_smfmac_f32_16x16x64_bf16 v[60:63], v[20:23], a[56:63], v8
ds_read_b128 v[40:43], v3 offset:4096
v_smfmac_f32_16x16x64_bf16 v[64:67], v[20:23], a[112:119], v8
ds_read_b128 v[44:47], v3 offset:6144
s_waitcnt lgkmcnt(8)
v_smfmac_f32_16x16x64_bf16 v[56:59], v[28:31], a[8:15], v8
ds_read_b128 v[48:51], v3 offset:5120
v_smfmac_f32_16x16x64_bf16 v[60:63], v[28:31], a[64:71], v8
ds_read_b128 v[52:55], v3 offset:7168
v_smfmac_f32_16x16x64_bf16 v[64:67], v[28:31], a[120:127], v8
ds_read_b128 v[96:99], v4 offset:6144
s_waitcnt lgkmcnt(9)
v_smfmac_f32_16x16x64_bf16 v[56:59], v[32:35], v[104:111], v8
ds_read_b128 v[100:103], v4 offset:7168
s_waitcnt lgkmcnt(9)
v_smfmac_f32_16x16x64_bf16 v[60:63], v[32:35], v[80:87], v8
ds_read_b128 v[104:107], v4 offset:8192
s_waitcnt lgkmcnt(7)
v_smfmac_f32_16x16x64_bf16 v[64:67], v[32:35], v[88:95], v8
ds_read_b128 v[108:111], v4 offset:9216
v_smfmac_f32_16x16x64_bf16 v[56:59], v[36:39], a[16:23], v8
ds_read_b128 v[80:83], v4 offset:10240
v_smfmac_f32_16x16x64_bf16 v[60:63], v[36:39], a[72:79], v8
ds_read_b128 v[84:87], v4 offset:11264
v_smfmac_f32_16x16x64_bf16 v[64:67], v[36:39], a[128:135], v8
ds_read_b128 v[88:91], v4 offset:18432
s_waitcnt lgkmcnt(10)
v_smfmac_f32_16x16x64_bf16 v[56:59], v[40:43], a[24:31], v8
ds_read_b128 v[92:95], v4 offset:19456
s_waitcnt lgkmcnt(10)
v_smfmac_f32_16x16x64_bf16 v[56:59], v[44:47], a[32:39], v8
s_waitcnt lgkmcnt(6)
v_smfmac_f32_16x16x64_bf16 v[56:59], v[48:51], v[96:103], v8
ds_read_b128 v[96:99], v4 offset:24576
v_smfmac_f32_16x16x64_bf16 v[56:59], v[52:55], a[40:47], v8
ds_read_b128 v[100:103], v4 offset:25600
v_smfmac_f32_16x16x64_bf16 v[60:63], v[40:43], a[80:87], v8
v_smfmac_f32_16x16x64_bf16 v[60:63], v[44:47], a[88:95], v8
s_waitcnt lgkmcnt(6)
v_add_f32 v56, v56, v58
v_smfmac_f32_16x16x64_bf16 v[60:63], v[48:51], v[104:111], v8
ds_read_b128 v[104:107], v4 offset:30720
v_add_f32 v57, v57, v59
v_smfmac_f32_16x16x64_bf16 v[60:63], v[52:55], a[96:103], v8
ds_read_b128 v[108:111], v4 offset:31744
v_cvt_pk_bf16_f32 v56, v56, v57
v_smfmac_f32_16x16x64_bf16 v[64:67], v[40:43], a[136:143], v8
ds_write_b32 v5, v56 offset:12736
v_smfmac_f32_16x16x64_bf16 v[64:67], v[44:47], a[144:151], v8
s_waitcnt lgkmcnt(7)
v_add_f32 v60, v60, v62
v_smfmac_f32_16x16x64_bf16 v[64:67], v[48:51], v[80:87], v8
ds_read_b128 v[80:83], v4 offset:20480
v_add_f32 v61, v61, v63
v_smfmac_f32_16x16x64_bf16 v[64:67], v[52:55], a[152:159], v8
ds_read_b128 v[84:87], v4 offset:21504
v_cvt_pk_bf16_f32 v60, v60, v61
v_smfmac_f32_16x16x64_bf16 v[68:71], v[20:23], a[168:175], v8
ds_write_b32 v5, v60 offset:13760
s_waitcnt lgkmcnt(8)
v_smfmac_f32_16x16x64_bf16 v[68:71], v[32:35], v[88:95], v8
ds_read_b128 v[88:91], v4 offset:26624
v_add_f32 v64, v64, v66
v_add_f32 v65, v65, v67
v_smfmac_f32_16x16x64_bf16 v[68:71], v[28:31], a[176:183], v8
ds_read_b128 v[92:95], v4 offset:27648
v_cvt_pk_bf16_f32 v64, v64, v65
v_smfmac_f32_16x16x64_bf16 v[68:71], v[36:39], a[184:191], v8
ds_write_b32 v5, v64 offset:14784
s_waitcnt lgkmcnt(9)
v_smfmac_f32_16x16x64_bf16 v[68:71], v[48:51], v[96:103], v8
ds_read_b128 v[96:99], v4 offset:32768
v_smfmac_f32_16x16x64_bf16 v[68:71], v[40:43], a[192:199], v8
ds_read_b128 v[100:103], v4 offset:33792
v_smfmac_f32_16x16x64_bf16 v[68:71], v[44:47], a[200:207], v8
s_waitcnt lgkmcnt(9)
v_smfmac_f32_16x16x64_bf16 v[68:71], v[24:27], v[104:111], v8
ds_read_b128 v[104:107], v4 offset:22528
v_smfmac_f32_16x16x64_bf16 v[68:71], v[52:55], a[208:215], v8
s_waitcnt vmcnt(0)
s_waitcnt lgkmcnt(3)
s_barrier
ds_read_b64_tr_b16 v[136:137], v7 offset:12736
ds_read_b64_tr_b16 v[138:139], v7 offset:12992
v_smfmac_f32_16x16x64_bf16 v[68:71], v[16:19], a[216:223], v8
ds_read_b64_tr_b16 v[140:141], v7 offset:13248
v_smfmac_f32_16x16x64_bf16 v[72:75], v[20:23], a[224:231], v8
ds_read_b64_tr_b16 v[142:143], v7 offset:13504
v_smfmac_f32_16x16x64_bf16 v[72:75], v[32:35], v[80:87], v8
ds_read_b64_tr_b16 v[144:145], v7 offset:13760
v_add_f32 v68, v68, v70
v_smfmac_f32_16x16x64_bf16 v[72:75], v[28:31], a[232:239], v8
ds_read_b64_tr_b16 v[146:147], v7 offset:14016
v_add_f32 v69, v69, v71
v_smfmac_f32_16x16x64_bf16 v[72:75], v[36:39], a[240:247], v8
ds_read_b64_tr_b16 v[148:149], v7 offset:14272
ds_read_b64_tr_b16 v[150:151], v7 offset:14528
v_cvt_pk_bf16_f32 v68, v68, v69
v_smfmac_f32_16x16x64_bf16 v[72:75], v[48:51], v[88:95], v8
ds_read_b64_tr_b16 v[152:153], v7 offset:14784
ds_write_b32 v5, v68 offset:0
v_smfmac_f32_16x16x64_bf16 v[72:75], v[40:43], a[248:255], v8
ds_read_b64_tr_b16 v[154:155], v7 offset:15040
v_smfmac_f32_16x16x64_bf16 v[72:75], v[44:47], v[176:183], v8
ds_read_b64_tr_b16 v[156:157], v7 offset:15296
s_waitcnt lgkmcnt(13)
v_smfmac_f32_16x16x64_bf16 v[72:75], v[24:27], v[96:103], v8
ds_read_b64_tr_b16 v[158:159], v7 offset:15552
v_smfmac_f32_16x16x64_bf16 v[72:75], v[52:55], v[184:191], v8
ds_read_b128 v[108:111], v4 offset:23552
v_smfmac_f32_16x16x64_bf16 v[72:75], v[16:19], v[192:199], v8
ds_read_b128 v[80:83], v4 offset:28672
s_waitcnt lgkmcnt(13)
v_mfma_f32_16x16x32_bf16 v[160:163], v[112:115], v[136:139], 0
ds_read_b128 v[84:87], v4 offset:29696
s_waitcnt lgkmcnt(12)
v_mfma_f32_16x16x32_bf16 v[160:163], v[116:119], v[140:143], v[160:163]
ds_read_b128 v[88:91], v4 offset:34816
s_waitcnt lgkmcnt(11)
v_add_f32 v72, v72, v74
v_mfma_f32_16x16x32_bf16 v[160:163], v[120:123], v[144:147], v[160:163]
ds_read_b128 v[92:95], v4 offset:35840
s_waitcnt lgkmcnt(10)
v_add_f32 v73, v73, v75
v_mfma_f32_16x16x32_bf16 v[160:163], v[124:127], v[148:151], v[160:163]
s_waitcnt lgkmcnt(7)
v_cvt_pk_bf16_f32 v72, v72, v73
v_mfma_f32_16x16x32_bf16 v[160:163], v[128:131], v[152:155], v[160:163]
ds_write_b32 v5, v72 offset:1024
s_waitcnt lgkmcnt(6)
v_mfma_f32_16x16x32_bf16 v[160:163], v[132:135], v[156:159], v[160:163]
v_smfmac_f32_16x16x64_bf16 v[76:79], v[20:23], v[200:207], v8
s_waitcnt lgkmcnt(5)
v_smfmac_f32_16x16x64_bf16 v[76:79], v[32:35], v[104:111], v8
v_cndmask_b32 v164, v160, v162, s[70:71]
v_cndmask_b32 v165, v161, v163, s[70:71]
v_smfmac_f32_16x16x64_bf16 v[76:79], v[28:31], v[208:215], v8
s_waitcnt lgkmcnt(0)
s_barrier
v_mul_f32 v164, s52, v164
v_mul_f32 v165, s52, v165
v_smfmac_f32_16x16x64_bf16 v[76:79], v[36:39], v[216:223], v8
v_exp_f32 v168, v164
v_smfmac_f32_16x16x64_bf16 v[76:79], v[48:51], v[80:87], v8
v_exp_f32 v169, v165
v_smfmac_f32_16x16x64_bf16 v[76:79], v[40:43], v[224:231], v8
v_max_f32 v172, |v164|, |v165|
v_smfmac_f32_16x16x64_bf16 v[76:79], v[44:47], v[232:239], v8
v_add_f32 v171, v168, v169
v_smfmac_f32_16x16x64_bf16 v[76:79], v[24:27], v[88:95], v8
v_cmp_lt_f32 vcc, s79, v172
v_smfmac_f32_16x16x64_bf16 v[76:79], v[52:55], v[240:247], v8
s_cbranch_vccnz Lsx_73
Lsxb_74:
ds_write_b128 v11, v[168:171] offset:1024
v_smfmac_f32_16x16x64_bf16 v[76:79], v[16:19], v[248:255], v8
s_nop 7
v_pk_add_f32 v[76:77], v[76:77], v[78:79]
v_cvt_pk_bf16_f32 v76, v76, v77
ds_write_b32 v5, v76 offset:2048
s_waitcnt lgkmcnt(0)
s_barrier
s_add_u32 s62, s62, 1
s_cmp_lt_u32 s62, 64
s_cbranch_scc1 Lqk_70
s_waitcnt vmcnt(0)
s_endpgm
Lg_86:
s_mov_b64 exec, s[16:17]
buffer_load_dwordx4 v[160:163], v1, s[8:11], s32 offen offset:0 sc1
s_mov_b64 exec, s[18:19]
buffer_load_dwordx4 v[164:167], v1, s[8:11], s32 offen offset:1024 sc1
s_mov_b64 exec, -1
s_waitcnt vmcnt(0)
v_max3_u32 v172, v160, v161, v162
v_max3_u32 v173, v164, v165, v166
v_max_u32 v172, v172, v163
v_max_u32 v173, v173, v167
v_cmp_eq_u32 s[16:17], -1, v172
v_cmp_eq_u32 s[18:19], -1, v173
s_nop 0
s_or_b64 s[28:29], s[16:17], s[18:19]
s_cbranch_scc0 Lg_87
s_cmp_eq_u32 s65, 0
s_cbranch_scc1 Lg_87
s_sub_u32 s65, s65, 1
s_branch Lg_86
Lg_88:
Lg_89:
s_mov_b64 exec, s[22:23]
buffer_load_dwordx4 v[136:139], v1, s[8:11], s33 offen offset:0 sc1
s_mov_b64 exec, s[24:25]
buffer_load_dwordx4 v[140:143], v1, s[8:11], s33 offen offset:1024 sc1
s_mov_b64 exec, -1
s_waitcnt vmcnt(0)
v_max3_u32 v172, v136, v137, v138
v_max3_u32 v173, v140, v141, v142
v_max_u32 v172, v172, v139
v_max_u32 v173, v173, v143
v_cmp_eq_u32 s[22:23], -1, v172
v_cmp_eq_u32 s[24:25], -1, v173
s_nop 0
s_or_b64 s[28:29], s[22:23], s[24:25]
s_cbranch_scc0 Lg_90
s_cmp_eq_u32 s65, 0
s_cbranch_scc1 Lg_90
s_sub_u32 s65, s65, 1
s_branch Lg_89
Lsx_73:
v_max_f32 v170, v164, v165
s_nop 1
v_max_f32_dpp v170, v170, v170 row_ror:8 row_mask:0xf bank_mask:0xf
v_mov_b32 v172, v170
s_nop 1
v_permlane16_swap_b32 v170, v172
v_max_f32 v170, v170, v172
v_mov_b32 v172, v170
s_nop 1
v_permlane32_swap_b32 v170, v172
v_max_f32 v170, v170, v172
v_sub_f32 v168, v164, v170
v_sub_f32 v169, v165, v170
v_exp_f32 v168, v168
v_exp_f32 v169, v169
s_nop 0
v_add_f32 v171, v168, v169
s_branch Lsxb_74
Lslow_13:
s_cmp_eq_u32 s3, 1
s_cbranch_scc1 Lw_92
s_cmp_eq_u32 s3, 2
s_cbranch_scc1 Lw_93
s_cmp_eq_u32 s3, 3
s_cbranch_scc1 Lw_94
Lw_91:
s_mov_b32 s62, 0
s_mov_b32 s52, 0x3dd53b95
s_mov_b32 s53, s52
s_mov_b32 s79, 0x42700000
s_mul_i32 s81, s63, 384
s_add_u32 s81, s81, 192950272
s_mov_b32 s45, 536870912
v_lshlrev_b32 v12, 7, v0
v_add_u32 v6, 8192, v12
v_min_u32 v6, 12160, v6
v_and_b32 v15, 15, v0
v_min_u32 v15, 2, v15
v_lshlrev_b32 v15, 7, v15
s_mov_b32 s54, s81
ds_read_b128 v[80:83], v4 offset:0
ds_read_b128 v[84:87], v4 offset:1024
ds_read_b128 v[88:91], v4 offset:2048
ds_read_b128 v[92:95], v4 offset:3072
ds_read_b128 v[96:99], v4 offset:4096
ds_read_b128 v[100:103], v4 offset:5120
ds_read_b128 v[104:107], v4 offset:6144
ds_read_b128 v[108:111], v4 offset:7168
v_mov_b64 v[56:57], 0
v_mov_b64 v[58:59], 0
v_mov_b64 v[60:61], 0
v_mov_b64 v[62:63], 0
v_mov_b64 v[64:65], 0
v_mov_b64 v[66:67], 0
v_mov_b64 v[68:69], 0
v_mov_b64 v[70:71], 0
v_mov_b64 v[72:73], 0
v_mov_b64 v[74:75], 0
v_mov_b64 v[76:77], 0
v_mov_b64 v[78:79], 0
s_bitcmp1_b32 s62, 0
s_cselect_b32 s78, -1.0, 1.0
s_lshl_b32 s55, s5, 7
s_add_u32 s55, s55, 193026048
s_cmp_gt_u32 s62, 60
s_cselect_b32 s55, s55, 536870912
v_mov_b32 v14, s62
v_min_u32 v13, 1, v0
v_lshlrev_b32 v13, 30, v13
ds_read_b128 v[16:19], v3 offset:0
ds_read_b128 v[24:27], v3 offset:1024
ds_read_b128 v[32:35], v3 offset:2048
s_waitcnt lgkmcnt(0)
s_branch Lqkent_96
Lqk_95:
s_barrier
s_sub_u32 s75, s62, 1
s_cmp_gt_u32 s62, 60
s_cbranch_scc1 Lkc_100
Lkb_99:
s_add_u32 s82, s62, 1
s_mov_b32 s45, 536870912
s_cmp_ge_u32 s82, 63
s_cbranch_scc1 Lnp_101
s_sub_u32 s61, s82, 12
s_max_i32 s61, s61, 0
s_lshr_b32 s61, s61, 2
s_add_u32 s61, s61, s82
s_cmp_gt_u32 s60, s61
s_cbranch_scc1 Lfd_103
v_and_b32 v14, 15, v0
v_min_u32 v14, 2, v14
v_lshlrev_b32 v14, 7, v14
Lf_102:
buffer_load_dword v13, v14, s[8:11], s81 offen sc1
s_waitcnt vmcnt(0)
v_min_u32_dpp v13, v13, v13 row_ror:8 row_mask:0xf bank_mask:0xf
s_nop 1
v_min_u32_dpp v13, v13, v13 row_ror:4 row_mask:0xf bank_mask:0xf
s_nop 1
v_min_u32_dpp v13, v13, v13 row_ror:2 row_mask:0xf bank_mask:0xf
s_nop 1
v_min_u32_dpp v13, v13, v13 row_ror:1 row_mask:0xf bank_mask:0xf
s_nop 0
v_readfirstlane_b32 s60, v13
s_nop 0
s_cmp_gt_u32 s60, s61
s_cbranch_scc1 Lfd_103
s_cmp_lt_u32 s82, 3
s_cbranch_scc1 Lnp_101
s_cmp_eq_u32 s65, 0
s_cbranch_scc1 Lfd_103
s_sub_u32 s65, s65, 1
s_branch Lf_102
Lfd_103:
s_lshl_b32 s45, s82, 5
s_add_u32 s45, s45, s63
s_mul_i32 s45, s45, 12288
s_add_u32 s45, s45, 29360128
Lnp_101:
ds_read_b128 v[80:83], v4 offset:0
ds_read_b128 v[84:87], v4 offset:1024
ds_read_b128 v[88:91], v4 offset:2048
ds_read_b128 v[92:95], v4 offset:3072
ds_read_b128 v[96:99], v4 offset:4096
ds_read_b128 v[100:103], v4 offset:5120
ds_read_b128 v[104:107], v4 offset:6144
ds_read_b128 v[108:111], v4 offset:7168
v_mov_b64 v[56:57], 0
v_mov_b64 v[58:59], 0
v_mov_b64 v[60:61], 0
v_mov_b64 v[62:63], 0
v_mov_b64 v[64:65], 0
v_mov_b64 v[66:67], 0
v_mov_b64 v[68:69], 0
v_mov_b64 v[70:71], 0
v_mov_b64 v[72:73], 0
v_mov_b64 v[74:75], 0
v_mov_b64 v[76:77], 0
v_mov_b64 v[78:79], 0
s_bitcmp1_b32 s62, 0
s_cselect_b32 s78, -1.0, 1.0
s_lshl_b32 s55, s5, 7
s_add_u32 s55, s55, 193026048
s_cmp_gt_u32 s62, 60
s_cselect_b32 s55, s55, 536870912
v_mov_b32 v14, s62
v_min_u32 v13, 1, v0
v_lshlrev_b32 v13, 30, v13
s_add_u32 s67, s62, 0
s_and_b32 s67, s67, 3
s_lshl_b32 s67, s67, 1
s_lshl_b32 s68, s67, 15
s_add_u32 s67, s67, s64
s_mul_i32 s67, s67, 10240
s_add_u32 s33, s68, s58
s_add_u32 s32, s67, s80
s_add_u32 s32, s32, 191889408
s_sleep 11
v_mov_b32 v175, 0
s_waitcnt lgkmcnt(0)
buffer_load_dwordx4 v[160:163], v1, s[8:11], s32 offen offset:0 sc1
buffer_load_dwordx4 v[164:167], v1, s[8:11], s32 offen offset:1024 sc1
buffer_load_dwordx4 v[168:171], v1, s[8:11], s32 offen offset:2048 sc1
s_waitcnt vmcnt(0)
v_max3_u32 v172, v160, v161, v162
v_max3_u32 v173, v164, v165, v166
v_max3_u32 v174, v168, v169, v170
v_max_u32 v172, v172, v163
v_max_u32 v173, v173, v167
v_max_u32 v174, v174, v171
v_cmp_eq_u32 s[16:17], -1, v172
v_cmp_eq_u32 s[18:19], -1, v173
v_cmp_eq_u32 s[20:21], -1, v174
s_or_b64 s[28:29], s[16:17], s[18:19]
s_or_b64 s[28:29], s[28:29], s[20:21]
s_cbranch_scc1 Lg_104
Lg_105:
buffer_load_dwordx4 v[136:139], v1, s[8:11], s33 offen offset:0 sc1
buffer_load_dwordx4 v[140:143], v1, s[8:11], s33 offen offset:1024 sc1
buffer_load_dwordx4 v[144:147], v1, s[8:11], s33 offen offset:2048 sc1
v_lshlrev_b32 v16, 16, v160
v_and_b32 v17, 0xffff0000, v160
v_lshlrev_b32 v18, 16, v161
v_and_b32 v19, 0xffff0000, v161
v_lshlrev_b32 v20, 16, v162
v_and_b32 v21, 0xffff0000, v162
v_lshlrev_b32 v22, 16, v163
v_and_b32 v23, 0xffff0000, v163
v_lshlrev_b32 v24, 16, v164
v_and_b32 v25, 0xffff0000, v164
v_lshlrev_b32 v26, 16, v165
v_and_b32 v27, 0xffff0000, v165
v_lshlrev_b32 v28, 16, v166
v_and_b32 v29, 0xffff0000, v166
v_lshlrev_b32 v30, 16, v167
v_and_b32 v31, 0xffff0000, v167
v_lshlrev_b32 v32, 16, v168
v_and_b32 v33, 0xffff0000, v168
v_lshlrev_b32 v34, 16, v169
v_and_b32 v35, 0xffff0000, v169
v_lshlrev_b32 v36, 16, v170
v_and_b32 v37, 0xffff0000, v170
v_lshlrev_b32 v38, 16, v171
v_and_b32 v39, 0xffff0000, v171
s_waitcnt vmcnt(0)
v_max3_u32 v172, v136, v137, v138
v_max3_u32 v173, v140, v141, v142
v_max3_u32 v174, v144, v145, v146
v_max_u32 v172, v172, v139
v_max_u32 v173, v173, v143
v_max_u32 v174, v174, v147
v_cmp_eq_u32 s[22:23], -1, v172
v_cmp_eq_u32 s[24:25], -1, v173
v_cmp_eq_u32 s[26:27], -1, v174
s_or_b64 s[28:29], s[22:23], s[24:25]
s_or_b64 s[28:29], s[28:29], s[26:27]
s_cbranch_scc1 Lg_106
Lg_108:
v_dot2c_f32_bf16 v16, s100, v136
v_dot2c_f32_bf16 v17, s101, v136
v_dot2c_f32_bf16 v18, s100, v137
v_dot2c_f32_bf16 v19, s101, v137
v_dot2c_f32_bf16 v20, s100, v138
v_dot2c_f32_bf16 v21, s101, v138
v_dot2c_f32_bf16 v22, s100, v139
v_dot2c_f32_bf16 v23, s101, v139
v_cvt_pk_bf16_f32 v16, v16, v17
v_cvt_pk_bf16_f32 v17, v18, v19
v_cvt_pk_bf16_f32 v18, v20, v21
v_cvt_pk_bf16_f32 v19, v22, v23
ds_write_b128 v2, v[16:19] offset:0
v_dot2c_f32_bf16 v24, s100, v140
v_dot2c_f32_bf16 v25, s101, v140
v_dot2c_f32_bf16 v26, s100, v141
v_dot2c_f32_bf16 v27, s101, v141
v_dot2c_f32_bf16 v28, s100, v142
v_dot2c_f32_bf16 v29, s101, v142
v_dot2c_f32_bf16 v30, s100, v143
v_dot2c_f32_bf16 v31, s101, v143
v_cvt_pk_bf16_f32 v24, v24, v25
v_cvt_pk_bf16_f32 v25, v26, v27
v_cvt_pk_bf16_f32 v26, v28, v29
v_cvt_pk_bf16_f32 v27, v30, v31
ds_write_b128 v2, v[24:27] offset:1024
v_dot2c_f32_bf16 v32, s100, v144
v_dot2c_f32_bf16 v33, s101, v144
v_dot2c_f32_bf16 v34, s100, v145
v_dot2c_f32_bf16 v35, s101, v145
v_dot2c_f32_bf16 v36, s100, v146
v_dot2c_f32_bf16 v37, s101, v146
v_dot2c_f32_bf16 v38, s100, v147
v_dot2c_f32_bf16 v39, s101, v147
v_cvt_pk_bf16_f32 v32, v32, v33
v_cvt_pk_bf16_f32 v33, v34, v35
v_cvt_pk_bf16_f32 v34, v36, v37
v_cvt_pk_bf16_f32 v35, v38, v39
ds_write_b128 v2, v[32:35] offset:2048
Lqkent_96:
v_smfmac_f32_16x16x64_bf16 v[56:59], v[16:19], a[0:7], v8
v_smfmac_f32_16x16x64_bf16 v[60:63], v[16:19], a[56:63], v8
buffer_load_dword v173, v12, s[8:11], s45 offen sc1
v_smfmac_f32_16x16x64_bf16 v[64:67], v[16:19], a[112:119], v8
v_smfmac_f32_16x16x64_bf16 v[56:59], v[24:27], a[8:15], v8
s_waitcnt lgkmcnt(0)
s_barrier
ds_read_b128 v[20:23], v3 offset:3072
v_smfmac_f32_16x16x64_bf16 v[60:63], v[24:27], a[64:71], v8
ds_read_b128 v[28:31], v3 offset:4096
v_smfmac_f32_16x16x64_bf16 v[64:67], v[24:27], a[120:127], v8
ds_read_b128 v[36:39], v3 offset:5120
buffer_load_dword v173, v6, s[8:11], s45 offen sc1
v_smfmac_f32_16x16x64_bf16 v[56:59], v[32:35], v[80:87], v8
ds_read_b128 v[40:43], v3 offset:6144
v_smfmac_f32_16x16x64_bf16 v[60:63], v[32:35], v[88:95], v8
ds_read_b128 v[44:47], v3 offset:7168
v_smfmac_f32_16x16x64_bf16 v[64:67], v[32:35], v[96:103], v8
ds_read_b128 v[48:51], v3 offset:9216
s_waitcnt lgkmcnt(5)
v_smfmac_f32_16x16x64_bf16 v[56:59], v[20:23], a[16:23], v8
ds_read_b128 v[52:55], v3 offset:8192
buffer_store_dword v14, v13, s[8:11], s55 offen sc1
v_smfmac_f32_16x16x64_bf16 v[60:63], v[20:23], a[72:79], v8
ds_read_b128 v[80:83], v4 offset:8192
ds_read_b128 v[84:87], v4 offset:9216
v_smfmac_f32_16x16x64_bf16 v[64:67], v[20:23], a[128:135], v8
ds_read_b128 v[88:91], v4 offset:10240
ds_read_b128 v[92:95], v4 offset:11264
s_waitcnt lgkmcnt(9)
v_smfmac_f32_16x16x64_bf16 v[56:59], v[28:31], a[24:31], v8
ds_read_b128 v[96:99], v4 offset:12288
v_smfmac_f32_16x16x64_bf16 v[60:63], v[28:31], a[80:87], v8
ds_read_b128 v[100:103], v4 offset:13312
v_smfmac_f32_16x16x64_bf16 v[64:67], v[28:31], a[136:143], v8
s_waitcnt lgkmcnt(10)
v_smfmac_f32_16x16x64_bf16 v[56:59], v[36:39], v[104:111], v8
ds_read_b128 v[104:107], v4 offset:14336
s_waitcnt lgkmcnt(5)
v_smfmac_f32_16x16x64_bf16 v[60:63], v[36:39], v[80:87], v8
ds_read_b128 v[108:111], v4 offset:15360
s_waitcnt lgkmcnt(4)
v_smfmac_f32_16x16x64_bf16 v[64:67], v[36:39], v[88:95], v8
ds_read_b128 v[80:83], v4 offset:16384
v_smfmac_f32_16x16x64_bf16 v[56:59], v[40:43], a[32:39], v8
ds_read_b128 v[84:87], v4 offset:17408
v_smfmac_f32_16x16x64_bf16 v[56:59], v[44:47], a[40:47], v8
ds_read_b128 v[88:91], v4 offset:18432
s_waitcnt lgkmcnt(5)
v_smfmac_f32_16x16x64_bf16 v[56:59], v[48:51], v[96:103], v8
ds_read_b128 v[92:95], v4 offset:19456
v_smfmac_f32_16x16x64_bf16 v[56:59], v[52:55], a[48:55], v8
ds_read_b128 v[96:99], v4 offset:24576
v_smfmac_f32_16x16x64_bf16 v[60:63], v[40:43], a[88:95], v8
ds_read_b128 v[100:103], v4 offset:25600
v_smfmac_f32_16x16x64_bf16 v[60:63], v[44:47], a[96:103], v8
s_waitcnt lgkmcnt(6)
v_add_f32 v56, v56, v58
v_smfmac_f32_16x16x64_bf16 v[60:63], v[48:51], v[104:111], v8
ds_read_b128 v[104:107], v4 offset:30720
v_add_f32 v57, v57, v59
v_smfmac_f32_16x16x64_bf16 v[60:63], v[52:55], a[104:111], v8
ds_read_b128 v[108:111], v4 offset:31744
v_cvt_pk_bf16_f32 v56, v56, v57
v_smfmac_f32_16x16x64_bf16 v[64:67], v[40:43], a[144:151], v8
ds_write_b32 v5, v56 offset:12736
v_smfmac_f32_16x16x64_bf16 v[64:67], v[44:47], a[152:159], v8
s_waitcnt lgkmcnt(7)
v_add_f32 v60, v60, v62
v_smfmac_f32_16x16x64_bf16 v[64:67], v[48:51], v[80:87], v8
ds_read_b128 v[80:83], v4 offset:20480
v_add_f32 v61, v61, v63
v_smfmac_f32_16x16x64_bf16 v[64:67], v[52:55], a[160:167], v8
ds_read_b128 v[84:87], v4 offset:21504
v_cvt_pk_bf16_f32 v60, v60, v61
v_smfmac_f32_16x16x64_bf16 v[68:71], v[16:19], a[168:175], v8
ds_write_b32 v5, v60 offset:13760
s_waitcnt lgkmcnt(8)
v_smfmac_f32_16x16x64_bf16 v[68:71], v[32:35], v[88:95], v8
ds_read_b128 v[88:91], v4 offset:26624
v_add_f32 v64, v64, v66
v_add_f32 v65, v65, v67
v_smfmac_f32_16x16x64_bf16 v[68:71], v[24:27], a[176:183], v8
ds_read_b128 v[92:95], v4 offset:27648
v_cvt_pk_bf16_f32 v64, v64, v65
v_smfmac_f32_16x16x64_bf16 v[68:71], v[20:23], a[184:191], v8
ds_write_b32 v5, v64 offset:14784
s_waitcnt lgkmcnt(9)
v_smfmac_f32_16x16x64_bf16 v[68:71], v[36:39], v[96:103], v8
ds_read_b128 v[96:99], v4 offset:32768
v_smfmac_f32_16x16x64_bf16 v[68:71], v[28:31], a[192:199], v8
ds_read_b128 v[100:103], v4 offset:33792
v_smfmac_f32_16x16x64_bf16 v[68:71], v[40:43], a[200:207], v8
s_waitcnt lgkmcnt(9)
v_smfmac_f32_16x16x64_bf16 v[68:71], v[48:51], v[104:111], v8
s_waitcnt vmcnt(3)
s_waitcnt lgkmcnt(2)
s_barrier
ds_read_b128 v[104:107], v4 offset:22528
v_smfmac_f32_16x16x64_bf16 v[68:71], v[44:47], a[208:215], v8
ds_read_b128 v[108:111], v4 offset:23552
v_smfmac_f32_16x16x64_bf16 v[68:71], v[52:55], a[216:223], v8
ds_read_b64_tr_b16 v[136:137], v7 offset:12736
v_smfmac_f32_16x16x64_bf16 v[72:75], v[16:19], a[224:231], v8
ds_read_b64_tr_b16 v[138:139], v7 offset:12992
v_smfmac_f32_16x16x64_bf16 v[72:75], v[32:35], v[80:87], v8
ds_read_b128 v[80:83], v4 offset:28672
v_add_f32 v68, v68, v70
v_smfmac_f32_16x16x64_bf16 v[72:75], v[24:27], a[232:239], v8
ds_read_b128 v[84:87], v4 offset:29696
v_add_f32 v69, v69, v71
v_smfmac_f32_16x16x64_bf16 v[72:75], v[20:23], a[240:247], v8
ds_read_b64_tr_b16 v[140:141], v7 offset:13248
v_cvt_pk_bf16_f32 v68, v68, v69
v_smfmac_f32_16x16x64_bf16 v[72:75], v[36:39], v[88:95], v8
ds_write_b32 v5, v68 offset:0
v_smfmac_f32_16x16x64_bf16 v[72:75], v[28:31], a[248:255], v8
ds_read_b128 v[88:91], v4 offset:34816
v_smfmac_f32_16x16x64_bf16 v[72:75], v[40:43], v[176:183], v8
ds_read_b128 v[92:95], v4 offset:35840
s_waitcnt lgkmcnt(10)
v_smfmac_f32_16x16x64_bf16 v[72:75], v[48:51], v[96:103], v8
ds_read_b64_tr_b16 v[142:143], v7 offset:13504
v_smfmac_f32_16x16x64_bf16 v[72:75], v[44:47], v[184:191], v8
ds_read_b64_tr_b16 v[144:145], v7 offset:13760
v_smfmac_f32_16x16x64_bf16 v[72:75], v[52:55], v[192:199], v8
ds_read_b64_tr_b16 v[146:147], v7 offset:14016
v_smfmac_f32_16x16x64_bf16 v[76:79], v[16:19], v[200:207], v8
ds_read_b64_tr_b16 v[148:149], v7 offset:14272
s_waitcnt lgkmcnt(12)
v_smfmac_f32_16x16x64_bf16 v[76:79], v[32:35], v[104:111], v8
ds_read_b64_tr_b16 v[150:151], v7 offset:14528
ds_read_b64_tr_b16 v[158:159], v7 offset:15552
v_add_f32 v72, v72, v74
v_smfmac_f32_16x16x64_bf16 v[76:79], v[24:27], v[208:215], v8
ds_read_b64_tr_b16 v[152:153], v7 offset:14784
ds_read_b64_tr_b16 v[156:157], v7 offset:15296
v_add_f32 v73, v73, v75
v_smfmac_f32_16x16x64_bf16 v[76:79], v[20:23], v[216:223], v8
ds_read_b64_tr_b16 v[154:155], v7 offset:15040
s_waitcnt lgkmcnt(13)
v_cvt_pk_bf16_f32 v72, v72, v73
v_smfmac_f32_16x16x64_bf16 v[76:79], v[36:39], v[80:87], v8
ds_write_b32 v5, v72 offset:1024
v_smfmac_f32_16x16x64_bf16 v[76:79], v[28:31], v[224:231], v8
v_smfmac_f32_16x16x64_bf16 v[76:79], v[40:43], v[232:239], v8
s_waitcnt lgkmcnt(0)
s_barrier
ds_read_b64_tr_b16 v[112:113], v7 offset:0
ds_read_b64_tr_b16 v[114:115], v7 offset:256
ds_read_b64_tr_b16 v[116:117], v7 offset:512
v_smfmac_f32_16x16x64_bf16 v[76:79], v[48:51], v[88:95], v8
ds_read_b64_tr_b16 v[118:119], v7 offset:768
ds_read_b64_tr_b16 v[120:121], v7 offset:1024
ds_read_b64_tr_b16 v[122:123], v7 offset:1280
v_smfmac_f32_16x16x64_bf16 v[76:79], v[44:47], v[240:247], v8
ds_read_b64_tr_b16 v[124:125], v7 offset:1536
ds_read_b64_tr_b16 v[126:127], v7 offset:1792
v_smfmac_f32_16x16x64_bf16 v[76:79], v[52:55], v[248:255], v8
s_waitcnt lgkmcnt(6)
v_mfma_f32_16x16x32_bf16 v[164:167], v[112:115], v[136:139], 0
s_waitcnt lgkmcnt(4)
v_mfma_f32_16x16x32_bf16 v[164:167], v[116:119], v[140:143], v[164:167]
s_waitcnt lgkmcnt(2)
v_add_f32 v76, v76, v78
v_mfma_f32_16x16x32_bf16 v[164:167], v[120:123], v[144:147], v[164:167]
s_waitcnt lgkmcnt(0)
v_add_f32 v77, v77, v79
v_mfma_f32_16x16x32_bf16 v[164:167], v[124:127], v[148:151], v[164:167]
v_cvt_pk_bf16_f32 v76, v76, v77
ds_write_b32 v5, v76 offset:2048
s_waitcnt lgkmcnt(0)
s_barrier
ds_read_b64_tr_b16 v[128:129], v7 offset:2048
ds_read_b64_tr_b16 v[130:131], v7 offset:2304
ds_read_b64_tr_b16 v[132:133], v7 offset:2560
ds_read_b64_tr_b16 v[134:135], v7 offset:2816
ds_read_b128 v[80:83], v11
ds_read_b128 v[84:87], v11 offset:1024
s_cmp_eq_u32 s62, 63
s_cbranch_scc1 Lkm_98
s_waitcnt lgkmcnt(4)
v_mfma_f32_16x16x32_bf16 v[164:167], v[128:131], v[152:155], v[164:167]
s_waitcnt lgkmcnt(2)
v_mfma_f32_16x16x32_bf16 v[164:167], v[132:135], v[156:159], v[164:167]
s_waitcnt lgkmcnt(0)
v_add_f32 v92, v83, v87
v_max_f32 v88, |v82|, |v86|
v_mul_f32 v88, 0x71800000, v88
v_add_f32_dpp v92, v92, v92 row_ror:8 row_mask:0xf bank_mask:0xf
v_mov_b32 v172, v92
s_nop 1
v_cndmask_b32 v164, v164, v166, s[70:71]
v_cndmask_b32 v165, v165, v167, s[70:71]
v_mul_f32 v164, s52, v164
v_mul_f32 v165, s52, v165
v_exp_f32 v166, v164
v_exp_f32 v167, v165
v_permlane16_swap_b32 v92, v172
v_max3_f32 v88, |v164|, |v165|, v88
v_add_f32 v92, v92, v172
v_add_f32 v89, v166, v167
v_mov_b32 v172, v92
v_cmp_lt_f32 vcc, s79, v88
v_add_f32_dpp v89, v89, v89 row_ror:8 row_mask:0xf bank_mask:0xf
v_permlane32_swap_b32 v92, v172
v_mov_b32 v93, v89
v_add_f32 v92, v92, v172
v_mul_f32 v92, s78, v92
v_permlane16_swap_b32 v89, v93
v_add_f32 v89, v89, v93
v_fma_f32 v89, v89, s78, v92
v_rcp_f32 v89, v89
s_nop 0
v_pk_mul_f32 v[96:97], v[80:81], v[88:89] op_sel:[0,1]
v_pk_mul_f32 v[98:99], v[84:85], v[88:89] op_sel:[0,1]
v_cvt_pk_bf16_f32 v96, v96, v97
v_cvt_pk_bf16_f32 v97, v98, v99
s_cbranch_vccnz Lsm_109
Lsb_110:
buffer_store_dwordx2 v[96:97], v9, s[8:11], s76 offen sc1
v_pk_mul_f32 v[166:167], v[166:167], v[88:89] op_sel:[0,1]
v_cvt_pk_bf16_f32 v164, v166, v167
buffer_store_dword v164, v10, s[8:11], s77 offen sc1
s_add_u32 s62, s62, 1
s_cmp_lt_u32 s62, 64
s_cbranch_scc1 Lqk_95
s_waitcnt vmcnt(0)
s_endpgm
Lg_104:
s_mov_b64 exec, s[16:17]
buffer_load_dwordx4 v[160:163], v1, s[8:11], s32 offen offset:0 sc1
s_mov_b64 exec, s[18:19]
buffer_load_dwordx4 v[164:167], v1, s[8:11], s32 offen offset:1024 sc1
s_mov_b64 exec, s[20:21]
buffer_load_dwordx4 v[168:171], v1, s[8:11], s32 offen offset:2048 sc1
s_mov_b64 exec, -1
s_waitcnt vmcnt(0)
v_max3_u32 v172, v160, v161, v162
v_max3_u32 v173, v164, v165, v166
v_max3_u32 v174, v168, v169, v170
v_max_u32 v172, v172, v163
v_max_u32 v173, v173, v167
v_max_u32 v174, v174, v171
v_cmp_eq_u32 s[16:17], -1, v172
v_cmp_eq_u32 s[18:19], -1, v173
v_cmp_eq_u32 s[20:21], -1, v174
s_or_b64 s[28:29], s[16:17], s[18:19]
s_or_b64 s[28:29], s[28:29], s[20:21]
s_cbranch_scc0 Lg_105
s_cmp_eq_u32 s65, 0
s_cbranch_scc1 Lg_105
s_sub_u32 s65, s65, 1
s_branch Lg_104
Lg_106:
Lg_107:
s_mov_b64 exec, s[22:23]
buffer_load_dwordx4 v[136:139], v1, s[8:11], s33 offen offset:0 sc1
s_mov_b64 exec, s[24:25]
buffer_load_dwordx4 v[140:143], v1, s[8:11], s33 offen offset:1024 sc1
s_mov_b64 exec, s[26:27]
buffer_load_dwordx4 v[144:147], v1, s[8:11], s33 offen offset:2048 sc1
s_mov_b64 exec, -1
s_waitcnt vmcnt(0)
v_max3_u32 v172, v136, v137, v138
v_max3_u32 v173, v140, v141, v142
v_max3_u32 v174, v144, v145, v146
v_max_u32 v172, v172, v139
v_max_u32 v173, v173, v143
v_max_u32 v174, v174, v147
v_cmp_eq_u32 s[22:23], -1, v172
v_cmp_eq_u32 s[24:25], -1, v173
v_cmp_eq_u32 s[26:27], -1, v174
s_or_b64 s[28:29], s[22:23], s[24:25]
s_or_b64 s[28:29], s[28:29], s[26:27]
s_cbranch_scc0 Lg_108
s_cmp_eq_u32 s65, 0
s_cbranch_scc1 Lg_108
s_sub_u32 s65, s65, 1
s_branch Lg_107
Lkm_98:
s_mov_b32 s75, 63
Lkc_100:
s_mul_i32 s72, s63, 12288
s_bfe_u32 s67, s75, 0x10001
s_mul_i32 s67, s67, 6144
s_add_u32 s72, s72, s67
s_lshr_b32 s67, s75, 2
s_mul_i32 s67, s67, 393216
s_add_u32 s72, s72, s67
s_add_u32 s72, s72, 54525952
s_add_u32 s73, s72, 4096
s_bitcmp1_b32 s75, 0
s_cselect_b32 s74, 8, 0
s_lshl_b32 s74, 0x00ff00ff, s74
s_mov_b32 exec_lo, s74
s_mov_b32 exec_hi, s74
s_waitcnt lgkmcnt(0)
buffer_store_dwordx4 v[112:115], v1, s[8:11], s72 offen offset:0 sc1
buffer_store_dwordx4 v[116:119], v1, s[8:11], s72 offen offset:1024 sc1
buffer_store_dwordx4 v[120:123], v1, s[8:11], s72 offen offset:2048 sc1
buffer_store_dwordx4 v[124:127], v1, s[8:11], s72 offen offset:3072 sc1
buffer_store_dwordx4 v[128:131], v1, s[8:11], s73 offen offset:0 sc1
buffer_store_dwordx4 v[132:135], v1, s[8:11], s73 offen offset:1024 sc1
s_mov_b64 exec, -1
s_cmp_lt_u32 s75, 63
s_cbranch_scc1 Lkb_99
s_waitcnt vmcnt(0)
s_lshl_b32 s67, s5, 7
s_add_u32 s67, s67, 193026048
s_add_u32 s68, s62, 1
v_mov_b32 v13, s68
v_mov_b32 v14, 0
s_mov_b64 exec, 1
buffer_store_dword v13, v14, s[8:11], s67 offen sc1
s_mov_b64 exec, -1
s_waitcnt vmcnt(0)
s_endpgm
Lsm_109:
v_max_f32 v88, v164, v165
s_nop 1
v_max_f32_dpp v88, v88, v88 row_ror:8 row_mask:0xf bank_mask:0xf
v_mov_b32 v172, v88
s_nop 1
v_permlane16_swap_b32 v88, v172
v_max_f32 v88, v88, v172
v_max3_f32 v88, v88, v82, v86
v_sub_f32 v164, v164, v88
v_sub_f32 v165, v165, v88
v_sub_f32 v90, v82, v88
v_sub_f32 v91, v86, v88
v_exp_f32 v166, v164
v_exp_f32 v167, v165
v_exp_f32 v90, v90
v_exp_f32 v91, v91
v_mul_f32 v92, v83, v90
v_fmac_f32 v92, v87, v91
s_nop 1
v_add_f32_dpp v92, v92, v92 row_ror:8 row_mask:0xf bank_mask:0xf
v_mov_b32 v172, v92
s_nop 1
v_permlane16_swap_b32 v92, v172
v_add_f32 v92, v92, v172
v_mov_b32 v172, v92
s_nop 1
v_permlane32_swap_b32 v92, v172
v_add_f32 v92, v92, v172
v_mul_f32 v92, s78, v92
v_mul_f32 v80, v80, v90
v_mul_f32 v84, v84, v91
v_mul_f32 v81, v81, v90
v_mul_f32 v85, v85, v91
v_add_f32 v89, v166, v167
s_nop 1
v_add_f32_dpp v89, v89, v89 row_ror:8 row_mask:0xf bank_mask:0xf
v_mov_b32 v93, v89
s_nop 1
v_permlane16_swap_b32 v89, v93
v_add_f32 v89, v89, v93
v_fma_f32 v89, v89, s78, v92
v_rcp_f32 v89, v89
s_nop 0
v_pk_mul_f32 v[96:97], v[80:81], v[88:89] op_sel:[0,1]
v_pk_mul_f32 v[98:99], v[84:85], v[88:89] op_sel:[0,1]
v_cvt_pk_bf16_f32 v96, v96, v97
v_cvt_pk_bf16_f32 v97, v98, v99
s_branch Lsb_110
Lw_92:
s_mov_b32 s62, 0
s_mov_b32 s52, 0x3dd53b95
s_mov_b32 s53, s52
s_mov_b32 s79, 0x42700000
v_lshlrev_b32 v9, 7, v0
v_and_b32 v10, 15, v0
v_lshlrev_b32 v10, 7, v10
v_cmp_eq_u32 vcc, 0, v0
v_mov_b32 v15, 0x40000000
s_nop 0
v_cndmask_b32 v15, v15, 0, vcc
s_lshl_b32 s81, s64, 11
s_bfe_u32 s67, s63, 0x20002
s_mul_i32 s67, s67, 5120
s_add_u32 s81, s81, s67
s_add_u32 s81, s81, 192978944
s_and_b32 s50, s63, 15
s_mul_i32 s50, s50, 40960
s_lshl_b32 s67, s64, 14
s_add_u32 s50, s50, s67
s_add_u32 s50, s50, 60817408
s_lshl_b32 s46, s63, 7
s_add_u32 s46, s46, 193024000
s_lshl_b32 s47, s63, 11
s_add_u32 s47, s47, 2621440
s_cmp_ge_u32 s63, 10
s_cselect_b32 s46, 536870912, s46
s_cselect_b32 s47, 536870912, s47
s_mov_b32 s45, 536870912
s_mov_b32 s48, 536870912
s_mov_b32 s49, 536870912
s_mov_b32 s54, s81
s_mov_b32 s60, 0
ds_read_b128 v[80:83], v4 offset:6144
ds_read_b128 v[84:87], v4 offset:7168
ds_read_b128 v[88:91], v4 offset:8192
ds_read_b128 v[92:95], v4 offset:9216
ds_read_b128 v[96:99], v4 offset:10240
ds_read_b128 v[100:103], v4 offset:11264
ds_read_b128 v[104:107], v4 offset:0
ds_read_b128 v[108:111], v4 offset:1024
v_mov_b64 v[56:57], 0
v_mov_b64 v[58:59], 0
v_mov_b64 v[60:61], 0
v_mov_b64 v[62:63], 0
v_mov_b64 v[64:65], 0
v_mov_b64 v[66:67], 0
v_mov_b64 v[68:69], 0
v_mov_b64 v[70:71], 0
v_mov_b64 v[72:73], 0
v_mov_b64 v[74:75], 0
v_mov_b64 v[76:77], 0
v_mov_b64 v[78:79], 0
v_mov_b32 v14, s62
s_lshr_b32 s67, s62, 2
s_mul_i32 s44, s67, 40960
s_bfe_u32 s67, s62, 0x10001
s_mul_i32 s67, s67, 20480
s_add_u32 s44, s44, s67
s_and_b32 s67, s62, 1
s_lshl_b32 s67, s67, 7
s_add_u32 s44, s44, s67
s_add_u32 s44, s44, s47
ds_read_b128 v[16:19], v3 offset:3072
ds_read_b128 v[24:27], v3 offset:4096
ds_read_b128 v[32:35], v3 offset:5120
s_waitcnt lgkmcnt(0)
s_branch Lqkent_112
Lqk_111:
s_barrier
s_add_u32 s82, s62, 1
s_mov_b32 s45, 536870912
s_cmp_ge_u32 s82, 63
s_cbranch_scc1 Lnp_117
s_sub_u32 s61, s82, 12
s_max_i32 s61, s61, 0
s_lshr_b32 s61, s61, 2
s_add_u32 s61, s61, s82
s_cmp_gt_u32 s60, s61
s_cbranch_scc1 Lfd_119
v_and_b32 v14, 15, v0
v_lshlrev_b32 v14, 7, v14
Lf_118:
buffer_load_dword v13, v14, s[8:11], s81 offen sc1
s_waitcnt vmcnt(0)
v_min_u32_dpp v13, v13, v13 row_ror:8 row_mask:0xf bank_mask:0xf
s_nop 1
v_min_u32_dpp v13, v13, v13 row_ror:4 row_mask:0xf bank_mask:0xf
s_nop 1
v_min_u32_dpp v13, v13, v13 row_ror:2 row_mask:0xf bank_mask:0xf
s_nop 1
v_min_u32_dpp v13, v13, v13 row_ror:1 row_mask:0xf bank_mask:0xf
s_nop 0
v_readfirstlane_b32 s60, v13
s_nop 0
s_cmp_gt_u32 s60, s61
s_cbranch_scc1 Lfd_119
s_cmp_lt_u32 s82, 3
s_cbranch_scc1 Lnp_117
s_cmp_eq_u32 s65, 0
s_cbranch_scc1 Lfd_119
s_sub_u32 s65, s65, 1
s_branch Lf_118
Lfd_119:
s_mul_i32 s45, s82, 1638400
s_add_u32 s45, s45, s50
Lnp_117:
s_add_u32 s48, s45, 655360
s_add_u32 s49, s45, 1310720
s_bitcmp1_b32 s63, 3
s_cselect_b32 s49, 536870912, s49
ds_read_b128 v[80:83], v4 offset:6144
ds_read_b128 v[84:87], v4 offset:7168
ds_read_b128 v[88:91], v4 offset:8192
ds_read_b128 v[92:95], v4 offset:9216
ds_read_b128 v[96:99], v4 offset:10240
ds_read_b128 v[100:103], v4 offset:11264
ds_read_b128 v[104:107], v4 offset:0
ds_read_b128 v[108:111], v4 offset:1024
v_mov_b64 v[56:57], 0
v_mov_b64 v[58:59], 0
v_mov_b64 v[60:61], 0
v_mov_b64 v[62:63], 0
v_mov_b64 v[64:65], 0
v_mov_b64 v[66:67], 0
v_mov_b64 v[68:69], 0
v_mov_b64 v[70:71], 0
v_mov_b64 v[72:73], 0
v_mov_b64 v[74:75], 0
v_mov_b64 v[76:77], 0
v_mov_b64 v[78:79], 0
v_mov_b32 v14, s62
s_lshr_b32 s67, s62, 2
s_mul_i32 s44, s67, 40960
s_bfe_u32 s67, s62, 0x10001
s_mul_i32 s67, s67, 20480
s_add_u32 s44, s44, s67
s_and_b32 s67, s62, 1
s_lshl_b32 s67, s67, 7
s_add_u32 s44, s44, s67
s_add_u32 s44, s44, s47
s_add_u32 s67, s62, 0
s_and_b32 s67, s67, 3
s_lshl_b32 s67, s67, 1
s_lshl_b32 s68, s67, 15
s_add_u32 s67, s67, s64
s_mul_i32 s67, s67, 10240
s_add_u32 s33, s68, s58
s_add_u32 s32, s67, s80
s_add_u32 s32, s32, 191889408
s_sleep 11
v_mov_b32 v175, 0
s_waitcnt lgkmcnt(0)
buffer_load_dwordx4 v[160:163], v1, s[8:11], s32 offen offset:0 sc1
buffer_load_dwordx4 v[164:167], v1, s[8:11], s32 offen offset:1024 sc1
buffer_load_dwordx4 v[168:171], v1, s[8:11], s32 offen offset:2048 sc1
s_waitcnt vmcnt(0)
v_max3_u32 v172, v160, v161, v162
v_max3_u32 v173, v164, v165, v166
v_max3_u32 v174, v168, v169, v170
v_max_u32 v172, v172, v163
v_max_u32 v173, v173, v167
v_max_u32 v174, v174, v171
v_cmp_eq_u32 s[16:17], -1, v172
v_cmp_eq_u32 s[18:19], -1, v173
v_cmp_eq_u32 s[20:21], -1, v174
s_or_b64 s[28:29], s[16:17], s[18:19]
s_or_b64 s[28:29], s[28:29], s[20:21]
s_cbranch_scc1 Lg_120
Lg_121:
buffer_load_dwordx4 v[136:139], v1, s[8:11], s33 offen offset:0 sc1
buffer_load_dwordx4 v[140:143], v1, s[8:11], s33 offen offset:1024 sc1
buffer_load_dwordx4 v[144:147], v1, s[8:11], s33 offen offset:2048 sc1
v_lshlrev_b32 v16, 16, v160
v_and_b32 v17, 0xffff0000, v160
v_lshlrev_b32 v18, 16, v161
v_and_b32 v19, 0xffff0000, v161
v_lshlrev_b32 v20, 16, v162
v_and_b32 v21, 0xffff0000, v162
v_lshlrev_b32 v22, 16, v163
v_and_b32 v23, 0xffff0000, v163
v_lshlrev_b32 v24, 16, v164
v_and_b32 v25, 0xffff0000, v164
v_lshlrev_b32 v26, 16, v165
v_and_b32 v27, 0xffff0000, v165
v_lshlrev_b32 v28, 16, v166
v_and_b32 v29, 0xffff0000, v166
v_lshlrev_b32 v30, 16, v167
v_and_b32 v31, 0xffff0000, v167
v_lshlrev_b32 v32, 16, v168
v_and_b32 v33, 0xffff0000, v168
v_lshlrev_b32 v34, 16, v169
v_and_b32 v35, 0xffff0000, v169
v_lshlrev_b32 v36, 16, v170
v_and_b32 v37, 0xffff0000, v170
v_lshlrev_b32 v38, 16, v171
v_and_b32 v39, 0xffff0000, v171
s_waitcnt vmcnt(0)
v_max3_u32 v172, v136, v137, v138
v_max3_u32 v173, v140, v141, v142
v_max3_u32 v174, v144, v145, v146
v_max_u32 v172, v172, v139
v_max_u32 v173, v173, v143
v_max_u32 v174, v174, v147
v_cmp_eq_u32 s[22:23], -1, v172
v_cmp_eq_u32 s[24:25], -1, v173
v_cmp_eq_u32 s[26:27], -1, v174
s_or_b64 s[28:29], s[22:23], s[24:25]
s_or_b64 s[28:29], s[28:29], s[26:27]
s_cbranch_scc1 Lg_122
Lg_124:
v_dot2c_f32_bf16 v16, s100, v136
v_dot2c_f32_bf16 v17, s101, v136
v_dot2c_f32_bf16 v18, s100, v137
v_dot2c_f32_bf16 v19, s101, v137
v_dot2c_f32_bf16 v20, s100, v138
v_dot2c_f32_bf16 v21, s101, v138
v_dot2c_f32_bf16 v22, s100, v139
v_dot2c_f32_bf16 v23, s101, v139
v_cvt_pk_bf16_f32 v16, v16, v17
v_cvt_pk_bf16_f32 v17, v18, v19
v_cvt_pk_bf16_f32 v18, v20, v21
v_cvt_pk_bf16_f32 v19, v22, v23
ds_write_b128 v2, v[16:19] offset:0
v_dot2c_f32_bf16 v24, s100, v140
v_dot2c_f32_bf16 v25, s101, v140
v_dot2c_f32_bf16 v26, s100, v141
v_dot2c_f32_bf16 v27, s101, v141
v_dot2c_f32_bf16 v28, s100, v142
v_dot2c_f32_bf16 v29, s101, v142
v_dot2c_f32_bf16 v30, s100, v143
v_dot2c_f32_bf16 v31, s101, v143
v_cvt_pk_bf16_f32 v24, v24, v25
v_cvt_pk_bf16_f32 v25, v26, v27
v_cvt_pk_bf16_f32 v26, v28, v29
v_cvt_pk_bf16_f32 v27, v30, v31
ds_write_b128 v2, v[24:27] offset:1024
v_dot2c_f32_bf16 v32, s100, v144
v_dot2c_f32_bf16 v33, s101, v144
v_dot2c_f32_bf16 v34, s100, v145
v_dot2c_f32_bf16 v35, s101, v145
v_dot2c_f32_bf16 v36, s100, v146
v_dot2c_f32_bf16 v37, s101, v146
v_dot2c_f32_bf16 v38, s100, v147
v_dot2c_f32_bf16 v39, s101, v147
v_cvt_pk_bf16_f32 v32, v32, v33
v_cvt_pk_bf16_f32 v33, v34, v35
v_cvt_pk_bf16_f32 v34, v36, v37
v_cvt_pk_bf16_f32 v35, v38, v39
ds_write_b128 v2, v[32:35] offset:2048
Lqkent_112:
v_smfmac_f32_16x16x64_bf16 v[56:59], v[16:19], a[16:23], v8
buffer_store_dword v14, v15, s[8:11], s46 offen sc1
v_smfmac_f32_16x16x64_bf16 v[60:63], v[16:19], a[72:79], v8
buffer_load_dword v116, v9, s[8:11], s45 offen sc1
v_smfmac_f32_16x16x64_bf16 v[64:67], v[16:19], a[128:135], v8
s_add_u32 s45, s45, 8192
v_smfmac_f32_16x16x64_bf16 v[56:59], v[24:27], a[24:31], v8
s_waitcnt lgkmcnt(0)
s_barrier
ds_read_b128 v[20:23], v3 offset:0
v_smfmac_f32_16x16x64_bf16 v[60:63], v[24:27], a[80:87], v8
ds_read_b128 v[28:31], v3 offset:1024
buffer_load_dword v117, v9, s[8:11], s45 offen sc1
v_smfmac_f32_16x16x64_bf16 v[64:67], v[24:27], a[136:143], v8
ds_read_b128 v[36:39], v3 offset:2048
v_smfmac_f32_16x16x64_bf16 v[56:59], v[32:35], v[80:87], v8
ds_read_b128 v[40:43], v3 offset:6144
v_smfmac_f32_16x16x64_bf16 v[60:63], v[32:35], v[88:95], v8
ds_read_b128 v[44:47], v3 offset:7168
buffer_load_dword v118, v9, s[8:11], s48 offen sc1
v_smfmac_f32_16x16x64_bf16 v[64:67], v[32:35], v[96:103], v8
ds_read_b128 v[48:51], v3 offset:9216
s_add_u32 s48, s48, 8192
s_waitcnt lgkmcnt(5)
v_smfmac_f32_16x16x64_bf16 v[56:59], v[20:23], a[0:7], v8
ds_read_b128 v[52:55], v3 offset:8192
v_smfmac_f32_16x16x64_bf16 v[60:63], v[20:23], a[56:63], v8
buffer_load_dword v119, v9, s[8:11], s48 offen sc1
ds_read_b128 v[80:83], v4 offset:2048
ds_read_b128 v[84:87], v4 offset:3072
v_smfmac_f32_16x16x64_bf16 v[64:67], v[20:23], a[112:119], v8
ds_read_b128 v[88:91], v4 offset:4096
ds_read_b128 v[92:95], v4 offset:5120
s_waitcnt lgkmcnt(9)
v_smfmac_f32_16x16x64_bf16 v[56:59], v[28:31], a[8:15], v8
ds_read_b128 v[96:99], v4 offset:12288
v_smfmac_f32_16x16x64_bf16 v[60:63], v[28:31], a[64:71], v8
buffer_load_dword v120, v9, s[8:11], s49 offen sc1
ds_read_b128 v[100:103], v4 offset:13312
v_smfmac_f32_16x16x64_bf16 v[64:67], v[28:31], a[120:127], v8
s_add_u32 s49, s49, 8192
s_waitcnt lgkmcnt(10)
v_smfmac_f32_16x16x64_bf16 v[56:59], v[36:39], v[104:111], v8
ds_read_b128 v[104:107], v4 offset:14336
s_waitcnt lgkmcnt(5)
v_smfmac_f32_16x16x64_bf16 v[60:63], v[36:39], v[80:87], v8
buffer_load_dword v121, v9, s[8:11], s49 offen sc1
ds_read_b128 v[108:111], v4 offset:15360
s_waitcnt lgkmcnt(4)
v_smfmac_f32_16x16x64_bf16 v[64:67], v[36:39], v[88:95], v8
ds_read_b128 v[80:83], v4 offset:16384
v_smfmac_f32_16x16x64_bf16 v[56:59], v[40:43], a[32:39], v8
ds_read_b64 v[112:113], v12 offset:0
v_smfmac_f32_16x16x64_bf16 v[56:59], v[44:47], a[40:47], v8
ds_read_b64 v[114:115], v12 offset:256
s_waitcnt lgkmcnt(5)
v_smfmac_f32_16x16x64_bf16 v[56:59], v[48:51], v[96:103], v8
ds_read_b128 v[84:87], v4 offset:17408
v_smfmac_f32_16x16x64_bf16 v[56:59], v[52:55], a[48:55], v8
ds_read_b128 v[88:91], v4 offset:18432
v_smfmac_f32_16x16x64_bf16 v[60:63], v[40:43], a[88:95], v8
ds_read_b128 v[92:95], v4 offset:19456
v_smfmac_f32_16x16x64_bf16 v[60:63], v[44:47], a[96:103], v8
ds_read_b128 v[96:99], v4 offset:24576
s_waitcnt lgkmcnt(7)
v_add_f32 v56, v56, v58
v_smfmac_f32_16x16x64_bf16 v[60:63], v[48:51], v[104:111], v8
ds_read_b128 v[100:103], v4 offset:25600
v_add_f32 v57, v57, v59
v_smfmac_f32_16x16x64_bf16 v[60:63], v[52:55], a[104:111], v8
s_waitcnt lgkmcnt(5)
buffer_store_dwordx4 v[112:115], v6, s[8:11], s44 offen sc1
ds_read_b128 v[104:107], v4 offset:30720
v_cvt_pk_bf16_f32 v56, v56, v57
v_smfmac_f32_16x16x64_bf16 v[64:67], v[40:43], a[144:151], v8
ds_write_b32 v5, v56 offset:12736
v_smfmac_f32_16x16x64_bf16 v[64:67], v[44:47], a[152:159], v8
ds_read_b128 v[108:111], v4 offset:31744
s_waitcnt lgkmcnt(7)
v_add_f32 v60, v60, v62
v_smfmac_f32_16x16x64_bf16 v[64:67], v[48:51], v[80:87], v8
ds_read_b128 v[80:83], v4 offset:20480
v_add_f32 v61, v61, v63
v_smfmac_f32_16x16x64_bf16 v[64:67], v[52:55], a[160:167], v8
ds_read_b128 v[84:87], v4 offset:21504
v_cvt_pk_bf16_f32 v60, v60, v61
v_smfmac_f32_16x16x64_bf16 v[68:71], v[20:23], a[168:175], v8
ds_write_b32 v5, v60 offset:13760
s_waitcnt lgkmcnt(8)
v_smfmac_f32_16x16x64_bf16 v[68:71], v[36:39], v[88:95], v8
ds_read_b128 v[88:91], v4 offset:26624
v_add_f32 v64, v64, v66
v_add_f32 v65, v65, v67
v_smfmac_f32_16x16x64_bf16 v[68:71], v[28:31], a[176:183], v8
ds_read_b128 v[92:95], v4 offset:27648
v_cvt_pk_bf16_f32 v64, v64, v65
v_smfmac_f32_16x16x64_bf16 v[68:71], v[16:19], a[184:191], v8
ds_write_b32 v5, v64 offset:14784
s_waitcnt lgkmcnt(9)
v_smfmac_f32_16x16x64_bf16 v[68:71], v[32:35], v[96:103], v8
ds_read_b128 v[96:99], v4 offset:32768
v_smfmac_f32_16x16x64_bf16 v[68:71], v[24:27], a[192:199], v8
s_waitcnt lgkmcnt(1)
s_barrier
ds_read_b128 v[100:103], v4 offset:33792
v_smfmac_f32_16x16x64_bf16 v[68:71], v[40:43], a[200:207], v8
v_smfmac_f32_16x16x64_bf16 v[68:71], v[48:51], v[104:111], v8
ds_read_b128 v[104:107], v4 offset:22528
v_smfmac_f32_16x16x64_bf16 v[68:71], v[44:47], a[208:215], v8
ds_read_b128 v[108:111], v4 offset:23552
v_smfmac_f32_16x16x64_bf16 v[68:71], v[52:55], a[216:223], v8
v_smfmac_f32_16x16x64_bf16 v[72:75], v[20:23], a[224:231], v8
v_smfmac_f32_16x16x64_bf16 v[72:75], v[36:39], v[80:87], v8
ds_read_b128 v[80:83], v4 offset:28672
v_add_f32 v68, v68, v70
v_smfmac_f32_16x16x64_bf16 v[72:75], v[28:31], a[232:239], v8
ds_read_b128 v[84:87], v4 offset:29696
v_add_f32 v69, v69, v71
v_smfmac_f32_16x16x64_bf16 v[72:75], v[16:19], a[240:247], v8
v_cvt_pk_bf16_f32 v68, v68, v69
v_smfmac_f32_16x16x64_bf16 v[72:75], v[32:35], v[88:95], v8
ds_write_b32 v5, v68 offset:0
v_smfmac_f32_16x16x64_bf16 v[72:75], v[24:27], a[248:255], v8
ds_read_b128 v[88:91], v4 offset:34816
v_smfmac_f32_16x16x64_bf16 v[72:75], v[40:43], v[176:183], v8
ds_read_b128 v[92:95], v4 offset:35840
s_waitcnt lgkmcnt(7)
v_smfmac_f32_16x16x64_bf16 v[72:75], v[48:51], v[96:103], v8
v_smfmac_f32_16x16x64_bf16 v[72:75], v[44:47], v[184:191], v8
v_smfmac_f32_16x16x64_bf16 v[72:75], v[52:55], v[192:199], v8
v_smfmac_f32_16x16x64_bf16 v[76:79], v[20:23], v[200:207], v8
s_waitcnt lgkmcnt(5)
v_smfmac_f32_16x16x64_bf16 v[76:79], v[36:39], v[104:111], v8
v_add_f32 v72, v72, v74
v_smfmac_f32_16x16x64_bf16 v[76:79], v[28:31], v[208:215], v8
v_add_f32 v73, v73, v75
v_smfmac_f32_16x16x64_bf16 v[76:79], v[16:19], v[216:223], v8
s_waitcnt lgkmcnt(3)
v_cvt_pk_bf16_f32 v72, v72, v73
v_smfmac_f32_16x16x64_bf16 v[76:79], v[32:35], v[80:87], v8
ds_write_b32 v5, v72 offset:1024
v_smfmac_f32_16x16x64_bf16 v[76:79], v[24:27], v[224:231], v8
v_smfmac_f32_16x16x64_bf16 v[76:79], v[40:43], v[232:239], v8
s_waitcnt lgkmcnt(0)
s_barrier
v_smfmac_f32_16x16x64_bf16 v[76:79], v[48:51], v[88:95], v8
v_smfmac_f32_16x16x64_bf16 v[76:79], v[44:47], v[240:247], v8
v_smfmac_f32_16x16x64_bf16 v[76:79], v[52:55], v[248:255], v8
s_nop 7
v_pk_add_f32 v[76:77], v[76:77], v[78:79]
v_cvt_pk_bf16_f32 v76, v76, v77
ds_write_b32 v5, v76 offset:2048
s_waitcnt lgkmcnt(0)
s_barrier
s_add_u32 s62, s62, 1
s_cmp_lt_u32 s62, 64
s_cbranch_scc1 Lqk_111
s_waitcnt vmcnt(0)
s_endpgm
Lg_120:
s_mov_b64 exec, s[16:17]
buffer_load_dwordx4 v[160:163], v1, s[8:11], s32 offen offset:0 sc1
s_mov_b64 exec, s[18:19]
buffer_load_dwordx4 v[164:167], v1, s[8:11], s32 offen offset:1024 sc1
s_mov_b64 exec, s[20:21]
buffer_load_dwordx4 v[168:171], v1, s[8:11], s32 offen offset:2048 sc1
s_mov_b64 exec, -1
s_waitcnt vmcnt(0)
v_max3_u32 v172, v160, v161, v162
v_max3_u32 v173, v164, v165, v166
v_max3_u32 v174, v168, v169, v170
v_max_u32 v172, v172, v163
v_max_u32 v173, v173, v167
v_max_u32 v174, v174, v171
v_cmp_eq_u32 s[16:17], -1, v172
v_cmp_eq_u32 s[18:19], -1, v173
v_cmp_eq_u32 s[20:21], -1, v174
s_or_b64 s[28:29], s[16:17], s[18:19]
s_or_b64 s[28:29], s[28:29], s[20:21]
s_cbranch_scc0 Lg_121
s_cmp_eq_u32 s65, 0
s_cbranch_scc1 Lg_121
s_sub_u32 s65, s65, 1
s_branch Lg_120
Lg_122:
Lg_123:
s_mov_b64 exec, s[22:23]
buffer_load_dwordx4 v[136:139], v1, s[8:11], s33 offen offset:0 sc1
s_mov_b64 exec, s[24:25]
buffer_load_dwordx4 v[140:143], v1, s[8:11], s33 offen offset:1024 sc1
s_mov_b64 exec, s[26:27]
buffer_load_dwordx4 v[144:147], v1, s[8:11], s33 offen offset:2048 sc1
s_mov_b64 exec, -1
s_waitcnt vmcnt(0)
v_max3_u32 v172, v136, v137, v138
v_max3_u32 v173, v140, v141, v142
v_max3_u32 v174, v144, v145, v146
v_max_u32 v172, v172, v139
v_max_u32 v173, v173, v143
v_max_u32 v174, v174, v147
v_cmp_eq_u32 s[22:23], -1, v172
v_cmp_eq_u32 s[24:25], -1, v173
v_cmp_eq_u32 s[26:27], -1, v174
s_or_b64 s[28:29], s[22:23], s[24:25]
s_or_b64 s[28:29], s[28:29], s[26:27]
s_cbranch_scc0 Lg_124
s_cmp_eq_u32 s65, 0
s_cbranch_scc1 Lg_124
s_sub_u32 s65, s65, 1
s_branch Lg_123
Lw_93:
s_mov_b32 s62, 0
s_mov_b32 s52, 0x3dd53b95
s_mov_b32 s53, s52
s_mov_b32 s79, 0x42700000
s_mul_i32 s81, s63, 384
s_add_u32 s81, s81, 192950272
s_mov_b32 s82, 0
s_cmp_ge_u32 s82, 63
s_cbranch_scc1 Lnp_130
s_cmp_ge_u32 s82, 3
s_cbranch_scc1 Lk_131
s_sub_u32 s61, s82, 12
s_max_i32 s61, s61, 0
s_lshr_b32 s61, s61, 2
s_add_u32 s61, s61, s82
s_cmp_gt_u32 s60, s61
s_cbranch_scc1 Lfd_133
v_and_b32 v14, 15, v0
v_min_u32 v14, 2, v14
v_lshlrev_b32 v14, 7, v14
Lf_132:
buffer_load_dword v13, v14, s[8:11], s81 offen sc1
s_waitcnt vmcnt(0)
v_min_u32_dpp v13, v13, v13 row_ror:8 row_mask:0xf bank_mask:0xf
s_nop 1
v_min_u32_dpp v13, v13, v13 row_ror:4 row_mask:0xf bank_mask:0xf
s_nop 1
v_min_u32_dpp v13, v13, v13 row_ror:2 row_mask:0xf bank_mask:0xf
s_nop 1
v_min_u32_dpp v13, v13, v13 row_ror:1 row_mask:0xf bank_mask:0xf
s_nop 0
v_readfirstlane_b32 s60, v13
s_nop 0
s_cmp_gt_u32 s60, s61
s_cbranch_scc1 Lfd_133
s_cmp_eq_u32 s65, 0
s_cbranch_scc1 Lfd_133
s_sub_u32 s65, s65, 1
s_branch Lf_132
Lfd_133:
Lk_131:
s_lshl_b32 s67, s82, 5
s_add_u32 s67, s67, s63
s_mul_i32 s67, s67, 12288
s_add_u32 s67, s67, 29360128
s_add_u32 s68, s67, 4096
buffer_load_dwordx4 v[112:115], v1, s[8:11], s67 offen offset:0 sc1
buffer_load_dwordx4 v[116:119], v1, s[8:11], s67 offen offset:1024 sc1
buffer_load_dwordx4 v[120:123], v1, s[8:11], s67 offen offset:2048 sc1
buffer_load_dwordx4 v[124:127], v1, s[8:11], s67 offen offset:3072 sc1
buffer_load_dwordx4 v[128:131], v1, s[8:11], s68 offen offset:0 sc1
buffer_load_dwordx4 v[132:135], v1, s[8:11], s68 offen offset:1024 sc1
Lnp_130:
ds_read_b128 v[80:83], v4 offset:0
ds_read_b128 v[84:87], v4 offset:1024
ds_read_b128 v[88:91], v4 offset:2048
ds_read_b128 v[92:95], v4 offset:3072
ds_read_b128 v[96:99], v4 offset:4096
ds_read_b128 v[100:103], v4 offset:5120
ds_read_b128 v[104:107], v4 offset:6144
ds_read_b128 v[108:111], v4 offset:7168
v_mov_b64 v[56:57], 0
v_mov_b64 v[58:59], 0
v_mov_b64 v[60:61], 0
v_mov_b64 v[62:63], 0
v_mov_b64 v[64:65], 0
v_mov_b64 v[66:67], 0
v_mov_b64 v[68:69], 0
v_mov_b64 v[70:71], 0
v_mov_b64 v[72:73], 0
v_mov_b64 v[74:75], 0
v_mov_b64 v[76:77], 0
v_mov_b64 v[78:79], 0
ds_read_b128 v[16:19], v3 offset:6144
ds_read_b128 v[24:27], v3 offset:7168
s_waitcnt lgkmcnt(0)
s_branch Lqkent_126
Lqk_125:
s_barrier
s_add_u32 s82, s62, 0
s_cmp_ge_u32 s82, 63
s_cbranch_scc1 Lnp_137
s_cmp_ge_u32 s82, 3
s_cbranch_scc1 Lk_138
s_sub_u32 s61, s82, 12
s_max_i32 s61, s61, 0
s_lshr_b32 s61, s61, 2
s_add_u32 s61, s61, s82
s_cmp_gt_u32 s60, s61
s_cbranch_scc1 Lfd_140
v_and_b32 v14, 15, v0
v_min_u32 v14, 2, v14
v_lshlrev_b32 v14, 7, v14
Lf_139:
buffer_load_dword v13, v14, s[8:11], s81 offen sc1
s_waitcnt vmcnt(0)
v_min_u32_dpp v13, v13, v13 row_ror:8 row_mask:0xf bank_mask:0xf
s_nop 1
v_min_u32_dpp v13, v13, v13 row_ror:4 row_mask:0xf bank_mask:0xf
s_nop 1
v_min_u32_dpp v13, v13, v13 row_ror:2 row_mask:0xf bank_mask:0xf
s_nop 1
v_min_u32_dpp v13, v13, v13 row_ror:1 row_mask:0xf bank_mask:0xf
s_nop 0
v_readfirstlane_b32 s60, v13
s_nop 0
s_cmp_gt_u32 s60, s61
s_cbranch_scc1 Lfd_140
s_cmp_eq_u32 s65, 0
s_cbranch_scc1 Lfd_140
s_sub_u32 s65, s65, 1
s_branch Lf_139
Lfd_140:
Lk_138:
s_lshl_b32 s67, s82, 5
s_add_u32 s67, s67, s63
s_mul_i32 s67, s67, 12288
s_add_u32 s67, s67, 29360128
s_add_u32 s68, s67, 4096
buffer_load_dwordx4 v[112:115], v1, s[8:11], s67 offen offset:0 sc1
buffer_load_dwordx4 v[116:119], v1, s[8:11], s67 offen offset:1024 sc1
buffer_load_dwordx4 v[120:123], v1, s[8:11], s67 offen offset:2048 sc1
buffer_load_dwordx4 v[124:127], v1, s[8:11], s67 offen offset:3072 sc1
buffer_load_dwordx4 v[128:131], v1, s[8:11], s68 offen offset:0 sc1
buffer_load_dwordx4 v[132:135], v1, s[8:11], s68 offen offset:1024 sc1
Lnp_137:
ds_read_b128 v[80:83], v4 offset:0
ds_read_b128 v[84:87], v4 offset:1024
ds_read_b128 v[88:91], v4 offset:2048
ds_read_b128 v[92:95], v4 offset:3072
ds_read_b128 v[96:99], v4 offset:4096
ds_read_b128 v[100:103], v4 offset:5120
ds_read_b128 v[104:107], v4 offset:6144
ds_read_b128 v[108:111], v4 offset:7168
v_mov_b64 v[56:57], 0
v_mov_b64 v[58:59], 0
v_mov_b64 v[60:61], 0
v_mov_b64 v[62:63], 0
v_mov_b64 v[64:65], 0
v_mov_b64 v[66:67], 0
v_mov_b64 v[68:69], 0
v_mov_b64 v[70:71], 0
v_mov_b64 v[72:73], 0
v_mov_b64 v[74:75], 0
v_mov_b64 v[76:77], 0
v_mov_b64 v[78:79], 0
s_add_u32 s67, s62, 0
s_and_b32 s67, s67, 3
s_lshl_b32 s67, s67, 1
s_lshl_b32 s68, s67, 15
s_add_u32 s67, s67, s64
s_mul_i32 s67, s67, 10240
s_add_u32 s33, s68, s58
s_add_u32 s32, s67, s80
s_add_u32 s32, s32, 191889408
s_sleep 9
v_mov_b32 v175, 0
s_waitcnt lgkmcnt(0)
buffer_load_dwordx4 v[160:163], v1, s[8:11], s32 offen offset:0 sc1
buffer_load_dwordx4 v[164:167], v1, s[8:11], s32 offen offset:1024 sc1
s_waitcnt vmcnt(0)
v_max3_u32 v172, v160, v161, v162
v_max3_u32 v173, v164, v165, v166
v_max_u32 v172, v172, v163
v_max_u32 v173, v173, v167
v_cmp_eq_u32 s[16:17], -1, v172
v_cmp_eq_u32 s[18:19], -1, v173
s_nop 0
s_or_b64 s[28:29], s[16:17], s[18:19]
s_cbranch_scc1 Lg_141
Lg_142:
buffer_load_dwordx4 v[136:139], v1, s[8:11], s33 offen offset:0 sc1
buffer_load_dwordx4 v[140:143], v1, s[8:11], s33 offen offset:1024 sc1
v_lshlrev_b32 v16, 16, v160
v_and_b32 v17, 0xffff0000, v160
v_lshlrev_b32 v18, 16, v161
v_and_b32 v19, 0xffff0000, v161
v_lshlrev_b32 v20, 16, v162
v_and_b32 v21, 0xffff0000, v162
v_lshlrev_b32 v22, 16, v163
v_and_b32 v23, 0xffff0000, v163
v_lshlrev_b32 v24, 16, v164
v_and_b32 v25, 0xffff0000, v164
v_lshlrev_b32 v26, 16, v165
v_and_b32 v27, 0xffff0000, v165
v_lshlrev_b32 v28, 16, v166
v_and_b32 v29, 0xffff0000, v166
v_lshlrev_b32 v30, 16, v167
v_and_b32 v31, 0xffff0000, v167
s_waitcnt vmcnt(0)
v_max3_u32 v172, v136, v137, v138
v_max3_u32 v173, v140, v141, v142
v_max_u32 v172, v172, v139
v_max_u32 v173, v173, v143
v_cmp_eq_u32 s[22:23], -1, v172
v_cmp_eq_u32 s[24:25], -1, v173
s_nop 0
s_or_b64 s[28:29], s[22:23], s[24:25]
s_cbranch_scc1 Lg_143
Lg_145:
v_dot2c_f32_bf16 v16, s100, v136
v_dot2c_f32_bf16 v17, s101, v136
v_dot2c_f32_bf16 v18, s100, v137
v_dot2c_f32_bf16 v19, s101, v137
v_dot2c_f32_bf16 v20, s100, v138
v_dot2c_f32_bf16 v21, s101, v138
v_dot2c_f32_bf16 v22, s100, v139
v_dot2c_f32_bf16 v23, s101, v139
v_cvt_pk_bf16_f32 v16, v16, v17
v_cvt_pk_bf16_f32 v17, v18, v19
v_cvt_pk_bf16_f32 v18, v20, v21
v_cvt_pk_bf16_f32 v19, v22, v23
ds_write_b128 v2, v[16:19] offset:0
v_dot2c_f32_bf16 v24, s100, v140
v_dot2c_f32_bf16 v25, s101, v140
v_dot2c_f32_bf16 v26, s100, v141
v_dot2c_f32_bf16 v27, s101, v141
v_dot2c_f32_bf16 v28, s100, v142
v_dot2c_f32_bf16 v29, s101, v142
v_dot2c_f32_bf16 v30, s100, v143
v_dot2c_f32_bf16 v31, s101, v143
v_cvt_pk_bf16_f32 v24, v24, v25
v_cvt_pk_bf16_f32 v25, v26, v27
v_cvt_pk_bf16_f32 v26, v28, v29
v_cvt_pk_bf16_f32 v27, v30, v31
ds_write_b128 v2, v[24:27] offset:1024
Lqkent_126:
v_smfmac_f32_16x16x64_bf16 v[56:59], v[16:19], a[32:39], v8
v_smfmac_f32_16x16x64_bf16 v[60:63], v[16:19], a[88:95], v8
v_smfmac_f32_16x16x64_bf16 v[64:67], v[16:19], a[144:151], v8
v_smfmac_f32_16x16x64_bf16 v[56:59], v[24:27], a[40:47], v8
s_waitcnt lgkmcnt(0)
s_barrier
ds_read_b128 v[20:23], v3 offset:2048
v_smfmac_f32_16x16x64_bf16 v[60:63], v[24:27], a[96:103], v8
ds_read_b128 v[28:31], v3 offset:0
v_smfmac_f32_16x16x64_bf16 v[64:67], v[24:27], a[152:159], v8
ds_read_b128 v[32:35], v3 offset:1024
s_waitcnt lgkmcnt(2)
v_mov_b32 v170, 0
v_smfmac_f32_16x16x64_bf16 v[56:59], v[20:23], v[80:87], v8
ds_read_b128 v[36:39], v3 offset:5120
v_smfmac_f32_16x16x64_bf16 v[60:63], v[20:23], v[88:95], v8
ds_read_b128 v[40:43], v3 offset:3072
ds_read_b128 v[80:83], v4 offset:8192
v_smfmac_f32_16x16x64_bf16 v[64:67], v[20:23], v[96:103], v8
ds_read_b128 v[44:47], v3 offset:4096
ds_read_b128 v[84:87], v4 offset:9216
s_waitcnt lgkmcnt(6)
v_smfmac_f32_16x16x64_bf16 v[56:59], v[28:31], a[0:7], v8
ds_read_b128 v[48:51], v3 offset:9216
v_smfmac_f32_16x16x64_bf16 v[60:63], v[28:31], a[56:63], v8
ds_read_b128 v[52:55], v3 offset:8192
v_smfmac_f32_16x16x64_bf16 v[64:67], v[28:31], a[112:119], v8
ds_read_b128 v[88:91], v4 offset:10240
ds_read_b128 v[92:95], v4 offset:11264
s_waitcnt lgkmcnt(9)
v_smfmac_f32_16x16x64_bf16 v[56:59], v[32:35], a[8:15], v8
ds_read_b128 v[96:99], v4 offset:12288
v_smfmac_f32_16x16x64_bf16 v[60:63], v[32:35], a[64:71], v8
ds_read_b128 v[100:103], v4 offset:13312
v_smfmac_f32_16x16x64_bf16 v[64:67], v[32:35], a[120:127], v8
s_waitcnt lgkmcnt(10)
v_smfmac_f32_16x16x64_bf16 v[56:59], v[36:39], v[104:111], v8
ds_read_b128 v[104:107], v4 offset:14336
s_waitcnt lgkmcnt(7)
v_smfmac_f32_16x16x64_bf16 v[60:63], v[36:39], v[80:87], v8
ds_read_b128 v[108:111], v4 offset:15360
s_waitcnt lgkmcnt(4)
v_smfmac_f32_16x16x64_bf16 v[64:67], v[36:39], v[88:95], v8
ds_read_b128 v[80:83], v4 offset:16384
v_smfmac_f32_16x16x64_bf16 v[56:59], v[40:43], a[16:23], v8
ds_read_b128 v[84:87], v4 offset:17408
v_smfmac_f32_16x16x64_bf16 v[56:59], v[44:47], a[24:31], v8
ds_read_b128 v[88:91], v4 offset:18432
s_waitcnt lgkmcnt(5)
v_smfmac_f32_16x16x64_bf16 v[56:59], v[48:51], v[96:103], v8
ds_read_b128 v[92:95], v4 offset:19456
v_smfmac_f32_16x16x64_bf16 v[56:59], v[52:55], a[48:55], v8
ds_read_b128 v[96:99], v4 offset:24576
v_smfmac_f32_16x16x64_bf16 v[60:63], v[40:43], a[72:79], v8
ds_read_b128 v[100:103], v4 offset:25600
v_smfmac_f32_16x16x64_bf16 v[60:63], v[44:47], a[80:87], v8
s_waitcnt lgkmcnt(6)
v_add_f32 v56, v56, v58
v_smfmac_f32_16x16x64_bf16 v[60:63], v[48:51], v[104:111], v8
ds_read_b128 v[104:107], v4 offset:30720
v_add_f32 v57, v57, v59
v_smfmac_f32_16x16x64_bf16 v[60:63], v[52:55], a[104:111], v8
ds_read_b128 v[108:111], v4 offset:31744
v_cvt_pk_bf16_f32 v56, v56, v57
v_smfmac_f32_16x16x64_bf16 v[64:67], v[40:43], a[128:135], v8
ds_write_b32 v5, v56 offset:12736
v_smfmac_f32_16x16x64_bf16 v[64:67], v[44:47], a[136:143], v8
s_waitcnt lgkmcnt(7)
v_add_f32 v60, v60, v62
v_smfmac_f32_16x16x64_bf16 v[64:67], v[48:51], v[80:87], v8
ds_read_b128 v[80:83], v4 offset:20480
v_add_f32 v61, v61, v63
v_smfmac_f32_16x16x64_bf16 v[64:67], v[52:55], a[160:167], v8
ds_read_b128 v[84:87], v4 offset:21504
v_cvt_pk_bf16_f32 v60, v60, v61
v_smfmac_f32_16x16x64_bf16 v[68:71], v[28:31], a[168:175], v8
ds_write_b32 v5, v60 offset:13760
s_waitcnt lgkmcnt(8)
v_smfmac_f32_16x16x64_bf16 v[68:71], v[20:23], v[88:95], v8
ds_read_b128 v[88:91], v4 offset:26624
v_add_f32 v64, v64, v66
v_add_f32 v65, v65, v67
v_smfmac_f32_16x16x64_bf16 v[68:71], v[32:35], a[176:183], v8
ds_read_b128 v[92:95], v4 offset:27648
v_cvt_pk_bf16_f32 v64, v64, v65
v_smfmac_f32_16x16x64_bf16 v[68:71], v[40:43], a[184:191], v8
ds_write_b32 v5, v64 offset:14784
s_waitcnt lgkmcnt(9)
v_smfmac_f32_16x16x64_bf16 v[68:71], v[36:39], v[96:103], v8
ds_read_b128 v[96:99], v4 offset:32768
v_smfmac_f32_16x16x64_bf16 v[68:71], v[44:47], a[192:199], v8
ds_read_b128 v[100:103], v4 offset:33792
v_smfmac_f32_16x16x64_bf16 v[68:71], v[16:19], a[200:207], v8
s_waitcnt lgkmcnt(9)
v_smfmac_f32_16x16x64_bf16 v[68:71], v[48:51], v[104:111], v8
ds_read_b128 v[104:107], v4 offset:22528
v_smfmac_f32_16x16x64_bf16 v[68:71], v[24:27], a[208:215], v8
s_waitcnt vmcnt(0)
s_waitcnt lgkmcnt(3)
s_barrier
ds_read_b64_tr_b16 v[136:137], v7 offset:12736
ds_read_b64_tr_b16 v[138:139], v7 offset:12992
v_smfmac_f32_16x16x64_bf16 v[68:71], v[52:55], a[216:223], v8
ds_read_b64_tr_b16 v[140:141], v7 offset:13248
v_smfmac_f32_16x16x64_bf16 v[72:75], v[28:31], a[224:231], v8
ds_read_b64_tr_b16 v[142:143], v7 offset:13504
v_smfmac_f32_16x16x64_bf16 v[72:75], v[20:23], v[80:87], v8
ds_read_b64_tr_b16 v[144:145], v7 offset:13760
v_add_f32 v68, v68, v70
v_smfmac_f32_16x16x64_bf16 v[72:75], v[32:35], a[232:239], v8
ds_read_b64_tr_b16 v[146:147], v7 offset:14016
v_add_f32 v69, v69, v71
v_smfmac_f32_16x16x64_bf16 v[72:75], v[40:43], a[240:247], v8
ds_read_b64_tr_b16 v[148:149], v7 offset:14272
ds_read_b64_tr_b16 v[150:151], v7 offset:14528
v_cvt_pk_bf16_f32 v68, v68, v69
v_smfmac_f32_16x16x64_bf16 v[72:75], v[36:39], v[88:95], v8
ds_read_b64_tr_b16 v[152:153], v7 offset:14784
ds_write_b32 v5, v68 offset:0
v_smfmac_f32_16x16x64_bf16 v[72:75], v[44:47], a[248:255], v8
ds_read_b64_tr_b16 v[154:155], v7 offset:15040
v_smfmac_f32_16x16x64_bf16 v[72:75], v[16:19], v[176:183], v8
ds_read_b64_tr_b16 v[156:157], v7 offset:15296
s_waitcnt lgkmcnt(13)
v_smfmac_f32_16x16x64_bf16 v[72:75], v[48:51], v[96:103], v8
ds_read_b64_tr_b16 v[158:159], v7 offset:15552
v_smfmac_f32_16x16x64_bf16 v[72:75], v[24:27], v[184:191], v8
ds_read_b128 v[108:111], v4 offset:23552
v_smfmac_f32_16x16x64_bf16 v[72:75], v[52:55], v[192:199], v8
ds_read_b128 v[80:83], v4 offset:28672
s_waitcnt lgkmcnt(13)
v_mfma_f32_16x16x32_bf16 v[160:163], v[112:115], v[136:139], 0
ds_read_b128 v[84:87], v4 offset:29696
s_waitcnt lgkmcnt(12)
v_mfma_f32_16x16x32_bf16 v[160:163], v[116:119], v[140:143], v[160:163]
ds_read_b128 v[88:91], v4 offset:34816
s_waitcnt lgkmcnt(11)
v_add_f32 v72, v72, v74
v_mfma_f32_16x16x32_bf16 v[160:163], v[120:123], v[144:147], v[160:163]
ds_read_b128 v[92:95], v4 offset:35840
s_waitcnt lgkmcnt(10)
v_add_f32 v73, v73, v75
v_mfma_f32_16x16x32_bf16 v[160:163], v[124:127], v[148:151], v[160:163]
s_waitcnt lgkmcnt(7)
v_cvt_pk_bf16_f32 v72, v72, v73
v_mfma_f32_16x16x32_bf16 v[160:163], v[128:131], v[152:155], v[160:163]
ds_write_b32 v5, v72 offset:1024
s_waitcnt lgkmcnt(6)
v_mfma_f32_16x16x32_bf16 v[160:163], v[132:135], v[156:159], v[160:163]
v_smfmac_f32_16x16x64_bf16 v[76:79], v[28:31], v[200:207], v8
s_waitcnt lgkmcnt(5)
v_smfmac_f32_16x16x64_bf16 v[76:79], v[20:23], v[104:111], v8
v_cndmask_b32 v164, v160, v162, s[70:71]
v_cndmask_b32 v165, v161, v163, s[70:71]
v_smfmac_f32_16x16x64_bf16 v[76:79], v[32:35], v[208:215], v8
s_waitcnt lgkmcnt(0)
s_barrier
v_mul_f32 v164, s52, v164
v_mul_f32 v165, s52, v165
v_smfmac_f32_16x16x64_bf16 v[76:79], v[40:43], v[216:223], v8
v_exp_f32 v168, v164
v_smfmac_f32_16x16x64_bf16 v[76:79], v[36:39], v[80:87], v8
v_exp_f32 v169, v165
v_smfmac_f32_16x16x64_bf16 v[76:79], v[44:47], v[224:231], v8
v_max_f32 v172, |v164|, |v165|
v_smfmac_f32_16x16x64_bf16 v[76:79], v[16:19], v[232:239], v8
v_add_f32 v171, v168, v169
v_smfmac_f32_16x16x64_bf16 v[76:79], v[48:51], v[88:95], v8
v_cmp_lt_f32 vcc, s79, v172
v_smfmac_f32_16x16x64_bf16 v[76:79], v[24:27], v[240:247], v8
s_cbranch_vccnz Lsx_128
Lsxb_129:
ds_write_b128 v11, v[168:171] offset:0
v_smfmac_f32_16x16x64_bf16 v[76:79], v[52:55], v[248:255], v8
s_nop 7
v_pk_add_f32 v[76:77], v[76:77], v[78:79]
v_cvt_pk_bf16_f32 v76, v76, v77
ds_write_b32 v5, v76 offset:2048
s_waitcnt lgkmcnt(0)
s_barrier
s_add_u32 s62, s62, 1
s_cmp_lt_u32 s62, 64
s_cbranch_scc1 Lqk_125
s_waitcnt vmcnt(0)
s_endpgm
Lg_141:
s_mov_b64 exec, s[16:17]
buffer_load_dwordx4 v[160:163], v1, s[8:11], s32 offen offset:0 sc1
s_mov_b64 exec, s[18:19]
buffer_load_dwordx4 v[164:167], v1, s[8:11], s32 offen offset:1024 sc1
s_mov_b64 exec, -1
s_waitcnt vmcnt(0)
v_max3_u32 v172, v160, v161, v162
v_max3_u32 v173, v164, v165, v166
v_max_u32 v172, v172, v163
v_max_u32 v173, v173, v167
v_cmp_eq_u32 s[16:17], -1, v172
v_cmp_eq_u32 s[18:19], -1, v173
s_nop 0
s_or_b64 s[28:29], s[16:17], s[18:19]
s_cbranch_scc0 Lg_142
s_cmp_eq_u32 s65, 0
s_cbranch_scc1 Lg_142
s_sub_u32 s65, s65, 1
s_branch Lg_141
Lg_143:
Lg_144:
s_mov_b64 exec, s[22:23]
buffer_load_dwordx4 v[136:139], v1, s[8:11], s33 offen offset:0 sc1
s_mov_b64 exec, s[24:25]
buffer_load_dwordx4 v[140:143], v1, s[8:11], s33 offen offset:1024 sc1
s_mov_b64 exec, -1
s_waitcnt vmcnt(0)
v_max3_u32 v172, v136, v137, v138
v_max3_u32 v173, v140, v141, v142
v_max_u32 v172, v172, v139
v_max_u32 v173, v173, v143
v_cmp_eq_u32 s[22:23], -1, v172
v_cmp_eq_u32 s[24:25], -1, v173
s_nop 0
s_or_b64 s[28:29], s[22:23], s[24:25]
s_cbranch_scc0 Lg_145
s_cmp_eq_u32 s65, 0
s_cbranch_scc1 Lg_145
s_sub_u32 s65, s65, 1
s_branch Lg_144
Lsx_128:
v_max_f32 v170, v164, v165
s_nop 1
v_max_f32_dpp v170, v170, v170 row_ror:8 row_mask:0xf bank_mask:0xf
v_mov_b32 v172, v170
s_nop 1
v_permlane16_swap_b32 v170, v172
v_max_f32 v170, v170, v172
v_mov_b32 v172, v170
s_nop 1
v_permlane32_swap_b32 v170, v172
v_max_f32 v170, v170, v172
v_sub_f32 v168, v164, v170
v_sub_f32 v169, v165, v170
v_exp_f32 v168, v168
v_exp_f32 v169, v169
s_nop 0
v_add_f32 v171, v168, v169
s_branch Lsxb_129
Lw_94:
s_mov_b32 s62, 0
s_mov_b32 s52, 0x3dd53b95
s_mov_b32 s53, s52
s_mov_b32 s79, 0x42700000
s_mul_i32 s81, s63, 384
s_add_u32 s81, s81, 192950272
s_mov_b32 s82, 0
s_cmp_ge_u32 s82, 63
s_cbranch_scc1 Lnp_151
s_cmp_ge_u32 s82, 3
s_cbranch_scc1 Lk_152
s_sub_u32 s61, s82, 12
s_max_i32 s61, s61, 0
s_lshr_b32 s61, s61, 2
s_add_u32 s61, s61, s82
s_cmp_gt_u32 s60, s61
s_cbranch_scc1 Lfd_154
v_and_b32 v14, 15, v0
v_min_u32 v14, 2, v14
v_lshlrev_b32 v14, 7, v14
Lf_153:
buffer_load_dword v13, v14, s[8:11], s81 offen sc1
s_waitcnt vmcnt(0)
v_min_u32_dpp v13, v13, v13 row_ror:8 row_mask:0xf bank_mask:0xf
s_nop 1
v_min_u32_dpp v13, v13, v13 row_ror:4 row_mask:0xf bank_mask:0xf
s_nop 1
v_min_u32_dpp v13, v13, v13 row_ror:2 row_mask:0xf bank_mask:0xf
s_nop 1
v_min_u32_dpp v13, v13, v13 row_ror:1 row_mask:0xf bank_mask:0xf
s_nop 0
v_readfirstlane_b32 s60, v13
s_nop 0
s_cmp_gt_u32 s60, s61
s_cbranch_scc1 Lfd_154
s_cmp_eq_u32 s65, 0
s_cbranch_scc1 Lfd_154
s_sub_u32 s65, s65, 1
s_branch Lf_153
Lfd_154:
Lk_152:
s_lshl_b32 s67, s82, 5
s_add_u32 s67, s67, s63
s_mul_i32 s67, s67, 12288
s_add_u32 s67, s67, 29366272
s_add_u32 s68, s67, 4096
buffer_load_dwordx4 v[112:115], v1, s[8:11], s67 offen offset:0 sc1
buffer_load_dwordx4 v[116:119], v1, s[8:11], s67 offen offset:1024 sc1
buffer_load_dwordx4 v[120:123], v1, s[8:11], s67 offen offset:2048 sc1
buffer_load_dwordx4 v[124:127], v1, s[8:11], s67 offen offset:3072 sc1
buffer_load_dwordx4 v[128:131], v1, s[8:11], s68 offen offset:0 sc1
buffer_load_dwordx4 v[132:135], v1, s[8:11], s68 offen offset:1024 sc1
Lnp_151:
ds_read_b128 v[80:83], v4 offset:12288
ds_read_b128 v[84:87], v4 offset:13312
ds_read_b128 v[88:91], v4 offset:14336
ds_read_b128 v[92:95], v4 offset:15360
ds_read_b128 v[96:99], v4 offset:16384
ds_read_b128 v[100:103], v4 offset:17408
ds_read_b128 v[104:107], v4 offset:0
ds_read_b128 v[108:111], v4 offset:1024
v_mov_b64 v[56:57], 0
v_mov_b64 v[58:59], 0
v_mov_b64 v[60:61], 0
v_mov_b64 v[62:63], 0
v_mov_b64 v[64:65], 0
v_mov_b64 v[66:67], 0
v_mov_b64 v[68:69], 0
v_mov_b64 v[70:71], 0
v_mov_b64 v[72:73], 0
v_mov_b64 v[74:75], 0
v_mov_b64 v[76:77], 0
v_mov_b64 v[78:79], 0
ds_read_b128 v[16:19], v3 offset:8192
ds_read_b128 v[24:27], v3 offset:9216
s_waitcnt lgkmcnt(0)
s_branch Lqkent_147
Lqk_146:
s_barrier
s_add_u32 s82, s62, 0
s_cmp_ge_u32 s82, 63
s_cbranch_scc1 Lnp_158
s_cmp_ge_u32 s82, 3
s_cbranch_scc1 Lk_159
s_sub_u32 s61, s82, 12
s_max_i32 s61, s61, 0
s_lshr_b32 s61, s61, 2
s_add_u32 s61, s61, s82
s_cmp_gt_u32 s60, s61
s_cbranch_scc1 Lfd_161
v_and_b32 v14, 15, v0
v_min_u32 v14, 2, v14
v_lshlrev_b32 v14, 7, v14
Lf_160:
buffer_load_dword v13, v14, s[8:11], s81 offen sc1
s_waitcnt vmcnt(0)
v_min_u32_dpp v13, v13, v13 row_ror:8 row_mask:0xf bank_mask:0xf
s_nop 1
v_min_u32_dpp v13, v13, v13 row_ror:4 row_mask:0xf bank_mask:0xf
s_nop 1
v_min_u32_dpp v13, v13, v13 row_ror:2 row_mask:0xf bank_mask:0xf
s_nop 1
v_min_u32_dpp v13, v13, v13 row_ror:1 row_mask:0xf bank_mask:0xf
s_nop 0
v_readfirstlane_b32 s60, v13
s_nop 0
s_cmp_gt_u32 s60, s61
s_cbranch_scc1 Lfd_161
s_cmp_eq_u32 s65, 0
s_cbranch_scc1 Lfd_161
s_sub_u32 s65, s65, 1
s_branch Lf_160
Lfd_161:
Lk_159:
s_lshl_b32 s67, s82, 5
s_add_u32 s67, s67, s63
s_mul_i32 s67, s67, 12288
s_add_u32 s67, s67, 29366272
s_add_u32 s68, s67, 4096
buffer_load_dwordx4 v[112:115], v1, s[8:11], s67 offen offset:0 sc1
buffer_load_dwordx4 v[116:119], v1, s[8:11], s67 offen offset:1024 sc1
buffer_load_dwordx4 v[120:123], v1, s[8:11], s67 offen offset:2048 sc1
buffer_load_dwordx4 v[124:127], v1, s[8:11], s67 offen offset:3072 sc1
buffer_load_dwordx4 v[128:131], v1, s[8:11], s68 offen offset:0 sc1
buffer_load_dwordx4 v[132:135], v1, s[8:11], s68 offen offset:1024 sc1
Lnp_158:
ds_read_b128 v[80:83], v4 offset:12288
ds_read_b128 v[84:87], v4 offset:13312
ds_read_b128 v[88:91], v4 offset:14336
ds_read_b128 v[92:95], v4 offset:15360
ds_read_b128 v[96:99], v4 offset:16384
ds_read_b128 v[100:103], v4 offset:17408
ds_read_b128 v[104:107], v4 offset:0
ds_read_b128 v[108:111], v4 offset:1024
v_mov_b64 v[56:57], 0
v_mov_b64 v[58:59], 0
v_mov_b64 v[60:61], 0
v_mov_b64 v[62:63], 0
v_mov_b64 v[64:65], 0
v_mov_b64 v[66:67], 0
v_mov_b64 v[68:69], 0
v_mov_b64 v[70:71], 0
v_mov_b64 v[72:73], 0
v_mov_b64 v[74:75], 0
v_mov_b64 v[76:77], 0
v_mov_b64 v[78:79], 0
s_add_u32 s67, s62, 0
s_and_b32 s67, s67, 3
s_lshl_b32 s67, s67, 1
s_lshl_b32 s68, s67, 15
s_add_u32 s67, s67, s64
s_mul_i32 s67, s67, 10240
s_add_u32 s33, s68, s58
s_add_u32 s32, s67, s80
s_add_u32 s32, s32, 191889408
s_sleep 9
v_mov_b32 v175, 0
s_waitcnt lgkmcnt(0)
buffer_load_dwordx4 v[160:163], v1, s[8:11], s32 offen offset:0 sc1
buffer_load_dwordx4 v[164:167], v1, s[8:11], s32 offen offset:1024 sc1
s_waitcnt vmcnt(0)
v_max3_u32 v172, v160, v161, v162
v_max3_u32 v173, v164, v165, v166
v_max_u32 v172, v172, v163
v_max_u32 v173, v173, v167
v_cmp_eq_u32 s[16:17], -1, v172
v_cmp_eq_u32 s[18:19], -1, v173
s_nop 0
s_or_b64 s[28:29], s[16:17], s[18:19]
s_cbranch_scc1 Lg_162
Lg_163:
buffer_load_dwordx4 v[136:139], v1, s[8:11], s33 offen offset:0 sc1
buffer_load_dwordx4 v[140:143], v1, s[8:11], s33 offen offset:1024 sc1
v_lshlrev_b32 v16, 16, v160
v_and_b32 v17, 0xffff0000, v160
v_lshlrev_b32 v18, 16, v161
v_and_b32 v19, 0xffff0000, v161
v_lshlrev_b32 v20, 16, v162
v_and_b32 v21, 0xffff0000, v162
v_lshlrev_b32 v22, 16, v163
v_and_b32 v23, 0xffff0000, v163
v_lshlrev_b32 v24, 16, v164
v_and_b32 v25, 0xffff0000, v164
v_lshlrev_b32 v26, 16, v165
v_and_b32 v27, 0xffff0000, v165
v_lshlrev_b32 v28, 16, v166
v_and_b32 v29, 0xffff0000, v166
v_lshlrev_b32 v30, 16, v167
v_and_b32 v31, 0xffff0000, v167
s_waitcnt vmcnt(0)
v_max3_u32 v172, v136, v137, v138
v_max3_u32 v173, v140, v141, v142
v_max_u32 v172, v172, v139
v_max_u32 v173, v173, v143
v_cmp_eq_u32 s[22:23], -1, v172
v_cmp_eq_u32 s[24:25], -1, v173
s_nop 0
s_or_b64 s[28:29], s[22:23], s[24:25]
s_cbranch_scc1 Lg_164
Lg_166:
v_dot2c_f32_bf16 v16, s100, v136
v_dot2c_f32_bf16 v17, s101, v136
v_dot2c_f32_bf16 v18, s100, v137
v_dot2c_f32_bf16 v19, s101, v137
v_dot2c_f32_bf16 v20, s100, v138
v_dot2c_f32_bf16 v21, s101, v138
v_dot2c_f32_bf16 v22, s100, v139
v_dot2c_f32_bf16 v23, s101, v139
v_cvt_pk_bf16_f32 v16, v16, v17
v_cvt_pk_bf16_f32 v17, v18, v19
v_cvt_pk_bf16_f32 v18, v20, v21
v_cvt_pk_bf16_f32 v19, v22, v23
ds_write_b128 v2, v[16:19] offset:0
v_dot2c_f32_bf16 v24, s100, v140
v_dot2c_f32_bf16 v25, s101, v140
v_dot2c_f32_bf16 v26, s100, v141
v_dot2c_f32_bf16 v27, s101, v141
v_dot2c_f32_bf16 v28, s100, v142
v_dot2c_f32_bf16 v29, s101, v142
v_dot2c_f32_bf16 v30, s100, v143
v_dot2c_f32_bf16 v31, s101, v143
v_cvt_pk_bf16_f32 v24, v24, v25
v_cvt_pk_bf16_f32 v25, v26, v27
v_cvt_pk_bf16_f32 v26, v28, v29
v_cvt_pk_bf16_f32 v27, v30, v31
ds_write_b128 v2, v[24:27] offset:1024
Lqkent_147:
v_smfmac_f32_16x16x64_bf16 v[56:59], v[16:19], a[48:55], v8
v_smfmac_f32_16x16x64_bf16 v[60:63], v[16:19], a[104:111], v8
v_smfmac_f32_16x16x64_bf16 v[64:67], v[16:19], a[160:167], v8
v_smfmac_f32_16x16x64_bf16 v[56:59], v[24:27], v[80:87], v8
s_waitcnt lgkmcnt(0)
s_barrier
ds_read_b128 v[20:23], v3 offset:0
v_smfmac_f32_16x16x64_bf16 v[60:63], v[24:27], v[88:95], v8
ds_read_b128 v[28:31], v3 offset:1024
ds_read_b128 v[80:83], v4 offset:2048
v_smfmac_f32_16x16x64_bf16 v[64:67], v[24:27], v[96:103], v8
ds_read_b128 v[32:35], v3 offset:2048
ds_read_b128 v[84:87], v4 offset:3072
ds_read_b128 v[88:91], v4 offset:4096
s_waitcnt lgkmcnt(5)
v_mov_b32 v170, 0
v_smfmac_f32_16x16x64_bf16 v[56:59], v[20:23], a[0:7], v8
ds_read_b128 v[36:39], v3 offset:3072
ds_read_b128 v[92:95], v4 offset:5120
v_smfmac_f32_16x16x64_bf16 v[60:63], v[20:23], a[56:63], v8
ds_read_b128 v[40:43], v3 offset:4096
v_smfmac_f32_16x16x64_bf16 v[64:67], v[20:23], a[112:119], v8
ds_read_b128 v[44:47], v3 offset:6144
s_waitcnt lgkmcnt(8)
v_smfmac_f32_16x16x64_bf16 v[56:59], v[28:31], a[8:15], v8
ds_read_b128 v[48:51], v3 offset:5120
v_smfmac_f32_16x16x64_bf16 v[60:63], v[28:31], a[64:71], v8
ds_read_b128 v[52:55], v3 offset:7168
v_smfmac_f32_16x16x64_bf16 v[64:67], v[28:31], a[120:127], v8
ds_read_b128 v[96:99], v4 offset:6144
s_waitcnt lgkmcnt(9)
v_smfmac_f32_16x16x64_bf16 v[56:59], v[32:35], v[104:111], v8
ds_read_b128 v[100:103], v4 offset:7168
s_waitcnt lgkmcnt(9)
v_smfmac_f32_16x16x64_bf16 v[60:63], v[32:35], v[80:87], v8
ds_read_b128 v[104:107], v4 offset:8192
s_waitcnt lgkmcnt(7)
v_smfmac_f32_16x16x64_bf16 v[64:67], v[32:35], v[88:95], v8
ds_read_b128 v[108:111], v4 offset:9216
v_smfmac_f32_16x16x64_bf16 v[56:59], v[36:39], a[16:23], v8
ds_read_b128 v[80:83], v4 offset:10240
v_smfmac_f32_16x16x64_bf16 v[60:63], v[36:39], a[72:79], v8
ds_read_b128 v[84:87], v4 offset:11264
v_smfmac_f32_16x16x64_bf16 v[64:67], v[36:39], a[128:135], v8
ds_read_b128 v[88:91], v4 offset:18432
s_waitcnt lgkmcnt(10)
v_smfmac_f32_16x16x64_bf16 v[56:59], v[40:43], a[24:31], v8
ds_read_b128 v[92:95], v4 offset:19456
s_waitcnt lgkmcnt(10)
v_smfmac_f32_16x16x64_bf16 v[56:59], v[44:47], a[32:39], v8
s_waitcnt lgkmcnt(6)
v_smfmac_f32_16x16x64_bf16 v[56:59], v[48:51], v[96:103], v8
ds_read_b128 v[96:99], v4 offset:24576
v_smfmac_f32_16x16x64_bf16 v[56:59], v[52:55], a[40:47], v8
ds_read_b128 v[100:103], v4 offset:25600
v_smfmac_f32_16x16x64_bf16 v[60:63], v[40:43], a[80:87], v8
v_smfmac_f32_16x16x64_bf16 v[60:63], v[44:47], a[88:95], v8
s_waitcnt lgkmcnt(6)
v_add_f32 v56, v56, v58
v_smfmac_f32_16x16x64_bf16 v[60:63], v[48:51], v[104:111], v8
ds_read_b128 v[104:107], v4 offset:30720
v_add_f32 v57, v57, v59
v_smfmac_f32_16x16x64_bf16 v[60:63], v[52:55], a[96:103], v8
ds_read_b128 v[108:111], v4 offset:31744
v_cvt_pk_bf16_f32 v56, v56, v57
v_smfmac_f32_16x16x64_bf16 v[64:67], v[40:43], a[136:143], v8
ds_write_b32 v5, v56 offset:12736
v_smfmac_f32_16x16x64_bf16 v[64:67], v[44:47], a[144:151], v8
s_waitcnt lgkmcnt(7)
v_add_f32 v60, v60, v62
v_smfmac_f32_16x16x64_bf16 v[64:67], v[48:51], v[80:87], v8
ds_read_b128 v[80:83], v4 offset:20480
v_add_f32 v61, v61, v63
v_smfmac_f32_16x16x64_bf16 v[64:67], v[52:55], a[152:159], v8
ds_read_b128 v[84:87], v4 offset:21504
v_cvt_pk_bf16_f32 v60, v60, v61
v_smfmac_f32_16x16x64_bf16 v[68:71], v[20:23], a[168:175], v8
ds_write_b32 v5, v60 offset:13760
s_waitcnt lgkmcnt(8)
v_smfmac_f32_16x16x64_bf16 v[68:71], v[32:35], v[88:95], v8
ds_read_b128 v[88:91], v4 offset:26624
v_add_f32 v64, v64, v66
v_add_f32 v65, v65, v67
v_smfmac_f32_16x16x64_bf16 v[68:71], v[28:31], a[176:183], v8
ds_read_b128 v[92:95], v4 offset:27648
v_cvt_pk_bf16_f32 v64, v64, v65
v_smfmac_f32_16x16x64_bf16 v[68:71], v[36:39], a[184:191], v8
ds_write_b32 v5, v64 offset:14784
s_waitcnt lgkmcnt(9)
v_smfmac_f32_16x16x64_bf16 v[68:71], v[48:51], v[96:103], v8
ds_read_b128 v[96:99], v4 offset:32768
v_smfmac_f32_16x16x64_bf16 v[68:71], v[40:43], a[192:199], v8
ds_read_b128 v[100:103], v4 offset:33792
v_smfmac_f32_16x16x64_bf16 v[68:71], v[44:47], a[200:207], v8
s_waitcnt lgkmcnt(9)
v_smfmac_f32_16x16x64_bf16 v[68:71], v[24:27], v[104:111], v8
ds_read_b128 v[104:107], v4 offset:22528
v_smfmac_f32_16x16x64_bf16 v[68:71], v[52:55], a[208:215], v8
s_waitcnt vmcnt(0)
s_waitcnt lgkmcnt(3)
s_barrier
ds_read_b64_tr_b16 v[136:137], v7 offset:12736
ds_read_b64_tr_b16 v[138:139], v7 offset:12992
v_smfmac_f32_16x16x64_bf16 v[68:71], v[16:19], a[216:223], v8
ds_read_b64_tr_b16 v[140:141], v7 offset:13248
v_smfmac_f32_16x16x64_bf16 v[72:75], v[20:23], a[224:231], v8
ds_read_b64_tr_b16 v[142:143], v7 offset:13504
v_smfmac_f32_16x16x64_bf16 v[72:75], v[32:35], v[80:87], v8
ds_read_b64_tr_b16 v[144:145], v7 offset:13760
v_add_f32 v68, v68, v70
v_smfmac_f32_16x16x64_bf16 v[72:75], v[28:31], a[232:239], v8
ds_read_b64_tr_b16 v[146:147], v7 offset:14016
v_add_f32 v69, v69, v71
v_smfmac_f32_16x16x64_bf16 v[72:75], v[36:39], a[240:247], v8
ds_read_b64_tr_b16 v[148:149], v7 offset:14272
ds_read_b64_tr_b16 v[150:151], v7 offset:14528
v_cvt_pk_bf16_f32 v68, v68, v69
v_smfmac_f32_16x16x64_bf16 v[72:75], v[48:51], v[88:95], v8
ds_read_b64_tr_b16 v[152:153], v7 offset:14784
ds_write_b32 v5, v68 offset:0
v_smfmac_f32_16x16x64_bf16 v[72:75], v[40:43], a[248:255], v8
ds_read_b64_tr_b16 v[154:155], v7 offset:15040
v_smfmac_f32_16x16x64_bf16 v[72:75], v[44:47], v[176:183], v8
ds_read_b64_tr_b16 v[156:157], v7 offset:15296
s_waitcnt lgkmcnt(13)
v_smfmac_f32_16x16x64_bf16 v[72:75], v[24:27], v[96:103], v8
ds_read_b64_tr_b16 v[158:159], v7 offset:15552
v_smfmac_f32_16x16x64_bf16 v[72:75], v[52:55], v[184:191], v8
ds_read_b128 v[108:111], v4 offset:23552
v_smfmac_f32_16x16x64_bf16 v[72:75], v[16:19], v[192:199], v8
ds_read_b128 v[80:83], v4 offset:28672
s_waitcnt lgkmcnt(13)
v_mfma_f32_16x16x32_bf16 v[160:163], v[112:115], v[136:139], 0
ds_read_b128 v[84:87], v4 offset:29696
s_waitcnt lgkmcnt(12)
v_mfma_f32_16x16x32_bf16 v[160:163], v[116:119], v[140:143], v[160:163]
ds_read_b128 v[88:91], v4 offset:34816
s_waitcnt lgkmcnt(11)
v_add_f32 v72, v72, v74
v_mfma_f32_16x16x32_bf16 v[160:163], v[120:123], v[144:147], v[160:163]
ds_read_b128 v[92:95], v4 offset:35840
s_waitcnt lgkmcnt(10)
v_add_f32 v73, v73, v75
v_mfma_f32_16x16x32_bf16 v[160:163], v[124:127], v[148:151], v[160:163]
s_waitcnt lgkmcnt(7)
v_cvt_pk_bf16_f32 v72, v72, v73
v_mfma_f32_16x16x32_bf16 v[160:163], v[128:131], v[152:155], v[160:163]
ds_write_b32 v5, v72 offset:1024
s_waitcnt lgkmcnt(6)
v_mfma_f32_16x16x32_bf16 v[160:163], v[132:135], v[156:159], v[160:163]
v_smfmac_f32_16x16x64_bf16 v[76:79], v[20:23], v[200:207], v8
s_waitcnt lgkmcnt(5)
v_smfmac_f32_16x16x64_bf16 v[76:79], v[32:35], v[104:111], v8
v_cndmask_b32 v164, v160, v162, s[70:71]
v_cndmask_b32 v165, v161, v163, s[70:71]
v_smfmac_f32_16x16x64_bf16 v[76:79], v[28:31], v[208:215], v8
s_waitcnt lgkmcnt(0)
s_barrier
v_mul_f32 v164, s52, v164
v_mul_f32 v165, s52, v165
v_smfmac_f32_16x16x64_bf16 v[76:79], v[36:39], v[216:223], v8
v_exp_f32 v168, v164
v_smfmac_f32_16x16x64_bf16 v[76:79], v[48:51], v[80:87], v8
v_exp_f32 v169, v165
v_smfmac_f32_16x16x64_bf16 v[76:79], v[40:43], v[224:231], v8
v_max_f32 v172, |v164|, |v165|
v_smfmac_f32_16x16x64_bf16 v[76:79], v[44:47], v[232:239], v8
v_add_f32 v171, v168, v169
v_smfmac_f32_16x16x64_bf16 v[76:79], v[24:27], v[88:95], v8
v_cmp_lt_f32 vcc, s79, v172
v_smfmac_f32_16x16x64_bf16 v[76:79], v[52:55], v[240:247], v8
s_cbranch_vccnz Lsx_149
Lsxb_150:
ds_write_b128 v11, v[168:171] offset:1024
v_smfmac_f32_16x16x64_bf16 v[76:79], v[16:19], v[248:255], v8
s_nop 7
v_pk_add_f32 v[76:77], v[76:77], v[78:79]
v_cvt_pk_bf16_f32 v76, v76, v77
ds_write_b32 v5, v76 offset:2048
s_waitcnt lgkmcnt(0)
s_barrier
s_add_u32 s62, s62, 1
s_cmp_lt_u32 s62, 64
s_cbranch_scc1 Lqk_146
s_waitcnt vmcnt(0)
s_endpgm
Lg_162:
s_mov_b64 exec, s[16:17]
buffer_load_dwordx4 v[160:163], v1, s[8:11], s32 offen offset:0 sc1
s_mov_b64 exec, s[18:19]
buffer_load_dwordx4 v[164:167], v1, s[8:11], s32 offen offset:1024 sc1
s_mov_b64 exec, -1
s_waitcnt vmcnt(0)
v_max3_u32 v172, v160, v161, v162
v_max3_u32 v173, v164, v165, v166
v_max_u32 v172, v172, v163
v_max_u32 v173, v173, v167
v_cmp_eq_u32 s[16:17], -1, v172
v_cmp_eq_u32 s[18:19], -1, v173
s_nop 0
s_or_b64 s[28:29], s[16:17], s[18:19]
s_cbranch_scc0 Lg_163
s_cmp_eq_u32 s65, 0
s_cbranch_scc1 Lg_163
s_sub_u32 s65, s65, 1
s_branch Lg_162
Lg_164:
Lg_165:
s_mov_b64 exec, s[22:23]
buffer_load_dwordx4 v[136:139], v1, s[8:11], s33 offen offset:0 sc1
s_mov_b64 exec, s[24:25]
buffer_load_dwordx4 v[140:143], v1, s[8:11], s33 offen offset:1024 sc1
s_mov_b64 exec, -1
s_waitcnt vmcnt(0)
v_max3_u32 v172, v136, v137, v138
v_max3_u32 v173, v140, v141, v142
v_max_u32 v172, v172, v139
v_max_u32 v173, v173, v143
v_cmp_eq_u32 s[22:23], -1, v172
v_cmp_eq_u32 s[24:25], -1, v173
s_nop 0
s_or_b64 s[28:29], s[22:23], s[24:25]
s_cbranch_scc0 Lg_166
s_cmp_eq_u32 s65, 0
s_cbranch_scc1 Lg_166
s_sub_u32 s65, s65, 1
s_branch Lg_165
Lsx_149:
v_max_f32 v170, v164, v165
s_nop 1
v_max_f32_dpp v170, v170, v170 row_ror:8 row_mask:0xf bank_mask:0xf
v_mov_b32 v172, v170
s_nop 1
v_permlane16_swap_b32 v170, v172
v_max_f32 v170, v170, v172
v_mov_b32 v172, v170
s_nop 1
v_permlane32_swap_b32 v170, v172
v_max_f32 v170, v170, v172
v_sub_f32 v168, v164, v170
v_sub_f32 v169, v165, v170
v_exp_f32 v168, v168
v_exp_f32 v169, v169
s_nop 0
v_add_f32 v171, v168, v169
s_branch Lsxb_150
Lrole_vo_3:
s_mov_b32 s16, s44
s_mov_b32 s17, s45
s_mov_b32 s18, 7864320
s_mov_b32 s19, 0x20000
s_mov_b32 s20, s46
s_mov_b32 s21, s47
s_mov_b32 s22, 7864320
s_mov_b32 s23, 0x20000
v_lshlrev_b32 v1, 4, v0
s_mul_i32 s6, s3, 3
s_lshl_b32 s7, s3, 1
s_add_u32 s7, s7, 2
s_min_u32 s6, s6, s7
s_lshl_b32 s80, s6, 10
v_add_u32 v3, 147456, v1
v_add_u32 v2, s80, v3
s_mul_i32 s67, s3, 36864
s_add_u32 s67, s67, 0
v_mov_b32 v4, s67
v_bfe_u32 v160, v0, 0, 6
s_mov_b32 s67, 16
v_mad_i32_i24 v4, v160, s67, v4
v_mov_b32 v8, 17476
v_bfe_u32 v160, v0, 1, 1
s_mov_b32 s67, 43690
v_mad_i32_i24 v8, v160, s67, v8
v_and_b32 v160, 8, v0
v_cmp_ne_u32 s[70:71], 0, v160
s_mul_i32 s67, s3, 256
s_add_u32 s67, s67, 160192
v_mov_b32 v5, s67
v_bfe_u32 v160, v0, 0, 1
s_mov_b32 s67, 16
v_mad_i32_i24 v5, v160, s67, v5
v_bfe_u32 v160, v0, 1, 2
s_mov_b32 s67, 4
v_mad_i32_i24 v5, v160, s67, v5
v_bfe_u32 v160, v0, 3, 3
s_mov_b32 s67, 32
v_mad_i32_i24 v5, v160, s67, v5
v_and_b32 v160, 1, v0
v_cmp_ne_u32 vcc, 0, v160
v_mov_b32 v160, 0x05040100
v_mov_b32 v161, 0x03020706
v_cndmask_b32 v6, v160, v161, vcc
s_mul_i32 s67, s3, 256
s_add_u32 s67, s67, 0
v_mov_b32 v9, s67
v_bfe_u32 v160, v0, 0, 4
s_mov_b32 s67, 16
v_mad_i32_i24 v9, v160, s67, v9
v_bfe_u32 v160, v0, 4, 1
s_mov_b32 s67, 1024
v_mad_i32_i24 v9, v160, s67, v9
v_bfe_u32 v160, v0, 5, 1
s_mov_b32 s67, 8
v_mad_i32_i24 v9, v160, s67, v9
v_mov_b32 v10, 0
v_bfe_u32 v160, v0, 0, 4
s_mov_b32 s67, 16
v_mad_i32_i24 v10, v160, s67, v10
v_bfe_u32 v160, v0, 4, 2
s_mov_b32 s67, 10240
v_mad_i32_i24 v10, v160, s67, v10
s_mul_i32 s67, s3, 256
s_add_u32 s67, s67, 0
v_mov_b32 v11, s67
v_bfe_u32 v160, v0, 0, 4
s_mov_b32 s67, 16
v_mad_i32_i24 v11, v160, s67, v11
v_bfe_u32 v160, v0, 4, 2
s_mov_b32 s67, 1024
v_mad_i32_i24 v11, v160, s67, v11
v_mov_b32 v12, 0
v_bfe_u32 v160, v0, 0, 1
s_mov_b32 s67, 16
v_mad_i32_i24 v12, v160, s67, v12
v_bfe_u32 v160, v0, 1, 2
s_mov_b32 s67, 4
v_mad_i32_i24 v12, v160, s67, v12
v_bfe_u32 v160, v0, 3, 3
s_mov_b32 s67, 32
v_mad_i32_i24 v12, v160, s67, v12
s_and_b32 s66, s63, 15
s_lshl_b32 s67, s3, 4
s_add_u32 s66, s66, s67
s_lshl_b32 s81, s64, 11
s_bfe_u32 s67, s66, 0x20002
s_mul_i32 s67, s67, 5120
s_add_u32 s81, s81, s67
s_add_u32 s81, s81, 192978944
s_mul_i32 s44, s63, 10240
s_add_u32 s44, s44, 192151552
s_add_u32 s45, s44, 4096
s_add_u32 s46, s44, 8192
s_mul_i32 s72, s64, 163840
s_lshl_b32 s68, s66, 8
s_add_u32 s72, s72, s68
s_add_u32 s72, s72, 192151552
s_add_u32 s73, s72, 40960
s_add_u32 s74, s73, 40960
s_add_u32 s75, s74, 40960
s_mul_i32 s49, s64, 12288
s_add_u32 s49, s49, 192053248
s_add_u32 s76, s49, s80
s_mul_i32 s47, s66, 40960
s_lshl_b32 s67, s64, 14
s_add_u32 s47, s47, s67
s_add_u32 s47, s47, 60817408
s_mov_b32 s60, 0
s_cmp_lg_u32 s3, 0
s_cbranch_scc1 Ls_168
v_mov_b32 v18, 0
v_bfe_u32 v16, v0, 0, 3
s_mov_b32 s67, 1280
v_mad_i32_i24 v18, v16, s67, v18
v_bfe_u32 v16, v0, 3, 3
s_mov_b32 s67, 16
v_mad_i32_i24 v18, v16, s67, v18
v_mov_b32 v19, 147456
v_bfe_u32 v16, v0, 0, 1
s_mov_b32 s67, 16
v_mad_i32_i24 v19, v16, s67, v19
v_bfe_u32 v16, v0, 1, 2
s_mov_b32 s67, 64
v_mad_i32_i24 v19, v16, s67, v19
v_bfe_u32 v16, v0, 3, 1
s_mov_b32 s67, 32
v_mad_i32_i24 v19, v16, s67, v19
v_bfe_u32 v16, v0, 4, 2
s_mov_b32 s67, 256
v_mad_i32_i24 v19, v16, s67, v19
buffer_load_dwordx4 v[24:27], v18, s[24:27], 0 offen offset:0
buffer_load_dwordx4 v[28:31], v18, s[24:27], 0 offen offset:128
buffer_load_dwordx4 v[32:35], v18, s[24:27], 0 offen offset:256
buffer_load_dwordx4 v[36:39], v18, s[24:27], 0 offen offset:384
buffer_load_dwordx4 v[40:43], v18, s[24:27], 0 offen offset:512
buffer_load_dwordx4 v[44:47], v18, s[24:27], 0 offen offset:640
buffer_load_dwordx4 v[48:51], v18, s[24:27], 0 offen offset:768
buffer_load_dwordx4 v[52:55], v18, s[24:27], 0 offen offset:896
buffer_load_dwordx4 v[56:59], v18, s[24:27], 0 offen offset:1024
buffer_load_dwordx4 v[60:63], v18, s[24:27], 0 offen offset:1152
Ls_168:
v_lshrrev_b32 v168, 3, v0
v_and_b32 v169, 6, v168
v_and_b32 v160, 7, v0
v_xor_b32 v160, v160, v169
v_lshlrev_b32 v160, 4, v160
s_mov_b32 s67, 12288
v_mad_u32_u24 v160, v168, s67, v160
v_lshrrev_b32 v168, 3, v0
v_and_b32 v169, 6, v168
v_and_b32 v161, 7, v0
v_xor_b32 v161, v161, v169
v_lshlrev_b32 v161, 4, v161
s_mov_b32 s67, 1280
v_mad_u32_u24 v161, v168, s67, v161
v_mov_b32 v168, 0
v_bfe_u32 v170, v0, 4, 1
s_mov_b32 s67, 4
v_mad_i32_i24 v168, v170, s67, v168
s_mul_i32 s67, s3, 2
s_add_u32 s67, s67, 0
v_mov_b32 v169, s67
v_bfe_u32 v170, v0, 1, 1
s_mov_b32 s67, 1
v_mad_i32_i24 v169, v170, s67, v169
v_xor_b32 v169, v169, v168
v_mov_b32 v162, 0
v_bfe_u32 v170, v0, 0, 1
s_mov_b32 s67, 8
v_mad_i32_i24 v162, v170, s67, v162
v_bfe_u32 v170, v0, 2, 1
s_mov_b32 s67, 128
v_mad_i32_i24 v162, v170, s67, v162
v_bfe_u32 v170, v0, 3, 1
s_mov_b32 s67, 1024
v_mad_i32_i24 v162, v170, s67, v162
v_bfe_u32 v170, v0, 4, 1
s_mov_b32 s67, 512
v_mad_i32_i24 v162, v170, s67, v162
v_bfe_u32 v170, v0, 5, 1
s_mov_b32 s67, 2048
v_mad_i32_i24 v162, v170, s67, v162
v_lshl_add_u32 v162, v169, 4, v162
v_add_u32 v163, 49152, v162
v_add_u32 v164, 98304, v162
v_mov_b32 v168, 2
v_bfe_u32 v170, v0, 4, 1
s_mov_b32 s67, 4
v_mad_i32_i24 v168, v170, s67, v168
s_mul_i32 s67, s3, 2
s_add_u32 s67, s67, 0
v_mov_b32 v169, s67
v_bfe_u32 v170, v0, 1, 1
s_mov_b32 s67, 1
v_mad_i32_i24 v169, v170, s67, v169
v_xor_b32 v169, v169, v168
v_mov_b32 v165, 256
v_bfe_u32 v170, v0, 0, 1
s_mov_b32 s67, 8
v_mad_i32_i24 v165, v170, s67, v165
v_bfe_u32 v170, v0, 2, 1
s_mov_b32 s67, 128
v_mad_i32_i24 v165, v170, s67, v165
v_bfe_u32 v170, v0, 3, 1
s_mov_b32 s67, 1024
v_mad_i32_i24 v165, v170, s67, v165
v_bfe_u32 v170, v0, 4, 1
s_mov_b32 s67, 512
v_mad_i32_i24 v165, v170, s67, v165
v_bfe_u32 v170, v0, 5, 1
s_mov_b32 s67, 2048
v_mad_i32_i24 v165, v170, s67, v165
v_lshl_add_u32 v165, v169, 4, v165
v_add_u32 v166, 49152, v165
v_add_u32 v167, 98304, v165
s_mul_i32 s68, s63, 384
s_mul_i32 s67, s3, 98304
s_add_u32 s68, s68, s67
s_mul_i32 s69, s63, 245760
s_mul_i32 s67, s3, 10240
s_add_u32 s69, s69, s67
s_lshl_b32 s7, s3, 10
s_add_u32 m0, s7, 0
s_add_u32 s67, s68, 0
buffer_load_dwordx4 v160, s[16:19], s67 offen lds
s_add_u32 m0, s7, 4096
s_add_u32 s67, s68, 128
buffer_load_dwordx4 v160, s[16:19], s67 offen lds
s_add_u32 m0, s7, 8192
s_add_u32 s67, s68, 256
buffer_load_dwordx4 v160, s[16:19], s67 offen lds
s_add_u32 m0, s7, 12288
s_add_u32 s67, s68, 393216
buffer_load_dwordx4 v160, s[16:19], s67 offen lds
s_add_u32 m0, s7, 16384
s_add_u32 s67, s68, 393344
buffer_load_dwordx4 v160, s[16:19], s67 offen lds
s_add_u32 m0, s7, 20480
s_add_u32 s67, s68, 393472
buffer_load_dwordx4 v160, s[16:19], s67 offen lds
s_add_u32 m0, s7, 24576
s_add_u32 s67, s68, 786432
buffer_load_dwordx4 v160, s[16:19], s67 offen lds
s_add_u32 m0, s7, 28672
s_add_u32 s67, s68, 786560
buffer_load_dwordx4 v160, s[16:19], s67 offen lds
s_add_u32 m0, s7, 32768
s_add_u32 s67, s68, 786688
buffer_load_dwordx4 v160, s[16:19], s67 offen lds
s_add_u32 m0, s7, 36864
s_add_u32 s67, s68, 1179648
buffer_load_dwordx4 v160, s[16:19], s67 offen lds
s_add_u32 m0, s7, 40960
s_add_u32 s67, s68, 1179776
buffer_load_dwordx4 v160, s[16:19], s67 offen lds
s_add_u32 m0, s7, 45056
s_add_u32 s67, s68, 1179904
buffer_load_dwordx4 v160, s[16:19], s67 offen lds
s_add_u32 m0, s7, 49152
s_add_u32 s67, s68, 2359296
buffer_load_dwordx4 v160, s[16:19], s67 offen lds
s_add_u32 m0, s7, 53248
s_add_u32 s67, s68, 2359424
buffer_load_dwordx4 v160, s[16:19], s67 offen lds
s_add_u32 m0, s7, 57344
s_add_u32 s67, s68, 2359552
buffer_load_dwordx4 v160, s[16:19], s67 offen lds
s_add_u32 m0, s7, 61440
s_add_u32 s67, s68, 2752512
buffer_load_dwordx4 v160, s[16:19], s67 offen lds
s_add_u32 m0, s7, 65536
s_add_u32 s67, s68, 2752640
buffer_load_dwordx4 v160, s[16:19], s67 offen lds
s_add_u32 m0, s7, 69632
s_add_u32 s67, s68, 2752768
buffer_load_dwordx4 v160, s[16:19], s67 offen lds
s_waitcnt vmcnt(15)
s_waitcnt lgkmcnt(0)
s_barrier
s_add_u32 m0, s7, 73728
s_add_u32 s67, s68, 3145728
buffer_load_dwordx4 v160, s[16:19], s67 offen lds
s_add_u32 m0, s7, 77824
s_add_u32 s67, s68, 3145856
buffer_load_dwordx4 v160, s[16:19], s67 offen lds
s_add_u32 m0, s7, 81920
s_add_u32 s67, s68, 3145984
buffer_load_dwordx4 v160, s[16:19], s67 offen lds
ds_read_b64_tr_b16 a[0:1], v162 offset:0
ds_read_b64_tr_b16 a[2:3], v165 offset:0
ds_read_b64_tr_b16 a[56:57], v162 offset:4096
ds_read_b64_tr_b16 a[58:59], v165 offset:4096
ds_read_b64_tr_b16 a[112:113], v162 offset:8192
ds_read_b64_tr_b16 a[114:115], v165 offset:8192
s_cmp_lg_u32 s3, 0
s_cbranch_scc1 Ls_169
ds_write_b128 v19, v[24:27] offset:0
ds_write_b128 v19, v[28:31] offset:1024
ds_write_b128 v19, v[32:35] offset:2048
ds_write_b128 v19, v[36:39] offset:3072
ds_write_b128 v19, v[40:43] offset:4096
ds_write_b128 v19, v[44:47] offset:5120
ds_write_b128 v19, v[48:51] offset:6144
ds_write_b128 v19, v[52:55] offset:7168
ds_write_b128 v19, v[56:59] offset:8192
ds_write_b128 v19, v[60:63] offset:9216
Ls_169:
s_waitcnt vmcnt(15)
s_waitcnt lgkmcnt(0)
s_barrier
s_add_u32 m0, s7, 86016
s_add_u32 s67, s68, 3538944
buffer_load_dwordx4 v160, s[16:19], s67 offen lds
s_add_u32 m0, s7, 90112
s_add_u32 s67, s68, 3539072
buffer_load_dwordx4 v160, s[16:19], s67 offen lds
s_add_u32 m0, s7, 94208
s_add_u32 s67, s68, 3539200
buffer_load_dwordx4 v160, s[16:19], s67 offen lds
ds_read_b64_tr_b16 a[4:5], v162 offset:12288
ds_read_b64_tr_b16 a[6:7], v165 offset:12288
ds_read_b64_tr_b16 a[60:61], v162 offset:16384
ds_read_b64_tr_b16 a[62:63], v165 offset:16384
ds_read_b64_tr_b16 a[116:117], v162 offset:20480
ds_read_b64_tr_b16 a[118:119], v165 offset:20480
v_mov_b32 v173, 176
buffer_load_dword v172, v173, s[12:15], 0 offen sc1
s_waitcnt vmcnt(16)
s_waitcnt lgkmcnt(0)
s_barrier
s_add_u32 m0, s7, 98304
s_add_u32 s67, s68, 4718592
buffer_load_dwordx4 v160, s[16:19], s67 offen lds
s_add_u32 m0, s7, 102400
s_add_u32 s67, s68, 4718720
buffer_load_dwordx4 v160, s[16:19], s67 offen lds
s_add_u32 m0, s7, 106496
s_add_u32 s67, s68, 4718848
buffer_load_dwordx4 v160, s[16:19], s67 offen lds
ds_read_b64_tr_b16 a[8:9], v162 offset:24576
ds_read_b64_tr_b16 a[10:11], v165 offset:24576
ds_read_b64_tr_b16 a[64:65], v162 offset:28672
ds_read_b64_tr_b16 a[66:67], v165 offset:28672
ds_read_b64_tr_b16 a[120:121], v162 offset:32768
ds_read_b64_tr_b16 a[122:123], v165 offset:32768
s_waitcnt vmcnt(16)
s_waitcnt lgkmcnt(0)
s_barrier
s_add_u32 m0, s7, 110592
s_add_u32 s67, s68, 5111808
buffer_load_dwordx4 v160, s[16:19], s67 offen lds
s_add_u32 m0, s7, 114688
s_add_u32 s67, s68, 5111936
buffer_load_dwordx4 v160, s[16:19], s67 offen lds
s_add_u32 m0, s7, 118784
s_add_u32 s67, s68, 5112064
buffer_load_dwordx4 v160, s[16:19], s67 offen lds
ds_read_b64_tr_b16 a[12:13], v162 offset:36864
ds_read_b64_tr_b16 a[14:15], v165 offset:36864
ds_read_b64_tr_b16 a[68:69], v162 offset:40960
ds_read_b64_tr_b16 a[70:71], v165 offset:40960
ds_read_b64_tr_b16 a[124:125], v162 offset:45056
ds_read_b64_tr_b16 a[126:127], v165 offset:45056
s_waitcnt vmcnt(16)
s_waitcnt lgkmcnt(0)
s_barrier
s_add_u32 m0, s7, 122880
s_add_u32 s67, s68, 5505024
buffer_load_dwordx4 v160, s[16:19], s67 offen lds
s_add_u32 m0, s7, 126976
s_add_u32 s67, s68, 5505152
buffer_load_dwordx4 v160, s[16:19], s67 offen lds
s_add_u32 m0, s7, 131072
s_add_u32 s67, s68, 5505280
buffer_load_dwordx4 v160, s[16:19], s67 offen lds
ds_read_b64_tr_b16 a[16:17], v163 offset:0
ds_read_b64_tr_b16 a[18:19], v166 offset:0
ds_read_b64_tr_b16 a[72:73], v163 offset:4096
ds_read_b64_tr_b16 a[74:75], v166 offset:4096
ds_read_b64_tr_b16 a[128:129], v163 offset:8192
ds_read_b64_tr_b16 a[130:131], v166 offset:8192
s_waitcnt vmcnt(16)
s_waitcnt lgkmcnt(0)
s_barrier
s_add_u32 m0, s7, 135168
s_add_u32 s67, s68, 5898240
buffer_load_dwordx4 v160, s[16:19], s67 offen lds
s_add_u32 m0, s7, 139264
s_add_u32 s67, s68, 5898368
buffer_load_dwordx4 v160, s[16:19], s67 offen lds
s_add_u32 m0, s7, 143360
s_add_u32 s67, s68, 5898496
buffer_load_dwordx4 v160, s[16:19], s67 offen lds
ds_read_b64_tr_b16 a[20:21], v163 offset:12288
ds_read_b64_tr_b16 a[22:23], v166 offset:12288
ds_read_b64_tr_b16 a[76:77], v163 offset:16384
ds_read_b64_tr_b16 a[78:79], v166 offset:16384
ds_read_b64_tr_b16 a[132:133], v163 offset:20480
ds_read_b64_tr_b16 a[134:135], v166 offset:20480
s_waitcnt vmcnt(16)
s_waitcnt lgkmcnt(0)
s_barrier
s_add_u32 m0, s7, 0
s_add_u32 s67, s68, 6291456
buffer_load_dwordx4 v160, s[16:19], s67 offen lds
s_add_u32 m0, s7, 4096
s_add_u32 s67, s68, 6291584
buffer_load_dwordx4 v160, s[16:19], s67 offen lds
s_add_u32 m0, s7, 8192
s_add_u32 s67, s68, 6291712
buffer_load_dwordx4 v160, s[16:19], s67 offen lds
ds_read_b64_tr_b16 a[24:25], v163 offset:24576
ds_read_b64_tr_b16 a[26:27], v166 offset:24576
ds_read_b64_tr_b16 a[80:81], v163 offset:28672
ds_read_b64_tr_b16 a[82:83], v166 offset:28672
ds_read_b64_tr_b16 a[136:137], v163 offset:32768
ds_read_b64_tr_b16 a[138:139], v166 offset:32768
s_waitcnt vmcnt(16)
s_waitcnt lgkmcnt(0)
s_barrier
s_add_u32 m0, s7, 12288
s_add_u32 s67, s68, 6684672
buffer_load_dwordx4 v160, s[16:19], s67 offen lds
s_add_u32 m0, s7, 16384
s_add_u32 s67, s68, 6684800
buffer_load_dwordx4 v160, s[16:19], s67 offen lds
s_add_u32 m0, s7, 20480
s_add_u32 s67, s68, 6684928
buffer_load_dwordx4 v160, s[16:19], s67 offen lds
ds_read_b64_tr_b16 a[28:29], v163 offset:36864
ds_read_b64_tr_b16 a[30:31], v166 offset:36864
ds_read_b64_tr_b16 a[84:85], v163 offset:40960
ds_read_b64_tr_b16 a[86:87], v166 offset:40960
ds_read_b64_tr_b16 a[140:141], v163 offset:45056
ds_read_b64_tr_b16 a[142:143], v166 offset:45056
s_waitcnt vmcnt(15)
s_waitcnt lgkmcnt(0)
s_barrier
s_add_u32 m0, s7, 24576
s_add_u32 s67, s69, 0
buffer_load_dwordx4 v161, s[20:23], s67 offen lds
s_add_u32 m0, s7, 28672
s_add_u32 s67, s69, 40960
buffer_load_dwordx4 v161, s[20:23], s67 offen lds
s_add_u32 m0, s7, 32768
s_add_u32 s67, s69, 81920
buffer_load_dwordx4 v161, s[20:23], s67 offen lds
ds_read_b64_tr_b16 a[32:33], v164 offset:0
ds_read_b64_tr_b16 a[34:35], v167 offset:0
ds_read_b64_tr_b16 a[88:89], v164 offset:4096
ds_read_b64_tr_b16 a[90:91], v167 offset:4096
ds_read_b64_tr_b16 a[144:145], v164 offset:8192
ds_read_b64_tr_b16 a[146:147], v167 offset:8192
s_waitcnt vmcnt(15)
s_waitcnt lgkmcnt(0)
s_barrier
s_add_u32 m0, s7, 36864
s_add_u32 s67, s69, 122880
buffer_load_dwordx4 v161, s[20:23], s67 offen lds
s_add_u32 m0, s7, 40960
s_add_u32 s67, s69, 163840
buffer_load_dwordx4 v161, s[20:23], s67 offen lds
s_add_u32 m0, s7, 45056
s_add_u32 s67, s69, 204800
buffer_load_dwordx4 v161, s[20:23], s67 offen lds
ds_read_b64_tr_b16 a[36:37], v164 offset:12288
ds_read_b64_tr_b16 a[38:39], v167 offset:12288
ds_read_b64_tr_b16 a[92:93], v164 offset:16384
ds_read_b64_tr_b16 a[94:95], v167 offset:16384
ds_read_b64_tr_b16 a[148:149], v164 offset:20480
ds_read_b64_tr_b16 a[150:151], v167 offset:20480
s_waitcnt vmcnt(15)
s_waitcnt lgkmcnt(0)
s_barrier
s_add_u32 m0, s7, 49152
s_add_u32 s67, s69, 256
buffer_load_dwordx4 v161, s[20:23], s67 offen lds
s_add_u32 m0, s7, 53248
s_add_u32 s67, s69, 41216
buffer_load_dwordx4 v161, s[20:23], s67 offen lds
s_add_u32 m0, s7, 57344
s_add_u32 s67, s69, 82176
buffer_load_dwordx4 v161, s[20:23], s67 offen lds
ds_read_b64_tr_b16 a[40:41], v164 offset:24576
ds_read_b64_tr_b16 a[42:43], v167 offset:24576
ds_read_b64_tr_b16 a[96:97], v164 offset:28672
ds_read_b64_tr_b16 a[98:99], v167 offset:28672
ds_read_b64_tr_b16 a[152:153], v164 offset:32768
ds_read_b64_tr_b16 a[154:155], v167 offset:32768
s_waitcnt vmcnt(15)
s_waitcnt lgkmcnt(0)
s_barrier
s_add_u32 m0, s7, 61440
s_add_u32 s67, s69, 123136
buffer_load_dwordx4 v161, s[20:23], s67 offen lds
s_add_u32 m0, s7, 65536
s_add_u32 s67, s69, 164096
buffer_load_dwordx4 v161, s[20:23], s67 offen lds
s_add_u32 m0, s7, 69632
s_add_u32 s67, s69, 205056
buffer_load_dwordx4 v161, s[20:23], s67 offen lds
ds_read_b64_tr_b16 a[44:45], v164 offset:36864
ds_read_b64_tr_b16 a[46:47], v167 offset:36864
ds_read_b64_tr_b16 a[100:101], v164 offset:40960
ds_read_b64_tr_b16 a[102:103], v167 offset:40960
ds_read_b64_tr_b16 a[156:157], v164 offset:45056
ds_read_b64_tr_b16 a[158:159], v167 offset:45056
s_waitcnt vmcnt(15)
s_waitcnt lgkmcnt(0)
s_barrier
s_add_u32 m0, s7, 73728
s_add_u32 s67, s69, 384
buffer_load_dwordx4 v161, s[20:23], s67 offen lds
s_add_u32 m0, s7, 77824
s_add_u32 s67, s69, 41344
buffer_load_dwordx4 v161, s[20:23], s67 offen lds
s_add_u32 m0, s7, 81920
s_add_u32 s67, s69, 82304
buffer_load_dwordx4 v161, s[20:23], s67 offen lds
ds_read_b64_tr_b16 a[48:49], v162 offset:0
ds_read_b64_tr_b16 a[50:51], v165 offset:0
ds_read_b64_tr_b16 a[104:105], v162 offset:4096
ds_read_b64_tr_b16 a[106:107], v165 offset:4096
ds_read_b64_tr_b16 a[160:161], v162 offset:8192
ds_read_b64_tr_b16 a[162:163], v165 offset:8192
s_waitcnt vmcnt(15)
s_waitcnt lgkmcnt(0)
s_barrier
s_add_u32 m0, s7, 86016
s_add_u32 s67, s69, 123264
buffer_load_dwordx4 v161, s[20:23], s67 offen lds
s_add_u32 m0, s7, 90112
s_add_u32 s67, s69, 164224
buffer_load_dwordx4 v161, s[20:23], s67 offen lds
s_add_u32 m0, s7, 94208
s_add_u32 s67, s69, 205184
buffer_load_dwordx4 v161, s[20:23], s67 offen lds
ds_read_b64_tr_b16 a[52:53], v162 offset:12288
ds_read_b64_tr_b16 a[54:55], v165 offset:12288
ds_read_b64_tr_b16 a[108:109], v162 offset:16384
ds_read_b64_tr_b16 a[110:111], v165 offset:16384
ds_read_b64_tr_b16 a[164:165], v162 offset:20480
ds_read_b64_tr_b16 a[166:167], v165 offset:20480
s_branch Lrc_171
Lrp_170:
v_mov_b32 v173, 176
buffer_load_dword v172, v173, s[12:15], 0 offen sc1
s_waitcnt vmcnt(0)
Lrc_171:
v_readfirstlane_b32 s67, v172
s_nop 0
s_sub_u32 s67, s67, 1
s_cmp_eq_u32 s67, s34
s_cbranch_scc1 Lro_172
s_sub_u32 s65, s65, 1
s_cmp_eq_u32 s65, 0
s_cbranch_scc1 Lro_172
s_cmp_gt_u32 s67, 7
s_cbranch_scc1 Lrp_170
s_mov_b32 s34, s67
s_waitcnt vmcnt(0) lgkmcnt(0)
s_barrier
s_branch L_restart
Lro_172:
v_mov_b32 v32, -1
v_mov_b32 v33, -1
v_mov_b32 v34, -1
v_mov_b32 v35, -1
buffer_store_dwordx4 v[32:35], v11, s[8:11], s44 offen sc1
buffer_store_dwordx4 v[32:35], v11, s[8:11], s45 offen sc1
buffer_store_dwordx2 v[32:33], v9, s[8:11], s46 offen sc1
s_add_u32 s67, s62, 0
s_and_b32 s67, s67, 3
s_lshl_b32 s67, s67, 1
s_lshl_b32 s33, s67, 15
s_add_u32 s67, s67, s64
s_mul_i32 s32, s67, 10240
s_lshl_b32 s67, s66, 8
s_add_u32 s32, s32, s67
s_add_u32 s33, s33, s67
s_add_u32 s32, s32, 191889408
s_add_u32 s33, s33, s59
s_cmp_ge_u32 s66, 24
s_cselect_b32 s67, 26624, 0
s_add_u32 s33, s33, s67
s_cmp_ge_u32 s66, 40
s_cselect_b32 s32, 536870912, s32
s_cselect_b32 s33, 536870912, s33
buffer_store_dword v32, v12, s[8:11], s32 offen sc1
buffer_store_dword v32, v12, s[8:11], s33 offen sc1
s_add_u32 s33, s33, 8192
buffer_store_dword v32, v12, s[8:11], s33 offen sc1
s_add_u32 s33, s33, 8192
buffer_store_dword v32, v12, s[8:11], s33 offen sc1
s_add_u32 s33, s33, 8192
buffer_store_dword v32, v12, s[8:11], s33 offen sc1
s_add_u32 s67, s62, 1
s_and_b32 s67, s67, 3
s_lshl_b32 s67, s67, 1
s_lshl_b32 s33, s67, 15
s_add_u32 s67, s67, s64
s_mul_i32 s32, s67, 10240
s_lshl_b32 s67, s66, 8
s_add_u32 s32, s32, s67
s_add_u32 s33, s33, s67
s_add_u32 s32, s32, 191889408
s_add_u32 s33, s33, s59
s_cmp_ge_u32 s66, 24
s_cselect_b32 s67, 26624, 0
s_add_u32 s33, s33, s67
s_cmp_ge_u32 s66, 40
s_cselect_b32 s32, 536870912, s32
s_cselect_b32 s33, 536870912, s33
buffer_store_dword v32, v12, s[8:11], s32 offen sc1
buffer_store_dword v32, v12, s[8:11], s33 offen sc1
s_add_u32 s33, s33, 8192
buffer_store_dword v32, v12, s[8:11], s33 offen sc1
s_add_u32 s33, s33, 8192
buffer_store_dword v32, v12, s[8:11], s33 offen sc1
s_add_u32 s33, s33, 8192
buffer_store_dword v32, v12, s[8:11], s33 offen sc1
s_add_u32 s67, s62, 2
s_and_b32 s67, s67, 3
s_lshl_b32 s67, s67, 1
s_lshl_b32 s33, s67, 15
s_add_u32 s67, s67, s64
s_mul_i32 s32, s67, 10240
s_lshl_b32 s67, s66, 8
s_add_u32 s32, s32, s67
s_add_u32 s33, s33, s67
s_add_u32 s32, s32, 191889408
s_add_u32 s33, s33, s59
s_cmp_ge_u32 s66, 24
s_cselect_b32 s67, 26624, 0
s_add_u32 s33, s33, s67
s_cmp_ge_u32 s66, 40
s_cselect_b32 s32, 536870912, s32
s_cselect_b32 s33, 536870912, s33
buffer_store_dword v32, v12, s[8:11], s32 offen sc1
buffer_store_dword v32, v12, s[8:11], s33 offen sc1
s_add_u32 s33, s33, 8192
buffer_store_dword v32, v12, s[8:11], s33 offen sc1
s_add_u32 s33, s33, 8192
buffer_store_dword v32, v12, s[8:11], s33 offen sc1
s_add_u32 s33, s33, 8192
buffer_store_dword v32, v12, s[8:11], s33 offen sc1
s_add_u32 s67, s62, 3
s_and_b32 s67, s67, 3
s_lshl_b32 s67, s67, 1
s_lshl_b32 s33, s67, 15
s_add_u32 s67, s67, s64
s_mul_i32 s32, s67, 10240
s_lshl_b32 s67, s66, 8
s_add_u32 s32, s32, s67
s_add_u32 s33, s33, s67
s_add_u32 s32, s32, 191889408
s_add_u32 s33, s33, s59
s_cmp_ge_u32 s66, 24
s_cselect_b32 s67, 26624, 0
s_add_u32 s33, s33, s67
s_cmp_ge_u32 s66, 40
s_cselect_b32 s32, 536870912, s32
s_cselect_b32 s33, 536870912, s33
buffer_store_dword v32, v12, s[8:11], s32 offen sc1
buffer_store_dword v32, v12, s[8:11], s33 offen sc1
s_add_u32 s33, s33, 8192
buffer_store_dword v32, v12, s[8:11], s33 offen sc1
s_add_u32 s33, s33, 8192
buffer_store_dword v32, v12, s[8:11], s33 offen sc1
s_add_u32 s33, s33, 8192
buffer_store_dword v32, v12, s[8:11], s33 offen sc1
s_cmp_lg_u32 s3, 0
s_cbranch_scc1 Ls_167
s_lshl_b32 s67, 1, s4
v_mov_b32 v13, s67
s_lshl_b32 s67, s64, 2
v_mov_b32 v14, s67
s_mov_b64 exec, 1
buffer_atomic_or v13, v14, s[12:15], 0 offen sc1
s_mov_b64 exec, -1
Ls_167:
s_waitcnt vmcnt(38)
s_waitcnt lgkmcnt(0)
s_barrier
s_add_u32 m0, s7, 98304
s_add_u32 s67, s69, 512
buffer_load_dwordx4 v161, s[20:23], s67 offen lds
s_add_u32 m0, s7, 102400
s_add_u32 s67, s69, 41472
buffer_load_dwordx4 v161, s[20:23], s67 offen lds
s_add_u32 m0, s7, 106496
s_add_u32 s67, s69, 82432
buffer_load_dwordx4 v161, s[20:23], s67 offen lds
ds_read_b64_tr_b16 a[168:169], v162 offset:24576
ds_read_b64_tr_b16 a[170:171], v165 offset:24576
ds_read_b64_tr_b16 a[172:173], v162 offset:28672
ds_read_b64_tr_b16 a[174:175], v165 offset:28672
ds_read_b64_tr_b16 a[176:177], v162 offset:32768
ds_read_b64_tr_b16 a[178:179], v165 offset:32768
s_waitcnt vmcnt(38)
s_waitcnt lgkmcnt(0)
s_barrier
s_add_u32 m0, s7, 110592
s_add_u32 s67, s69, 123392
buffer_load_dwordx4 v161, s[20:23], s67 offen lds
s_add_u32 m0, s7, 114688
s_add_u32 s67, s69, 164352
buffer_load_dwordx4 v161, s[20:23], s67 offen lds
s_add_u32 m0, s7, 118784
s_add_u32 s67, s69, 205312
buffer_load_dwordx4 v161, s[20:23], s67 offen lds
ds_read_b64_tr_b16 a[180:181], v162 offset:36864
ds_read_b64_tr_b16 a[182:183], v165 offset:36864
ds_read_b64_tr_b16 a[184:185], v162 offset:40960
ds_read_b64_tr_b16 a[186:187], v165 offset:40960
ds_read_b64_tr_b16 a[188:189], v162 offset:45056
ds_read_b64_tr_b16 a[190:191], v165 offset:45056
s_waitcnt vmcnt(38)
s_waitcnt lgkmcnt(0)
s_barrier
s_add_u32 m0, s7, 122880
s_add_u32 s67, s69, 768
buffer_load_dwordx4 v161, s[20:23], s67 offen lds
s_add_u32 m0, s7, 126976
s_add_u32 s67, s69, 41728
buffer_load_dwordx4 v161, s[20:23], s67 offen lds
s_add_u32 m0, s7, 131072
s_add_u32 s67, s69, 82688
buffer_load_dwordx4 v161, s[20:23], s67 offen lds
ds_read_b64_tr_b16 a[192:193], v163 offset:0
ds_read_b64_tr_b16 a[194:195], v166 offset:0
ds_read_b64_tr_b16 a[196:197], v163 offset:4096
ds_read_b64_tr_b16 a[198:199], v166 offset:4096
ds_read_b64_tr_b16 a[200:201], v163 offset:8192
ds_read_b64_tr_b16 a[202:203], v166 offset:8192
s_waitcnt vmcnt(38)
s_waitcnt lgkmcnt(0)
s_barrier
s_add_u32 m0, s7, 135168
s_add_u32 s67, s69, 123648
buffer_load_dwordx4 v161, s[20:23], s67 offen lds
s_add_u32 m0, s7, 139264
s_add_u32 s67, s69, 164608
buffer_load_dwordx4 v161, s[20:23], s67 offen lds
s_add_u32 m0, s7, 143360
s_add_u32 s67, s69, 205568
buffer_load_dwordx4 v161, s[20:23], s67 offen lds
ds_read_b64_tr_b16 a[204:205], v163 offset:12288
ds_read_b64_tr_b16 a[206:207], v166 offset:12288
ds_read_b64_tr_b16 a[208:209], v163 offset:16384
ds_read_b64_tr_b16 a[210:211], v166 offset:16384
ds_read_b64_tr_b16 a[212:213], v163 offset:20480
ds_read_b64_tr_b16 a[214:215], v166 offset:20480
s_waitcnt vmcnt(38)
s_waitcnt lgkmcnt(0)
s_barrier
s_add_u32 m0, s7, 0
s_add_u32 s67, s69, 896
buffer_load_dwordx4 v161, s[20:23], s67 offen lds
s_add_u32 m0, s7, 4096
s_add_u32 s67, s69, 41856
buffer_load_dwordx4 v161, s[20:23], s67 offen lds
s_add_u32 m0, s7, 8192
s_add_u32 s67, s69, 82816
buffer_load_dwordx4 v161, s[20:23], s67 offen lds
ds_read_b64_tr_b16 a[216:217], v163 offset:24576
ds_read_b64_tr_b16 a[218:219], v166 offset:24576
ds_read_b64_tr_b16 a[220:221], v163 offset:28672
ds_read_b64_tr_b16 a[222:223], v166 offset:28672
ds_read_b64_tr_b16 a[224:225], v163 offset:32768
ds_read_b64_tr_b16 a[226:227], v166 offset:32768
s_waitcnt vmcnt(38)
s_waitcnt lgkmcnt(0)
s_barrier
s_add_u32 m0, s7, 12288
s_add_u32 s67, s69, 123776
buffer_load_dwordx4 v161, s[20:23], s67 offen lds
s_add_u32 m0, s7, 16384
s_add_u32 s67, s69, 164736
buffer_load_dwordx4 v161, s[20:23], s67 offen lds
s_add_u32 m0, s7, 20480
s_add_u32 s67, s69, 205696
buffer_load_dwordx4 v161, s[20:23], s67 offen lds
ds_read_b64_tr_b16 a[228:229], v163 offset:36864
ds_read_b64_tr_b16 a[230:231], v166 offset:36864
ds_read_b64_tr_b16 a[232:233], v163 offset:40960
ds_read_b64_tr_b16 a[234:235], v166 offset:40960
ds_read_b64_tr_b16 a[236:237], v163 offset:45056
ds_read_b64_tr_b16 a[238:239], v166 offset:45056
s_waitcnt vmcnt(15)
s_waitcnt lgkmcnt(0)
s_barrier
s_add_u32 m0, s7, 24576
s_add_u32 s67, s69, 1024
buffer_load_dwordx4 v161, s[20:23], s67 offen lds
s_add_u32 m0, s7, 28672
s_add_u32 s67, s69, 41984
buffer_load_dwordx4 v161, s[20:23], s67 offen lds
s_add_u32 m0, s7, 32768
s_add_u32 s67, s69, 82944
buffer_load_dwordx4 v161, s[20:23], s67 offen lds
ds_read_b64_tr_b16 a[240:241], v164 offset:0
ds_read_b64_tr_b16 a[242:243], v167 offset:0
ds_read_b64_tr_b16 a[244:245], v164 offset:4096
ds_read_b64_tr_b16 a[246:247], v167 offset:4096
ds_read_b64_tr_b16 a[248:249], v164 offset:8192
ds_read_b64_tr_b16 a[250:251], v167 offset:8192
s_cmp_lg_u32 s3, 0
s_cbranch_scc1 Ls_173
v_mov_b32 v13, 1
v_mov_b32 v14, 36
s_mov_b64 exec, 1
buffer_atomic_add v13, v14, s[12:15], 0 offen sc1
s_mov_b64 exec, -1
Ls_173:
s_waitcnt vmcnt(15)
s_waitcnt lgkmcnt(0)
s_barrier
s_add_u32 m0, s7, 36864
s_add_u32 s67, s69, 123904
buffer_load_dwordx4 v161, s[20:23], s67 offen lds
s_add_u32 m0, s7, 40960
s_add_u32 s67, s69, 164864
buffer_load_dwordx4 v161, s[20:23], s67 offen lds
s_add_u32 m0, s7, 45056
s_add_u32 s67, s69, 205824
buffer_load_dwordx4 v161, s[20:23], s67 offen lds
ds_read_b64_tr_b16 a[252:253], v164 offset:12288
ds_read_b64_tr_b16 a[254:255], v167 offset:12288
ds_read_b64_tr_b16 v[176:177], v164 offset:16384
ds_read_b64_tr_b16 v[178:179], v167 offset:16384
ds_read_b64_tr_b16 v[180:181], v164 offset:20480
ds_read_b64_tr_b16 v[182:183], v167 offset:20480
s_waitcnt vmcnt(15)
s_waitcnt lgkmcnt(0)
s_barrier
s_add_u32 m0, s7, 49152
s_add_u32 s67, s68, 1572864
buffer_load_dwordx4 v160, s[16:19], s67 offen lds
s_add_u32 m0, s7, 53248
s_add_u32 s67, s68, 1572992
buffer_load_dwordx4 v160, s[16:19], s67 offen lds
s_add_u32 m0, s7, 57344
s_add_u32 s67, s68, 1573120
buffer_load_dwordx4 v160, s[16:19], s67 offen lds
ds_read_b64_tr_b16 v[184:185], v164 offset:24576
ds_read_b64_tr_b16 v[186:187], v167 offset:24576
ds_read_b64_tr_b16 v[188:189], v164 offset:28672
ds_read_b64_tr_b16 v[190:191], v167 offset:28672
ds_read_b64_tr_b16 v[192:193], v164 offset:32768
ds_read_b64_tr_b16 v[194:195], v167 offset:32768
s_waitcnt vmcnt(15)
s_waitcnt lgkmcnt(0)
s_barrier
s_add_u32 m0, s7, 61440
s_add_u32 s67, s68, 1966080
buffer_load_dwordx4 v160, s[16:19], s67 offen lds
s_add_u32 m0, s7, 65536
s_add_u32 s67, s68, 1966208
buffer_load_dwordx4 v160, s[16:19], s67 offen lds
s_add_u32 m0, s7, 69632
s_add_u32 s67, s68, 1966336
buffer_load_dwordx4 v160, s[16:19], s67 offen lds
ds_read_b64_tr_b16 v[196:197], v164 offset:36864
ds_read_b64_tr_b16 v[198:199], v167 offset:36864
ds_read_b64_tr_b16 v[200:201], v164 offset:40960
ds_read_b64_tr_b16 v[202:203], v167 offset:40960
ds_read_b64_tr_b16 v[204:205], v164 offset:45056
ds_read_b64_tr_b16 v[206:207], v167 offset:45056
s_waitcnt vmcnt(15)
s_waitcnt lgkmcnt(0)
s_barrier
s_add_u32 m0, s7, 73728
s_add_u32 s67, s68, 3932160
buffer_load_dwordx4 v160, s[16:19], s67 offen lds
s_add_u32 m0, s7, 77824
s_add_u32 s67, s68, 3932288
buffer_load_dwordx4 v160, s[16:19], s67 offen lds
s_add_u32 m0, s7, 81920
s_add_u32 s67, s68, 3932416
buffer_load_dwordx4 v160, s[16:19], s67 offen lds
ds_read_b64_tr_b16 v[208:209], v162 offset:0
ds_read_b64_tr_b16 v[210:211], v165 offset:0
ds_read_b64_tr_b16 v[212:213], v162 offset:4096
ds_read_b64_tr_b16 v[214:215], v165 offset:4096
ds_read_b64_tr_b16 v[216:217], v162 offset:8192
ds_read_b64_tr_b16 v[218:219], v165 offset:8192
s_waitcnt vmcnt(15)
s_waitcnt lgkmcnt(0)
s_barrier
s_add_u32 m0, s7, 86016
s_add_u32 s67, s68, 4325376
buffer_load_dwordx4 v160, s[16:19], s67 offen lds
s_add_u32 m0, s7, 90112
s_add_u32 s67, s68, 4325504
buffer_load_dwordx4 v160, s[16:19], s67 offen lds
s_add_u32 m0, s7, 94208
s_add_u32 s67, s68, 4325632
buffer_load_dwordx4 v160, s[16:19], s67 offen lds
ds_read_b64_tr_b16 v[220:221], v162 offset:12288
ds_read_b64_tr_b16 v[222:223], v165 offset:12288
ds_read_b64_tr_b16 v[224:225], v162 offset:16384
ds_read_b64_tr_b16 v[226:227], v165 offset:16384
ds_read_b64_tr_b16 v[228:229], v162 offset:20480
ds_read_b64_tr_b16 v[230:231], v165 offset:20480
s_waitcnt vmcnt(15)
s_waitcnt lgkmcnt(0)
s_barrier
s_add_u32 m0, s7, 98304
s_add_u32 s67, s68, 7077888
buffer_load_dwordx4 v160, s[16:19], s67 offen lds
s_add_u32 m0, s7, 102400
s_add_u32 s67, s68, 7078016
buffer_load_dwordx4 v160, s[16:19], s67 offen lds
s_add_u32 m0, s7, 106496
s_add_u32 s67, s68, 7078144
buffer_load_dwordx4 v160, s[16:19], s67 offen lds
ds_read_b64_tr_b16 v[232:233], v162 offset:24576
ds_read_b64_tr_b16 v[234:235], v165 offset:24576
ds_read_b64_tr_b16 v[236:237], v162 offset:28672
ds_read_b64_tr_b16 v[238:239], v165 offset:28672
ds_read_b64_tr_b16 v[240:241], v162 offset:32768
ds_read_b64_tr_b16 v[242:243], v165 offset:32768
s_waitcnt vmcnt(15)
s_waitcnt lgkmcnt(0)
s_barrier
s_add_u32 m0, s7, 110592
s_add_u32 s67, s68, 7471104
buffer_load_dwordx4 v160, s[16:19], s67 offen lds
s_add_u32 m0, s7, 114688
s_add_u32 s67, s68, 7471232
buffer_load_dwordx4 v160, s[16:19], s67 offen lds
s_add_u32 m0, s7, 118784
s_add_u32 s67, s68, 7471360
buffer_load_dwordx4 v160, s[16:19], s67 offen lds
ds_read_b64_tr_b16 v[244:245], v162 offset:36864
ds_read_b64_tr_b16 v[246:247], v165 offset:36864
ds_read_b64_tr_b16 v[248:249], v162 offset:40960
ds_read_b64_tr_b16 v[250:251], v165 offset:40960
ds_read_b64_tr_b16 v[252:253], v162 offset:45056
ds_read_b64_tr_b16 v[254:255], v165 offset:45056
s_waitcnt vmcnt(15)
s_waitcnt lgkmcnt(0)
s_barrier
s_add_u32 m0, s7, 122880
s_add_u32 s67, s69, 128
buffer_load_dwordx4 v161, s[20:23], s67 offen lds
s_add_u32 m0, s7, 126976
s_add_u32 s67, s69, 41088
buffer_load_dwordx4 v161, s[20:23], s67 offen lds
s_add_u32 m0, s7, 131072
s_add_u32 s67, s69, 82048
buffer_load_dwordx4 v161, s[20:23], s67 offen lds
ds_read_b64_tr_b16 v[16:17], v163 offset:0
ds_read_b64_tr_b16 v[18:19], v166 offset:0
ds_read_b64_tr_b16 v[24:25], v163 offset:4096
ds_read_b64_tr_b16 v[26:27], v166 offset:4096
ds_read_b64_tr_b16 v[32:33], v163 offset:8192
ds_read_b64_tr_b16 v[34:35], v166 offset:8192
s_waitcnt vmcnt(15)
s_waitcnt lgkmcnt(0)
s_barrier
s_add_u32 m0, s7, 135168
s_add_u32 s67, s69, 123008
buffer_load_dwordx4 v161, s[20:23], s67 offen lds
s_add_u32 m0, s7, 139264
s_add_u32 s67, s69, 163968
buffer_load_dwordx4 v161, s[20:23], s67 offen lds
s_add_u32 m0, s7, 143360
s_add_u32 s67, s69, 204928
buffer_load_dwordx4 v161, s[20:23], s67 offen lds
ds_read_b64_tr_b16 v[20:21], v163 offset:12288
ds_read_b64_tr_b16 v[22:23], v166 offset:12288
ds_read_b64_tr_b16 v[28:29], v163 offset:16384
ds_read_b64_tr_b16 v[30:31], v166 offset:16384
ds_read_b64_tr_b16 v[36:37], v163 offset:20480
ds_read_b64_tr_b16 v[38:39], v166 offset:20480
s_waitcnt vmcnt(15)
s_waitcnt lgkmcnt(0)
s_barrier
s_add_u32 m0, s7, 0
s_add_u32 s67, s69, 640
buffer_load_dwordx4 v161, s[20:23], s67 offen lds
s_add_u32 m0, s7, 4096
s_add_u32 s67, s69, 41600
buffer_load_dwordx4 v161, s[20:23], s67 offen lds
s_add_u32 m0, s7, 8192
s_add_u32 s67, s69, 82560
buffer_load_dwordx4 v161, s[20:23], s67 offen lds
ds_read_b64_tr_b16 v[40:41], v163 offset:24576
ds_read_b64_tr_b16 v[42:43], v166 offset:24576
ds_read_b64_tr_b16 v[48:49], v163 offset:28672
ds_read_b64_tr_b16 v[50:51], v166 offset:28672
ds_read_b64_tr_b16 v[56:57], v163 offset:32768
ds_read_b64_tr_b16 v[58:59], v166 offset:32768
s_waitcnt vmcnt(15)
s_waitcnt lgkmcnt(0)
s_barrier
s_add_u32 m0, s7, 12288
s_add_u32 s67, s69, 123520
buffer_load_dwordx4 v161, s[20:23], s67 offen lds
s_add_u32 m0, s7, 16384
s_add_u32 s67, s69, 164480
buffer_load_dwordx4 v161, s[20:23], s67 offen lds
s_add_u32 m0, s7, 20480
s_add_u32 s67, s69, 205440
buffer_load_dwordx4 v161, s[20:23], s67 offen lds
ds_read_b64_tr_b16 v[44:45], v163 offset:36864
ds_read_b64_tr_b16 v[46:47], v166 offset:36864
ds_read_b64_tr_b16 v[52:53], v163 offset:40960
ds_read_b64_tr_b16 v[54:55], v166 offset:40960
ds_read_b64_tr_b16 v[60:61], v163 offset:45056
ds_read_b64_tr_b16 v[62:63], v166 offset:45056
v_lshlrev_b32 v173, 2, v0
buffer_load_dword v172, v173, s[12:15], 0 offen sc1
s_waitcnt vmcnt(16)
s_waitcnt lgkmcnt(0)
s_barrier
s_add_u32 m0, s7, 24576
s_add_u32 s67, s69, 1152
buffer_load_dwordx4 v161, s[20:23], s67 offen lds
s_add_u32 m0, s7, 28672
s_add_u32 s67, s69, 42112
buffer_load_dwordx4 v161, s[20:23], s67 offen lds
s_add_u32 m0, s7, 32768
s_add_u32 s67, s69, 83072
buffer_load_dwordx4 v161, s[20:23], s67 offen lds
ds_read_b64_tr_b16 v[64:65], v164 offset:0
ds_read_b64_tr_b16 v[66:67], v167 offset:0
ds_read_b64_tr_b16 v[72:73], v164 offset:4096
ds_read_b64_tr_b16 v[74:75], v167 offset:4096
ds_read_b64_tr_b16 v[80:81], v164 offset:8192
ds_read_b64_tr_b16 v[82:83], v167 offset:8192
s_waitcnt vmcnt(16)
s_waitcnt lgkmcnt(0)
s_barrier
s_add_u32 m0, s7, 36864
s_add_u32 s67, s69, 124032
buffer_load_dwordx4 v161, s[20:23], s67 offen lds
s_add_u32 m0, s7, 40960
s_add_u32 s67, s69, 164992
buffer_load_dwordx4 v161, s[20:23], s67 offen lds
s_add_u32 m0, s7, 45056
s_add_u32 s67, s69, 205952
buffer_load_dwordx4 v161, s[20:23], s67 offen lds
ds_read_b64_tr_b16 v[68:69], v164 offset:12288
ds_read_b64_tr_b16 v[70:71], v167 offset:12288
ds_read_b64_tr_b16 v[76:77], v164 offset:16384
ds_read_b64_tr_b16 v[78:79], v167 offset:16384
ds_read_b64_tr_b16 v[84:85], v164 offset:20480
ds_read_b64_tr_b16 v[86:87], v167 offset:20480
s_waitcnt vmcnt(16)
s_waitcnt lgkmcnt(0)
s_barrier
ds_read_b64_tr_b16 v[88:89], v164 offset:24576
ds_read_b64_tr_b16 v[90:91], v167 offset:24576
ds_read_b64_tr_b16 v[92:93], v164 offset:28672
ds_read_b64_tr_b16 v[94:95], v167 offset:28672
ds_read_b64_tr_b16 v[96:97], v164 offset:32768
ds_read_b64_tr_b16 v[98:99], v167 offset:32768
s_waitcnt vmcnt(13)
s_waitcnt lgkmcnt(0)
s_barrier
ds_read_b64_tr_b16 v[100:101], v164 offset:36864
ds_read_b64_tr_b16 v[102:103], v167 offset:36864
ds_read_b64_tr_b16 v[104:105], v164 offset:40960
ds_read_b64_tr_b16 v[106:107], v167 offset:40960
ds_read_b64_tr_b16 v[108:109], v164 offset:45056
ds_read_b64_tr_b16 v[110:111], v167 offset:45056
s_waitcnt vmcnt(10)
s_waitcnt lgkmcnt(0)
s_barrier
ds_read_b64_tr_b16 v[112:113], v162 offset:0
ds_read_b64_tr_b16 v[114:115], v165 offset:0
ds_read_b64_tr_b16 v[116:117], v162 offset:4096
ds_read_b64_tr_b16 v[118:119], v165 offset:4096
ds_read_b64_tr_b16 v[120:121], v162 offset:8192
ds_read_b64_tr_b16 v[122:123], v165 offset:8192
s_waitcnt vmcnt(7)
s_waitcnt lgkmcnt(0)
s_barrier
ds_read_b64_tr_b16 v[124:125], v162 offset:12288
ds_read_b64_tr_b16 v[126:127], v165 offset:12288
ds_read_b64_tr_b16 v[128:129], v162 offset:16384
ds_read_b64_tr_b16 v[130:131], v165 offset:16384
ds_read_b64_tr_b16 v[132:133], v162 offset:20480
ds_read_b64_tr_b16 v[134:135], v165 offset:20480
s_waitcnt vmcnt(3)
s_waitcnt lgkmcnt(0)
s_barrier
ds_read_b64_tr_b16 v[136:137], v162 offset:24576
ds_read_b64_tr_b16 v[138:139], v165 offset:24576
ds_read_b64_tr_b16 v[140:141], v162 offset:28672
ds_read_b64_tr_b16 v[142:143], v165 offset:28672
ds_read_b64_tr_b16 v[144:145], v162 offset:32768
ds_read_b64_tr_b16 v[146:147], v165 offset:32768
v_and_b32 v175, 15, v0
v_lshlrev_b32 v175, 7, v175
buffer_load_dword v174, v175, s[8:11], s81 offen sc1
s_waitcnt vmcnt(1)
s_waitcnt lgkmcnt(0)
s_barrier
ds_read_b64_tr_b16 v[148:149], v162 offset:36864
ds_read_b64_tr_b16 v[150:151], v165 offset:36864
ds_read_b64_tr_b16 v[152:153], v162 offset:40960
ds_read_b64_tr_b16 v[154:155], v165 offset:40960
ds_read_b64_tr_b16 v[156:157], v162 offset:45056
ds_read_b64_tr_b16 v[158:159], v165 offset:45056
s_waitcnt lgkmcnt(0)
s_barrier
ds_write_b128 v4, v[16:19] offset:0
ds_write_b128 v4, v[20:23] offset:1024
ds_write_b128 v4, v[24:27] offset:2048
ds_write_b128 v4, v[28:31] offset:3072
ds_write_b128 v4, v[32:35] offset:4096
ds_write_b128 v4, v[36:39] offset:5120
ds_write_b128 v4, v[40:43] offset:6144
ds_write_b128 v4, v[44:47] offset:7168
ds_write_b128 v4, v[48:51] offset:8192
ds_write_b128 v4, v[52:55] offset:9216
ds_write_b128 v4, v[56:59] offset:10240
ds_write_b128 v4, v[60:63] offset:11264
ds_write_b128 v4, v[64:67] offset:12288
ds_write_b128 v4, v[68:71] offset:13312
ds_write_b128 v4, v[72:75] offset:14336
ds_write_b128 v4, v[76:79] offset:15360
ds_write_b128 v4, v[80:83] offset:16384
ds_write_b128 v4, v[84:87] offset:17408
ds_write_b128 v4, v[88:91] offset:18432
ds_write_b128 v4, v[92:95] offset:19456
ds_write_b128 v4, v[96:99] offset:20480
ds_write_b128 v4, v[100:103] offset:21504
ds_write_b128 v4, v[104:107] offset:22528
ds_write_b128 v4, v[108:111] offset:23552
ds_write_b128 v4, v[112:115] offset:24576
ds_write_b128 v4, v[116:119] offset:25600
ds_write_b128 v4, v[120:123] offset:26624
ds_write_b128 v4, v[124:127] offset:27648
ds_write_b128 v4, v[128:131] offset:28672
ds_write_b128 v4, v[132:135] offset:29696
ds_write_b128 v4, v[136:139] offset:30720
ds_write_b128 v4, v[140:143] offset:31744
ds_write_b128 v4, v[144:147] offset:32768
ds_write_b128 v4, v[148:151] offset:33792
ds_write_b128 v4, v[152:155] offset:34816
ds_write_b128 v4, v[156:159] offset:35840
s_waitcnt lgkmcnt(0)
s_waitcnt vmcnt(0)
v_min_u32_dpp v174, v174, v174 row_ror:8 row_mask:0xf bank_mask:0xf
s_nop 1
v_min_u32_dpp v174, v174, v174 row_ror:4 row_mask:0xf bank_mask:0xf
s_nop 1
v_min_u32_dpp v174, v174, v174 row_ror:2 row_mask:0xf bank_mask:0xf
s_nop 1
v_min_u32_dpp v174, v174, v174 row_ror:1 row_mask:0xf bank_mask:0xf
s_nop 0
v_readfirstlane_b32 s60, v174
v_lshlrev_b32 v14, 2, v0
v_mov_b32 v13, v172
s_branch Lrc_177
Lr_174:
s_mov_b32 s60, 0
buffer_load_dword v13, v14, s[12:15], 0 offen sc1
s_waitcnt vmcnt(0)
Lrc_177:
v_readlane_b32 s67, v13, 9
v_readlane_b32 s68, v13, 10
s_nop 0
s_cmp_lt_u32 s68, 2560
s_cselect_b32 s67, 0, s67
v_readlane_b32 s68, v13, 40
s_nop 0
s_cmp_lt_u32 s68, 10
s_cselect_b32 s67, 0, s67
s_cmp_eq_u32 s65, 0
s_cbranch_scc1 Lrd_175
s_sub_u32 s65, s65, 1
s_cmp_lt_u32 s67, 64
s_cbranch_scc1 Lr_174
Lrd_175:
v_readlane_b32 s69, v13, 10
s_nop 0
s_and_b32 s67, s69, 15
s_cmp_gt_u32 s67, 5
s_cselect_b32 s67, 1, 0
v_readlane_b32 s68, v13, 0
s_nop 0
s_cmp_gt_u32 s68, 15
s_cselect_b32 s68, 1, 0
s_xor_b32 s67, s67, s68
s_lshl_b32 s67, s67, 13
s_add_u32 s59, s59, s67
s_bfe_u32 s69, s69, 0x40004
s_cmp_gt_u32 s69, 5
s_cselect_b32 s69, 1, 0
v_readlane_b32 s68, v13, 1
s_nop 0
s_and_b32 s68, s68, 0xaa
s_cselect_b32 s68, 1, 0
s_xor_b32 s69, s69, s68
s_xor_b32 s69, s69, s64
s_lshl_b32 s69, s69, 14
s_add_u32 s58, s58, s59
s_add_u32 s59, s59, s69
s_xor_b32 s69, s69, 16384
s_add_u32 s58, s58, s69
v_readlane_b32 s67, v13, 0
v_readlane_b32 s68, v13, 1
s_bcnt1_i32_b32 s67, s67
s_bcnt1_i32_b32 s68, s68
s_max_u32 s67, s67, s68
s_cmp_lg_u32 s67, 1
s_cbranch_scc1 Lslow_176
s_cmp_eq_u32 s3, 1
s_cbranch_scc1 Lw_179
s_cmp_eq_u32 s3, 3
s_cbranch_scc1 Lw_182
s_cmp_ge_u32 s66, 40
s_cbranch_scc1 Lw_181
s_cmp_eq_u32 s3, 2
s_cbranch_scc1 Lw_180
Lw_178:
s_mov_b32 s62, 0
s_mov_b32 s36, 0x03030303
s_mov_b32 s37, s36
ds_read_b128 v[80:83], v4 offset:0
ds_read_b128 v[84:87], v4 offset:1024
ds_read_b128 v[88:91], v4 offset:2048
ds_read_b128 v[92:95], v4 offset:3072
ds_read_b128 v[96:99], v4 offset:4096
ds_read_b128 v[100:103], v4 offset:5120
ds_read_b128 v[104:107], v4 offset:6144
ds_read_b128 v[108:111], v4 offset:7168
s_bitcmp1_b32 s62, 0
s_cselect_b32 s50, 0x80008000, 0
s_add_u32 s67, s62, 1
s_and_b32 s67, s67, 3
s_lshl_b32 s67, s67, 1
s_lshl_b32 s78, s67, 15
s_add_u32 s67, s67, s64
s_mul_i32 s77, s67, 10240
s_lshl_b32 s67, s66, 8
s_add_u32 s77, s77, s67
s_add_u32 s78, s78, s67
s_add_u32 s77, s77, 191889408
s_add_u32 s78, s78, s59
s_cmp_ge_u32 s66, 24
s_cselect_b32 s67, 26624, 0
s_add_u32 s78, s78, s67
s_mov_b32 s82, s62
s_mul_i32 s83, s82, 1638400
s_add_u32 s83, s83, s47
s_cmp_eq_u32 s62, 63
s_cselect_b32 s83, 536870912, s83
v_mov_b64 v[56:57], 0
v_mov_b64 v[58:59], 0
v_mov_b64 v[60:61], 0
v_mov_b64 v[62:63], 0
v_mov_b64 v[64:65], 0
v_mov_b64 v[66:67], 0
v_mov_b64 v[156:157], 0
v_mov_b64 v[158:159], 0
v_mov_b64 v[160:161], 0
v_mov_b64 v[162:163], 0
v_mov_b64 v[164:165], 0
v_mov_b64 v[166:167], 0
v_mov_b64 v[168:169], 0
v_mov_b64 v[170:171], 0
v_mov_b64 v[172:173], 0
v_mov_b64 v[174:175], 0
s_cmp_ge_u32 s62, 3
s_cbranch_scc1 Lk_185
s_sub_u32 s61, s82, 12
s_max_i32 s61, s61, 0
s_lshr_b32 s61, s61, 2
s_add_u32 s61, s61, s82
s_cmp_gt_u32 s60, s61
s_cbranch_scc1 Lfd_187
v_and_b32 v14, 15, v0
v_lshlrev_b32 v14, 7, v14
Lf_186:
buffer_load_dword v13, v14, s[8:11], s81 offen sc1
s_waitcnt vmcnt(0)
v_min_u32_dpp v13, v13, v13 row_ror:8 row_mask:0xf bank_mask:0xf
s_nop 1
v_min_u32_dpp v13, v13, v13 row_ror:4 row_mask:0xf bank_mask:0xf
s_nop 1
v_min_u32_dpp v13, v13, v13 row_ror:2 row_mask:0xf bank_mask:0xf
s_nop 1
v_min_u32_dpp v13, v13, v13 row_ror:1 row_mask:0xf bank_mask:0xf
s_nop 0
v_readfirstlane_b32 s60, v13
s_nop 0
s_cmp_gt_u32 s60, s61
s_cbranch_scc1 Lfd_187
s_cmp_eq_u32 s65, 0
s_cbranch_scc1 Lfd_187
s_sub_u32 s65, s65, 1
s_branch Lf_186
Lfd_187:
Lk_185:
ds_read_b128 v[16:19], v3 offset:0
ds_read_b128 v[24:27], v3 offset:1024
ds_read_b128 v[32:35], v3 offset:2048
s_waitcnt lgkmcnt(0)
s_branch Lvoent_184
Lvo_183:
s_barrier
ds_read_b128 v[80:83], v4 offset:0
ds_read_b128 v[84:87], v4 offset:1024
ds_read_b128 v[88:91], v4 offset:2048
ds_read_b128 v[92:95], v4 offset:3072
ds_read_b128 v[96:99], v4 offset:4096
ds_read_b128 v[100:103], v4 offset:5120
ds_read_b128 v[104:107], v4 offset:6144
ds_read_b128 v[108:111], v4 offset:7168
s_bitcmp1_b32 s62, 0
s_cselect_b32 s50, 0x80008000, 0
s_add_u32 s67, s62, 1
s_and_b32 s67, s67, 3
s_lshl_b32 s67, s67, 1
s_lshl_b32 s78, s67, 15
s_add_u32 s67, s67, s64
s_mul_i32 s77, s67, 10240
s_lshl_b32 s67, s66, 8
s_add_u32 s77, s77, s67
s_add_u32 s78, s78, s67
s_add_u32 s77, s77, 191889408
s_add_u32 s78, s78, s59
s_cmp_ge_u32 s66, 24
s_cselect_b32 s67, 26624, 0
s_add_u32 s78, s78, s67
s_mov_b32 s82, s62
s_mul_i32 s83, s82, 1638400
s_add_u32 s83, s83, s47
s_cmp_eq_u32 s62, 63
s_cselect_b32 s83, 536870912, s83
v_mov_b64 v[56:57], 0
v_mov_b64 v[58:59], 0
v_mov_b64 v[60:61], 0
v_mov_b64 v[62:63], 0
v_mov_b64 v[64:65], 0
v_mov_b64 v[66:67], 0
v_mov_b64 v[156:157], 0
v_mov_b64 v[158:159], 0
v_mov_b64 v[160:161], 0
v_mov_b64 v[162:163], 0
v_mov_b64 v[164:165], 0
v_mov_b64 v[166:167], 0
v_mov_b64 v[168:169], 0
v_mov_b64 v[170:171], 0
v_mov_b64 v[172:173], 0
v_mov_b64 v[174:175], 0
s_cmp_ge_u32 s62, 3
s_cbranch_scc1 Lk_188
s_sub_u32 s61, s82, 12
s_max_i32 s61, s61, 0
s_lshr_b32 s61, s61, 2
s_add_u32 s61, s61, s82
s_cmp_gt_u32 s60, s61
s_cbranch_scc1 Lfd_190
v_and_b32 v14, 15, v0
v_lshlrev_b32 v14, 7, v14
Lf_189:
buffer_load_dword v13, v14, s[8:11], s81 offen sc1
s_waitcnt vmcnt(0)
v_min_u32_dpp v13, v13, v13 row_ror:8 row_mask:0xf bank_mask:0xf
s_nop 1
v_min_u32_dpp v13, v13, v13 row_ror:4 row_mask:0xf bank_mask:0xf
s_nop 1
v_min_u32_dpp v13, v13, v13 row_ror:2 row_mask:0xf bank_mask:0xf
s_nop 1
v_min_u32_dpp v13, v13, v13 row_ror:1 row_mask:0xf bank_mask:0xf
s_nop 0
v_readfirstlane_b32 s60, v13
s_nop 0
s_cmp_gt_u32 s60, s61
s_cbranch_scc1 Lfd_190
s_cmp_eq_u32 s65, 0
s_cbranch_scc1 Lfd_190
s_sub_u32 s65, s65, 1
s_branch Lf_189
Lfd_190:
Lk_188:
s_sleep 1
s_waitcnt lgkmcnt(0)
buffer_load_dwordx4 v[68:71], v1, s[8:11], s32 offen offset:0 sc1
buffer_load_dwordx4 v[72:75], v1, s[8:11], s32 offen offset:1024 sc1
buffer_load_dwordx4 v[76:79], v1, s[8:11], s32 offen offset:2048 sc1
s_waitcnt vmcnt(0)
v_max3_u32 v52, v68, v69, v70
v_max3_u32 v53, v72, v73, v74
v_max3_u32 v54, v76, v77, v78
v_max_u32 v52, v52, v71
v_max_u32 v53, v53, v75
v_max_u32 v54, v54, v79
v_cmp_eq_u32 s[16:17], -1, v52
v_cmp_eq_u32 s[18:19], -1, v53
v_cmp_eq_u32 s[20:21], -1, v54
s_or_b64 s[28:29], s[16:17], s[18:19]
s_or_b64 s[28:29], s[28:29], s[20:21]
s_cbranch_scc1 Lg_191
Lg_192:
buffer_load_dwordx4 v[112:115], v1, s[8:11], s33 offen offset:0 sc1
buffer_load_dwordx4 v[116:119], v1, s[8:11], s33 offen offset:1024 sc1
buffer_load_dwordx4 v[120:123], v1, s[8:11], s33 offen offset:2048 sc1
v_lshlrev_b32 v16, 16, v68
v_and_b32 v17, 0xffff0000, v68
v_lshlrev_b32 v18, 16, v69
v_and_b32 v19, 0xffff0000, v69
v_lshlrev_b32 v20, 16, v70
v_and_b32 v21, 0xffff0000, v70
v_lshlrev_b32 v22, 16, v71
v_and_b32 v23, 0xffff0000, v71
v_lshlrev_b32 v24, 16, v72
v_and_b32 v25, 0xffff0000, v72
v_lshlrev_b32 v26, 16, v73
v_and_b32 v27, 0xffff0000, v73
v_lshlrev_b32 v28, 16, v74
v_and_b32 v29, 0xffff0000, v74
v_lshlrev_b32 v30, 16, v75
v_and_b32 v31, 0xffff0000, v75
v_lshlrev_b32 v32, 16, v76
v_and_b32 v33, 0xffff0000, v76
v_lshlrev_b32 v34, 16, v77
v_and_b32 v35, 0xffff0000, v77
v_lshlrev_b32 v36, 16, v78
v_and_b32 v37, 0xffff0000, v78
v_lshlrev_b32 v38, 16, v79
v_and_b32 v39, 0xffff0000, v79
s_waitcnt vmcnt(0)
v_max3_u32 v52, v112, v113, v114
v_max3_u32 v53, v116, v117, v118
v_max3_u32 v54, v120, v121, v122
v_max_u32 v52, v52, v115
v_max_u32 v53, v53, v119
v_max_u32 v54, v54, v123
v_cmp_eq_u32 s[22:23], -1, v52
v_cmp_eq_u32 s[24:25], -1, v53
v_cmp_eq_u32 s[26:27], -1, v54
s_or_b64 s[28:29], s[22:23], s[24:25]
s_or_b64 s[28:29], s[28:29], s[26:27]
s_cbranch_scc1 Lg_193
Lg_195:
v_dot2c_f32_bf16 v16, s100, v112
v_dot2c_f32_bf16 v17, s101, v112
v_dot2c_f32_bf16 v18, s100, v113
v_dot2c_f32_bf16 v19, s101, v113
v_dot2c_f32_bf16 v20, s100, v114
v_dot2c_f32_bf16 v21, s101, v114
v_dot2c_f32_bf16 v22, s100, v115
v_dot2c_f32_bf16 v23, s101, v115
v_cvt_pk_bf16_f32 v16, v16, v17
v_cvt_pk_bf16_f32 v17, v18, v19
v_cvt_pk_bf16_f32 v18, v20, v21
v_cvt_pk_bf16_f32 v19, v22, v23
ds_write_b128 v2, v[16:19] offset:0
v_dot2c_f32_bf16 v24, s100, v116
v_dot2c_f32_bf16 v25, s101, v116
v_dot2c_f32_bf16 v26, s100, v117
v_dot2c_f32_bf16 v27, s101, v117
v_dot2c_f32_bf16 v28, s100, v118
v_dot2c_f32_bf16 v29, s101, v118
v_dot2c_f32_bf16 v30, s100, v119
v_dot2c_f32_bf16 v31, s101, v119
v_cvt_pk_bf16_f32 v24, v24, v25
v_cvt_pk_bf16_f32 v25, v26, v27
v_cvt_pk_bf16_f32 v26, v28, v29
v_cvt_pk_bf16_f32 v27, v30, v31
ds_write_b128 v2, v[24:27] offset:1024
v_dot2c_f32_bf16 v32, s100, v120
v_dot2c_f32_bf16 v33, s101, v120
v_dot2c_f32_bf16 v34, s100, v121
v_dot2c_f32_bf16 v35, s101, v121
v_dot2c_f32_bf16 v36, s100, v122
v_dot2c_f32_bf16 v37, s101, v122
v_dot2c_f32_bf16 v38, s100, v123
v_dot2c_f32_bf16 v39, s101, v123
v_cvt_pk_bf16_f32 v32, v32, v33
v_cvt_pk_bf16_f32 v33, v34, v35
v_cvt_pk_bf16_f32 v34, v36, v37
v_cvt_pk_bf16_f32 v35, v38, v39
ds_write_b128 v2, v[32:35] offset:2048
Lvoent_184:
v_smfmac_f32_16x16x64_bf16 v[56:59], v[16:19], a[0:7], v8
v_smfmac_f32_16x16x64_bf16 v[60:63], v[16:19], a[56:63], v8
buffer_load_dwordx4 v[112:115], v1, s[8:11], s83 offen offset:0 sc1
v_smfmac_f32_16x16x64_bf16 v[64:67], v[16:19], a[112:119], v8
v_smfmac_f32_16x16x64_bf16 v[56:59], v[24:27], a[8:15], v8
s_waitcnt lgkmcnt(0)
s_barrier
ds_read_b128 v[20:23], v3 offset:3072
v_mov_b64 v[16:17], 0
v_smfmac_f32_16x16x64_bf16 v[60:63], v[24:27], a[64:71], v8
ds_read_b128 v[28:31], v3 offset:4096
buffer_load_dwordx4 v[116:119], v1, s[8:11], s83 offen offset:1024 sc1
v_mov_b64 v[18:19], 0
v_smfmac_f32_16x16x64_bf16 v[64:67], v[24:27], a[120:127], v8
ds_read_b128 v[36:39], v3 offset:5120
v_smfmac_f32_16x16x64_bf16 v[56:59], v[32:35], v[80:87], v8
ds_read_b128 v[40:43], v3 offset:6144
v_mov_b64 v[24:25], 0
v_smfmac_f32_16x16x64_bf16 v[60:63], v[32:35], v[88:95], v8
ds_read_b128 v[44:47], v3 offset:7168
buffer_load_dwordx4 v[120:123], v1, s[8:11], s83 offen offset:2048 sc1
ds_read_b128 v[80:83], v4 offset:12288
v_mov_b64 v[26:27], 0
v_smfmac_f32_16x16x64_bf16 v[64:67], v[32:35], v[96:103], v8
ds_read_b128 v[48:51], v3 offset:9216
ds_read_b128 v[84:87], v4 offset:13312
s_waitcnt lgkmcnt(7)
v_smfmac_f32_16x16x64_bf16 v[56:59], v[20:23], a[16:23], v8
ds_read_b128 v[52:55], v3 offset:8192
s_waitcnt lgkmcnt(7)
v_mov_b64 v[32:33], 0
v_smfmac_f32_16x16x64_bf16 v[56:59], v[28:31], a[24:31], v8
buffer_load_dwordx4 v[124:127], v1, s[8:11], s83 offen offset:3072 sc1
ds_read_b128 v[88:91], v4 offset:8192
s_waitcnt lgkmcnt(7)
v_mov_b64 v[34:35], 0
v_smfmac_f32_16x16x64_bf16 v[56:59], v[36:39], v[104:111], v8
s_add_u32 s83, s83, 4096
ds_read_b128 v[92:95], v4 offset:9216
s_waitcnt lgkmcnt(7)
v_smfmac_f32_16x16x64_bf16 v[56:59], v[40:43], a[32:39], v8
ds_read_b128 v[96:99], v4 offset:14336
s_waitcnt lgkmcnt(7)
v_smfmac_f32_16x16x64_bf16 v[56:59], v[44:47], a[40:47], v8
buffer_load_dwordx4 v[128:131], v1, s[8:11], s83 offen offset:0 sc1
ds_read_b128 v[100:103], v4 offset:15360
s_waitcnt lgkmcnt(5)
v_smfmac_f32_16x16x64_bf16 v[56:59], v[48:51], v[80:87], v8
ds_read_b128 v[104:107], v4 offset:10240
s_waitcnt lgkmcnt(5)
v_smfmac_f32_16x16x64_bf16 v[56:59], v[52:55], a[48:55], v8
ds_read_b128 v[108:111], v4 offset:11264
v_smfmac_f32_16x16x64_bf16 v[60:63], v[20:23], a[72:79], v8
buffer_load_dwordx4 v[132:135], v1, s[8:11], s83 offen offset:1024 sc1
ds_read_b128 v[80:83], v4 offset:16384
v_smfmac_f32_16x16x64_bf16 v[60:63], v[28:31], a[80:87], v8
ds_read_b128 v[84:87], v4 offset:17408
s_waitcnt lgkmcnt(6)
v_add_f32 v56, v56, v58
v_smfmac_f32_16x16x64_bf16 v[60:63], v[36:39], v[88:95], v8
ds_read_b128 v[88:91], v4 offset:18432
v_add_f32 v57, v57, v59
v_smfmac_f32_16x16x64_bf16 v[60:63], v[40:43], a[88:95], v8
buffer_load_dwordx4 v[136:139], v1, s[8:11], s83 offen offset:2048 sc1
ds_read_b128 v[92:95], v4 offset:19456
v_cvt_pk_bf16_f32 v56, v56, v57
v_smfmac_f32_16x16x64_bf16 v[60:63], v[44:47], a[96:103], v8
s_waitcnt lgkmcnt(6)
v_smfmac_f32_16x16x64_bf16 v[60:63], v[48:51], v[96:103], v8
ds_read_b128 v[96:99], v4 offset:20480
v_mov_b32_dpp v57, v56 quad_perm:[1,0,3,2] row_mask:0xf bank_mask:0xf
v_smfmac_f32_16x16x64_bf16 v[60:63], v[52:55], a[104:111], v8
buffer_load_dwordx4 v[140:143], v1, s[8:11], s83 offen offset:3072 sc1
ds_read_b128 v[100:103], v4 offset:21504
v_perm_b32 v56, v57, v56, v6
v_smfmac_f32_16x16x64_bf16 v[64:67], v[20:23], a[128:135], v8
s_add_u32 s83, s83, 4096
ds_write_b32 v5, v56 offset:0
v_smfmac_f32_16x16x64_bf16 v[64:67], v[28:31], a[136:143], v8
s_waitcnt lgkmcnt(7)
v_add_f32 v60, v60, v62
v_smfmac_f32_16x16x64_bf16 v[64:67], v[36:39], v[104:111], v8
buffer_load_dwordx4 v[144:147], v1, s[8:11], s83 offen offset:0 sc1
ds_read_b128 v[104:107], v4 offset:24576
v_add_f32 v61, v61, v63
v_smfmac_f32_16x16x64_bf16 v[64:67], v[40:43], a[144:151], v8
s_waitcnt lgkmcnt(1)
s_barrier
ds_read_b128 v[68:71], v3 offset:12736
v_cvt_pk_bf16_f32 v60, v60, v61
v_smfmac_f32_16x16x64_bf16 v[64:67], v[44:47], a[152:159], v8
ds_read_b128 v[108:111], v4 offset:25600
v_mov_b64 v[20:21], 0
v_smfmac_f32_16x16x64_bf16 v[64:67], v[48:51], v[80:87], v8
buffer_load_dwordx4 v[148:151], v1, s[8:11], s83 offen offset:1024 sc1
ds_read_b128 v[80:83], v4 offset:22528
v_mov_b32_dpp v61, v60 quad_perm:[1,0,3,2] row_mask:0xf bank_mask:0xf
v_smfmac_f32_16x16x64_bf16 v[64:67], v[52:55], a[160:167], v8
ds_read_b128 v[84:87], v4 offset:23552
s_waitcnt lgkmcnt(3)
v_perm_b32 v60, v61, v60, v6
v_smfmac_f32_16x16x64_bf16 v[156:159], v[68:71], a[168:175], v8
ds_write_b32 v5, v60 offset:1024
v_mov_b64 v[22:23], 0
v_smfmac_f32_16x16x64_bf16 v[164:167], v[68:71], a[192:199], v8
buffer_load_dwordx4 v[152:155], v1, s[8:11], s83 offen offset:2048 sc1
v_add_f32 v64, v64, v66
v_add_f32 v65, v65, v67
v_smfmac_f32_16x16x64_bf16 v[160:163], v[68:71], v[88:95], v8
ds_read_b128 v[88:91], v4 offset:26624
v_cvt_pk_bf16_f32 v64, v64, v65
v_smfmac_f32_16x16x64_bf16 v[168:171], v[68:71], a[216:223], v8
s_waitcnt lgkmcnt(1)
s_barrier
ds_read_b128 v[72:75], v3 offset:13760
v_mov_b64 v[28:29], 0
v_smfmac_f32_16x16x64_bf16 v[172:175], v[68:71], a[240:247], v8
ds_read_b128 v[92:95], v4 offset:27648
v_mov_b32_dpp v65, v64 quad_perm:[1,0,3,2] row_mask:0xf bank_mask:0xf
v_perm_b32 v64, v65, v64, v6
v_smfmac_f32_16x16x64_bf16 v[24:27], v[68:71], v[184:191], v8
ds_write_b32 v5, v64 offset:2048
s_waitcnt lgkmcnt(2)
v_mov_b64 v[30:31], 0
v_smfmac_f32_16x16x64_bf16 v[156:159], v[72:75], a[176:183], v8
v_smfmac_f32_16x16x64_bf16 v[164:167], v[72:75], a[200:207], v8
v_smfmac_f32_16x16x64_bf16 v[160:163], v[72:75], v[96:103], v8
s_waitcnt lgkmcnt(0)
s_barrier
ds_read_b128 v[76:79], v3 offset:14784
v_smfmac_f32_16x16x64_bf16 v[168:171], v[72:75], a[224:231], v8
ds_read_b128 v[96:99], v4 offset:28672
v_smfmac_f32_16x16x64_bf16 v[16:19], v[68:71], v[104:111], v8
ds_read_b128 v[100:103], v4 offset:29696
v_smfmac_f32_16x16x64_bf16 v[32:35], v[68:71], v[208:215], v8
ds_read_b128 v[104:107], v4 offset:30720
s_waitcnt lgkmcnt(3)
v_smfmac_f32_16x16x64_bf16 v[156:159], v[76:79], a[184:191], v8
ds_read_b128 v[108:111], v4 offset:31744
v_smfmac_f32_16x16x64_bf16 v[160:163], v[76:79], v[80:87], v8
ds_read_b128 v[80:83], v4 offset:32768
v_smfmac_f32_16x16x64_bf16 v[164:167], v[76:79], a[208:215], v8
ds_read_b128 v[84:87], v4 offset:33792
v_add_f32 v156, v156, v158
v_add_f32 v157, v157, v159
v_smfmac_f32_16x16x64_bf16 v[168:171], v[76:79], a[232:239], v8
v_cvt_pk_bf16_f32 v56, v156, v157
v_add_f32 v160, v160, v162
v_smfmac_f32_16x16x64_bf16 v[172:175], v[72:75], a[248:255], v8
buffer_load_dwordx4 v[156:159], v1, s[8:11], s83 offen offset:3072 sc1
s_add_u32 s83, s83, 4096
v_add_f32 v161, v161, v163
v_add_f32 v164, v164, v166
v_smfmac_f32_16x16x64_bf16 v[16:19], v[72:75], v[88:95], v8
ds_read_b128 v[88:91], v4 offset:34816
v_cvt_pk_bf16_f32 v57, v160, v161
v_add_f32 v165, v165, v167
v_smfmac_f32_16x16x64_bf16 v[172:175], v[76:79], v[176:183], v8
buffer_load_dwordx4 v[160:163], v1, s[8:11], s83 offen offset:0 sc1
ds_read_b128 v[92:95], v4 offset:35840
v_cvt_pk_bf16_f32 v58, v164, v165
v_add_f32 v168, v168, v170
v_smfmac_f32_16x16x64_bf16 v[24:27], v[72:75], v[192:199], v8
buffer_load_dwordx4 v[164:167], v1, s[8:11], s83 offen offset:1024 sc1
s_waitcnt lgkmcnt(6)
v_add_f32 v169, v169, v171
v_permlane16_swap_b32 v56, v57
v_smfmac_f32_16x16x64_bf16 v[16:19], v[76:79], v[96:103], v8
v_cvt_pk_bf16_f32 v59, v168, v169
v_add_f32 v172, v172, v174
v_smfmac_f32_16x16x64_bf16 v[32:35], v[72:75], v[216:223], v8
buffer_load_dwordx4 v[168:171], v1, s[8:11], s83 offen offset:2048 sc1
v_permlane16_swap_b32 v58, v59
v_add_f32 v173, v173, v175
v_smfmac_f32_16x16x64_bf16 v[24:27], v[76:79], v[200:207], v8
v_permlane32_swap_b32 v56, v58
v_permlane32_swap_b32 v57, v59
v_smfmac_f32_16x16x64_bf16 v[20:23], v[68:71], v[232:239], v8
v_bfi_b32 v56, 1, s62, v56
v_cvt_pk_bf16_f32 v60, v172, v173
v_smfmac_f32_16x16x64_bf16 v[32:35], v[76:79], v[224:231], v8
buffer_store_dwordx4 v[56:59], v11, s[8:11], s44 offen
s_waitcnt lgkmcnt(4)
v_add_f32 v16, v16, v18
v_add_f32 v17, v17, v19
v_smfmac_f32_16x16x64_bf16 v[28:31], v[68:71], v[104:111], v8
buffer_load_dwordx4 v[172:175], v1, s[8:11], s83 offen offset:3072 sc1
v_cvt_pk_bf16_f32 v61, v16, v17
v_add_f32 v24, v24, v26
v_smfmac_f32_16x16x64_bf16 v[20:23], v[72:75], v[240:247], v8
s_waitcnt lgkmcnt(2)
v_add_f32 v25, v25, v27
v_add_f32 v32, v32, v34
v_smfmac_f32_16x16x64_bf16 v[28:31], v[72:75], v[80:87], v8
v_cvt_pk_bf16_f32 v62, v24, v25
v_add_f32 v33, v33, v35
v_smfmac_f32_16x16x64_bf16 v[20:23], v[76:79], v[248:255], v8
s_waitcnt lgkmcnt(0)
v_cvt_pk_bf16_f32 v63, v32, v33
v_permlane16_swap_b32 v60, v61
v_smfmac_f32_16x16x64_bf16 v[28:31], v[76:79], v[88:95], v8
v_permlane16_swap_b32 v62, v63
s_nop 1
v_permlane32_swap_b32 v60, v62
v_permlane32_swap_b32 v61, v63
v_pk_add_f32 v[20:21], v[20:21], v[22:23]
v_bfi_b32 v60, 1, s62, v60
v_cvt_pk_bf16_f32 v64, v20, v21
v_pk_add_f32 v[28:29], v[28:29], v[30:31]
buffer_store_dwordx4 v[60:63], v11, s[8:11], s45 offen
v_cvt_pk_bf16_f32 v65, v28, v29
s_nop 1
v_permlane16_swap_b32 v64, v65
v_bfi_b32 v64, 1, s62, v64
buffer_store_dwordx2 v[64:65], v9, s[8:11], s46 offen
s_cmp_eq_u32 s62, 63
s_cbranch_scc1 Lc_196
s_add_u32 s67, s62, 1
s_and_b32 s67, s67, 3
s_lshl_b32 s67, s67, 1
s_lshl_b32 s68, s67, 15
s_add_u32 s67, s67, s64
s_mul_i32 s67, s67, 10240
s_add_u32 s33, s68, s58
s_add_u32 s32, s67, s80
s_add_u32 s32, s32, 191889408
s_sleep 4
buffer_load_dwordx4 v[80:83], v10, s[8:11], s72 offen sc1
buffer_load_dwordx4 v[84:87], v10, s[8:11], s73 offen sc1
buffer_load_dwordx4 v[88:91], v10, s[8:11], s74 offen sc1
buffer_load_dwordx4 v[92:95], v10, s[8:11], s75 offen sc1
v_mov_b32 v108, 0
v_mov_b32 v109, 0
v_mov_b32 v110, 0
v_mov_b32 v111, 0
s_waitcnt vmcnt(0)
v_bitop3_b32 v20, v80, s62, 1 bitop3:0x28
v_bitop3_b32 v21, v84, s62, 1 bitop3:0x28
v_bitop3_b32 v22, v88, s62, 1 bitop3:0x28
v_bitop3_b32 v23, v92, s62, 1 bitop3:0x28
v_cmp_ne_u32 s[22:23], 0, v20
v_cmp_ne_u32 s[24:25], 0, v21
v_cmp_ne_u32 s[26:27], 0, v22
v_cmp_ne_u32 s[30:31], 0, v23
s_or_b64 s[28:29], s[22:23], s[24:25]
s_or_b64 s[28:29], s[28:29], s[26:27]
s_or_b64 s[28:29], s[28:29], s[30:31]
s_cbranch_scc1 Lp_204
s_sleep 1
buffer_load_dwordx4 v[96:99], v1, s[8:11], s76 offen offset:0 sc1
buffer_load_dwordx4 v[100:103], v1, s[8:11], s76 offen offset:1024 sc1
buffer_load_dwordx4 v[104:107], v1, s[8:11], s76 offen offset:2048 sc1
Lp_204x:
s_waitcnt vmcnt(2)
ds_write_b128 v2, v[96:99] offset:0
v_bitop3_b32 v16, v96, v98, s50 bitop3:0x7e
v_cmp_gt_i32 s[16:17], 0, v16
s_waitcnt vmcnt(1)
ds_write_b128 v2, v[100:103] offset:1024
v_bitop3_b32 v17, v100, v102, s50 bitop3:0x7e
v_cmp_gt_i32 s[18:19], 0, v17
s_waitcnt vmcnt(0)
ds_write_b128 v2, v[104:107] offset:2048
v_bitop3_b32 v18, v104, v106, s50 bitop3:0x7e
v_cmp_gt_i32 s[20:21], 0, v18
s_or_b64 s[28:29], s[16:17], s[18:19]
s_or_b64 s[28:29], s[28:29], s[20:21]
s_cbranch_scc1 Lp_202
Lp_203:
v_smfmac_f32_16x16x64_bf16 v[108:111], v[96:99], v[112:119], v8
s_waitcnt lgkmcnt(0)
s_barrier
ds_read_b128 v[28:31], v3 offset:3072
ds_read_b128 v[32:35], v3 offset:4096
ds_read_b128 v[36:39], v3 offset:5120
v_smfmac_f32_16x16x64_bf16 v[108:111], v[100:103], v[120:127], v8
ds_read_b128 v[40:43], v3 offset:6144
ds_read_b128 v[44:47], v3 offset:7168
v_smfmac_f32_16x16x64_bf16 v[108:111], v[104:107], v[128:135], v8
ds_read_b128 v[48:51], v3 offset:8192
ds_read_b128 v[52:55], v3 offset:9216
s_waitcnt vmcnt(0)
s_waitcnt lgkmcnt(6)
v_smfmac_f32_16x16x64_bf16 v[108:111], v[28:31], v[136:143], v8
s_waitcnt lgkmcnt(5)
v_smfmac_f32_16x16x64_bf16 v[108:111], v[32:35], v[144:151], v8
s_waitcnt lgkmcnt(4)
v_smfmac_f32_16x16x64_bf16 v[108:111], v[36:39], v[152:159], v8
s_waitcnt lgkmcnt(3)
v_smfmac_f32_16x16x64_bf16 v[108:111], v[40:43], v[160:167], v8
s_waitcnt lgkmcnt(2)
v_smfmac_f32_16x16x64_bf16 v[108:111], v[44:47], v[168:175], v8
s_waitcnt lgkmcnt(1)
v_smfmac_f32_16x16x64_bf16 v[108:111], v[48:51], v[80:87], v8
s_waitcnt lgkmcnt(0)
v_smfmac_f32_16x16x64_bf16 v[108:111], v[52:55], v[88:95], v8
s_nop 7
v_pk_add_f32 v[108:109], v[108:109], v[110:111]
v_cvt_pk_bf16_f32 v108, v108, v109
v_xor_b32 v108, s50, v108
s_nop 1
v_mov_b32_dpp v109, v108 quad_perm:[1,0,3,2] row_mask:0xf bank_mask:0xf
v_perm_b32 v108, v109, v108, v6
buffer_store_dword v108, v12, s[8:11], s77 offen
buffer_store_dword v108, v12, s[8:11], s78 offen sc1
s_cmp_ge_u32 s62, 60
s_cbranch_scc1 Lc_196
Lc_197:
s_add_u32 s62, s62, 1
s_branch Lvo_183
Lg_191:
s_mov_b64 exec, s[16:17]
buffer_load_dwordx4 v[68:71], v1, s[8:11], s32 offen offset:0 sc1
s_mov_b64 exec, s[18:19]
buffer_load_dwordx4 v[72:75], v1, s[8:11], s32 offen offset:1024 sc1
s_mov_b64 exec, s[20:21]
buffer_load_dwordx4 v[76:79], v1, s[8:11], s32 offen offset:2048 sc1
s_mov_b64 exec, -1
s_waitcnt vmcnt(0)
v_max3_u32 v52, v68, v69, v70
v_max3_u32 v53, v72, v73, v74
v_max3_u32 v54, v76, v77, v78
v_max_u32 v52, v52, v71
v_max_u32 v53, v53, v75
v_max_u32 v54, v54, v79
v_cmp_eq_u32 s[16:17], -1, v52
v_cmp_eq_u32 s[18:19], -1, v53
v_cmp_eq_u32 s[20:21], -1, v54
s_or_b64 s[28:29], s[16:17], s[18:19]
s_or_b64 s[28:29], s[28:29], s[20:21]
s_cbranch_scc0 Lg_192
s_cmp_eq_u32 s65, 0
s_cbranch_scc1 Lg_192
s_sub_u32 s65, s65, 1
s_branch Lg_191
Lg_193:
Lg_194:
s_mov_b64 exec, s[22:23]
buffer_load_dwordx4 v[112:115], v1, s[8:11], s33 offen offset:0 sc1
s_mov_b64 exec, s[24:25]
buffer_load_dwordx4 v[116:119], v1, s[8:11], s33 offen offset:1024 sc1
s_mov_b64 exec, s[26:27]
buffer_load_dwordx4 v[120:123], v1, s[8:11], s33 offen offset:2048 sc1
s_mov_b64 exec, -1
s_waitcnt vmcnt(0)
v_max3_u32 v52, v112, v113, v114
v_max3_u32 v53, v116, v117, v118
v_max3_u32 v54, v120, v121, v122
v_max_u32 v52, v52, v115
v_max_u32 v53, v53, v119
v_max_u32 v54, v54, v123
v_cmp_eq_u32 s[22:23], -1, v52
v_cmp_eq_u32 s[24:25], -1, v53
v_cmp_eq_u32 s[26:27], -1, v54
s_or_b64 s[28:29], s[22:23], s[24:25]
s_or_b64 s[28:29], s[28:29], s[26:27]
s_cbranch_scc0 Lg_195
s_cmp_eq_u32 s65, 0
s_cbranch_scc1 Lg_195
s_sub_u32 s65, s65, 1
s_branch Lg_194
Lp_204:
s_mov_b64 exec, s[22:23]
buffer_load_dwordx4 v[80:83], v10, s[8:11], s72 offen sc1
s_mov_b64 exec, s[24:25]
buffer_load_dwordx4 v[84:87], v10, s[8:11], s73 offen sc1
s_mov_b64 exec, s[26:27]
buffer_load_dwordx4 v[88:91], v10, s[8:11], s74 offen sc1
s_mov_b64 exec, s[30:31]
buffer_load_dwordx4 v[92:95], v10, s[8:11], s75 offen sc1
s_mov_b64 exec, -1
buffer_load_dwordx4 v[96:99], v1, s[8:11], s76 offen offset:0 sc1
buffer_load_dwordx4 v[100:103], v1, s[8:11], s76 offen offset:1024 sc1
buffer_load_dwordx4 v[104:107], v1, s[8:11], s76 offen offset:2048 sc1
s_waitcnt vmcnt(3)
v_bitop3_b32 v20, v80, s62, 1 bitop3:0x28
v_bitop3_b32 v21, v84, s62, 1 bitop3:0x28
v_bitop3_b32 v22, v88, s62, 1 bitop3:0x28
v_bitop3_b32 v23, v92, s62, 1 bitop3:0x28
v_cmp_ne_u32 s[22:23], 0, v20
v_cmp_ne_u32 s[24:25], 0, v21
v_cmp_ne_u32 s[26:27], 0, v22
v_cmp_ne_u32 s[30:31], 0, v23
s_or_b64 s[28:29], s[22:23], s[24:25]
s_or_b64 s[28:29], s[28:29], s[26:27]
s_or_b64 s[28:29], s[28:29], s[30:31]
s_cbranch_scc1 Lp_200
s_branch Lp_204x
Lp_200:
s_waitcnt vmcnt(0)
v_bitop3_b32 v16, v96, v98, s50 bitop3:0x7e
v_bitop3_b32 v19, v97, v99, s50 bitop3:0x7e
v_or_b32 v16, v16, v19
v_cmp_gt_i32 s[16:17], 0, v16
v_bitop3_b32 v17, v100, v102, s50 bitop3:0x7e
v_bitop3_b32 v19, v101, v103, s50 bitop3:0x7e
v_or_b32 v17, v17, v19
v_cmp_gt_i32 s[18:19], 0, v17
v_bitop3_b32 v18, v104, v106, s50 bitop3:0x7e
v_bitop3_b32 v19, v105, v107, s50 bitop3:0x7e
v_or_b32 v18, v18, v19
v_cmp_gt_i32 s[20:21], 0, v18
s_or_b64 s[28:29], s[16:17], s[18:19]
s_or_b64 s[28:29], s[28:29], s[20:21]
Lp_205:
s_mov_b64 exec, s[22:23]
buffer_load_dwordx4 v[80:83], v10, s[8:11], s72 offen sc1
s_mov_b64 exec, s[24:25]
buffer_load_dwordx4 v[84:87], v10, s[8:11], s73 offen sc1
s_mov_b64 exec, s[26:27]
buffer_load_dwordx4 v[88:91], v10, s[8:11], s74 offen sc1
s_mov_b64 exec, s[30:31]
buffer_load_dwordx4 v[92:95], v10, s[8:11], s75 offen sc1
s_mov_b64 exec, -1
s_mov_b64 exec, s[16:17]
buffer_load_dwordx4 v[96:99], v1, s[8:11], s76 offen offset:0 sc1
s_mov_b64 exec, s[18:19]
buffer_load_dwordx4 v[100:103], v1, s[8:11], s76 offen offset:1024 sc1
s_mov_b64 exec, s[20:21]
buffer_load_dwordx4 v[104:107], v1, s[8:11], s76 offen offset:2048 sc1
s_mov_b64 exec, -1
s_waitcnt vmcnt(0)
v_bitop3_b32 v16, v96, v98, s50 bitop3:0x7e
v_bitop3_b32 v19, v97, v99, s50 bitop3:0x7e
v_or_b32 v16, v16, v19
v_cmp_gt_i32 s[16:17], 0, v16
v_bitop3_b32 v17, v100, v102, s50 bitop3:0x7e
v_bitop3_b32 v19, v101, v103, s50 bitop3:0x7e
v_or_b32 v17, v17, v19
v_cmp_gt_i32 s[18:19], 0, v17
v_bitop3_b32 v18, v104, v106, s50 bitop3:0x7e
v_bitop3_b32 v19, v105, v107, s50 bitop3:0x7e
v_or_b32 v18, v18, v19
v_cmp_gt_i32 s[20:21], 0, v18
s_or_b64 s[28:29], s[16:17], s[18:19]
s_or_b64 s[28:29], s[28:29], s[20:21]
s_cselect_b32 s51, 1, 0
v_bitop3_b32 v20, v80, s62, 1 bitop3:0x28
v_bitop3_b32 v21, v84, s62, 1 bitop3:0x28
v_bitop3_b32 v22, v88, s62, 1 bitop3:0x28
v_bitop3_b32 v23, v92, s62, 1 bitop3:0x28
v_cmp_ne_u32 s[22:23], 0, v20
v_cmp_ne_u32 s[24:25], 0, v21
v_cmp_ne_u32 s[26:27], 0, v22
v_cmp_ne_u32 s[30:31], 0, v23
s_or_b64 s[28:29], s[22:23], s[24:25]
s_or_b64 s[28:29], s[28:29], s[26:27]
s_or_b64 s[28:29], s[28:29], s[30:31]
s_cbranch_scc0 Lp_201
s_cmp_eq_u32 s65, 0
s_cbranch_scc1 Lp_201
s_sub_u32 s65, s65, 1
s_branch Lp_205
Lp_201:
s_cmp_eq_u32 s51, 0
s_cbranch_scc1 Lp_207
Lp_202:
Lp_206:
s_mov_b64 exec, s[16:17]
buffer_load_dwordx4 v[96:99], v1, s[8:11], s76 offen offset:0 sc1
s_mov_b64 exec, s[18:19]
buffer_load_dwordx4 v[100:103], v1, s[8:11], s76 offen offset:1024 sc1
s_mov_b64 exec, s[20:21]
buffer_load_dwordx4 v[104:107], v1, s[8:11], s76 offen offset:2048 sc1
s_mov_b64 exec, -1
s_waitcnt vmcnt(0)
v_bitop3_b32 v16, v96, v98, s50 bitop3:0x7e
v_bitop3_b32 v19, v97, v99, s50 bitop3:0x7e
v_or_b32 v16, v16, v19
v_cmp_gt_i32 s[16:17], 0, v16
v_bitop3_b32 v17, v100, v102, s50 bitop3:0x7e
v_bitop3_b32 v19, v101, v103, s50 bitop3:0x7e
v_or_b32 v17, v17, v19
v_cmp_gt_i32 s[18:19], 0, v17
v_bitop3_b32 v18, v104, v106, s50 bitop3:0x7e
v_bitop3_b32 v19, v105, v107, s50 bitop3:0x7e
v_or_b32 v18, v18, v19
v_cmp_gt_i32 s[20:21], 0, v18
s_or_b64 s[28:29], s[16:17], s[18:19]
s_or_b64 s[28:29], s[28:29], s[20:21]
s_cbranch_scc0 Lp_207
s_cmp_eq_u32 s65, 0
s_cbranch_scc1 Lp_207
s_sub_u32 s65, s65, 1
s_branch Lp_206
Lp_207:
ds_write_b128 v2, v[96:99] offset:0
ds_write_b128 v2, v[100:103] offset:1024
ds_write_b128 v2, v[104:107] offset:2048
s_branch Lp_203
Lc_196:
s_lshl_b32 s52, s62, 5
s_add_u32 s52, s52, s63
s_mul_i32 s52, s52, 10240
s_add_u32 s52, s52, 165675008
s_add_u32 s53, s52, 4096
s_add_u32 s54, s52, 8192
buffer_store_dwordx4 v[56:59], v11, s[8:11], s52 offen sc1
buffer_store_dwordx4 v[60:63], v11, s[8:11], s53 offen sc1
buffer_store_dwordx2 v[64:65], v9, s[8:11], s54 offen sc1
s_cmp_lt_u32 s62, 63
s_cbranch_scc1 Lc_197
s_waitcnt vmcnt(0)
s_barrier
s_waitcnt vmcnt(0)
s_endpgm
Lw_179:
s_mov_b32 s62, 0
s_mov_b32 s36, 0x03030303
s_mov_b32 s37, s36
ds_read_b128 v[80:83], v4 offset:6144
ds_read_b128 v[84:87], v4 offset:7168
ds_read_b128 v[88:91], v4 offset:8192
ds_read_b128 v[92:95], v4 offset:9216
ds_read_b128 v[96:99], v4 offset:10240
ds_read_b128 v[100:103], v4 offset:11264
ds_read_b128 v[104:107], v4 offset:0
ds_read_b128 v[108:111], v4 offset:1024
s_bitcmp1_b32 s62, 0
s_cselect_b32 s50, 0x80008000, 0
s_add_u32 s67, s62, 1
s_and_b32 s67, s67, 3
s_lshl_b32 s67, s67, 1
s_lshl_b32 s78, s67, 15
s_add_u32 s67, s67, s64
s_mul_i32 s77, s67, 10240
s_lshl_b32 s67, s66, 8
s_add_u32 s77, s77, s67
s_add_u32 s78, s78, s67
s_add_u32 s77, s77, 191889408
s_add_u32 s78, s78, s59
s_cmp_ge_u32 s66, 24
s_cselect_b32 s67, 26624, 0
s_add_u32 s78, s78, s67
s_mov_b32 s82, s62
s_mul_i32 s83, s82, 1638400
s_add_u32 s83, s83, s47
s_cmp_eq_u32 s62, 63
s_cselect_b32 s83, 536870912, s83
v_mov_b64 v[56:57], 0
v_mov_b64 v[58:59], 0
v_mov_b64 v[60:61], 0
v_mov_b64 v[62:63], 0
v_mov_b64 v[64:65], 0
v_mov_b64 v[66:67], 0
v_mov_b64 v[156:157], 0
v_mov_b64 v[158:159], 0
v_mov_b64 v[160:161], 0
v_mov_b64 v[162:163], 0
v_mov_b64 v[164:165], 0
v_mov_b64 v[166:167], 0
v_mov_b64 v[168:169], 0
v_mov_b64 v[170:171], 0
v_mov_b64 v[172:173], 0
v_mov_b64 v[174:175], 0
s_cmp_ge_u32 s62, 3
s_cbranch_scc1 Lk_210
s_sub_u32 s61, s82, 12
s_max_i32 s61, s61, 0
s_lshr_b32 s61, s61, 2
s_add_u32 s61, s61, s82
s_cmp_gt_u32 s60, s61
s_cbranch_scc1 Lfd_212
v_and_b32 v14, 15, v0
v_lshlrev_b32 v14, 7, v14
Lf_211:
buffer_load_dword v13, v14, s[8:11], s81 offen sc1
s_waitcnt vmcnt(0)
v_min_u32_dpp v13, v13, v13 row_ror:8 row_mask:0xf bank_mask:0xf
s_nop 1
v_min_u32_dpp v13, v13, v13 row_ror:4 row_mask:0xf bank_mask:0xf
s_nop 1
v_min_u32_dpp v13, v13, v13 row_ror:2 row_mask:0xf bank_mask:0xf
s_nop 1
v_min_u32_dpp v13, v13, v13 row_ror:1 row_mask:0xf bank_mask:0xf
s_nop 0
v_readfirstlane_b32 s60, v13
s_nop 0
s_cmp_gt_u32 s60, s61
s_cbranch_scc1 Lfd_212
s_cmp_eq_u32 s65, 0
s_cbranch_scc1 Lfd_212
s_sub_u32 s65, s65, 1
s_branch Lf_211
Lfd_212:
Lk_210:
ds_read_b128 v[16:19], v3 offset:3072
ds_read_b128 v[24:27], v3 offset:4096
ds_read_b128 v[32:35], v3 offset:5120
s_waitcnt lgkmcnt(0)
s_branch Lvoent_209
Lvo_208:
s_barrier
ds_read_b128 v[80:83], v4 offset:6144
ds_read_b128 v[84:87], v4 offset:7168
ds_read_b128 v[88:91], v4 offset:8192
ds_read_b128 v[92:95], v4 offset:9216
ds_read_b128 v[96:99], v4 offset:10240
ds_read_b128 v[100:103], v4 offset:11264
ds_read_b128 v[104:107], v4 offset:0
ds_read_b128 v[108:111], v4 offset:1024
s_bitcmp1_b32 s62, 0
s_cselect_b32 s50, 0x80008000, 0
s_add_u32 s67, s62, 1
s_and_b32 s67, s67, 3
s_lshl_b32 s67, s67, 1
s_lshl_b32 s78, s67, 15
s_add_u32 s67, s67, s64
s_mul_i32 s77, s67, 10240
s_lshl_b32 s67, s66, 8
s_add_u32 s77, s77, s67
s_add_u32 s78, s78, s67
s_add_u32 s77, s77, 191889408
s_add_u32 s78, s78, s59
s_cmp_ge_u32 s66, 24
s_cselect_b32 s67, 26624, 0
s_add_u32 s78, s78, s67
s_mov_b32 s82, s62
s_mul_i32 s83, s82, 1638400
s_add_u32 s83, s83, s47
s_cmp_eq_u32 s62, 63
s_cselect_b32 s83, 536870912, s83
v_mov_b64 v[56:57], 0
v_mov_b64 v[58:59], 0
v_mov_b64 v[60:61], 0
v_mov_b64 v[62:63], 0
v_mov_b64 v[64:65], 0
v_mov_b64 v[66:67], 0
v_mov_b64 v[156:157], 0
v_mov_b64 v[158:159], 0
v_mov_b64 v[160:161], 0
v_mov_b64 v[162:163], 0
v_mov_b64 v[164:165], 0
v_mov_b64 v[166:167], 0
v_mov_b64 v[168:169], 0
v_mov_b64 v[170:171], 0
v_mov_b64 v[172:173], 0
v_mov_b64 v[174:175], 0
s_cmp_ge_u32 s62, 3
s_cbranch_scc1 Lk_213
s_sub_u32 s61, s82, 12
s_max_i32 s61, s61, 0
s_lshr_b32 s61, s61, 2
s_add_u32 s61, s61, s82
s_cmp_gt_u32 s60, s61
s_cbranch_scc1 Lfd_215
v_and_b32 v14, 15, v0
v_lshlrev_b32 v14, 7, v14
Lf_214:
buffer_load_dword v13, v14, s[8:11], s81 offen sc1
s_waitcnt vmcnt(0)
v_min_u32_dpp v13, v13, v13 row_ror:8 row_mask:0xf bank_mask:0xf
s_nop 1
v_min_u32_dpp v13, v13, v13 row_ror:4 row_mask:0xf bank_mask:0xf
s_nop 1
v_min_u32_dpp v13, v13, v13 row_ror:2 row_mask:0xf bank_mask:0xf
s_nop 1
v_min_u32_dpp v13, v13, v13 row_ror:1 row_mask:0xf bank_mask:0xf
s_nop 0
v_readfirstlane_b32 s60, v13
s_nop 0
s_cmp_gt_u32 s60, s61
s_cbranch_scc1 Lfd_215
s_cmp_eq_u32 s65, 0
s_cbranch_scc1 Lfd_215
s_sub_u32 s65, s65, 1
s_branch Lf_214
Lfd_215:
Lk_213:
s_sleep 1
s_waitcnt lgkmcnt(0)
buffer_load_dwordx4 v[68:71], v1, s[8:11], s32 offen offset:0 sc1
buffer_load_dwordx4 v[72:75], v1, s[8:11], s32 offen offset:1024 sc1
buffer_load_dwordx4 v[76:79], v1, s[8:11], s32 offen offset:2048 sc1
s_waitcnt vmcnt(0)
v_max3_u32 v52, v68, v69, v70
v_max3_u32 v53, v72, v73, v74
v_max3_u32 v54, v76, v77, v78
v_max_u32 v52, v52, v71
v_max_u32 v53, v53, v75
v_max_u32 v54, v54, v79
v_cmp_eq_u32 s[16:17], -1, v52
v_cmp_eq_u32 s[18:19], -1, v53
v_cmp_eq_u32 s[20:21], -1, v54
s_or_b64 s[28:29], s[16:17], s[18:19]
s_or_b64 s[28:29], s[28:29], s[20:21]
s_cbranch_scc1 Lg_216
Lg_217:
buffer_load_dwordx4 v[112:115], v1, s[8:11], s33 offen offset:0 sc1
buffer_load_dwordx4 v[116:119], v1, s[8:11], s33 offen offset:1024 sc1
buffer_load_dwordx4 v[120:123], v1, s[8:11], s33 offen offset:2048 sc1
v_lshlrev_b32 v16, 16, v68
v_and_b32 v17, 0xffff0000, v68
v_lshlrev_b32 v18, 16, v69
v_and_b32 v19, 0xffff0000, v69
v_lshlrev_b32 v20, 16, v70
v_and_b32 v21, 0xffff0000, v70
v_lshlrev_b32 v22, 16, v71
v_and_b32 v23, 0xffff0000, v71
v_lshlrev_b32 v24, 16, v72
v_and_b32 v25, 0xffff0000, v72
v_lshlrev_b32 v26, 16, v73
v_and_b32 v27, 0xffff0000, v73
v_lshlrev_b32 v28, 16, v74
v_and_b32 v29, 0xffff0000, v74
v_lshlrev_b32 v30, 16, v75
v_and_b32 v31, 0xffff0000, v75
v_lshlrev_b32 v32, 16, v76
v_and_b32 v33, 0xffff0000, v76
v_lshlrev_b32 v34, 16, v77
v_and_b32 v35, 0xffff0000, v77
v_lshlrev_b32 v36, 16, v78
v_and_b32 v37, 0xffff0000, v78
v_lshlrev_b32 v38, 16, v79
v_and_b32 v39, 0xffff0000, v79
s_waitcnt vmcnt(0)
v_max3_u32 v52, v112, v113, v114
v_max3_u32 v53, v116, v117, v118
v_max3_u32 v54, v120, v121, v122
v_max_u32 v52, v52, v115
v_max_u32 v53, v53, v119
v_max_u32 v54, v54, v123
v_cmp_eq_u32 s[22:23], -1, v52
v_cmp_eq_u32 s[24:25], -1, v53
v_cmp_eq_u32 s[26:27], -1, v54
s_or_b64 s[28:29], s[22:23], s[24:25]
s_or_b64 s[28:29], s[28:29], s[26:27]
s_cbranch_scc1 Lg_218
Lg_220:
v_dot2c_f32_bf16 v16, s100, v112
v_dot2c_f32_bf16 v17, s101, v112
v_dot2c_f32_bf16 v18, s100, v113
v_dot2c_f32_bf16 v19, s101, v113
v_dot2c_f32_bf16 v20, s100, v114
v_dot2c_f32_bf16 v21, s101, v114
v_dot2c_f32_bf16 v22, s100, v115
v_dot2c_f32_bf16 v23, s101, v115
v_cvt_pk_bf16_f32 v16, v16, v17
v_cvt_pk_bf16_f32 v17, v18, v19
v_cvt_pk_bf16_f32 v18, v20, v21
v_cvt_pk_bf16_f32 v19, v22, v23
ds_write_b128 v2, v[16:19] offset:0
v_dot2c_f32_bf16 v24, s100, v116
v_dot2c_f32_bf16 v25, s101, v116
v_dot2c_f32_bf16 v26, s100, v117
v_dot2c_f32_bf16 v27, s101, v117
v_dot2c_f32_bf16 v28, s100, v118
v_dot2c_f32_bf16 v29, s101, v118
v_dot2c_f32_bf16 v30, s100, v119
v_dot2c_f32_bf16 v31, s101, v119
v_cvt_pk_bf16_f32 v24, v24, v25
v_cvt_pk_bf16_f32 v25, v26, v27
v_cvt_pk_bf16_f32 v26, v28, v29
v_cvt_pk_bf16_f32 v27, v30, v31
ds_write_b128 v2, v[24:27] offset:1024
v_dot2c_f32_bf16 v32, s100, v120
v_dot2c_f32_bf16 v33, s101, v120
v_dot2c_f32_bf16 v34, s100, v121
v_dot2c_f32_bf16 v35, s101, v121
v_dot2c_f32_bf16 v36, s100, v122
v_dot2c_f32_bf16 v37, s101, v122
v_dot2c_f32_bf16 v38, s100, v123
v_dot2c_f32_bf16 v39, s101, v123
v_cvt_pk_bf16_f32 v32, v32, v33
v_cvt_pk_bf16_f32 v33, v34, v35
v_cvt_pk_bf16_f32 v34, v36, v37
v_cvt_pk_bf16_f32 v35, v38, v39
ds_write_b128 v2, v[32:35] offset:2048
Lvoent_209:
v_smfmac_f32_16x16x64_bf16 v[56:59], v[16:19], a[16:23], v8
v_smfmac_f32_16x16x64_bf16 v[60:63], v[16:19], a[72:79], v8
buffer_load_dwordx4 v[112:115], v1, s[8:11], s83 offen offset:0 sc1
v_smfmac_f32_16x16x64_bf16 v[64:67], v[16:19], a[128:135], v8
v_smfmac_f32_16x16x64_bf16 v[56:59], v[24:27], a[24:31], v8
s_waitcnt lgkmcnt(0)
s_barrier
ds_read_b128 v[20:23], v3 offset:0
v_mov_b64 v[16:17], 0
v_smfmac_f32_16x16x64_bf16 v[60:63], v[24:27], a[80:87], v8
ds_read_b128 v[28:31], v3 offset:1024
buffer_load_dwordx4 v[116:119], v1, s[8:11], s83 offen offset:1024 sc1
v_mov_b64 v[18:19], 0
v_smfmac_f32_16x16x64_bf16 v[64:67], v[24:27], a[136:143], v8
ds_read_b128 v[36:39], v3 offset:2048
v_smfmac_f32_16x16x64_bf16 v[56:59], v[32:35], v[80:87], v8
ds_read_b128 v[40:43], v3 offset:6144
v_mov_b64 v[24:25], 0
v_smfmac_f32_16x16x64_bf16 v[60:63], v[32:35], v[88:95], v8
ds_read_b128 v[44:47], v3 offset:7168
buffer_load_dwordx4 v[120:123], v1, s[8:11], s83 offen offset:2048 sc1
ds_read_b128 v[80:83], v4 offset:12288
v_mov_b64 v[26:27], 0
v_smfmac_f32_16x16x64_bf16 v[64:67], v[32:35], v[96:103], v8
ds_read_b128 v[48:51], v3 offset:9216
ds_read_b128 v[84:87], v4 offset:13312
s_waitcnt lgkmcnt(7)
v_smfmac_f32_16x16x64_bf16 v[56:59], v[20:23], a[0:7], v8
ds_read_b128 v[52:55], v3 offset:8192
s_waitcnt lgkmcnt(7)
v_mov_b64 v[32:33], 0
v_smfmac_f32_16x16x64_bf16 v[56:59], v[28:31], a[8:15], v8
buffer_load_dwordx4 v[124:127], v1, s[8:11], s83 offen offset:3072 sc1
ds_read_b128 v[88:91], v4 offset:2048
s_waitcnt lgkmcnt(7)
v_mov_b64 v[34:35], 0
v_smfmac_f32_16x16x64_bf16 v[56:59], v[36:39], v[104:111], v8
s_add_u32 s83, s83, 4096
ds_read_b128 v[92:95], v4 offset:3072
s_waitcnt lgkmcnt(7)
v_smfmac_f32_16x16x64_bf16 v[56:59], v[40:43], a[32:39], v8
ds_read_b128 v[96:99], v4 offset:14336
s_waitcnt lgkmcnt(7)
v_smfmac_f32_16x16x64_bf16 v[56:59], v[44:47], a[40:47], v8
buffer_load_dwordx4 v[128:131], v1, s[8:11], s83 offen offset:0 sc1
ds_read_b128 v[100:103], v4 offset:15360
s_waitcnt lgkmcnt(5)
v_smfmac_f32_16x16x64_bf16 v[56:59], v[48:51], v[80:87], v8
ds_read_b128 v[104:107], v4 offset:4096
s_waitcnt lgkmcnt(5)
v_smfmac_f32_16x16x64_bf16 v[56:59], v[52:55], a[48:55], v8
ds_read_b128 v[108:111], v4 offset:5120
v_smfmac_f32_16x16x64_bf16 v[60:63], v[20:23], a[56:63], v8
buffer_load_dwordx4 v[132:135], v1, s[8:11], s83 offen offset:1024 sc1
ds_read_b128 v[80:83], v4 offset:16384
v_smfmac_f32_16x16x64_bf16 v[60:63], v[28:31], a[64:71], v8
ds_read_b128 v[84:87], v4 offset:17408
s_waitcnt lgkmcnt(6)
v_add_f32 v56, v56, v58
v_smfmac_f32_16x16x64_bf16 v[60:63], v[36:39], v[88:95], v8
ds_read_b128 v[88:91], v4 offset:18432
v_add_f32 v57, v57, v59
v_smfmac_f32_16x16x64_bf16 v[60:63], v[40:43], a[88:95], v8
buffer_load_dwordx4 v[136:139], v1, s[8:11], s83 offen offset:2048 sc1
ds_read_b128 v[92:95], v4 offset:19456
v_cvt_pk_bf16_f32 v56, v56, v57
v_smfmac_f32_16x16x64_bf16 v[60:63], v[44:47], a[96:103], v8
s_waitcnt lgkmcnt(6)
v_smfmac_f32_16x16x64_bf16 v[60:63], v[48:51], v[96:103], v8
ds_read_b128 v[96:99], v4 offset:20480
v_mov_b32_dpp v57, v56 quad_perm:[1,0,3,2] row_mask:0xf bank_mask:0xf
v_smfmac_f32_16x16x64_bf16 v[60:63], v[52:55], a[104:111], v8
buffer_load_dwordx4 v[140:143], v1, s[8:11], s83 offen offset:3072 sc1
ds_read_b128 v[100:103], v4 offset:21504
v_perm_b32 v56, v57, v56, v6
v_smfmac_f32_16x16x64_bf16 v[64:67], v[20:23], a[112:119], v8
s_add_u32 s83, s83, 4096
ds_write_b32 v5, v56 offset:0
v_smfmac_f32_16x16x64_bf16 v[64:67], v[28:31], a[120:127], v8
s_waitcnt lgkmcnt(7)
v_add_f32 v60, v60, v62
v_smfmac_f32_16x16x64_bf16 v[64:67], v[36:39], v[104:111], v8
buffer_load_dwordx4 v[144:147], v1, s[8:11], s83 offen offset:0 sc1
ds_read_b128 v[104:107], v4 offset:24576
v_add_f32 v61, v61, v63
v_smfmac_f32_16x16x64_bf16 v[64:67], v[40:43], a[144:151], v8
s_waitcnt lgkmcnt(1)
s_barrier
ds_read_b128 v[68:71], v3 offset:12736
v_cvt_pk_bf16_f32 v60, v60, v61
v_smfmac_f32_16x16x64_bf16 v[64:67], v[44:47], a[152:159], v8
ds_read_b128 v[108:111], v4 offset:25600
v_mov_b64 v[20:21], 0
v_smfmac_f32_16x16x64_bf16 v[64:67], v[48:51], v[80:87], v8
buffer_load_dwordx4 v[148:151], v1, s[8:11], s83 offen offset:1024 sc1
ds_read_b128 v[80:83], v4 offset:22528
v_mov_b32_dpp v61, v60 quad_perm:[1,0,3,2] row_mask:0xf bank_mask:0xf
v_smfmac_f32_16x16x64_bf16 v[64:67], v[52:55], a[160:167], v8
ds_read_b128 v[84:87], v4 offset:23552
s_waitcnt lgkmcnt(3)
v_perm_b32 v60, v61, v60, v6
v_smfmac_f32_16x16x64_bf16 v[156:159], v[68:71], a[168:175], v8
ds_write_b32 v5, v60 offset:1024
v_mov_b64 v[22:23], 0
v_smfmac_f32_16x16x64_bf16 v[164:167], v[68:71], a[192:199], v8
buffer_load_dwordx4 v[152:155], v1, s[8:11], s83 offen offset:2048 sc1
v_add_f32 v64, v64, v66
v_add_f32 v65, v65, v67
v_smfmac_f32_16x16x64_bf16 v[160:163], v[68:71], v[88:95], v8
ds_read_b128 v[88:91], v4 offset:26624
v_cvt_pk_bf16_f32 v64, v64, v65
v_smfmac_f32_16x16x64_bf16 v[168:171], v[68:71], a[216:223], v8
s_waitcnt lgkmcnt(1)
s_barrier
ds_read_b128 v[72:75], v3 offset:13760
v_mov_b64 v[28:29], 0
v_smfmac_f32_16x16x64_bf16 v[172:175], v[68:71], a[240:247], v8
ds_read_b128 v[92:95], v4 offset:27648
v_mov_b32_dpp v65, v64 quad_perm:[1,0,3,2] row_mask:0xf bank_mask:0xf
v_perm_b32 v64, v65, v64, v6
v_smfmac_f32_16x16x64_bf16 v[24:27], v[68:71], v[184:191], v8
ds_write_b32 v5, v64 offset:2048
s_waitcnt lgkmcnt(2)
v_mov_b64 v[30:31], 0
v_smfmac_f32_16x16x64_bf16 v[156:159], v[72:75], a[176:183], v8
v_smfmac_f32_16x16x64_bf16 v[164:167], v[72:75], a[200:207], v8
v_smfmac_f32_16x16x64_bf16 v[160:163], v[72:75], v[96:103], v8
s_waitcnt lgkmcnt(0)
s_barrier
ds_read_b128 v[76:79], v3 offset:14784
v_smfmac_f32_16x16x64_bf16 v[168:171], v[72:75], a[224:231], v8
ds_read_b128 v[96:99], v4 offset:28672
v_smfmac_f32_16x16x64_bf16 v[16:19], v[68:71], v[104:111], v8
ds_read_b128 v[100:103], v4 offset:29696
v_smfmac_f32_16x16x64_bf16 v[32:35], v[68:71], v[208:215], v8
ds_read_b128 v[104:107], v4 offset:30720
s_waitcnt lgkmcnt(3)
v_smfmac_f32_16x16x64_bf16 v[156:159], v[76:79], a[184:191], v8
ds_read_b128 v[108:111], v4 offset:31744
v_smfmac_f32_16x16x64_bf16 v[160:163], v[76:79], v[80:87], v8
ds_read_b128 v[80:83], v4 offset:32768
v_smfmac_f32_16x16x64_bf16 v[164:167], v[76:79], a[208:215], v8
ds_read_b128 v[84:87], v4 offset:33792
v_add_f32 v156, v156, v158
v_add_f32 v157, v157, v159
v_smfmac_f32_16x16x64_bf16 v[168:171], v[76:79], a[232:239], v8
v_cvt_pk_bf16_f32 v56, v156, v157
v_add_f32 v160, v160, v162
v_smfmac_f32_16x16x64_bf16 v[172:175], v[72:75], a[248:255], v8
buffer_load_dwordx4 v[156:159], v1, s[8:11], s83 offen offset:3072 sc1
s_add_u32 s83, s83, 4096
v_add_f32 v161, v161, v163
v_add_f32 v164, v164, v166
v_smfmac_f32_16x16x64_bf16 v[16:19], v[72:75], v[88:95], v8
ds_read_b128 v[88:91], v4 offset:34816
v_cvt_pk_bf16_f32 v57, v160, v161
v_add_f32 v165, v165, v167
v_smfmac_f32_16x16x64_bf16 v[172:175], v[76:79], v[176:183], v8
buffer_load_dwordx4 v[160:163], v1, s[8:11], s83 offen offset:0 sc1
ds_read_b128 v[92:95], v4 offset:35840
v_cvt_pk_bf16_f32 v58, v164, v165
v_add_f32 v168, v168, v170
v_smfmac_f32_16x16x64_bf16 v[24:27], v[72:75], v[192:199], v8
buffer_load_dwordx4 v[164:167], v1, s[8:11], s83 offen offset:1024 sc1
s_waitcnt lgkmcnt(6)
v_add_f32 v169, v169, v171
v_permlane16_swap_b32 v56, v57
v_smfmac_f32_16x16x64_bf16 v[16:19], v[76:79], v[96:103], v8
v_cvt_pk_bf16_f32 v59, v168, v169
v_add_f32 v172, v172, v174
v_smfmac_f32_16x16x64_bf16 v[32:35], v[72:75], v[216:223], v8
buffer_load_dwordx4 v[168:171], v1, s[8:11], s83 offen offset:2048 sc1
v_permlane16_swap_b32 v58, v59
v_add_f32 v173, v173, v175
v_smfmac_f32_16x16x64_bf16 v[24:27], v[76:79], v[200:207], v8
v_permlane32_swap_b32 v56, v58
v_permlane32_swap_b32 v57, v59
v_smfmac_f32_16x16x64_bf16 v[20:23], v[68:71], v[232:239], v8
v_bfi_b32 v56, 1, s62, v56
v_cvt_pk_bf16_f32 v60, v172, v173
v_smfmac_f32_16x16x64_bf16 v[32:35], v[76:79], v[224:231], v8
buffer_store_dwordx4 v[56:59], v11, s[8:11], s44 offen
s_waitcnt lgkmcnt(4)
v_add_f32 v16, v16, v18
v_add_f32 v17, v17, v19
v_smfmac_f32_16x16x64_bf16 v[28:31], v[68:71], v[104:111], v8
buffer_load_dwordx4 v[172:175], v1, s[8:11], s83 offen offset:3072 sc1
v_cvt_pk_bf16_f32 v61, v16, v17
v_add_f32 v24, v24, v26
v_smfmac_f32_16x16x64_bf16 v[20:23], v[72:75], v[240:247], v8
s_waitcnt lgkmcnt(2)
v_add_f32 v25, v25, v27
v_add_f32 v32, v32, v34
v_smfmac_f32_16x16x64_bf16 v[28:31], v[72:75], v[80:87], v8
v_cvt_pk_bf16_f32 v62, v24, v25
v_add_f32 v33, v33, v35
v_smfmac_f32_16x16x64_bf16 v[20:23], v[76:79], v[248:255], v8
s_waitcnt lgkmcnt(0)
v_cvt_pk_bf16_f32 v63, v32, v33
v_permlane16_swap_b32 v60, v61
v_smfmac_f32_16x16x64_bf16 v[28:31], v[76:79], v[88:95], v8
v_permlane16_swap_b32 v62, v63
s_nop 1
v_permlane32_swap_b32 v60, v62
v_permlane32_swap_b32 v61, v63
v_pk_add_f32 v[20:21], v[20:21], v[22:23]
v_bfi_b32 v60, 1, s62, v60
v_cvt_pk_bf16_f32 v64, v20, v21
v_pk_add_f32 v[28:29], v[28:29], v[30:31]
buffer_store_dwordx4 v[60:63], v11, s[8:11], s45 offen
v_cvt_pk_bf16_f32 v65, v28, v29
s_nop 1
v_permlane16_swap_b32 v64, v65
v_bfi_b32 v64, 1, s62, v64
buffer_store_dwordx2 v[64:65], v9, s[8:11], s46 offen
s_cmp_eq_u32 s62, 63
s_cbranch_scc1 Lc_221
s_add_u32 s67, s62, 1
s_and_b32 s67, s67, 3
s_lshl_b32 s67, s67, 1
s_lshl_b32 s68, s67, 15
s_add_u32 s67, s67, s64
s_mul_i32 s67, s67, 10240
s_add_u32 s33, s68, s58
s_add_u32 s32, s67, s80
s_add_u32 s32, s32, 191889408
s_sleep 4
buffer_load_dwordx4 v[80:83], v10, s[8:11], s72 offen sc1
buffer_load_dwordx4 v[84:87], v10, s[8:11], s73 offen sc1
buffer_load_dwordx4 v[88:91], v10, s[8:11], s74 offen sc1
buffer_load_dwordx4 v[92:95], v10, s[8:11], s75 offen sc1
v_mov_b32 v108, 0
v_mov_b32 v109, 0
v_mov_b32 v110, 0
v_mov_b32 v111, 0
s_waitcnt vmcnt(0)
v_bitop3_b32 v20, v80, s62, 1 bitop3:0x28
v_bitop3_b32 v21, v84, s62, 1 bitop3:0x28
v_bitop3_b32 v22, v88, s62, 1 bitop3:0x28
v_bitop3_b32 v23, v92, s62, 1 bitop3:0x28
v_cmp_ne_u32 s[22:23], 0, v20
v_cmp_ne_u32 s[24:25], 0, v21
v_cmp_ne_u32 s[26:27], 0, v22
v_cmp_ne_u32 s[30:31], 0, v23
s_or_b64 s[28:29], s[22:23], s[24:25]
s_or_b64 s[28:29], s[28:29], s[26:27]
s_or_b64 s[28:29], s[28:29], s[30:31]
s_cbranch_scc1 Lp_229
s_sleep 1
buffer_load_dwordx4 v[96:99], v1, s[8:11], s76 offen offset:0 sc1
buffer_load_dwordx4 v[100:103], v1, s[8:11], s76 offen offset:1024 sc1
buffer_load_dwordx4 v[104:107], v1, s[8:11], s76 offen offset:2048 sc1
Lp_229x:
s_waitcnt vmcnt(2)
ds_write_b128 v2, v[96:99] offset:0
v_bitop3_b32 v16, v96, v98, s50 bitop3:0x7e
v_cmp_gt_i32 s[16:17], 0, v16
s_waitcnt vmcnt(1)
ds_write_b128 v2, v[100:103] offset:1024
v_bitop3_b32 v17, v100, v102, s50 bitop3:0x7e
v_cmp_gt_i32 s[18:19], 0, v17
s_waitcnt vmcnt(0)
ds_write_b128 v2, v[104:107] offset:2048
v_bitop3_b32 v18, v104, v106, s50 bitop3:0x7e
v_cmp_gt_i32 s[20:21], 0, v18
s_or_b64 s[28:29], s[16:17], s[18:19]
s_or_b64 s[28:29], s[28:29], s[20:21]
s_cbranch_scc1 Lp_227
Lp_228:
v_smfmac_f32_16x16x64_bf16 v[108:111], v[96:99], v[136:143], v8
s_waitcnt lgkmcnt(0)
s_barrier
ds_read_b128 v[16:19], v3 offset:0
ds_read_b128 v[20:23], v3 offset:1024
ds_read_b128 v[24:27], v3 offset:2048
v_smfmac_f32_16x16x64_bf16 v[108:111], v[100:103], v[144:151], v8
ds_read_b128 v[40:43], v3 offset:6144
ds_read_b128 v[44:47], v3 offset:7168
v_smfmac_f32_16x16x64_bf16 v[108:111], v[104:107], v[152:159], v8
ds_read_b128 v[48:51], v3 offset:8192
ds_read_b128 v[52:55], v3 offset:9216
s_waitcnt vmcnt(0)
s_waitcnt lgkmcnt(6)
v_smfmac_f32_16x16x64_bf16 v[108:111], v[16:19], v[112:119], v8
s_waitcnt lgkmcnt(5)
v_smfmac_f32_16x16x64_bf16 v[108:111], v[20:23], v[120:127], v8
s_waitcnt lgkmcnt(4)
v_smfmac_f32_16x16x64_bf16 v[108:111], v[24:27], v[128:135], v8
s_waitcnt lgkmcnt(3)
v_smfmac_f32_16x16x64_bf16 v[108:111], v[40:43], v[160:167], v8
s_waitcnt lgkmcnt(2)
v_smfmac_f32_16x16x64_bf16 v[108:111], v[44:47], v[168:175], v8
s_waitcnt lgkmcnt(1)
v_smfmac_f32_16x16x64_bf16 v[108:111], v[48:51], v[80:87], v8
s_waitcnt lgkmcnt(0)
v_smfmac_f32_16x16x64_bf16 v[108:111], v[52:55], v[88:95], v8
s_nop 7
v_pk_add_f32 v[108:109], v[108:109], v[110:111]
v_cvt_pk_bf16_f32 v108, v108, v109
v_xor_b32 v108, s50, v108
s_nop 1
v_mov_b32_dpp v109, v108 quad_perm:[1,0,3,2] row_mask:0xf bank_mask:0xf
v_perm_b32 v108, v109, v108, v6
buffer_store_dword v108, v12, s[8:11], s77 offen
buffer_store_dword v108, v12, s[8:11], s78 offen sc1
s_cmp_ge_u32 s62, 60
s_cbranch_scc1 Lc_221
Lc_222:
s_add_u32 s62, s62, 1
s_branch Lvo_208
Lg_216:
s_mov_b64 exec, s[16:17]
buffer_load_dwordx4 v[68:71], v1, s[8:11], s32 offen offset:0 sc1
s_mov_b64 exec, s[18:19]
buffer_load_dwordx4 v[72:75], v1, s[8:11], s32 offen offset:1024 sc1
s_mov_b64 exec, s[20:21]
buffer_load_dwordx4 v[76:79], v1, s[8:11], s32 offen offset:2048 sc1
s_mov_b64 exec, -1
s_waitcnt vmcnt(0)
v_max3_u32 v52, v68, v69, v70
v_max3_u32 v53, v72, v73, v74
v_max3_u32 v54, v76, v77, v78
v_max_u32 v52, v52, v71
v_max_u32 v53, v53, v75
v_max_u32 v54, v54, v79
v_cmp_eq_u32 s[16:17], -1, v52
v_cmp_eq_u32 s[18:19], -1, v53
v_cmp_eq_u32 s[20:21], -1, v54
s_or_b64 s[28:29], s[16:17], s[18:19]
s_or_b64 s[28:29], s[28:29], s[20:21]
s_cbranch_scc0 Lg_217
s_cmp_eq_u32 s65, 0
s_cbranch_scc1 Lg_217
s_sub_u32 s65, s65, 1
s_branch Lg_216
Lg_218:
Lg_219:
s_mov_b64 exec, s[22:23]
buffer_load_dwordx4 v[112:115], v1, s[8:11], s33 offen offset:0 sc1
s_mov_b64 exec, s[24:25]
buffer_load_dwordx4 v[116:119], v1, s[8:11], s33 offen offset:1024 sc1
s_mov_b64 exec, s[26:27]
buffer_load_dwordx4 v[120:123], v1, s[8:11], s33 offen offset:2048 sc1
s_mov_b64 exec, -1
s_waitcnt vmcnt(0)
v_max3_u32 v52, v112, v113, v114
v_max3_u32 v53, v116, v117, v118
v_max3_u32 v54, v120, v121, v122
v_max_u32 v52, v52, v115
v_max_u32 v53, v53, v119
v_max_u32 v54, v54, v123
v_cmp_eq_u32 s[22:23], -1, v52
v_cmp_eq_u32 s[24:25], -1, v53
v_cmp_eq_u32 s[26:27], -1, v54
s_or_b64 s[28:29], s[22:23], s[24:25]
s_or_b64 s[28:29], s[28:29], s[26:27]
s_cbranch_scc0 Lg_220
s_cmp_eq_u32 s65, 0
s_cbranch_scc1 Lg_220
s_sub_u32 s65, s65, 1
s_branch Lg_219
Lp_229:
s_mov_b64 exec, s[22:23]
buffer_load_dwordx4 v[80:83], v10, s[8:11], s72 offen sc1
s_mov_b64 exec, s[24:25]
buffer_load_dwordx4 v[84:87], v10, s[8:11], s73 offen sc1
s_mov_b64 exec, s[26:27]
buffer_load_dwordx4 v[88:91], v10, s[8:11], s74 offen sc1
s_mov_b64 exec, s[30:31]
buffer_load_dwordx4 v[92:95], v10, s[8:11], s75 offen sc1
s_mov_b64 exec, -1
buffer_load_dwordx4 v[96:99], v1, s[8:11], s76 offen offset:0 sc1
buffer_load_dwordx4 v[100:103], v1, s[8:11], s76 offen offset:1024 sc1
buffer_load_dwordx4 v[104:107], v1, s[8:11], s76 offen offset:2048 sc1
s_waitcnt vmcnt(3)
v_bitop3_b32 v20, v80, s62, 1 bitop3:0x28
v_bitop3_b32 v21, v84, s62, 1 bitop3:0x28
v_bitop3_b32 v22, v88, s62, 1 bitop3:0x28
v_bitop3_b32 v23, v92, s62, 1 bitop3:0x28
v_cmp_ne_u32 s[22:23], 0, v20
v_cmp_ne_u32 s[24:25], 0, v21
v_cmp_ne_u32 s[26:27], 0, v22
v_cmp_ne_u32 s[30:31], 0, v23
s_or_b64 s[28:29], s[22:23], s[24:25]
s_or_b64 s[28:29], s[28:29], s[26:27]
s_or_b64 s[28:29], s[28:29], s[30:31]
s_cbranch_scc1 Lp_225
s_branch Lp_229x
Lp_225:
s_waitcnt vmcnt(0)
v_bitop3_b32 v16, v96, v98, s50 bitop3:0x7e
v_bitop3_b32 v19, v97, v99, s50 bitop3:0x7e
v_or_b32 v16, v16, v19
v_cmp_gt_i32 s[16:17], 0, v16
v_bitop3_b32 v17, v100, v102, s50 bitop3:0x7e
v_bitop3_b32 v19, v101, v103, s50 bitop3:0x7e
v_or_b32 v17, v17, v19
v_cmp_gt_i32 s[18:19], 0, v17
v_bitop3_b32 v18, v104, v106, s50 bitop3:0x7e
v_bitop3_b32 v19, v105, v107, s50 bitop3:0x7e
v_or_b32 v18, v18, v19
v_cmp_gt_i32 s[20:21], 0, v18
s_or_b64 s[28:29], s[16:17], s[18:19]
s_or_b64 s[28:29], s[28:29], s[20:21]
Lp_230:
s_mov_b64 exec, s[22:23]
buffer_load_dwordx4 v[80:83], v10, s[8:11], s72 offen sc1
s_mov_b64 exec, s[24:25]
buffer_load_dwordx4 v[84:87], v10, s[8:11], s73 offen sc1
s_mov_b64 exec, s[26:27]
buffer_load_dwordx4 v[88:91], v10, s[8:11], s74 offen sc1
s_mov_b64 exec, s[30:31]
buffer_load_dwordx4 v[92:95], v10, s[8:11], s75 offen sc1
s_mov_b64 exec, -1
s_mov_b64 exec, s[16:17]
buffer_load_dwordx4 v[96:99], v1, s[8:11], s76 offen offset:0 sc1
s_mov_b64 exec, s[18:19]
buffer_load_dwordx4 v[100:103], v1, s[8:11], s76 offen offset:1024 sc1
s_mov_b64 exec, s[20:21]
buffer_load_dwordx4 v[104:107], v1, s[8:11], s76 offen offset:2048 sc1
s_mov_b64 exec, -1
s_waitcnt vmcnt(0)
v_bitop3_b32 v16, v96, v98, s50 bitop3:0x7e
v_bitop3_b32 v19, v97, v99, s50 bitop3:0x7e
v_or_b32 v16, v16, v19
v_cmp_gt_i32 s[16:17], 0, v16
v_bitop3_b32 v17, v100, v102, s50 bitop3:0x7e
v_bitop3_b32 v19, v101, v103, s50 bitop3:0x7e
v_or_b32 v17, v17, v19
v_cmp_gt_i32 s[18:19], 0, v17
v_bitop3_b32 v18, v104, v106, s50 bitop3:0x7e
v_bitop3_b32 v19, v105, v107, s50 bitop3:0x7e
v_or_b32 v18, v18, v19
v_cmp_gt_i32 s[20:21], 0, v18
s_or_b64 s[28:29], s[16:17], s[18:19]
s_or_b64 s[28:29], s[28:29], s[20:21]
s_cselect_b32 s51, 1, 0
v_bitop3_b32 v20, v80, s62, 1 bitop3:0x28
v_bitop3_b32 v21, v84, s62, 1 bitop3:0x28
v_bitop3_b32 v22, v88, s62, 1 bitop3:0x28
v_bitop3_b32 v23, v92, s62, 1 bitop3:0x28
v_cmp_ne_u32 s[22:23], 0, v20
v_cmp_ne_u32 s[24:25], 0, v21
v_cmp_ne_u32 s[26:27], 0, v22
v_cmp_ne_u32 s[30:31], 0, v23
s_or_b64 s[28:29], s[22:23], s[24:25]
s_or_b64 s[28:29], s[28:29], s[26:27]
s_or_b64 s[28:29], s[28:29], s[30:31]
s_cbranch_scc0 Lp_226
s_cmp_eq_u32 s65, 0
s_cbranch_scc1 Lp_226
s_sub_u32 s65, s65, 1
s_branch Lp_230
Lp_226:
s_cmp_eq_u32 s51, 0
s_cbranch_scc1 Lp_232
Lp_227:
Lp_231:
s_mov_b64 exec, s[16:17]
buffer_load_dwordx4 v[96:99], v1, s[8:11], s76 offen offset:0 sc1
s_mov_b64 exec, s[18:19]
buffer_load_dwordx4 v[100:103], v1, s[8:11], s76 offen offset:1024 sc1
s_mov_b64 exec, s[20:21]
buffer_load_dwordx4 v[104:107], v1, s[8:11], s76 offen offset:2048 sc1
s_mov_b64 exec, -1
s_waitcnt vmcnt(0)
v_bitop3_b32 v16, v96, v98, s50 bitop3:0x7e
v_bitop3_b32 v19, v97, v99, s50 bitop3:0x7e
v_or_b32 v16, v16, v19
v_cmp_gt_i32 s[16:17], 0, v16
v_bitop3_b32 v17, v100, v102, s50 bitop3:0x7e
v_bitop3_b32 v19, v101, v103, s50 bitop3:0x7e
v_or_b32 v17, v17, v19
v_cmp_gt_i32 s[18:19], 0, v17
v_bitop3_b32 v18, v104, v106, s50 bitop3:0x7e
v_bitop3_b32 v19, v105, v107, s50 bitop3:0x7e
v_or_b32 v18, v18, v19
v_cmp_gt_i32 s[20:21], 0, v18
s_or_b64 s[28:29], s[16:17], s[18:19]
s_or_b64 s[28:29], s[28:29], s[20:21]
s_cbranch_scc0 Lp_232
s_cmp_eq_u32 s65, 0
s_cbranch_scc1 Lp_232
s_sub_u32 s65, s65, 1
s_branch Lp_231
Lp_232:
ds_write_b128 v2, v[96:99] offset:0
ds_write_b128 v2, v[100:103] offset:1024
ds_write_b128 v2, v[104:107] offset:2048
s_branch Lp_228
Lc_221:
s_lshl_b32 s52, s62, 5
s_add_u32 s52, s52, s63
s_mul_i32 s52, s52, 10240
s_add_u32 s52, s52, 165675008
s_add_u32 s53, s52, 4096
s_add_u32 s54, s52, 8192
buffer_store_dwordx4 v[56:59], v11, s[8:11], s52 offen sc1
buffer_store_dwordx4 v[60:63], v11, s[8:11], s53 offen sc1
buffer_store_dwordx2 v[64:65], v9, s[8:11], s54 offen sc1
s_cmp_lt_u32 s62, 63
s_cbranch_scc1 Lc_222
s_waitcnt vmcnt(0)
s_barrier
s_waitcnt vmcnt(0)
s_endpgm
Lw_180:
s_mov_b32 s62, 0
s_mov_b32 s36, 0x03030303
s_mov_b32 s37, s36
ds_read_b128 v[80:83], v4 offset:0
ds_read_b128 v[84:87], v4 offset:1024
ds_read_b128 v[88:91], v4 offset:2048
ds_read_b128 v[92:95], v4 offset:3072
ds_read_b128 v[96:99], v4 offset:4096
ds_read_b128 v[100:103], v4 offset:5120
ds_read_b128 v[104:107], v4 offset:6144
ds_read_b128 v[108:111], v4 offset:7168
s_bitcmp1_b32 s62, 0
s_cselect_b32 s50, 0x80008000, 0
s_add_u32 s67, s62, 1
s_and_b32 s67, s67, 3
s_lshl_b32 s67, s67, 1
s_lshl_b32 s78, s67, 15
s_add_u32 s67, s67, s64
s_mul_i32 s77, s67, 10240
s_lshl_b32 s67, s66, 8
s_add_u32 s77, s77, s67
s_add_u32 s78, s78, s67
s_add_u32 s77, s77, 191889408
s_add_u32 s78, s78, s59
s_cmp_ge_u32 s66, 24
s_cselect_b32 s67, 26624, 0
s_add_u32 s78, s78, s67
s_mov_b32 s82, s62
s_mul_i32 s83, s82, 1638400
s_add_u32 s83, s83, s47
s_cmp_eq_u32 s62, 63
s_cselect_b32 s83, 536870912, s83
v_mov_b64 v[56:57], 0
v_mov_b64 v[58:59], 0
v_mov_b64 v[60:61], 0
v_mov_b64 v[62:63], 0
v_mov_b64 v[64:65], 0
v_mov_b64 v[66:67], 0
v_mov_b64 v[156:157], 0
v_mov_b64 v[158:159], 0
v_mov_b64 v[160:161], 0
v_mov_b64 v[162:163], 0
v_mov_b64 v[164:165], 0
v_mov_b64 v[166:167], 0
v_mov_b64 v[168:169], 0
v_mov_b64 v[170:171], 0
v_mov_b64 v[172:173], 0
v_mov_b64 v[174:175], 0
s_cmp_ge_u32 s62, 3
s_cbranch_scc1 Lk_235
s_sub_u32 s61, s82, 12
s_max_i32 s61, s61, 0
s_lshr_b32 s61, s61, 2
s_add_u32 s61, s61, s82
s_cmp_gt_u32 s60, s61
s_cbranch_scc1 Lfd_237
v_and_b32 v14, 15, v0
v_lshlrev_b32 v14, 7, v14
Lf_236:
buffer_load_dword v13, v14, s[8:11], s81 offen sc1
s_waitcnt vmcnt(0)
v_min_u32_dpp v13, v13, v13 row_ror:8 row_mask:0xf bank_mask:0xf
s_nop 1
v_min_u32_dpp v13, v13, v13 row_ror:4 row_mask:0xf bank_mask:0xf
s_nop 1
v_min_u32_dpp v13, v13, v13 row_ror:2 row_mask:0xf bank_mask:0xf
s_nop 1
v_min_u32_dpp v13, v13, v13 row_ror:1 row_mask:0xf bank_mask:0xf
s_nop 0
v_readfirstlane_b32 s60, v13
s_nop 0
s_cmp_gt_u32 s60, s61
s_cbranch_scc1 Lfd_237
s_cmp_eq_u32 s65, 0
s_cbranch_scc1 Lfd_237
s_sub_u32 s65, s65, 1
s_branch Lf_236
Lfd_237:
Lk_235:
ds_read_b128 v[16:19], v3 offset:6144
ds_read_b128 v[24:27], v3 offset:7168
s_waitcnt lgkmcnt(0)
s_branch Lvoent_234
Lvo_233:
s_barrier
ds_read_b128 v[80:83], v4 offset:0
ds_read_b128 v[84:87], v4 offset:1024
ds_read_b128 v[88:91], v4 offset:2048
ds_read_b128 v[92:95], v4 offset:3072
ds_read_b128 v[96:99], v4 offset:4096
ds_read_b128 v[100:103], v4 offset:5120
ds_read_b128 v[104:107], v4 offset:6144
ds_read_b128 v[108:111], v4 offset:7168
s_bitcmp1_b32 s62, 0
s_cselect_b32 s50, 0x80008000, 0
s_add_u32 s67, s62, 1
s_and_b32 s67, s67, 3
s_lshl_b32 s67, s67, 1
s_lshl_b32 s78, s67, 15
s_add_u32 s67, s67, s64
s_mul_i32 s77, s67, 10240
s_lshl_b32 s67, s66, 8
s_add_u32 s77, s77, s67
s_add_u32 s78, s78, s67
s_add_u32 s77, s77, 191889408
s_add_u32 s78, s78, s59
s_cmp_ge_u32 s66, 24
s_cselect_b32 s67, 26624, 0
s_add_u32 s78, s78, s67
s_mov_b32 s82, s62
s_mul_i32 s83, s82, 1638400
s_add_u32 s83, s83, s47
s_cmp_eq_u32 s62, 63
s_cselect_b32 s83, 536870912, s83
v_mov_b64 v[56:57], 0
v_mov_b64 v[58:59], 0
v_mov_b64 v[60:61], 0
v_mov_b64 v[62:63], 0
v_mov_b64 v[64:65], 0
v_mov_b64 v[66:67], 0
v_mov_b64 v[156:157], 0
v_mov_b64 v[158:159], 0
v_mov_b64 v[160:161], 0
v_mov_b64 v[162:163], 0
v_mov_b64 v[164:165], 0
v_mov_b64 v[166:167], 0
v_mov_b64 v[168:169], 0
v_mov_b64 v[170:171], 0
v_mov_b64 v[172:173], 0
v_mov_b64 v[174:175], 0
s_cmp_ge_u32 s62, 3
s_cbranch_scc1 Lk_238
s_sub_u32 s61, s82, 12
s_max_i32 s61, s61, 0
s_lshr_b32 s61, s61, 2
s_add_u32 s61, s61, s82
s_cmp_gt_u32 s60, s61
s_cbranch_scc1 Lfd_240
v_and_b32 v14, 15, v0
v_lshlrev_b32 v14, 7, v14
Lf_239:
buffer_load_dword v13, v14, s[8:11], s81 offen sc1
s_waitcnt vmcnt(0)
v_min_u32_dpp v13, v13, v13 row_ror:8 row_mask:0xf bank_mask:0xf
s_nop 1
v_min_u32_dpp v13, v13, v13 row_ror:4 row_mask:0xf bank_mask:0xf
s_nop 1
v_min_u32_dpp v13, v13, v13 row_ror:2 row_mask:0xf bank_mask:0xf
s_nop 1
v_min_u32_dpp v13, v13, v13 row_ror:1 row_mask:0xf bank_mask:0xf
s_nop 0
v_readfirstlane_b32 s60, v13
s_nop 0
s_cmp_gt_u32 s60, s61
s_cbranch_scc1 Lfd_240
s_cmp_eq_u32 s65, 0
s_cbranch_scc1 Lfd_240
s_sub_u32 s65, s65, 1
s_branch Lf_239
Lfd_240:
Lk_238:
s_sleep 1
s_waitcnt lgkmcnt(0)
buffer_load_dwordx4 v[68:71], v1, s[8:11], s32 offen offset:0 sc1
buffer_load_dwordx4 v[72:75], v1, s[8:11], s32 offen offset:1024 sc1
s_waitcnt vmcnt(0)
v_max3_u32 v52, v68, v69, v70
v_max3_u32 v53, v72, v73, v74
v_max_u32 v52, v52, v71
v_max_u32 v53, v53, v75
v_cmp_eq_u32 s[16:17], -1, v52
v_cmp_eq_u32 s[18:19], -1, v53
s_nop 0
s_or_b64 s[28:29], s[16:17], s[18:19]
s_cbranch_scc1 Lg_241
Lg_242:
buffer_load_dwordx4 v[112:115], v1, s[8:11], s33 offen offset:0 sc1
buffer_load_dwordx4 v[116:119], v1, s[8:11], s33 offen offset:1024 sc1
v_lshlrev_b32 v16, 16, v68
v_and_b32 v17, 0xffff0000, v68
v_lshlrev_b32 v18, 16, v69
v_and_b32 v19, 0xffff0000, v69
v_lshlrev_b32 v20, 16, v70
v_and_b32 v21, 0xffff0000, v70
v_lshlrev_b32 v22, 16, v71
v_and_b32 v23, 0xffff0000, v71
v_lshlrev_b32 v24, 16, v72
v_and_b32 v25, 0xffff0000, v72
v_lshlrev_b32 v26, 16, v73
v_and_b32 v27, 0xffff0000, v73
v_lshlrev_b32 v28, 16, v74
v_and_b32 v29, 0xffff0000, v74
v_lshlrev_b32 v30, 16, v75
v_and_b32 v31, 0xffff0000, v75
s_waitcnt vmcnt(0)
v_max3_u32 v52, v112, v113, v114
v_max3_u32 v53, v116, v117, v118
v_max_u32 v52, v52, v115
v_max_u32 v53, v53, v119
v_cmp_eq_u32 s[22:23], -1, v52
v_cmp_eq_u32 s[24:25], -1, v53
s_nop 0
s_or_b64 s[28:29], s[22:23], s[24:25]
s_cbranch_scc1 Lg_243
Lg_245:
v_dot2c_f32_bf16 v16, s100, v112
v_dot2c_f32_bf16 v17, s101, v112
v_dot2c_f32_bf16 v18, s100, v113
v_dot2c_f32_bf16 v19, s101, v113
v_dot2c_f32_bf16 v20, s100, v114
v_dot2c_f32_bf16 v21, s101, v114
v_dot2c_f32_bf16 v22, s100, v115
v_dot2c_f32_bf16 v23, s101, v115
v_cvt_pk_bf16_f32 v16, v16, v17
v_cvt_pk_bf16_f32 v17, v18, v19
v_cvt_pk_bf16_f32 v18, v20, v21
v_cvt_pk_bf16_f32 v19, v22, v23
ds_write_b128 v2, v[16:19] offset:0
v_dot2c_f32_bf16 v24, s100, v116
v_dot2c_f32_bf16 v25, s101, v116
v_dot2c_f32_bf16 v26, s100, v117
v_dot2c_f32_bf16 v27, s101, v117
v_dot2c_f32_bf16 v28, s100, v118
v_dot2c_f32_bf16 v29, s101, v118
v_dot2c_f32_bf16 v30, s100, v119
v_dot2c_f32_bf16 v31, s101, v119
v_cvt_pk_bf16_f32 v24, v24, v25
v_cvt_pk_bf16_f32 v25, v26, v27
v_cvt_pk_bf16_f32 v26, v28, v29
v_cvt_pk_bf16_f32 v27, v30, v31
ds_write_b128 v2, v[24:27] offset:1024
Lvoent_234:
v_smfmac_f32_16x16x64_bf16 v[56:59], v[16:19], a[32:39], v8
v_smfmac_f32_16x16x64_bf16 v[60:63], v[16:19], a[88:95], v8
buffer_load_dwordx4 v[112:115], v1, s[8:11], s83 offen offset:0 sc1
v_smfmac_f32_16x16x64_bf16 v[64:67], v[16:19], a[144:151], v8
v_smfmac_f32_16x16x64_bf16 v[56:59], v[24:27], a[40:47], v8
s_waitcnt lgkmcnt(0)
s_barrier
ds_read_b128 v[20:23], v3 offset:2048
v_mov_b64 v[16:17], 0
v_smfmac_f32_16x16x64_bf16 v[60:63], v[24:27], a[96:103], v8
ds_read_b128 v[28:31], v3 offset:0
buffer_load_dwordx4 v[116:119], v1, s[8:11], s83 offen offset:1024 sc1
v_mov_b64 v[18:19], 0
v_smfmac_f32_16x16x64_bf16 v[64:67], v[24:27], a[152:159], v8
ds_read_b128 v[32:35], v3 offset:1024
s_waitcnt lgkmcnt(2)
v_smfmac_f32_16x16x64_bf16 v[56:59], v[20:23], v[80:87], v8
ds_read_b128 v[36:39], v3 offset:5120
v_mov_b64 v[24:25], 0
v_smfmac_f32_16x16x64_bf16 v[60:63], v[20:23], v[88:95], v8
ds_read_b128 v[40:43], v3 offset:3072
buffer_load_dwordx4 v[120:123], v1, s[8:11], s83 offen offset:2048 sc1
ds_read_b128 v[80:83], v4 offset:12288
v_mov_b64 v[26:27], 0
v_smfmac_f32_16x16x64_bf16 v[64:67], v[20:23], v[96:103], v8
ds_read_b128 v[44:47], v3 offset:4096
ds_read_b128 v[84:87], v4 offset:13312
s_waitcnt lgkmcnt(6)
v_smfmac_f32_16x16x64_bf16 v[56:59], v[28:31], a[0:7], v8
ds_read_b128 v[48:51], v3 offset:9216
s_waitcnt lgkmcnt(6)
v_mov_b64 v[20:21], 0
v_smfmac_f32_16x16x64_bf16 v[56:59], v[32:35], a[8:15], v8
ds_read_b128 v[52:55], v3 offset:8192
buffer_load_dwordx4 v[124:127], v1, s[8:11], s83 offen offset:3072 sc1
s_waitcnt lgkmcnt(6)
v_mov_b64 v[22:23], 0
v_smfmac_f32_16x16x64_bf16 v[56:59], v[36:39], v[104:111], v8
s_add_u32 s83, s83, 4096
ds_read_b128 v[88:91], v4 offset:8192
s_waitcnt lgkmcnt(6)
v_smfmac_f32_16x16x64_bf16 v[56:59], v[40:43], a[16:23], v8
ds_read_b128 v[92:95], v4 offset:9216
s_waitcnt lgkmcnt(5)
v_smfmac_f32_16x16x64_bf16 v[56:59], v[44:47], a[24:31], v8
buffer_load_dwordx4 v[128:131], v1, s[8:11], s83 offen offset:0 sc1
ds_read_b128 v[96:99], v4 offset:14336
s_waitcnt lgkmcnt(4)
v_smfmac_f32_16x16x64_bf16 v[56:59], v[48:51], v[80:87], v8
ds_read_b128 v[100:103], v4 offset:15360
s_waitcnt lgkmcnt(4)
v_smfmac_f32_16x16x64_bf16 v[56:59], v[52:55], a[48:55], v8
ds_read_b128 v[104:107], v4 offset:10240
v_smfmac_f32_16x16x64_bf16 v[60:63], v[28:31], a[56:63], v8
buffer_load_dwordx4 v[132:135], v1, s[8:11], s83 offen offset:1024 sc1
ds_read_b128 v[108:111], v4 offset:11264
v_smfmac_f32_16x16x64_bf16 v[60:63], v[32:35], a[64:71], v8
ds_read_b128 v[80:83], v4 offset:16384
s_waitcnt lgkmcnt(5)
v_add_f32 v56, v56, v58
v_smfmac_f32_16x16x64_bf16 v[60:63], v[36:39], v[88:95], v8
ds_read_b128 v[84:87], v4 offset:17408
v_add_f32 v57, v57, v59
v_smfmac_f32_16x16x64_bf16 v[60:63], v[40:43], a[72:79], v8
buffer_load_dwordx4 v[136:139], v1, s[8:11], s83 offen offset:2048 sc1
ds_read_b128 v[88:91], v4 offset:18432
v_cvt_pk_bf16_f32 v56, v56, v57
v_smfmac_f32_16x16x64_bf16 v[60:63], v[44:47], a[80:87], v8
ds_read_b128 v[92:95], v4 offset:19456
s_waitcnt lgkmcnt(6)
v_smfmac_f32_16x16x64_bf16 v[60:63], v[48:51], v[96:103], v8
ds_read_b128 v[96:99], v4 offset:20480
v_mov_b32_dpp v57, v56 quad_perm:[1,0,3,2] row_mask:0xf bank_mask:0xf
v_smfmac_f32_16x16x64_bf16 v[60:63], v[52:55], a[104:111], v8
buffer_load_dwordx4 v[140:143], v1, s[8:11], s83 offen offset:3072 sc1
ds_read_b128 v[100:103], v4 offset:21504
v_perm_b32 v56, v57, v56, v6
v_smfmac_f32_16x16x64_bf16 v[64:67], v[28:31], a[112:119], v8
s_add_u32 s83, s83, 4096
ds_write_b32 v5, v56 offset:0
v_smfmac_f32_16x16x64_bf16 v[64:67], v[32:35], a[120:127], v8
s_waitcnt lgkmcnt(7)
v_add_f32 v60, v60, v62
v_smfmac_f32_16x16x64_bf16 v[64:67], v[36:39], v[104:111], v8
buffer_load_dwordx4 v[144:147], v1, s[8:11], s83 offen offset:0 sc1
ds_read_b128 v[104:107], v4 offset:24576
v_add_f32 v61, v61, v63
v_smfmac_f32_16x16x64_bf16 v[64:67], v[40:43], a[128:135], v8
s_waitcnt lgkmcnt(1)
s_barrier
ds_read_b128 v[68:71], v3 offset:12736
v_cvt_pk_bf16_f32 v60, v60, v61
v_smfmac_f32_16x16x64_bf16 v[64:67], v[44:47], a[136:143], v8
ds_read_b128 v[108:111], v4 offset:25600
v_mov_b64 v[28:29], 0
v_smfmac_f32_16x16x64_bf16 v[64:67], v[48:51], v[80:87], v8
buffer_load_dwordx4 v[148:151], v1, s[8:11], s83 offen offset:1024 sc1
ds_read_b128 v[80:83], v4 offset:22528
v_mov_b32_dpp v61, v60 quad_perm:[1,0,3,2] row_mask:0xf bank_mask:0xf
v_smfmac_f32_16x16x64_bf16 v[64:67], v[52:55], a[160:167], v8
ds_read_b128 v[84:87], v4 offset:23552
s_waitcnt lgkmcnt(3)
v_perm_b32 v60, v61, v60, v6
v_smfmac_f32_16x16x64_bf16 v[156:159], v[68:71], a[168:175], v8
ds_write_b32 v5, v60 offset:1024
v_mov_b64 v[30:31], 0
v_smfmac_f32_16x16x64_bf16 v[164:167], v[68:71], a[192:199], v8
buffer_load_dwordx4 v[152:155], v1, s[8:11], s83 offen offset:2048 sc1
v_add_f32 v64, v64, v66
v_add_f32 v65, v65, v67
v_smfmac_f32_16x16x64_bf16 v[160:163], v[68:71], v[88:95], v8
ds_read_b128 v[88:91], v4 offset:26624
v_cvt_pk_bf16_f32 v64, v64, v65
v_smfmac_f32_16x16x64_bf16 v[168:171], v[68:71], a[216:223], v8
s_waitcnt lgkmcnt(1)
s_barrier
ds_read_b128 v[72:75], v3 offset:13760
v_mov_b64 v[32:33], 0
v_smfmac_f32_16x16x64_bf16 v[172:175], v[68:71], a[240:247], v8
ds_read_b128 v[92:95], v4 offset:27648
v_mov_b32_dpp v65, v64 quad_perm:[1,0,3,2] row_mask:0xf bank_mask:0xf
v_perm_b32 v64, v65, v64, v6
v_smfmac_f32_16x16x64_bf16 v[24:27], v[68:71], v[184:191], v8
ds_write_b32 v5, v64 offset:2048
s_waitcnt lgkmcnt(2)
v_mov_b64 v[34:35], 0
v_smfmac_f32_16x16x64_bf16 v[156:159], v[72:75], a[176:183], v8
v_smfmac_f32_16x16x64_bf16 v[164:167], v[72:75], a[200:207], v8
v_smfmac_f32_16x16x64_bf16 v[160:163], v[72:75], v[96:103], v8
s_waitcnt lgkmcnt(0)
s_barrier
ds_read_b128 v[76:79], v3 offset:14784
v_smfmac_f32_16x16x64_bf16 v[168:171], v[72:75], a[224:231], v8
ds_read_b128 v[96:99], v4 offset:28672
v_smfmac_f32_16x16x64_bf16 v[16:19], v[68:71], v[104:111], v8
ds_read_b128 v[100:103], v4 offset:29696
v_smfmac_f32_16x16x64_bf16 v[20:23], v[68:71], v[208:215], v8
ds_read_b128 v[104:107], v4 offset:30720
s_waitcnt lgkmcnt(3)
v_smfmac_f32_16x16x64_bf16 v[156:159], v[76:79], a[184:191], v8
ds_read_b128 v[108:111], v4 offset:31744
v_smfmac_f32_16x16x64_bf16 v[160:163], v[76:79], v[80:87], v8
ds_read_b128 v[80:83], v4 offset:32768
v_smfmac_f32_16x16x64_bf16 v[164:167], v[76:79], a[208:215], v8
ds_read_b128 v[84:87], v4 offset:33792
v_add_f32 v156, v156, v158
v_add_f32 v157, v157, v159
v_smfmac_f32_16x16x64_bf16 v[168:171], v[76:79], a[232:239], v8
v_cvt_pk_bf16_f32 v56, v156, v157
v_add_f32 v160, v160, v162
v_smfmac_f32_16x16x64_bf16 v[172:175], v[72:75], a[248:255], v8
buffer_load_dwordx4 v[156:159], v1, s[8:11], s83 offen offset:3072 sc1
s_add_u32 s83, s83, 4096
v_add_f32 v161, v161, v163
v_add_f32 v164, v164, v166
v_smfmac_f32_16x16x64_bf16 v[16:19], v[72:75], v[88:95], v8
ds_read_b128 v[88:91], v4 offset:34816
v_cvt_pk_bf16_f32 v57, v160, v161
v_add_f32 v165, v165, v167
v_smfmac_f32_16x16x64_bf16 v[172:175], v[76:79], v[176:183], v8
buffer_load_dwordx4 v[160:163], v1, s[8:11], s83 offen offset:0 sc1
ds_read_b128 v[92:95], v4 offset:35840
v_cvt_pk_bf16_f32 v58, v164, v165
v_add_f32 v168, v168, v170
v_smfmac_f32_16x16x64_bf16 v[24:27], v[72:75], v[192:199], v8
buffer_load_dwordx4 v[164:167], v1, s[8:11], s83 offen offset:1024 sc1
s_waitcnt lgkmcnt(6)
v_add_f32 v169, v169, v171
v_permlane16_swap_b32 v56, v57
v_smfmac_f32_16x16x64_bf16 v[16:19], v[76:79], v[96:103], v8
v_cvt_pk_bf16_f32 v59, v168, v169
v_add_f32 v172, v172, v174
v_smfmac_f32_16x16x64_bf16 v[20:23], v[72:75], v[216:223], v8
buffer_load_dwordx4 v[168:171], v1, s[8:11], s83 offen offset:2048 sc1
v_permlane16_swap_b32 v58, v59
v_add_f32 v173, v173, v175
v_smfmac_f32_16x16x64_bf16 v[24:27], v[76:79], v[200:207], v8
v_permlane32_swap_b32 v56, v58
v_permlane32_swap_b32 v57, v59
v_smfmac_f32_16x16x64_bf16 v[28:31], v[68:71], v[232:239], v8
v_bfi_b32 v56, 1, s62, v56
v_cvt_pk_bf16_f32 v60, v172, v173
v_smfmac_f32_16x16x64_bf16 v[20:23], v[76:79], v[224:231], v8
buffer_store_dwordx4 v[56:59], v11, s[8:11], s44 offen
s_waitcnt lgkmcnt(4)
v_add_f32 v16, v16, v18
v_add_f32 v17, v17, v19
v_smfmac_f32_16x16x64_bf16 v[32:35], v[68:71], v[104:111], v8
buffer_load_dwordx4 v[172:175], v1, s[8:11], s83 offen offset:3072 sc1
v_cvt_pk_bf16_f32 v61, v16, v17
v_add_f32 v24, v24, v26
v_smfmac_f32_16x16x64_bf16 v[28:31], v[72:75], v[240:247], v8
s_waitcnt lgkmcnt(2)
v_add_f32 v25, v25, v27
v_add_f32 v20, v20, v22
v_smfmac_f32_16x16x64_bf16 v[32:35], v[72:75], v[80:87], v8
v_cvt_pk_bf16_f32 v62, v24, v25
v_add_f32 v21, v21, v23
v_smfmac_f32_16x16x64_bf16 v[28:31], v[76:79], v[248:255], v8
s_waitcnt lgkmcnt(0)
v_cvt_pk_bf16_f32 v63, v20, v21
v_permlane16_swap_b32 v60, v61
v_smfmac_f32_16x16x64_bf16 v[32:35], v[76:79], v[88:95], v8
v_permlane16_swap_b32 v62, v63
s_nop 1
v_permlane32_swap_b32 v60, v62
v_permlane32_swap_b32 v61, v63
v_pk_add_f32 v[28:29], v[28:29], v[30:31]
v_bfi_b32 v60, 1, s62, v60
v_cvt_pk_bf16_f32 v64, v28, v29
v_pk_add_f32 v[32:33], v[32:33], v[34:35]
buffer_store_dwordx4 v[60:63], v11, s[8:11], s45 offen
v_cvt_pk_bf16_f32 v65, v32, v33
s_nop 1
v_permlane16_swap_b32 v64, v65
v_bfi_b32 v64, 1, s62, v64
buffer_store_dwordx2 v[64:65], v9, s[8:11], s46 offen
s_cmp_eq_u32 s62, 63
s_cbranch_scc1 Lc_246
s_add_u32 s67, s62, 1
s_and_b32 s67, s67, 3
s_lshl_b32 s67, s67, 1
s_lshl_b32 s68, s67, 15
s_add_u32 s67, s67, s64
s_mul_i32 s67, s67, 10240
s_add_u32 s33, s68, s58
s_add_u32 s32, s67, s80
s_add_u32 s32, s32, 191889408
s_sleep 4
buffer_load_dwordx4 v[80:83], v10, s[8:11], s72 offen sc1
buffer_load_dwordx4 v[84:87], v10, s[8:11], s73 offen sc1
buffer_load_dwordx4 v[88:91], v10, s[8:11], s74 offen sc1
buffer_load_dwordx4 v[92:95], v10, s[8:11], s75 offen sc1
v_mov_b32 v108, 0
v_mov_b32 v109, 0
v_mov_b32 v110, 0
v_mov_b32 v111, 0
s_waitcnt vmcnt(0)
v_bitop3_b32 v20, v80, v82, s62 bitop3:0x7e
v_and_b32 v20, 1, v20
v_bitop3_b32 v21, v84, v86, s62 bitop3:0x7e
v_and_b32 v21, 1, v21
v_bitop3_b32 v22, v88, v90, s62 bitop3:0x7e
v_and_b32 v22, 1, v22
v_bitop3_b32 v23, v92, v94, s62 bitop3:0x7e
v_and_b32 v23, 1, v23
v_cmp_ne_u32 s[22:23], 0, v20
v_cmp_ne_u32 s[24:25], 0, v21
v_cmp_ne_u32 s[26:27], 0, v22
v_cmp_ne_u32 s[30:31], 0, v23
s_or_b64 s[28:29], s[22:23], s[24:25]
s_or_b64 s[28:29], s[28:29], s[26:27]
s_or_b64 s[28:29], s[28:29], s[30:31]
s_cbranch_scc1 Lp_254
s_sleep 1
buffer_load_dwordx4 v[96:99], v1, s[8:11], s76 offen offset:0 sc1
buffer_load_dwordx4 v[100:103], v1, s[8:11], s76 offen offset:1024 sc1
Lp_254x:
s_waitcnt vmcnt(1)
ds_write_b128 v2, v[96:99] offset:0
v_bitop3_b32 v16, v96, v98, s50 bitop3:0x7e
v_cmp_gt_i32 s[16:17], 0, v16
s_waitcnt vmcnt(0)
ds_write_b128 v2, v[100:103] offset:1024
v_bitop3_b32 v17, v100, v102, s50 bitop3:0x7e
v_cmp_gt_i32 s[18:19], 0, v17
s_nop 0
s_or_b64 s[28:29], s[16:17], s[18:19]
s_cbranch_scc1 Lp_252
Lp_253:
v_smfmac_f32_16x16x64_bf16 v[108:111], v[96:99], v[160:167], v8
s_waitcnt lgkmcnt(0)
s_barrier
ds_read_b128 v[16:19], v3 offset:0
ds_read_b128 v[20:23], v3 offset:1024
ds_read_b128 v[24:27], v3 offset:2048
v_smfmac_f32_16x16x64_bf16 v[108:111], v[100:103], v[168:175], v8
ds_read_b128 v[28:31], v3 offset:3072
ds_read_b128 v[32:35], v3 offset:4096
ds_read_b128 v[36:39], v3 offset:5120
ds_read_b128 v[48:51], v3 offset:8192
ds_read_b128 v[52:55], v3 offset:9216
s_waitcnt vmcnt(0)
s_waitcnt lgkmcnt(7)
v_smfmac_f32_16x16x64_bf16 v[108:111], v[16:19], v[112:119], v8
s_waitcnt lgkmcnt(6)
v_smfmac_f32_16x16x64_bf16 v[108:111], v[20:23], v[120:127], v8
s_waitcnt lgkmcnt(5)
v_smfmac_f32_16x16x64_bf16 v[108:111], v[24:27], v[128:135], v8
s_waitcnt lgkmcnt(4)
v_smfmac_f32_16x16x64_bf16 v[108:111], v[28:31], v[136:143], v8
s_waitcnt lgkmcnt(3)
v_smfmac_f32_16x16x64_bf16 v[108:111], v[32:35], v[144:151], v8
s_waitcnt lgkmcnt(2)
v_smfmac_f32_16x16x64_bf16 v[108:111], v[36:39], v[152:159], v8
s_waitcnt lgkmcnt(1)
v_smfmac_f32_16x16x64_bf16 v[108:111], v[48:51], v[80:87], v8
s_waitcnt lgkmcnt(0)
v_smfmac_f32_16x16x64_bf16 v[108:111], v[52:55], v[88:95], v8
s_nop 7
v_pk_add_f32 v[108:109], v[108:109], v[110:111]
v_cvt_pk_bf16_f32 v108, v108, v109
v_xor_b32 v108, s50, v108
s_nop 1
v_mov_b32_dpp v109, v108 quad_perm:[1,0,3,2] row_mask:0xf bank_mask:0xf
v_perm_b32 v108, v109, v108, v6
buffer_store_dword v108, v12, s[8:11], s77 offen
buffer_store_dword v108, v12, s[8:11], s78 offen sc1
s_cmp_ge_u32 s62, 60
s_cbranch_scc1 Lc_246
Lc_247:
s_add_u32 s62, s62, 1
s_branch Lvo_233
Lg_241:
s_mov_b64 exec, s[16:17]
buffer_load_dwordx4 v[68:71], v1, s[8:11], s32 offen offset:0 sc1
s_mov_b64 exec, s[18:19]
buffer_load_dwordx4 v[72:75], v1, s[8:11], s32 offen offset:1024 sc1
s_mov_b64 exec, -1
s_waitcnt vmcnt(0)
v_max3_u32 v52, v68, v69, v70
v_max3_u32 v53, v72, v73, v74
v_max_u32 v52, v52, v71
v_max_u32 v53, v53, v75
v_cmp_eq_u32 s[16:17], -1, v52
v_cmp_eq_u32 s[18:19], -1, v53
s_nop 0
s_or_b64 s[28:29], s[16:17], s[18:19]
s_cbranch_scc0 Lg_242
s_cmp_eq_u32 s65, 0
s_cbranch_scc1 Lg_242
s_sub_u32 s65, s65, 1
s_branch Lg_241
Lg_243:
Lg_244:
s_mov_b64 exec, s[22:23]
buffer_load_dwordx4 v[112:115], v1, s[8:11], s33 offen offset:0 sc1
s_mov_b64 exec, s[24:25]
buffer_load_dwordx4 v[116:119], v1, s[8:11], s33 offen offset:1024 sc1
s_mov_b64 exec, -1
s_waitcnt vmcnt(0)
v_max3_u32 v52, v112, v113, v114
v_max3_u32 v53, v116, v117, v118
v_max_u32 v52, v52, v115
v_max_u32 v53, v53, v119
v_cmp_eq_u32 s[22:23], -1, v52
v_cmp_eq_u32 s[24:25], -1, v53
s_nop 0
s_or_b64 s[28:29], s[22:23], s[24:25]
s_cbranch_scc0 Lg_245
s_cmp_eq_u32 s65, 0
s_cbranch_scc1 Lg_245
s_sub_u32 s65, s65, 1
s_branch Lg_244
Lp_254:
s_mov_b64 exec, s[22:23]
buffer_load_dwordx4 v[80:83], v10, s[8:11], s72 offen sc1
s_mov_b64 exec, s[24:25]
buffer_load_dwordx4 v[84:87], v10, s[8:11], s73 offen sc1
s_mov_b64 exec, s[26:27]
buffer_load_dwordx4 v[88:91], v10, s[8:11], s74 offen sc1
s_mov_b64 exec, s[30:31]
buffer_load_dwordx4 v[92:95], v10, s[8:11], s75 offen sc1
s_mov_b64 exec, -1
buffer_load_dwordx4 v[96:99], v1, s[8:11], s76 offen offset:0 sc1
buffer_load_dwordx4 v[100:103], v1, s[8:11], s76 offen offset:1024 sc1
s_waitcnt vmcnt(2)
v_bitop3_b32 v20, v80, v82, s62 bitop3:0x7e
v_and_b32 v20, 1, v20
v_bitop3_b32 v21, v84, v86, s62 bitop3:0x7e
v_and_b32 v21, 1, v21
v_bitop3_b32 v22, v88, v90, s62 bitop3:0x7e
v_and_b32 v22, 1, v22
v_bitop3_b32 v23, v92, v94, s62 bitop3:0x7e
v_and_b32 v23, 1, v23
v_cmp_ne_u32 s[22:23], 0, v20
v_cmp_ne_u32 s[24:25], 0, v21
v_cmp_ne_u32 s[26:27], 0, v22
v_cmp_ne_u32 s[30:31], 0, v23
s_or_b64 s[28:29], s[22:23], s[24:25]
s_or_b64 s[28:29], s[28:29], s[26:27]
s_or_b64 s[28:29], s[28:29], s[30:31]
s_cbranch_scc1 Lp_250
s_branch Lp_254x
Lp_250:
s_waitcnt vmcnt(0)
v_bitop3_b32 v16, v96, v98, s50 bitop3:0x7e
v_bitop3_b32 v19, v97, v99, s50 bitop3:0x7e
v_or_b32 v16, v16, v19
v_cmp_gt_i32 s[16:17], 0, v16
v_bitop3_b32 v17, v100, v102, s50 bitop3:0x7e
v_bitop3_b32 v19, v101, v103, s50 bitop3:0x7e
v_or_b32 v17, v17, v19
v_cmp_gt_i32 s[18:19], 0, v17
s_nop 0
s_or_b64 s[28:29], s[16:17], s[18:19]
Lp_255:
s_mov_b64 exec, s[22:23]
buffer_load_dwordx4 v[80:83], v10, s[8:11], s72 offen sc1
s_mov_b64 exec, s[24:25]
buffer_load_dwordx4 v[84:87], v10, s[8:11], s73 offen sc1
s_mov_b64 exec, s[26:27]
buffer_load_dwordx4 v[88:91], v10, s[8:11], s74 offen sc1
s_mov_b64 exec, s[30:31]
buffer_load_dwordx4 v[92:95], v10, s[8:11], s75 offen sc1
s_mov_b64 exec, -1
s_mov_b64 exec, s[16:17]
buffer_load_dwordx4 v[96:99], v1, s[8:11], s76 offen offset:0 sc1
s_mov_b64 exec, s[18:19]
buffer_load_dwordx4 v[100:103], v1, s[8:11], s76 offen offset:1024 sc1
s_mov_b64 exec, -1
s_waitcnt vmcnt(0)
v_bitop3_b32 v16, v96, v98, s50 bitop3:0x7e
v_bitop3_b32 v19, v97, v99, s50 bitop3:0x7e
v_or_b32 v16, v16, v19
v_cmp_gt_i32 s[16:17], 0, v16
v_bitop3_b32 v17, v100, v102, s50 bitop3:0x7e
v_bitop3_b32 v19, v101, v103, s50 bitop3:0x7e
v_or_b32 v17, v17, v19
v_cmp_gt_i32 s[18:19], 0, v17
s_nop 0
s_or_b64 s[28:29], s[16:17], s[18:19]
s_cselect_b32 s51, 1, 0
v_bitop3_b32 v20, v80, v82, s62 bitop3:0x7e
v_and_b32 v20, 1, v20
v_bitop3_b32 v21, v84, v86, s62 bitop3:0x7e
v_and_b32 v21, 1, v21
v_bitop3_b32 v22, v88, v90, s62 bitop3:0x7e
v_and_b32 v22, 1, v22
v_bitop3_b32 v23, v92, v94, s62 bitop3:0x7e
v_and_b32 v23, 1, v23
v_cmp_ne_u32 s[22:23], 0, v20
v_cmp_ne_u32 s[24:25], 0, v21
v_cmp_ne_u32 s[26:27], 0, v22
v_cmp_ne_u32 s[30:31], 0, v23
s_or_b64 s[28:29], s[22:23], s[24:25]
s_or_b64 s[28:29], s[28:29], s[26:27]
s_or_b64 s[28:29], s[28:29], s[30:31]
s_cbranch_scc0 Lp_251
s_cmp_eq_u32 s65, 0
s_cbranch_scc1 Lp_251
s_sub_u32 s65, s65, 1
s_branch Lp_255
Lp_251:
s_cmp_eq_u32 s51, 0
s_cbranch_scc1 Lp_257
Lp_252:
Lp_256:
s_mov_b64 exec, s[16:17]
buffer_load_dwordx4 v[96:99], v1, s[8:11], s76 offen offset:0 sc1
s_mov_b64 exec, s[18:19]
buffer_load_dwordx4 v[100:103], v1, s[8:11], s76 offen offset:1024 sc1
s_mov_b64 exec, -1
s_waitcnt vmcnt(0)
v_bitop3_b32 v16, v96, v98, s50 bitop3:0x7e
v_bitop3_b32 v19, v97, v99, s50 bitop3:0x7e
v_or_b32 v16, v16, v19
v_cmp_gt_i32 s[16:17], 0, v16
v_bitop3_b32 v17, v100, v102, s50 bitop3:0x7e
v_bitop3_b32 v19, v101, v103, s50 bitop3:0x7e
v_or_b32 v17, v17, v19
v_cmp_gt_i32 s[18:19], 0, v17
s_nop 0
s_or_b64 s[28:29], s[16:17], s[18:19]
s_cbranch_scc0 Lp_257
s_cmp_eq_u32 s65, 0
s_cbranch_scc1 Lp_257
s_sub_u32 s65, s65, 1
s_branch Lp_256
Lp_257:
ds_write_b128 v2, v[96:99] offset:0
ds_write_b128 v2, v[100:103] offset:1024
s_branch Lp_253
Lc_246:
s_lshl_b32 s52, s62, 5
s_add_u32 s52, s52, s63
s_mul_i32 s52, s52, 10240
s_add_u32 s52, s52, 165675008
s_add_u32 s53, s52, 4096
s_add_u32 s54, s52, 8192
buffer_store_dwordx4 v[56:59], v11, s[8:11], s52 offen sc1
buffer_store_dwordx4 v[60:63], v11, s[8:11], s53 offen sc1
buffer_store_dwordx2 v[64:65], v9, s[8:11], s54 offen sc1
s_cmp_lt_u32 s62, 63
s_cbranch_scc1 Lc_247
s_waitcnt vmcnt(0)
s_barrier
s_waitcnt vmcnt(0)
s_endpgm
Lw_181:
s_mov_b32 s62, 0
s_mov_b32 s36, 0x03030303
s_mov_b32 s37, s36
ds_read_b128 v[80:83], v4 offset:0
ds_read_b128 v[84:87], v4 offset:1024
ds_read_b128 v[88:91], v4 offset:2048
ds_read_b128 v[92:95], v4 offset:3072
ds_read_b128 v[96:99], v4 offset:4096
ds_read_b128 v[100:103], v4 offset:5120
ds_read_b128 v[104:107], v4 offset:6144
ds_read_b128 v[108:111], v4 offset:7168
s_bitcmp1_b32 s62, 0
s_cselect_b32 s50, 0x80008000, 0
v_mov_b64 v[56:57], 0
v_mov_b64 v[58:59], 0
v_mov_b64 v[60:61], 0
v_mov_b64 v[62:63], 0
v_mov_b64 v[64:65], 0
v_mov_b64 v[66:67], 0
v_mov_b64 v[156:157], 0
v_mov_b64 v[158:159], 0
v_mov_b64 v[160:161], 0
v_mov_b64 v[162:163], 0
v_mov_b64 v[164:165], 0
v_mov_b64 v[166:167], 0
v_mov_b64 v[168:169], 0
v_mov_b64 v[170:171], 0
v_mov_b64 v[172:173], 0
v_mov_b64 v[174:175], 0
ds_read_b128 v[16:19], v3 offset:6144
ds_read_b128 v[24:27], v3 offset:7168
s_waitcnt lgkmcnt(0)
s_branch Lvoent_259
Lvo_258:
s_barrier
ds_read_b128 v[80:83], v4 offset:0
ds_read_b128 v[84:87], v4 offset:1024
ds_read_b128 v[88:91], v4 offset:2048
ds_read_b128 v[92:95], v4 offset:3072
ds_read_b128 v[96:99], v4 offset:4096
ds_read_b128 v[100:103], v4 offset:5120
ds_read_b128 v[104:107], v4 offset:6144
ds_read_b128 v[108:111], v4 offset:7168
s_bitcmp1_b32 s62, 0
s_cselect_b32 s50, 0x80008000, 0
v_mov_b64 v[56:57], 0
v_mov_b64 v[58:59], 0
v_mov_b64 v[60:61], 0
v_mov_b64 v[62:63], 0
v_mov_b64 v[64:65], 0
v_mov_b64 v[66:67], 0
v_mov_b64 v[156:157], 0
v_mov_b64 v[158:159], 0
v_mov_b64 v[160:161], 0
v_mov_b64 v[162:163], 0
v_mov_b64 v[164:165], 0
v_mov_b64 v[166:167], 0
v_mov_b64 v[168:169], 0
v_mov_b64 v[170:171], 0
v_mov_b64 v[172:173], 0
v_mov_b64 v[174:175], 0
s_sleep 1
s_waitcnt lgkmcnt(0)
buffer_load_dwordx4 v[68:71], v1, s[8:11], s32 offen offset:0 sc1
buffer_load_dwordx4 v[72:75], v1, s[8:11], s32 offen offset:1024 sc1
s_waitcnt vmcnt(0)
v_max3_u32 v52, v68, v69, v70
v_max3_u32 v53, v72, v73, v74
v_max_u32 v52, v52, v71
v_max_u32 v53, v53, v75
v_cmp_eq_u32 s[16:17], -1, v52
v_cmp_eq_u32 s[18:19], -1, v53
s_nop 0
s_or_b64 s[28:29], s[16:17], s[18:19]
s_cbranch_scc1 Lg_260
Lg_261:
buffer_load_dwordx4 v[112:115], v1, s[8:11], s33 offen offset:0 sc1
buffer_load_dwordx4 v[116:119], v1, s[8:11], s33 offen offset:1024 sc1
v_lshlrev_b32 v16, 16, v68
v_and_b32 v17, 0xffff0000, v68
v_lshlrev_b32 v18, 16, v69
v_and_b32 v19, 0xffff0000, v69
v_lshlrev_b32 v20, 16, v70
v_and_b32 v21, 0xffff0000, v70
v_lshlrev_b32 v22, 16, v71
v_and_b32 v23, 0xffff0000, v71
v_lshlrev_b32 v24, 16, v72
v_and_b32 v25, 0xffff0000, v72
v_lshlrev_b32 v26, 16, v73
v_and_b32 v27, 0xffff0000, v73
v_lshlrev_b32 v28, 16, v74
v_and_b32 v29, 0xffff0000, v74
v_lshlrev_b32 v30, 16, v75
v_and_b32 v31, 0xffff0000, v75
s_waitcnt vmcnt(0)
v_max3_u32 v52, v112, v113, v114
v_max3_u32 v53, v116, v117, v118
v_max_u32 v52, v52, v115
v_max_u32 v53, v53, v119
v_cmp_eq_u32 s[22:23], -1, v52
v_cmp_eq_u32 s[24:25], -1, v53
s_nop 0
s_or_b64 s[28:29], s[22:23], s[24:25]
s_cbranch_scc1 Lg_262
Lg_264:
v_dot2c_f32_bf16 v16, s100, v112
v_dot2c_f32_bf16 v17, s101, v112
v_dot2c_f32_bf16 v18, s100, v113
v_dot2c_f32_bf16 v19, s101, v113
v_dot2c_f32_bf16 v20, s100, v114
v_dot2c_f32_bf16 v21, s101, v114
v_dot2c_f32_bf16 v22, s100, v115
v_dot2c_f32_bf16 v23, s101, v115
v_cvt_pk_bf16_f32 v16, v16, v17
v_cvt_pk_bf16_f32 v17, v18, v19
v_cvt_pk_bf16_f32 v18, v20, v21
v_cvt_pk_bf16_f32 v19, v22, v23
ds_write_b128 v2, v[16:19] offset:0
v_dot2c_f32_bf16 v24, s100, v116
v_dot2c_f32_bf16 v25, s101, v116
v_dot2c_f32_bf16 v26, s100, v117
v_dot2c_f32_bf16 v27, s101, v117
v_dot2c_f32_bf16 v28, s100, v118
v_dot2c_f32_bf16 v29, s101, v118
v_dot2c_f32_bf16 v30, s100, v119
v_dot2c_f32_bf16 v31, s101, v119
v_cvt_pk_bf16_f32 v24, v24, v25
v_cvt_pk_bf16_f32 v25, v26, v27
v_cvt_pk_bf16_f32 v26, v28, v29
v_cvt_pk_bf16_f32 v27, v30, v31
ds_write_b128 v2, v[24:27] offset:1024
Lvoent_259:
v_smfmac_f32_16x16x64_bf16 v[56:59], v[16:19], a[32:39], v8
v_smfmac_f32_16x16x64_bf16 v[60:63], v[16:19], a[88:95], v8
v_smfmac_f32_16x16x64_bf16 v[64:67], v[16:19], a[144:151], v8
v_smfmac_f32_16x16x64_bf16 v[56:59], v[24:27], a[40:47], v8
s_waitcnt lgkmcnt(0)
s_barrier
ds_read_b128 v[20:23], v3 offset:2048
v_mov_b64 v[16:17], 0
v_smfmac_f32_16x16x64_bf16 v[60:63], v[24:27], a[96:103], v8
ds_read_b128 v[28:31], v3 offset:0
v_mov_b64 v[18:19], 0
v_smfmac_f32_16x16x64_bf16 v[64:67], v[24:27], a[152:159], v8
ds_read_b128 v[32:35], v3 offset:1024
s_waitcnt lgkmcnt(2)
v_smfmac_f32_16x16x64_bf16 v[56:59], v[20:23], v[80:87], v8
ds_read_b128 v[36:39], v3 offset:5120
v_mov_b64 v[24:25], 0
v_smfmac_f32_16x16x64_bf16 v[60:63], v[20:23], v[88:95], v8
ds_read_b128 v[40:43], v3 offset:3072
ds_read_b128 v[80:83], v4 offset:12288
v_mov_b64 v[26:27], 0
v_smfmac_f32_16x16x64_bf16 v[64:67], v[20:23], v[96:103], v8
ds_read_b128 v[44:47], v3 offset:4096
ds_read_b128 v[84:87], v4 offset:13312
s_waitcnt lgkmcnt(6)
v_smfmac_f32_16x16x64_bf16 v[56:59], v[28:31], a[0:7], v8
ds_read_b128 v[48:51], v3 offset:9216
s_waitcnt lgkmcnt(6)
v_mov_b64 v[20:21], 0
v_smfmac_f32_16x16x64_bf16 v[56:59], v[32:35], a[8:15], v8
ds_read_b128 v[52:55], v3 offset:8192
s_waitcnt lgkmcnt(6)
v_mov_b64 v[22:23], 0
v_smfmac_f32_16x16x64_bf16 v[56:59], v[36:39], v[104:111], v8
ds_read_b128 v[88:91], v4 offset:8192
s_waitcnt lgkmcnt(6)
v_smfmac_f32_16x16x64_bf16 v[56:59], v[40:43], a[16:23], v8
ds_read_b128 v[92:95], v4 offset:9216
s_waitcnt lgkmcnt(5)
v_smfmac_f32_16x16x64_bf16 v[56:59], v[44:47], a[24:31], v8
ds_read_b128 v[96:99], v4 offset:14336
s_waitcnt lgkmcnt(4)
v_smfmac_f32_16x16x64_bf16 v[56:59], v[48:51], v[80:87], v8
ds_read_b128 v[100:103], v4 offset:15360
s_waitcnt lgkmcnt(4)
v_smfmac_f32_16x16x64_bf16 v[56:59], v[52:55], a[48:55], v8
ds_read_b128 v[104:107], v4 offset:10240
v_smfmac_f32_16x16x64_bf16 v[60:63], v[28:31], a[56:63], v8
ds_read_b128 v[108:111], v4 offset:11264
v_smfmac_f32_16x16x64_bf16 v[60:63], v[32:35], a[64:71], v8
ds_read_b128 v[80:83], v4 offset:16384
s_waitcnt lgkmcnt(5)
v_add_f32 v56, v56, v58
v_smfmac_f32_16x16x64_bf16 v[60:63], v[36:39], v[88:95], v8
ds_read_b128 v[84:87], v4 offset:17408
v_add_f32 v57, v57, v59
v_smfmac_f32_16x16x64_bf16 v[60:63], v[40:43], a[72:79], v8
ds_read_b128 v[88:91], v4 offset:18432
v_cvt_pk_bf16_f32 v56, v56, v57
v_smfmac_f32_16x16x64_bf16 v[60:63], v[44:47], a[80:87], v8
ds_read_b128 v[92:95], v4 offset:19456
s_waitcnt lgkmcnt(6)
v_smfmac_f32_16x16x64_bf16 v[60:63], v[48:51], v[96:103], v8
ds_read_b128 v[96:99], v4 offset:20480
v_mov_b32_dpp v57, v56 quad_perm:[1,0,3,2] row_mask:0xf bank_mask:0xf
v_smfmac_f32_16x16x64_bf16 v[60:63], v[52:55], a[104:111], v8
ds_read_b128 v[100:103], v4 offset:21504
v_perm_b32 v56, v57, v56, v6
v_smfmac_f32_16x16x64_bf16 v[64:67], v[28:31], a[112:119], v8
ds_write_b32 v5, v56 offset:0
v_smfmac_f32_16x16x64_bf16 v[64:67], v[32:35], a[120:127], v8
s_waitcnt lgkmcnt(7)
v_add_f32 v60, v60, v62
v_smfmac_f32_16x16x64_bf16 v[64:67], v[36:39], v[104:111], v8
ds_read_b128 v[104:107], v4 offset:24576
v_add_f32 v61, v61, v63
v_smfmac_f32_16x16x64_bf16 v[64:67], v[40:43], a[128:135], v8
s_waitcnt lgkmcnt(1)
s_barrier
ds_read_b128 v[68:71], v3 offset:12736
v_cvt_pk_bf16_f32 v60, v60, v61
v_smfmac_f32_16x16x64_bf16 v[64:67], v[44:47], a[136:143], v8
ds_read_b128 v[108:111], v4 offset:25600
v_mov_b64 v[28:29], 0
v_smfmac_f32_16x16x64_bf16 v[64:67], v[48:51], v[80:87], v8
ds_read_b128 v[80:83], v4 offset:22528
v_mov_b32_dpp v61, v60 quad_perm:[1,0,3,2] row_mask:0xf bank_mask:0xf
v_smfmac_f32_16x16x64_bf16 v[64:67], v[52:55], a[160:167], v8
ds_read_b128 v[84:87], v4 offset:23552
s_waitcnt lgkmcnt(3)
v_perm_b32 v60, v61, v60, v6
v_smfmac_f32_16x16x64_bf16 v[156:159], v[68:71], a[168:175], v8
ds_write_b32 v5, v60 offset:1024
v_mov_b64 v[30:31], 0
v_smfmac_f32_16x16x64_bf16 v[164:167], v[68:71], a[192:199], v8
v_add_f32 v64, v64, v66
v_add_f32 v65, v65, v67
v_smfmac_f32_16x16x64_bf16 v[160:163], v[68:71], v[88:95], v8
ds_read_b128 v[88:91], v4 offset:26624
v_cvt_pk_bf16_f32 v64, v64, v65
v_smfmac_f32_16x16x64_bf16 v[168:171], v[68:71], a[216:223], v8
s_waitcnt lgkmcnt(1)
s_barrier
ds_read_b128 v[72:75], v3 offset:13760
v_mov_b64 v[32:33], 0
v_smfmac_f32_16x16x64_bf16 v[172:175], v[68:71], a[240:247], v8
ds_read_b128 v[92:95], v4 offset:27648
v_mov_b32_dpp v65, v64 quad_perm:[1,0,3,2] row_mask:0xf bank_mask:0xf
v_perm_b32 v64, v65, v64, v6
v_smfmac_f32_16x16x64_bf16 v[24:27], v[68:71], v[184:191], v8
ds_write_b32 v5, v64 offset:2048
s_waitcnt lgkmcnt(2)
v_mov_b64 v[34:35], 0
v_smfmac_f32_16x16x64_bf16 v[156:159], v[72:75], a[176:183], v8
v_smfmac_f32_16x16x64_bf16 v[164:167], v[72:75], a[200:207], v8
v_smfmac_f32_16x16x64_bf16 v[160:163], v[72:75], v[96:103], v8
s_waitcnt lgkmcnt(0)
s_barrier
ds_read_b128 v[76:79], v3 offset:14784
v_smfmac_f32_16x16x64_bf16 v[168:171], v[72:75], a[224:231], v8
ds_read_b128 v[96:99], v4 offset:28672
v_smfmac_f32_16x16x64_bf16 v[16:19], v[68:71], v[104:111], v8
ds_read_b128 v[100:103], v4 offset:29696
v_smfmac_f32_16x16x64_bf16 v[20:23], v[68:71], v[208:215], v8
ds_read_b128 v[104:107], v4 offset:30720
s_waitcnt lgkmcnt(3)
v_smfmac_f32_16x16x64_bf16 v[156:159], v[76:79], a[184:191], v8
ds_read_b128 v[108:111], v4 offset:31744
v_smfmac_f32_16x16x64_bf16 v[160:163], v[76:79], v[80:87], v8
ds_read_b128 v[80:83], v4 offset:32768
v_smfmac_f32_16x16x64_bf16 v[164:167], v[76:79], a[208:215], v8
ds_read_b128 v[84:87], v4 offset:33792
v_add_f32 v156, v156, v158
v_add_f32 v157, v157, v159
v_smfmac_f32_16x16x64_bf16 v[168:171], v[76:79], a[232:239], v8
v_cvt_pk_bf16_f32 v56, v156, v157
v_add_f32 v160, v160, v162
v_smfmac_f32_16x16x64_bf16 v[172:175], v[72:75], a[248:255], v8
v_add_f32 v161, v161, v163
v_add_f32 v164, v164, v166
v_smfmac_f32_16x16x64_bf16 v[16:19], v[72:75], v[88:95], v8
ds_read_b128 v[88:91], v4 offset:34816
v_cvt_pk_bf16_f32 v57, v160, v161
v_add_f32 v165, v165, v167
v_smfmac_f32_16x16x64_bf16 v[172:175], v[76:79], v[176:183], v8
ds_read_b128 v[92:95], v4 offset:35840
v_cvt_pk_bf16_f32 v58, v164, v165
v_add_f32 v168, v168, v170
v_smfmac_f32_16x16x64_bf16 v[24:27], v[72:75], v[192:199], v8
s_waitcnt lgkmcnt(6)
v_add_f32 v169, v169, v171
v_permlane16_swap_b32 v56, v57
v_smfmac_f32_16x16x64_bf16 v[16:19], v[76:79], v[96:103], v8
v_cvt_pk_bf16_f32 v59, v168, v169
v_add_f32 v172, v172, v174
v_smfmac_f32_16x16x64_bf16 v[20:23], v[72:75], v[216:223], v8
v_permlane16_swap_b32 v58, v59
v_add_f32 v173, v173, v175
v_smfmac_f32_16x16x64_bf16 v[24:27], v[76:79], v[200:207], v8
v_permlane32_swap_b32 v56, v58
v_permlane32_swap_b32 v57, v59
v_smfmac_f32_16x16x64_bf16 v[28:31], v[68:71], v[232:239], v8
v_bfi_b32 v56, 1, s62, v56
v_cvt_pk_bf16_f32 v60, v172, v173
v_smfmac_f32_16x16x64_bf16 v[20:23], v[76:79], v[224:231], v8
buffer_store_dwordx4 v[56:59], v11, s[8:11], s44 offen
s_waitcnt lgkmcnt(4)
v_add_f32 v16, v16, v18
v_add_f32 v17, v17, v19
v_smfmac_f32_16x16x64_bf16 v[32:35], v[68:71], v[104:111], v8
v_cvt_pk_bf16_f32 v61, v16, v17
v_add_f32 v24, v24, v26
v_smfmac_f32_16x16x64_bf16 v[28:31], v[72:75], v[240:247], v8
s_waitcnt lgkmcnt(2)
v_add_f32 v25, v25, v27
v_add_f32 v20, v20, v22
v_smfmac_f32_16x16x64_bf16 v[32:35], v[72:75], v[80:87], v8
v_cvt_pk_bf16_f32 v62, v24, v25
v_add_f32 v21, v21, v23
v_smfmac_f32_16x16x64_bf16 v[28:31], v[76:79], v[248:255], v8
s_waitcnt lgkmcnt(0)
v_cvt_pk_bf16_f32 v63, v20, v21
v_permlane16_swap_b32 v60, v61
v_smfmac_f32_16x16x64_bf16 v[32:35], v[76:79], v[88:95], v8
v_permlane16_swap_b32 v62, v63
s_nop 1
v_permlane32_swap_b32 v60, v62
v_permlane32_swap_b32 v61, v63
v_pk_add_f32 v[28:29], v[28:29], v[30:31]
v_bfi_b32 v60, 1, s62, v60
v_cvt_pk_bf16_f32 v64, v28, v29
v_pk_add_f32 v[32:33], v[32:33], v[34:35]
buffer_store_dwordx4 v[60:63], v11, s[8:11], s45 offen
v_cvt_pk_bf16_f32 v65, v32, v33
s_nop 1
v_permlane16_swap_b32 v64, v65
v_bfi_b32 v64, 1, s62, v64
buffer_store_dwordx2 v[64:65], v9, s[8:11], s46 offen
s_cmp_eq_u32 s62, 63
s_cbranch_scc1 Lc_265
s_add_u32 s67, s62, 1
s_and_b32 s67, s67, 3
s_lshl_b32 s67, s67, 1
s_lshl_b32 s68, s67, 15
s_add_u32 s67, s67, s64
s_mul_i32 s67, s67, 10240
s_add_u32 s33, s68, s58
s_add_u32 s32, s67, s80
s_add_u32 s32, s32, 191889408
s_sleep 9
buffer_load_dwordx4 v[96:99], v1, s[8:11], s76 offen offset:0 sc1
buffer_load_dwordx4 v[100:103], v1, s[8:11], s76 offen offset:1024 sc1
s_waitcnt vmcnt(1)
ds_write_b128 v2, v[96:99] offset:0
v_bitop3_b32 v16, v96, v98, s50 bitop3:0x7e
v_cmp_gt_i32 s[16:17], 0, v16
s_waitcnt vmcnt(0)
ds_write_b128 v2, v[100:103] offset:1024
v_bitop3_b32 v17, v100, v102, s50 bitop3:0x7e
v_cmp_gt_i32 s[18:19], 0, v17
s_nop 0
s_or_b64 s[28:29], s[16:17], s[18:19]
s_cbranch_scc1 Lp_271
Lp_272:
s_waitcnt lgkmcnt(0)
s_barrier
s_waitcnt vmcnt(0)
s_cmp_ge_u32 s62, 60
s_cbranch_scc1 Lc_265
Lc_266:
s_add_u32 s62, s62, 1
s_branch Lvo_258
Lg_260:
s_mov_b64 exec, s[16:17]
buffer_load_dwordx4 v[68:71], v1, s[8:11], s32 offen offset:0 sc1
s_mov_b64 exec, s[18:19]
buffer_load_dwordx4 v[72:75], v1, s[8:11], s32 offen offset:1024 sc1
s_mov_b64 exec, -1
s_waitcnt vmcnt(0)
v_max3_u32 v52, v68, v69, v70
v_max3_u32 v53, v72, v73, v74
v_max_u32 v52, v52, v71
v_max_u32 v53, v53, v75
v_cmp_eq_u32 s[16:17], -1, v52
v_cmp_eq_u32 s[18:19], -1, v53
s_nop 0
s_or_b64 s[28:29], s[16:17], s[18:19]
s_cbranch_scc0 Lg_261
s_cmp_eq_u32 s65, 0
s_cbranch_scc1 Lg_261
s_sub_u32 s65, s65, 1
s_branch Lg_260
Lg_262:
Lg_263:
s_mov_b64 exec, s[22:23]
buffer_load_dwordx4 v[112:115], v1, s[8:11], s33 offen offset:0 sc1
s_mov_b64 exec, s[24:25]
buffer_load_dwordx4 v[116:119], v1, s[8:11], s33 offen offset:1024 sc1
s_mov_b64 exec, -1
s_waitcnt vmcnt(0)
v_max3_u32 v52, v112, v113, v114
v_max3_u32 v53, v116, v117, v118
v_max_u32 v52, v52, v115
v_max_u32 v53, v53, v119
v_cmp_eq_u32 s[22:23], -1, v52
v_cmp_eq_u32 s[24:25], -1, v53
s_nop 0
s_or_b64 s[28:29], s[22:23], s[24:25]
s_cbranch_scc0 Lg_264
s_cmp_eq_u32 s65, 0
s_cbranch_scc1 Lg_264
s_sub_u32 s65, s65, 1
s_branch Lg_263
Lp_271:
Lp_274:
s_mov_b64 exec, s[16:17]
buffer_load_dwordx4 v[96:99], v1, s[8:11], s76 offen offset:0 sc1
s_mov_b64 exec, s[18:19]
buffer_load_dwordx4 v[100:103], v1, s[8:11], s76 offen offset:1024 sc1
s_mov_b64 exec, -1
s_waitcnt vmcnt(0)
v_bitop3_b32 v16, v96, v98, s50 bitop3:0x7e
v_bitop3_b32 v19, v97, v99, s50 bitop3:0x7e
v_or_b32 v16, v16, v19
v_cmp_gt_i32 s[16:17], 0, v16
v_bitop3_b32 v17, v100, v102, s50 bitop3:0x7e
v_bitop3_b32 v19, v101, v103, s50 bitop3:0x7e
v_or_b32 v17, v17, v19
v_cmp_gt_i32 s[18:19], 0, v17
s_nop 0
s_or_b64 s[28:29], s[16:17], s[18:19]
s_cbranch_scc0 Lp_275
s_cmp_eq_u32 s65, 0
s_cbranch_scc1 Lp_275
s_sub_u32 s65, s65, 1
s_branch Lp_274
Lp_275:
ds_write_b128 v2, v[96:99] offset:0
ds_write_b128 v2, v[100:103] offset:1024
s_branch Lp_272
Lc_265:
s_lshl_b32 s52, s62, 5
s_add_u32 s52, s52, s63
s_mul_i32 s52, s52, 10240
s_add_u32 s52, s52, 165675008
s_add_u32 s53, s52, 4096
s_add_u32 s54, s52, 8192
buffer_store_dwordx4 v[56:59], v11, s[8:11], s52 offen sc1
buffer_store_dwordx4 v[60:63], v11, s[8:11], s53 offen sc1
buffer_store_dwordx2 v[64:65], v9, s[8:11], s54 offen sc1
s_cmp_lt_u32 s62, 63
s_cbranch_scc1 Lc_266
s_waitcnt vmcnt(0)
s_barrier
s_waitcnt vmcnt(0)
s_endpgm
Lw_182:
s_mov_b32 s62, 0
s_mov_b32 s36, 0x03030303
s_mov_b32 s37, s36
ds_read_b128 v[80:83], v4 offset:12288
ds_read_b128 v[84:87], v4 offset:13312
ds_read_b128 v[88:91], v4 offset:14336
ds_read_b128 v[92:95], v4 offset:15360
ds_read_b128 v[96:99], v4 offset:16384
ds_read_b128 v[100:103], v4 offset:17408
ds_read_b128 v[104:107], v4 offset:0
ds_read_b128 v[108:111], v4 offset:1024
s_bitcmp1_b32 s62, 0
s_cselect_b32 s50, 0x80008000, 0
s_lshl_b32 s48, s5, 7
s_add_u32 s48, s48, 193026048
s_cmp_gt_u32 s62, 60
s_cselect_b32 s48, s48, 536870912
v_mov_b32 v14, s62
v_min_u32 v13, 1, v0
v_lshlrev_b32 v13, 30, v13
v_mov_b32 v15, -1
s_and_b32 s35, s63, 15
s_add_u32 s67, s62, 2
s_and_b32 s67, s67, 3
s_lshl_b32 s67, s67, 1
s_lshl_b32 s53, s67, 15
s_add_u32 s67, s67, s64
s_mul_i32 s52, s67, 10240
s_lshl_b32 s67, s35, 8
s_add_u32 s52, s52, s67
s_add_u32 s53, s53, s67
s_add_u32 s52, s52, 191889408
s_add_u32 s53, s53, s59
s_cmp_ge_u32 s35, 24
s_cselect_b32 s67, 26624, 0
s_add_u32 s53, s53, s67
s_add_u32 s35, s35, 16
s_add_u32 s67, s62, 2
s_and_b32 s67, s67, 3
s_lshl_b32 s67, s67, 1
s_lshl_b32 s55, s67, 15
s_add_u32 s67, s67, s64
s_mul_i32 s54, s67, 10240
s_lshl_b32 s67, s35, 8
s_add_u32 s54, s54, s67
s_add_u32 s55, s55, s67
s_add_u32 s54, s54, 191889408
s_add_u32 s55, s55, s59
s_cmp_ge_u32 s35, 24
s_cselect_b32 s67, 26624, 0
s_add_u32 s55, s55, s67
s_add_u32 s35, s35, 16
s_add_u32 s67, s62, 2
s_and_b32 s67, s67, 3
s_lshl_b32 s67, s67, 1
s_lshl_b32 s57, s67, 15
s_add_u32 s67, s67, s64
s_mul_i32 s56, s67, 10240
s_lshl_b32 s67, s35, 8
s_add_u32 s56, s56, s67
s_add_u32 s57, s57, s67
s_add_u32 s56, s56, 191889408
s_add_u32 s57, s57, s59
s_cmp_ge_u32 s35, 24
s_cselect_b32 s67, 26624, 0
s_add_u32 s57, s57, s67
s_cmp_ge_u32 s35, 40
s_cselect_b32 s56, 536870912, s56
s_cselect_b32 s57, 536870912, s57
v_mov_b64 v[56:57], 0
v_mov_b64 v[58:59], 0
v_mov_b64 v[60:61], 0
v_mov_b64 v[62:63], 0
v_mov_b64 v[64:65], 0
v_mov_b64 v[66:67], 0
v_mov_b64 v[156:157], 0
v_mov_b64 v[158:159], 0
v_mov_b64 v[160:161], 0
v_mov_b64 v[162:163], 0
v_mov_b64 v[164:165], 0
v_mov_b64 v[166:167], 0
v_mov_b64 v[168:169], 0
v_mov_b64 v[170:171], 0
v_mov_b64 v[172:173], 0
v_mov_b64 v[174:175], 0
ds_read_b128 v[16:19], v3 offset:8192
ds_read_b128 v[24:27], v3 offset:9216
s_waitcnt lgkmcnt(0)
s_branch Lvoent_277
Lvo_276:
s_barrier
ds_read_b128 v[80:83], v4 offset:12288
ds_read_b128 v[84:87], v4 offset:13312
ds_read_b128 v[88:91], v4 offset:14336
ds_read_b128 v[92:95], v4 offset:15360
ds_read_b128 v[96:99], v4 offset:16384
ds_read_b128 v[100:103], v4 offset:17408
ds_read_b128 v[104:107], v4 offset:0
ds_read_b128 v[108:111], v4 offset:1024
s_bitcmp1_b32 s62, 0
s_cselect_b32 s50, 0x80008000, 0
s_lshl_b32 s48, s5, 7
s_add_u32 s48, s48, 193026048
s_cmp_gt_u32 s62, 60
s_cselect_b32 s48, s48, 536870912
v_mov_b32 v14, s62
v_min_u32 v13, 1, v0
v_lshlrev_b32 v13, 30, v13
v_mov_b32 v15, -1
s_and_b32 s35, s63, 15
s_add_u32 s67, s62, 2
s_and_b32 s67, s67, 3
s_lshl_b32 s67, s67, 1
s_lshl_b32 s53, s67, 15
s_add_u32 s67, s67, s64
s_mul_i32 s52, s67, 10240
s_lshl_b32 s67, s35, 8
s_add_u32 s52, s52, s67
s_add_u32 s53, s53, s67
s_add_u32 s52, s52, 191889408
s_add_u32 s53, s53, s59
s_cmp_ge_u32 s35, 24
s_cselect_b32 s67, 26624, 0
s_add_u32 s53, s53, s67
s_add_u32 s35, s35, 16
s_add_u32 s67, s62, 2
s_and_b32 s67, s67, 3
s_lshl_b32 s67, s67, 1
s_lshl_b32 s55, s67, 15
s_add_u32 s67, s67, s64
s_mul_i32 s54, s67, 10240
s_lshl_b32 s67, s35, 8
s_add_u32 s54, s54, s67
s_add_u32 s55, s55, s67
s_add_u32 s54, s54, 191889408
s_add_u32 s55, s55, s59
s_cmp_ge_u32 s35, 24
s_cselect_b32 s67, 26624, 0
s_add_u32 s55, s55, s67
s_add_u32 s35, s35, 16
s_add_u32 s67, s62, 2
s_and_b32 s67, s67, 3
s_lshl_b32 s67, s67, 1
s_lshl_b32 s57, s67, 15
s_add_u32 s67, s67, s64
s_mul_i32 s56, s67, 10240
s_lshl_b32 s67, s35, 8
s_add_u32 s56, s56, s67
s_add_u32 s57, s57, s67
s_add_u32 s56, s56, 191889408
s_add_u32 s57, s57, s59
s_cmp_ge_u32 s35, 24
s_cselect_b32 s67, 26624, 0
s_add_u32 s57, s57, s67
s_cmp_ge_u32 s35, 40
s_cselect_b32 s56, 536870912, s56
s_cselect_b32 s57, 536870912, s57
v_mov_b64 v[56:57], 0
v_mov_b64 v[58:59], 0
v_mov_b64 v[60:61], 0
v_mov_b64 v[62:63], 0
v_mov_b64 v[64:65], 0
v_mov_b64 v[66:67], 0
v_mov_b64 v[156:157], 0
v_mov_b64 v[158:159], 0
v_mov_b64 v[160:161], 0
v_mov_b64 v[162:163], 0
v_mov_b64 v[164:165], 0
v_mov_b64 v[166:167], 0
v_mov_b64 v[168:169], 0
v_mov_b64 v[170:171], 0
v_mov_b64 v[172:173], 0
v_mov_b64 v[174:175], 0
s_sleep 1
s_waitcnt lgkmcnt(0)
buffer_load_dwordx4 v[68:71], v1, s[8:11], s32 offen offset:0 sc1
buffer_load_dwordx4 v[72:75], v1, s[8:11], s32 offen offset:1024 sc1
s_waitcnt vmcnt(0)
v_max3_u32 v52, v68, v69, v70
v_max3_u32 v53, v72, v73, v74
v_max_u32 v52, v52, v71
v_max_u32 v53, v53, v75
v_cmp_eq_u32 s[16:17], -1, v52
v_cmp_eq_u32 s[18:19], -1, v53
s_nop 0
s_or_b64 s[28:29], s[16:17], s[18:19]
s_cbranch_scc1 Lg_278
Lg_279:
buffer_load_dwordx4 v[112:115], v1, s[8:11], s33 offen offset:0 sc1
buffer_load_dwordx4 v[116:119], v1, s[8:11], s33 offen offset:1024 sc1
v_lshlrev_b32 v16, 16, v68
v_and_b32 v17, 0xffff0000, v68
v_lshlrev_b32 v18, 16, v69
v_and_b32 v19, 0xffff0000, v69
v_lshlrev_b32 v20, 16, v70
v_and_b32 v21, 0xffff0000, v70
v_lshlrev_b32 v22, 16, v71
v_and_b32 v23, 0xffff0000, v71
v_lshlrev_b32 v24, 16, v72
v_and_b32 v25, 0xffff0000, v72
v_lshlrev_b32 v26, 16, v73
v_and_b32 v27, 0xffff0000, v73
v_lshlrev_b32 v28, 16, v74
v_and_b32 v29, 0xffff0000, v74
v_lshlrev_b32 v30, 16, v75
v_and_b32 v31, 0xffff0000, v75
s_waitcnt vmcnt(0)
v_max3_u32 v52, v112, v113, v114
v_max3_u32 v53, v116, v117, v118
v_max_u32 v52, v52, v115
v_max_u32 v53, v53, v119
v_cmp_eq_u32 s[22:23], -1, v52
v_cmp_eq_u32 s[24:25], -1, v53
s_nop 0
s_or_b64 s[28:29], s[22:23], s[24:25]
s_cbranch_scc1 Lg_280
Lg_282:
v_dot2c_f32_bf16 v16, s100, v112
v_dot2c_f32_bf16 v17, s101, v112
v_dot2c_f32_bf16 v18, s100, v113
v_dot2c_f32_bf16 v19, s101, v113
v_dot2c_f32_bf16 v20, s100, v114
v_dot2c_f32_bf16 v21, s101, v114
v_dot2c_f32_bf16 v22, s100, v115
v_dot2c_f32_bf16 v23, s101, v115
v_cvt_pk_bf16_f32 v16, v16, v17
v_cvt_pk_bf16_f32 v17, v18, v19
v_cvt_pk_bf16_f32 v18, v20, v21
v_cvt_pk_bf16_f32 v19, v22, v23
ds_write_b128 v2, v[16:19] offset:0
v_dot2c_f32_bf16 v24, s100, v116
v_dot2c_f32_bf16 v25, s101, v116
v_dot2c_f32_bf16 v26, s100, v117
v_dot2c_f32_bf16 v27, s101, v117
v_dot2c_f32_bf16 v28, s100, v118
v_dot2c_f32_bf16 v29, s101, v118
v_dot2c_f32_bf16 v30, s100, v119
v_dot2c_f32_bf16 v31, s101, v119
v_cvt_pk_bf16_f32 v24, v24, v25
v_cvt_pk_bf16_f32 v25, v26, v27
v_cvt_pk_bf16_f32 v26, v28, v29
v_cvt_pk_bf16_f32 v27, v30, v31
ds_write_b128 v2, v[24:27] offset:1024
Lvoent_277:
v_smfmac_f32_16x16x64_bf16 v[56:59], v[16:19], a[48:55], v8
v_smfmac_f32_16x16x64_bf16 v[60:63], v[16:19], a[104:111], v8
buffer_store_dword v15, v12, s[8:11], s52 offen
v_smfmac_f32_16x16x64_bf16 v[64:67], v[16:19], a[160:167], v8
v_smfmac_f32_16x16x64_bf16 v[56:59], v[24:27], v[80:87], v8
s_waitcnt lgkmcnt(0)
s_barrier
ds_read_b128 v[20:23], v3 offset:0
v_mov_b64 v[16:17], 0
v_smfmac_f32_16x16x64_bf16 v[60:63], v[24:27], v[88:95], v8
ds_read_b128 v[28:31], v3 offset:1024
ds_read_b128 v[80:83], v4 offset:6144
v_mov_b64 v[18:19], 0
v_smfmac_f32_16x16x64_bf16 v[64:67], v[24:27], v[96:103], v8
ds_read_b128 v[32:35], v3 offset:3072
buffer_store_dword v15, v12, s[8:11], s53 offen sc1
ds_read_b128 v[84:87], v4 offset:7168
s_waitcnt lgkmcnt(4)
v_smfmac_f32_16x16x64_bf16 v[56:59], v[20:23], a[0:7], v8
ds_read_b128 v[36:39], v3 offset:2048
v_mov_b64 v[24:25], 0
v_smfmac_f32_16x16x64_bf16 v[60:63], v[20:23], a[56:63], v8
ds_read_b128 v[40:43], v3 offset:4096
v_mov_b64 v[26:27], 0
v_smfmac_f32_16x16x64_bf16 v[64:67], v[20:23], a[112:119], v8
ds_read_b128 v[44:47], v3 offset:6144
s_waitcnt lgkmcnt(6)
v_smfmac_f32_16x16x64_bf16 v[56:59], v[28:31], a[8:15], v8
ds_read_b128 v[48:51], v3 offset:5120
buffer_store_dword v15, v12, s[8:11], s54 offen
s_waitcnt lgkmcnt(5)
v_mov_b64 v[20:21], 0
v_smfmac_f32_16x16x64_bf16 v[56:59], v[32:35], a[16:23], v8
ds_read_b128 v[52:55], v3 offset:7168
s_waitcnt lgkmcnt(4)
v_mov_b64 v[22:23], 0
v_smfmac_f32_16x16x64_bf16 v[56:59], v[36:39], v[104:111], v8
ds_read_b128 v[88:91], v4 offset:2048
s_waitcnt lgkmcnt(4)
v_smfmac_f32_16x16x64_bf16 v[56:59], v[40:43], a[24:31], v8
ds_read_b128 v[92:95], v4 offset:3072
s_waitcnt lgkmcnt(4)
v_smfmac_f32_16x16x64_bf16 v[56:59], v[44:47], a[32:39], v8
buffer_store_dword v15, v12, s[8:11], s55 offen sc1
ds_read_b128 v[96:99], v4 offset:8192
s_waitcnt lgkmcnt(4)
v_smfmac_f32_16x16x64_bf16 v[56:59], v[48:51], v[80:87], v8
ds_read_b128 v[100:103], v4 offset:9216
s_waitcnt lgkmcnt(4)
v_smfmac_f32_16x16x64_bf16 v[56:59], v[52:55], a[40:47], v8
ds_read_b128 v[104:107], v4 offset:4096
v_smfmac_f32_16x16x64_bf16 v[60:63], v[28:31], a[64:71], v8
ds_read_b128 v[108:111], v4 offset:5120
v_smfmac_f32_16x16x64_bf16 v[60:63], v[32:35], a[72:79], v8
buffer_store_dword v15, v12, s[8:11], s56 offen
ds_read_b128 v[80:83], v4 offset:10240
s_waitcnt lgkmcnt(5)
v_add_f32 v56, v56, v58
v_smfmac_f32_16x16x64_bf16 v[60:63], v[36:39], v[88:95], v8
ds_read_b128 v[84:87], v4 offset:11264
v_add_f32 v57, v57, v59
v_smfmac_f32_16x16x64_bf16 v[60:63], v[40:43], a[80:87], v8
ds_read_b128 v[88:91], v4 offset:18432
v_cvt_pk_bf16_f32 v56, v56, v57
v_smfmac_f32_16x16x64_bf16 v[60:63], v[44:47], a[88:95], v8
ds_read_b128 v[92:95], v4 offset:19456
s_waitcnt lgkmcnt(6)
v_smfmac_f32_16x16x64_bf16 v[60:63], v[48:51], v[96:103], v8
buffer_store_dword v15, v12, s[8:11], s57 offen sc1
ds_read_b128 v[96:99], v4 offset:20480
v_mov_b32_dpp v57, v56 quad_perm:[1,0,3,2] row_mask:0xf bank_mask:0xf
v_smfmac_f32_16x16x64_bf16 v[60:63], v[52:55], a[96:103], v8
ds_read_b128 v[100:103], v4 offset:21504
v_perm_b32 v56, v57, v56, v6
v_smfmac_f32_16x16x64_bf16 v[64:67], v[28:31], a[120:127], v8
ds_write_b32 v5, v56 offset:0
v_smfmac_f32_16x16x64_bf16 v[64:67], v[32:35], a[128:135], v8
s_waitcnt lgkmcnt(7)
v_add_f32 v60, v60, v62
v_smfmac_f32_16x16x64_bf16 v[64:67], v[36:39], v[104:111], v8
ds_read_b128 v[104:107], v4 offset:24576
v_add_f32 v61, v61, v63
v_smfmac_f32_16x16x64_bf16 v[64:67], v[40:43], a[136:143], v8
buffer_store_dword v14, v13, s[8:11], s48 offen sc1
s_waitcnt lgkmcnt(1)
s_barrier
ds_read_b128 v[68:71], v3 offset:12736
v_cvt_pk_bf16_f32 v60, v60, v61
v_smfmac_f32_16x16x64_bf16 v[64:67], v[44:47], a[144:151], v8
ds_read_b128 v[108:111], v4 offset:25600
v_mov_b64 v[28:29], 0
v_smfmac_f32_16x16x64_bf16 v[64:67], v[48:51], v[80:87], v8
ds_read_b128 v[80:83], v4 offset:22528
v_mov_b32_dpp v61, v60 quad_perm:[1,0,3,2] row_mask:0xf bank_mask:0xf
v_smfmac_f32_16x16x64_bf16 v[64:67], v[52:55], a[152:159], v8
ds_read_b128 v[84:87], v4 offset:23552
s_waitcnt lgkmcnt(3)
v_perm_b32 v60, v61, v60, v6
v_smfmac_f32_16x16x64_bf16 v[156:159], v[68:71], a[168:175], v8
ds_write_b32 v5, v60 offset:1024
v_mov_b64 v[30:31], 0
v_smfmac_f32_16x16x64_bf16 v[164:167], v[68:71], a[192:199], v8
v_add_f32 v64, v64, v66
v_add_f32 v65, v65, v67
v_smfmac_f32_16x16x64_bf16 v[160:163], v[68:71], v[88:95], v8
ds_read_b128 v[88:91], v4 offset:26624
v_cvt_pk_bf16_f32 v64, v64, v65
v_smfmac_f32_16x16x64_bf16 v[168:171], v[68:71], a[216:223], v8
s_waitcnt lgkmcnt(1)
s_barrier
ds_read_b128 v[72:75], v3 offset:13760
v_mov_b64 v[32:33], 0
v_smfmac_f32_16x16x64_bf16 v[172:175], v[68:71], a[240:247], v8
ds_read_b128 v[92:95], v4 offset:27648
v_mov_b32_dpp v65, v64 quad_perm:[1,0,3,2] row_mask:0xf bank_mask:0xf
v_perm_b32 v64, v65, v64, v6
v_smfmac_f32_16x16x64_bf16 v[24:27], v[68:71], v[184:191], v8
ds_write_b32 v5, v64 offset:2048
s_waitcnt lgkmcnt(2)
v_mov_b64 v[34:35], 0
v_smfmac_f32_16x16x64_bf16 v[156:159], v[72:75], a[176:183], v8
v_smfmac_f32_16x16x64_bf16 v[164:167], v[72:75], a[200:207], v8
v_smfmac_f32_16x16x64_bf16 v[160:163], v[72:75], v[96:103], v8
s_waitcnt lgkmcnt(0)
s_barrier
ds_read_b128 v[76:79], v3 offset:14784
v_smfmac_f32_16x16x64_bf16 v[168:171], v[72:75], a[224:231], v8
ds_read_b128 v[96:99], v4 offset:28672
v_smfmac_f32_16x16x64_bf16 v[16:19], v[68:71], v[104:111], v8
ds_read_b128 v[100:103], v4 offset:29696
v_smfmac_f32_16x16x64_bf16 v[20:23], v[68:71], v[208:215], v8
ds_read_b128 v[104:107], v4 offset:30720
s_waitcnt lgkmcnt(3)
v_smfmac_f32_16x16x64_bf16 v[156:159], v[76:79], a[184:191], v8
ds_read_b128 v[108:111], v4 offset:31744
v_smfmac_f32_16x16x64_bf16 v[160:163], v[76:79], v[80:87], v8
ds_read_b128 v[80:83], v4 offset:32768
v_smfmac_f32_16x16x64_bf16 v[164:167], v[76:79], a[208:215], v8
ds_read_b128 v[84:87], v4 offset:33792
v_add_f32 v156, v156, v158
v_add_f32 v157, v157, v159
v_smfmac_f32_16x16x64_bf16 v[168:171], v[76:79], a[232:239], v8
v_cvt_pk_bf16_f32 v56, v156, v157
v_add_f32 v160, v160, v162
v_smfmac_f32_16x16x64_bf16 v[172:175], v[72:75], a[248:255], v8
v_add_f32 v161, v161, v163
v_add_f32 v164, v164, v166
v_smfmac_f32_16x16x64_bf16 v[16:19], v[72:75], v[88:95], v8
ds_read_b128 v[88:91], v4 offset:34816
v_cvt_pk_bf16_f32 v57, v160, v161
v_add_f32 v165, v165, v167
v_smfmac_f32_16x16x64_bf16 v[172:175], v[76:79], v[176:183], v8
ds_read_b128 v[92:95], v4 offset:35840
v_cvt_pk_bf16_f32 v58, v164, v165
v_add_f32 v168, v168, v170
v_smfmac_f32_16x16x64_bf16 v[24:27], v[72:75], v[192:199], v8
s_waitcnt lgkmcnt(6)
v_add_f32 v169, v169, v171
v_permlane16_swap_b32 v56, v57
v_smfmac_f32_16x16x64_bf16 v[16:19], v[76:79], v[96:103], v8
v_cvt_pk_bf16_f32 v59, v168, v169
v_add_f32 v172, v172, v174
v_smfmac_f32_16x16x64_bf16 v[20:23], v[72:75], v[216:223], v8
v_permlane16_swap_b32 v58, v59
v_add_f32 v173, v173, v175
v_smfmac_f32_16x16x64_bf16 v[24:27], v[76:79], v[200:207], v8
v_permlane32_swap_b32 v56, v58
v_permlane32_swap_b32 v57, v59
v_smfmac_f32_16x16x64_bf16 v[28:31], v[68:71], v[232:239], v8
v_bfi_b32 v56, 1, s62, v56
v_cvt_pk_bf16_f32 v60, v172, v173
v_smfmac_f32_16x16x64_bf16 v[20:23], v[76:79], v[224:231], v8
buffer_store_dwordx4 v[56:59], v11, s[8:11], s44 offen
s_waitcnt lgkmcnt(4)
v_add_f32 v16, v16, v18
v_add_f32 v17, v17, v19
v_smfmac_f32_16x16x64_bf16 v[32:35], v[68:71], v[104:111], v8
v_cvt_pk_bf16_f32 v61, v16, v17
v_add_f32 v24, v24, v26
v_smfmac_f32_16x16x64_bf16 v[28:31], v[72:75], v[240:247], v8
s_waitcnt lgkmcnt(2)
v_add_f32 v25, v25, v27
v_add_f32 v20, v20, v22
v_smfmac_f32_16x16x64_bf16 v[32:35], v[72:75], v[80:87], v8
v_cvt_pk_bf16_f32 v62, v24, v25
v_add_f32 v21, v21, v23
v_smfmac_f32_16x16x64_bf16 v[28:31], v[76:79], v[248:255], v8
s_waitcnt lgkmcnt(0)
v_cvt_pk_bf16_f32 v63, v20, v21
v_permlane16_swap_b32 v60, v61
v_smfmac_f32_16x16x64_bf16 v[32:35], v[76:79], v[88:95], v8
v_permlane16_swap_b32 v62, v63
s_nop 1
v_permlane32_swap_b32 v60, v62
v_permlane32_swap_b32 v61, v63
v_pk_add_f32 v[28:29], v[28:29], v[30:31]
v_bfi_b32 v60, 1, s62, v60
v_cvt_pk_bf16_f32 v64, v28, v29
v_pk_add_f32 v[32:33], v[32:33], v[34:35]
buffer_store_dwordx4 v[60:63], v11, s[8:11], s45 offen
v_cvt_pk_bf16_f32 v65, v32, v33
s_nop 1
v_permlane16_swap_b32 v64, v65
v_bfi_b32 v64, 1, s62, v64
buffer_store_dwordx2 v[64:65], v9, s[8:11], s46 offen
s_cmp_eq_u32 s62, 63
s_cbranch_scc1 Lc_283
s_add_u32 s67, s62, 1
s_and_b32 s67, s67, 3
s_lshl_b32 s67, s67, 1
s_lshl_b32 s68, s67, 15
s_add_u32 s67, s67, s64
s_mul_i32 s67, s67, 10240
s_add_u32 s33, s68, s58
s_add_u32 s32, s67, s80
s_add_u32 s32, s32, 191889408
s_sleep 9
buffer_load_dwordx4 v[96:99], v1, s[8:11], s76 offen offset:0 sc1
buffer_load_dwordx4 v[100:103], v1, s[8:11], s76 offen offset:1024 sc1
s_waitcnt vmcnt(1)
ds_write_b128 v2, v[96:99] offset:0
v_bitop3_b32 v16, v96, v98, s50 bitop3:0x7e
v_bitop3_b32 v19, v97, v99, s50 bitop3:0x7e
v_or_b32 v16, v16, v19
v_cmp_gt_i32 s[16:17], 0, v16
s_waitcnt vmcnt(0)
ds_write_b128 v2, v[100:103] offset:1024
v_bitop3_b32 v17, v100, v102, s50 bitop3:0x7e
v_bitop3_b32 v19, v101, v103, s50 bitop3:0x7e
v_or_b32 v17, v17, v19
v_cmp_gt_i32 s[18:19], 0, v17
s_nop 0
s_or_b64 s[28:29], s[16:17], s[18:19]
s_cbranch_scc1 Lp_289
Lp_290:
s_waitcnt lgkmcnt(0)
s_barrier
s_waitcnt vmcnt(0)
s_cmp_ge_u32 s62, 60
s_cbranch_scc1 Lc_283
Lc_284:
s_add_u32 s62, s62, 1
s_branch Lvo_276
Lg_278:
s_mov_b64 exec, s[16:17]
buffer_load_dwordx4 v[68:71], v1, s[8:11], s32 offen offset:0 sc1
s_mov_b64 exec, s[18:19]
buffer_load_dwordx4 v[72:75], v1, s[8:11], s32 offen offset:1024 sc1
s_mov_b64 exec, -1
s_waitcnt vmcnt(0)
v_max3_u32 v52, v68, v69, v70
v_max3_u32 v53, v72, v73, v74
v_max_u32 v52, v52, v71
v_max_u32 v53, v53, v75
v_cmp_eq_u32 s[16:17], -1, v52
v_cmp_eq_u32 s[18:19], -1, v53
s_nop 0
s_or_b64 s[28:29], s[16:17], s[18:19]
s_cbranch_scc0 Lg_279
s_cmp_eq_u32 s65, 0
s_cbranch_scc1 Lg_279
s_sub_u32 s65, s65, 1
s_branch Lg_278
Lg_280:
Lg_281:
s_mov_b64 exec, s[22:23]
buffer_load_dwordx4 v[112:115], v1, s[8:11], s33 offen offset:0 sc1
s_mov_b64 exec, s[24:25]
buffer_load_dwordx4 v[116:119], v1, s[8:11], s33 offen offset:1024 sc1
s_mov_b64 exec, -1
s_waitcnt vmcnt(0)
v_max3_u32 v52, v112, v113, v114
v_max3_u32 v53, v116, v117, v118
v_max_u32 v52, v52, v115
v_max_u32 v53, v53, v119
v_cmp_eq_u32 s[22:23], -1, v52
v_cmp_eq_u32 s[24:25], -1, v53
s_nop 0
s_or_b64 s[28:29], s[22:23], s[24:25]
s_cbranch_scc0 Lg_282
s_cmp_eq_u32 s65, 0
s_cbranch_scc1 Lg_282
s_sub_u32 s65, s65, 1
s_branch Lg_281
Lp_289:
Lp_292:
s_mov_b64 exec, s[16:17]
buffer_load_dwordx4 v[96:99], v1, s[8:11], s76 offen offset:0 sc1
s_mov_b64 exec, s[18:19]
buffer_load_dwordx4 v[100:103], v1, s[8:11], s76 offen offset:1024 sc1
s_mov_b64 exec, -1
s_waitcnt vmcnt(0)
v_bitop3_b32 v16, v96, v98, s50 bitop3:0x7e
v_bitop3_b32 v19, v97, v99, s50 bitop3:0x7e
v_or_b32 v16, v16, v19
v_cmp_gt_i32 s[16:17], 0, v16
v_bitop3_b32 v17, v100, v102, s50 bitop3:0x7e
v_bitop3_b32 v19, v101, v103, s50 bitop3:0x7e
v_or_b32 v17, v17, v19
v_cmp_gt_i32 s[18:19], 0, v17
s_nop 0
s_or_b64 s[28:29], s[16:17], s[18:19]
s_cbranch_scc0 Lp_293
s_cmp_eq_u32 s65, 0
s_cbranch_scc1 Lp_293
s_sub_u32 s65, s65, 1
s_branch Lp_292
Lp_293:
ds_write_b128 v2, v[96:99] offset:0
ds_write_b128 v2, v[100:103] offset:1024
s_branch Lp_290
Lc_283:
s_lshl_b32 s52, s62, 5
s_add_u32 s52, s52, s63
s_mul_i32 s52, s52, 10240
s_add_u32 s52, s52, 165675008
s_add_u32 s53, s52, 4096
s_add_u32 s54, s52, 8192
buffer_store_dwordx4 v[56:59], v11, s[8:11], s52 offen sc1
buffer_store_dwordx4 v[60:63], v11, s[8:11], s53 offen sc1
buffer_store_dwordx2 v[64:65], v9, s[8:11], s54 offen sc1
s_cmp_lt_u32 s62, 63
s_cbranch_scc1 Lc_284
s_waitcnt vmcnt(0)
s_barrier
s_waitcnt vmcnt(0)
s_lshl_b32 s67, s5, 7
s_add_u32 s67, s67, 193026048
s_add_u32 s68, s62, 1
v_mov_b32 v13, s68
v_mov_b32 v14, 0
s_mov_b64 exec, 1
buffer_store_dword v13, v14, s[8:11], s67 offen sc1
s_mov_b64 exec, -1
s_waitcnt vmcnt(0)
s_endpgm
Lslow_176:
s_cmp_eq_u32 s3, 1
s_cbranch_scc1 Lw_295
s_cmp_eq_u32 s3, 3
s_cbranch_scc1 Lw_298
s_cmp_ge_u32 s66, 40
s_cbranch_scc1 Lw_297
s_cmp_eq_u32 s3, 2
s_cbranch_scc1 Lw_296
Lw_294:
s_mov_b32 s62, 0
s_mov_b32 s36, 0x03030303
s_mov_b32 s37, s36
ds_read_b128 v[80:83], v4 offset:0
ds_read_b128 v[84:87], v4 offset:1024
ds_read_b128 v[88:91], v4 offset:2048
ds_read_b128 v[92:95], v4 offset:3072
ds_read_b128 v[96:99], v4 offset:4096
ds_read_b128 v[100:103], v4 offset:5120
ds_read_b128 v[104:107], v4 offset:6144
ds_read_b128 v[108:111], v4 offset:7168
s_bitcmp1_b32 s62, 0
s_cselect_b32 s50, 0x80008000, 0
s_add_u32 s67, s62, 1
s_and_b32 s67, s67, 3
s_lshl_b32 s67, s67, 1
s_lshl_b32 s78, s67, 15
s_add_u32 s67, s67, s64
s_mul_i32 s77, s67, 10240
s_lshl_b32 s67, s66, 8
s_add_u32 s77, s77, s67
s_add_u32 s78, s78, s67
s_add_u32 s77, s77, 191889408
s_add_u32 s78, s78, s59
s_cmp_ge_u32 s66, 24
s_cselect_b32 s67, 26624, 0
s_add_u32 s78, s78, s67
s_mov_b32 s82, s62
s_mul_i32 s83, s82, 1638400
s_add_u32 s83, s83, s47
s_cmp_eq_u32 s62, 63
s_cselect_b32 s83, 536870912, s83
v_mov_b64 v[56:57], 0
v_mov_b64 v[58:59], 0
v_mov_b64 v[60:61], 0
v_mov_b64 v[62:63], 0
v_mov_b64 v[64:65], 0
v_mov_b64 v[66:67], 0
v_mov_b64 v[156:157], 0
v_mov_b64 v[158:159], 0
v_mov_b64 v[160:161], 0
v_mov_b64 v[162:163], 0
v_mov_b64 v[164:165], 0
v_mov_b64 v[166:167], 0
v_mov_b64 v[168:169], 0
v_mov_b64 v[170:171], 0
v_mov_b64 v[172:173], 0
v_mov_b64 v[174:175], 0
s_cmp_ge_u32 s62, 3
s_cbranch_scc1 Lk_301
s_sub_u32 s61, s82, 12
s_max_i32 s61, s61, 0
s_lshr_b32 s61, s61, 2
s_add_u32 s61, s61, s82
s_cmp_gt_u32 s60, s61
s_cbranch_scc1 Lfd_303
v_and_b32 v14, 15, v0
v_lshlrev_b32 v14, 7, v14
Lf_302:
buffer_load_dword v13, v14, s[8:11], s81 offen sc1
s_waitcnt vmcnt(0)
v_min_u32_dpp v13, v13, v13 row_ror:8 row_mask:0xf bank_mask:0xf
s_nop 1
v_min_u32_dpp v13, v13, v13 row_ror:4 row_mask:0xf bank_mask:0xf
s_nop 1
v_min_u32_dpp v13, v13, v13 row_ror:2 row_mask:0xf bank_mask:0xf
s_nop 1
v_min_u32_dpp v13, v13, v13 row_ror:1 row_mask:0xf bank_mask:0xf
s_nop 0
v_readfirstlane_b32 s60, v13
s_nop 0
s_cmp_gt_u32 s60, s61
s_cbranch_scc1 Lfd_303
s_cmp_eq_u32 s65, 0
s_cbranch_scc1 Lfd_303
s_sub_u32 s65, s65, 1
s_branch Lf_302
Lfd_303:
Lk_301:
ds_read_b128 v[16:19], v3 offset:0
ds_read_b128 v[24:27], v3 offset:1024
ds_read_b128 v[32:35], v3 offset:2048
s_waitcnt lgkmcnt(0)
s_branch Lvoent_300
Lvo_299:
s_barrier
ds_read_b128 v[80:83], v4 offset:0
ds_read_b128 v[84:87], v4 offset:1024
ds_read_b128 v[88:91], v4 offset:2048
ds_read_b128 v[92:95], v4 offset:3072
ds_read_b128 v[96:99], v4 offset:4096
ds_read_b128 v[100:103], v4 offset:5120
ds_read_b128 v[104:107], v4 offset:6144
ds_read_b128 v[108:111], v4 offset:7168
s_bitcmp1_b32 s62, 0
s_cselect_b32 s50, 0x80008000, 0
s_add_u32 s67, s62, 1
s_and_b32 s67, s67, 3
s_lshl_b32 s67, s67, 1
s_lshl_b32 s78, s67, 15
s_add_u32 s67, s67, s64
s_mul_i32 s77, s67, 10240
s_lshl_b32 s67, s66, 8
s_add_u32 s77, s77, s67
s_add_u32 s78, s78, s67
s_add_u32 s77, s77, 191889408
s_add_u32 s78, s78, s59
s_cmp_ge_u32 s66, 24
s_cselect_b32 s67, 26624, 0
s_add_u32 s78, s78, s67
s_mov_b32 s82, s62
s_mul_i32 s83, s82, 1638400
s_add_u32 s83, s83, s47
s_cmp_eq_u32 s62, 63
s_cselect_b32 s83, 536870912, s83
v_mov_b64 v[56:57], 0
v_mov_b64 v[58:59], 0
v_mov_b64 v[60:61], 0
v_mov_b64 v[62:63], 0
v_mov_b64 v[64:65], 0
v_mov_b64 v[66:67], 0
v_mov_b64 v[156:157], 0
v_mov_b64 v[158:159], 0
v_mov_b64 v[160:161], 0
v_mov_b64 v[162:163], 0
v_mov_b64 v[164:165], 0
v_mov_b64 v[166:167], 0
v_mov_b64 v[168:169], 0
v_mov_b64 v[170:171], 0
v_mov_b64 v[172:173], 0
v_mov_b64 v[174:175], 0
s_cmp_ge_u32 s62, 3
s_cbranch_scc1 Lk_304
s_sub_u32 s61, s82, 12
s_max_i32 s61, s61, 0
s_lshr_b32 s61, s61, 2
s_add_u32 s61, s61, s82
s_cmp_gt_u32 s60, s61
s_cbranch_scc1 Lfd_306
v_and_b32 v14, 15, v0
v_lshlrev_b32 v14, 7, v14
Lf_305:
buffer_load_dword v13, v14, s[8:11], s81 offen sc1
s_waitcnt vmcnt(0)
v_min_u32_dpp v13, v13, v13 row_ror:8 row_mask:0xf bank_mask:0xf
s_nop 1
v_min_u32_dpp v13, v13, v13 row_ror:4 row_mask:0xf bank_mask:0xf
s_nop 1
v_min_u32_dpp v13, v13, v13 row_ror:2 row_mask:0xf bank_mask:0xf
s_nop 1
v_min_u32_dpp v13, v13, v13 row_ror:1 row_mask:0xf bank_mask:0xf
s_nop 0
v_readfirstlane_b32 s60, v13
s_nop 0
s_cmp_gt_u32 s60, s61
s_cbranch_scc1 Lfd_306
s_cmp_eq_u32 s65, 0
s_cbranch_scc1 Lfd_306
s_sub_u32 s65, s65, 1
s_branch Lf_305
Lfd_306:
Lk_304:
s_sleep 1
s_waitcnt lgkmcnt(0)
buffer_load_dwordx4 v[68:71], v1, s[8:11], s32 offen offset:0 sc1
buffer_load_dwordx4 v[72:75], v1, s[8:11], s32 offen offset:1024 sc1
buffer_load_dwordx4 v[76:79], v1, s[8:11], s32 offen offset:2048 sc1
s_waitcnt vmcnt(0)
v_max3_u32 v52, v68, v69, v70
v_max3_u32 v53, v72, v73, v74
v_max3_u32 v54, v76, v77, v78
v_max_u32 v52, v52, v71
v_max_u32 v53, v53, v75
v_max_u32 v54, v54, v79
v_cmp_eq_u32 s[16:17], -1, v52
v_cmp_eq_u32 s[18:19], -1, v53
v_cmp_eq_u32 s[20:21], -1, v54
s_or_b64 s[28:29], s[16:17], s[18:19]
s_or_b64 s[28:29], s[28:29], s[20:21]
s_cbranch_scc1 Lg_307
Lg_308:
buffer_load_dwordx4 v[112:115], v1, s[8:11], s33 offen offset:0 sc1
buffer_load_dwordx4 v[116:119], v1, s[8:11], s33 offen offset:1024 sc1
buffer_load_dwordx4 v[120:123], v1, s[8:11], s33 offen offset:2048 sc1
v_lshlrev_b32 v16, 16, v68
v_and_b32 v17, 0xffff0000, v68
v_lshlrev_b32 v18, 16, v69
v_and_b32 v19, 0xffff0000, v69
v_lshlrev_b32 v20, 16, v70
v_and_b32 v21, 0xffff0000, v70
v_lshlrev_b32 v22, 16, v71
v_and_b32 v23, 0xffff0000, v71
v_lshlrev_b32 v24, 16, v72
v_and_b32 v25, 0xffff0000, v72
v_lshlrev_b32 v26, 16, v73
v_and_b32 v27, 0xffff0000, v73
v_lshlrev_b32 v28, 16, v74
v_and_b32 v29, 0xffff0000, v74
v_lshlrev_b32 v30, 16, v75
v_and_b32 v31, 0xffff0000, v75
v_lshlrev_b32 v32, 16, v76
v_and_b32 v33, 0xffff0000, v76
v_lshlrev_b32 v34, 16, v77
v_and_b32 v35, 0xffff0000, v77
v_lshlrev_b32 v36, 16, v78
v_and_b32 v37, 0xffff0000, v78
v_lshlrev_b32 v38, 16, v79
v_and_b32 v39, 0xffff0000, v79
s_waitcnt vmcnt(0)
v_max3_u32 v52, v112, v113, v114
v_max3_u32 v53, v116, v117, v118
v_max3_u32 v54, v120, v121, v122
v_max_u32 v52, v52, v115
v_max_u32 v53, v53, v119
v_max_u32 v54, v54, v123
v_cmp_eq_u32 s[22:23], -1, v52
v_cmp_eq_u32 s[24:25], -1, v53
v_cmp_eq_u32 s[26:27], -1, v54
s_or_b64 s[28:29], s[22:23], s[24:25]
s_or_b64 s[28:29], s[28:29], s[26:27]
s_cbranch_scc1 Lg_309
Lg_311:
v_dot2c_f32_bf16 v16, s100, v112
v_dot2c_f32_bf16 v17, s101, v112
v_dot2c_f32_bf16 v18, s100, v113
v_dot2c_f32_bf16 v19, s101, v113
v_dot2c_f32_bf16 v20, s100, v114
v_dot2c_f32_bf16 v21, s101, v114
v_dot2c_f32_bf16 v22, s100, v115
v_dot2c_f32_bf16 v23, s101, v115
v_cvt_pk_bf16_f32 v16, v16, v17
v_cvt_pk_bf16_f32 v17, v18, v19
v_cvt_pk_bf16_f32 v18, v20, v21
v_cvt_pk_bf16_f32 v19, v22, v23
ds_write_b128 v2, v[16:19] offset:0
v_dot2c_f32_bf16 v24, s100, v116
v_dot2c_f32_bf16 v25, s101, v116
v_dot2c_f32_bf16 v26, s100, v117
v_dot2c_f32_bf16 v27, s101, v117
v_dot2c_f32_bf16 v28, s100, v118
v_dot2c_f32_bf16 v29, s101, v118
v_dot2c_f32_bf16 v30, s100, v119
v_dot2c_f32_bf16 v31, s101, v119
v_cvt_pk_bf16_f32 v24, v24, v25
v_cvt_pk_bf16_f32 v25, v26, v27
v_cvt_pk_bf16_f32 v26, v28, v29
v_cvt_pk_bf16_f32 v27, v30, v31
ds_write_b128 v2, v[24:27] offset:1024
v_dot2c_f32_bf16 v32, s100, v120
v_dot2c_f32_bf16 v33, s101, v120
v_dot2c_f32_bf16 v34, s100, v121
v_dot2c_f32_bf16 v35, s101, v121
v_dot2c_f32_bf16 v36, s100, v122
v_dot2c_f32_bf16 v37, s101, v122
v_dot2c_f32_bf16 v38, s100, v123
v_dot2c_f32_bf16 v39, s101, v123
v_cvt_pk_bf16_f32 v32, v32, v33
v_cvt_pk_bf16_f32 v33, v34, v35
v_cvt_pk_bf16_f32 v34, v36, v37
v_cvt_pk_bf16_f32 v35, v38, v39
ds_write_b128 v2, v[32:35] offset:2048
Lvoent_300:
v_smfmac_f32_16x16x64_bf16 v[56:59], v[16:19], a[0:7], v8
v_smfmac_f32_16x16x64_bf16 v[60:63], v[16:19], a[56:63], v8
buffer_load_dwordx4 v[112:115], v1, s[8:11], s83 offen offset:0 sc1
v_smfmac_f32_16x16x64_bf16 v[64:67], v[16:19], a[112:119], v8
v_smfmac_f32_16x16x64_bf16 v[56:59], v[24:27], a[8:15], v8
s_waitcnt lgkmcnt(0)
s_barrier
ds_read_b128 v[20:23], v3 offset:3072
v_mov_b64 v[16:17], 0
v_smfmac_f32_16x16x64_bf16 v[60:63], v[24:27], a[64:71], v8
ds_read_b128 v[28:31], v3 offset:4096
buffer_load_dwordx4 v[116:119], v1, s[8:11], s83 offen offset:1024 sc1
v_mov_b64 v[18:19], 0
v_smfmac_f32_16x16x64_bf16 v[64:67], v[24:27], a[120:127], v8
ds_read_b128 v[36:39], v3 offset:5120
v_smfmac_f32_16x16x64_bf16 v[56:59], v[32:35], v[80:87], v8
ds_read_b128 v[40:43], v3 offset:6144
v_mov_b64 v[24:25], 0
v_smfmac_f32_16x16x64_bf16 v[60:63], v[32:35], v[88:95], v8
ds_read_b128 v[44:47], v3 offset:7168
buffer_load_dwordx4 v[120:123], v1, s[8:11], s83 offen offset:2048 sc1
ds_read_b128 v[80:83], v4 offset:12288
v_mov_b64 v[26:27], 0
v_smfmac_f32_16x16x64_bf16 v[64:67], v[32:35], v[96:103], v8
ds_read_b128 v[48:51], v3 offset:9216
ds_read_b128 v[84:87], v4 offset:13312
s_waitcnt lgkmcnt(7)
v_smfmac_f32_16x16x64_bf16 v[56:59], v[20:23], a[16:23], v8
ds_read_b128 v[52:55], v3 offset:8192
s_waitcnt lgkmcnt(7)
v_mov_b64 v[32:33], 0
v_smfmac_f32_16x16x64_bf16 v[56:59], v[28:31], a[24:31], v8
buffer_load_dwordx4 v[124:127], v1, s[8:11], s83 offen offset:3072 sc1
ds_read_b128 v[88:91], v4 offset:8192
s_waitcnt lgkmcnt(7)
v_mov_b64 v[34:35], 0
v_smfmac_f32_16x16x64_bf16 v[56:59], v[36:39], v[104:111], v8
s_add_u32 s83, s83, 4096
ds_read_b128 v[92:95], v4 offset:9216
s_waitcnt lgkmcnt(7)
v_smfmac_f32_16x16x64_bf16 v[56:59], v[40:43], a[32:39], v8
ds_read_b128 v[96:99], v4 offset:14336
s_waitcnt lgkmcnt(7)
v_smfmac_f32_16x16x64_bf16 v[56:59], v[44:47], a[40:47], v8
buffer_load_dwordx4 v[128:131], v1, s[8:11], s83 offen offset:0 sc1
ds_read_b128 v[100:103], v4 offset:15360
s_waitcnt lgkmcnt(5)
v_smfmac_f32_16x16x64_bf16 v[56:59], v[48:51], v[80:87], v8
ds_read_b128 v[104:107], v4 offset:10240
s_waitcnt lgkmcnt(5)
v_smfmac_f32_16x16x64_bf16 v[56:59], v[52:55], a[48:55], v8
ds_read_b128 v[108:111], v4 offset:11264
v_smfmac_f32_16x16x64_bf16 v[60:63], v[20:23], a[72:79], v8
buffer_load_dwordx4 v[132:135], v1, s[8:11], s83 offen offset:1024 sc1
ds_read_b128 v[80:83], v4 offset:16384
v_smfmac_f32_16x16x64_bf16 v[60:63], v[28:31], a[80:87], v8
ds_read_b128 v[84:87], v4 offset:17408
s_waitcnt lgkmcnt(6)
v_add_f32 v56, v56, v58
v_smfmac_f32_16x16x64_bf16 v[60:63], v[36:39], v[88:95], v8
ds_read_b128 v[88:91], v4 offset:18432
v_add_f32 v57, v57, v59
v_smfmac_f32_16x16x64_bf16 v[60:63], v[40:43], a[88:95], v8
buffer_load_dwordx4 v[136:139], v1, s[8:11], s83 offen offset:2048 sc1
ds_read_b128 v[92:95], v4 offset:19456
v_cvt_pk_bf16_f32 v56, v56, v57
v_smfmac_f32_16x16x64_bf16 v[60:63], v[44:47], a[96:103], v8
s_waitcnt lgkmcnt(6)
v_smfmac_f32_16x16x64_bf16 v[60:63], v[48:51], v[96:103], v8
ds_read_b128 v[96:99], v4 offset:20480
v_mov_b32_dpp v57, v56 quad_perm:[1,0,3,2] row_mask:0xf bank_mask:0xf
v_smfmac_f32_16x16x64_bf16 v[60:63], v[52:55], a[104:111], v8
buffer_load_dwordx4 v[140:143], v1, s[8:11], s83 offen offset:3072 sc1
ds_read_b128 v[100:103], v4 offset:21504
v_perm_b32 v56, v57, v56, v6
v_smfmac_f32_16x16x64_bf16 v[64:67], v[20:23], a[128:135], v8
s_add_u32 s83, s83, 4096
ds_write_b32 v5, v56 offset:0
v_smfmac_f32_16x16x64_bf16 v[64:67], v[28:31], a[136:143], v8
s_waitcnt lgkmcnt(7)
v_add_f32 v60, v60, v62
v_smfmac_f32_16x16x64_bf16 v[64:67], v[36:39], v[104:111], v8
buffer_load_dwordx4 v[144:147], v1, s[8:11], s83 offen offset:0 sc1
ds_read_b128 v[104:107], v4 offset:24576
v_add_f32 v61, v61, v63
v_smfmac_f32_16x16x64_bf16 v[64:67], v[40:43], a[144:151], v8
s_waitcnt lgkmcnt(1)
s_barrier
ds_read_b128 v[68:71], v3 offset:12736
v_cvt_pk_bf16_f32 v60, v60, v61
v_smfmac_f32_16x16x64_bf16 v[64:67], v[44:47], a[152:159], v8
ds_read_b128 v[108:111], v4 offset:25600
v_mov_b64 v[20:21], 0
v_smfmac_f32_16x16x64_bf16 v[64:67], v[48:51], v[80:87], v8
buffer_load_dwordx4 v[148:151], v1, s[8:11], s83 offen offset:1024 sc1
ds_read_b128 v[80:83], v4 offset:22528
v_mov_b32_dpp v61, v60 quad_perm:[1,0,3,2] row_mask:0xf bank_mask:0xf
v_smfmac_f32_16x16x64_bf16 v[64:67], v[52:55], a[160:167], v8
ds_read_b128 v[84:87], v4 offset:23552
s_waitcnt lgkmcnt(3)
v_perm_b32 v60, v61, v60, v6
v_smfmac_f32_16x16x64_bf16 v[156:159], v[68:71], a[168:175], v8
ds_write_b32 v5, v60 offset:1024
v_mov_b64 v[22:23], 0
v_smfmac_f32_16x16x64_bf16 v[164:167], v[68:71], a[192:199], v8
buffer_load_dwordx4 v[152:155], v1, s[8:11], s83 offen offset:2048 sc1
v_add_f32 v64, v64, v66
v_add_f32 v65, v65, v67
v_smfmac_f32_16x16x64_bf16 v[160:163], v[68:71], v[88:95], v8
ds_read_b128 v[88:91], v4 offset:26624
v_cvt_pk_bf16_f32 v64, v64, v65
v_smfmac_f32_16x16x64_bf16 v[168:171], v[68:71], a[216:223], v8
s_waitcnt lgkmcnt(1)
s_barrier
ds_read_b128 v[72:75], v3 offset:13760
v_mov_b64 v[28:29], 0
v_smfmac_f32_16x16x64_bf16 v[172:175], v[68:71], a[240:247], v8
ds_read_b128 v[92:95], v4 offset:27648
v_mov_b32_dpp v65, v64 quad_perm:[1,0,3,2] row_mask:0xf bank_mask:0xf
v_perm_b32 v64, v65, v64, v6
v_smfmac_f32_16x16x64_bf16 v[24:27], v[68:71], v[184:191], v8
ds_write_b32 v5, v64 offset:2048
s_waitcnt lgkmcnt(2)
v_mov_b64 v[30:31], 0
v_smfmac_f32_16x16x64_bf16 v[156:159], v[72:75], a[176:183], v8
v_smfmac_f32_16x16x64_bf16 v[164:167], v[72:75], a[200:207], v8
v_smfmac_f32_16x16x64_bf16 v[160:163], v[72:75], v[96:103], v8
s_waitcnt lgkmcnt(0)
s_barrier
ds_read_b128 v[76:79], v3 offset:14784
v_smfmac_f32_16x16x64_bf16 v[168:171], v[72:75], a[224:231], v8
ds_read_b128 v[96:99], v4 offset:28672
v_smfmac_f32_16x16x64_bf16 v[16:19], v[68:71], v[104:111], v8
ds_read_b128 v[100:103], v4 offset:29696
v_smfmac_f32_16x16x64_bf16 v[32:35], v[68:71], v[208:215], v8
ds_read_b128 v[104:107], v4 offset:30720
s_waitcnt lgkmcnt(3)
v_smfmac_f32_16x16x64_bf16 v[156:159], v[76:79], a[184:191], v8
ds_read_b128 v[108:111], v4 offset:31744
v_smfmac_f32_16x16x64_bf16 v[160:163], v[76:79], v[80:87], v8
ds_read_b128 v[80:83], v4 offset:32768
v_smfmac_f32_16x16x64_bf16 v[164:167], v[76:79], a[208:215], v8
ds_read_b128 v[84:87], v4 offset:33792
v_add_f32 v156, v156, v158
v_add_f32 v157, v157, v159
v_smfmac_f32_16x16x64_bf16 v[168:171], v[76:79], a[232:239], v8
v_cvt_pk_bf16_f32 v56, v156, v157
v_add_f32 v160, v160, v162
v_smfmac_f32_16x16x64_bf16 v[172:175], v[72:75], a[248:255], v8
buffer_load_dwordx4 v[156:159], v1, s[8:11], s83 offen offset:3072 sc1
s_add_u32 s83, s83, 4096
v_add_f32 v161, v161, v163
v_add_f32 v164, v164, v166
v_smfmac_f32_16x16x64_bf16 v[16:19], v[72:75], v[88:95], v8
ds_read_b128 v[88:91], v4 offset:34816
v_cvt_pk_bf16_f32 v57, v160, v161
v_add_f32 v165, v165, v167
v_smfmac_f32_16x16x64_bf16 v[172:175], v[76:79], v[176:183], v8
buffer_load_dwordx4 v[160:163], v1, s[8:11], s83 offen offset:0 sc1
ds_read_b128 v[92:95], v4 offset:35840
v_cvt_pk_bf16_f32 v58, v164, v165
v_add_f32 v168, v168, v170
v_smfmac_f32_16x16x64_bf16 v[24:27], v[72:75], v[192:199], v8
buffer_load_dwordx4 v[164:167], v1, s[8:11], s83 offen offset:1024 sc1
s_waitcnt lgkmcnt(6)
v_add_f32 v169, v169, v171
v_permlane16_swap_b32 v56, v57
v_smfmac_f32_16x16x64_bf16 v[16:19], v[76:79], v[96:103], v8
v_cvt_pk_bf16_f32 v59, v168, v169
v_add_f32 v172, v172, v174
v_smfmac_f32_16x16x64_bf16 v[32:35], v[72:75], v[216:223], v8
buffer_load_dwordx4 v[168:171], v1, s[8:11], s83 offen offset:2048 sc1
v_permlane16_swap_b32 v58, v59
v_add_f32 v173, v173, v175
v_smfmac_f32_16x16x64_bf16 v[24:27], v[76:79], v[200:207], v8
v_permlane32_swap_b32 v56, v58
v_permlane32_swap_b32 v57, v59
v_smfmac_f32_16x16x64_bf16 v[20:23], v[68:71], v[232:239], v8
v_bfi_b32 v56, 1, s62, v56
v_cvt_pk_bf16_f32 v60, v172, v173
v_smfmac_f32_16x16x64_bf16 v[32:35], v[76:79], v[224:231], v8
buffer_store_dwordx4 v[56:59], v11, s[8:11], s44 offen sc1
s_waitcnt lgkmcnt(4)
v_add_f32 v16, v16, v18
v_add_f32 v17, v17, v19
v_smfmac_f32_16x16x64_bf16 v[28:31], v[68:71], v[104:111], v8
buffer_load_dwordx4 v[172:175], v1, s[8:11], s83 offen offset:3072 sc1
v_cvt_pk_bf16_f32 v61, v16, v17
v_add_f32 v24, v24, v26
v_smfmac_f32_16x16x64_bf16 v[20:23], v[72:75], v[240:247], v8
s_waitcnt lgkmcnt(2)
v_add_f32 v25, v25, v27
v_add_f32 v32, v32, v34
v_smfmac_f32_16x16x64_bf16 v[28:31], v[72:75], v[80:87], v8
v_cvt_pk_bf16_f32 v62, v24, v25
v_add_f32 v33, v33, v35
v_smfmac_f32_16x16x64_bf16 v[20:23], v[76:79], v[248:255], v8
s_waitcnt lgkmcnt(0)
v_cvt_pk_bf16_f32 v63, v32, v33
v_permlane16_swap_b32 v60, v61
v_smfmac_f32_16x16x64_bf16 v[28:31], v[76:79], v[88:95], v8
v_permlane16_swap_b32 v62, v63
s_nop 1
v_permlane32_swap_b32 v60, v62
v_permlane32_swap_b32 v61, v63
v_pk_add_f32 v[20:21], v[20:21], v[22:23]
v_bfi_b32 v60, 1, s62, v60
v_cvt_pk_bf16_f32 v64, v20, v21
v_pk_add_f32 v[28:29], v[28:29], v[30:31]
buffer_store_dwordx4 v[60:63], v11, s[8:11], s45 offen sc1
v_cvt_pk_bf16_f32 v65, v28, v29
s_nop 1
v_permlane16_swap_b32 v64, v65
v_bfi_b32 v64, 1, s62, v64
buffer_store_dwordx2 v[64:65], v9, s[8:11], s46 offen sc1
s_cmp_eq_u32 s62, 63
s_cbranch_scc1 Lc_312
s_add_u32 s67, s62, 1
s_and_b32 s67, s67, 3
s_lshl_b32 s67, s67, 1
s_lshl_b32 s68, s67, 15
s_add_u32 s67, s67, s64
s_mul_i32 s67, s67, 10240
s_add_u32 s33, s68, s58
s_add_u32 s32, s67, s80
s_add_u32 s32, s32, 191889408
s_sleep 4
buffer_load_dwordx4 v[80:83], v10, s[8:11], s72 offen sc1
buffer_load_dwordx4 v[84:87], v10, s[8:11], s73 offen sc1
buffer_load_dwordx4 v[88:91], v10, s[8:11], s74 offen sc1
buffer_load_dwordx4 v[92:95], v10, s[8:11], s75 offen sc1
v_mov_b32 v108, 0
v_mov_b32 v109, 0
v_mov_b32 v110, 0
v_mov_b32 v111, 0
s_waitcnt vmcnt(0)
v_bitop3_b32 v20, v80, s62, 1 bitop3:0x28
v_bitop3_b32 v21, v84, s62, 1 bitop3:0x28
v_bitop3_b32 v22, v88, s62, 1 bitop3:0x28
v_bitop3_b32 v23, v92, s62, 1 bitop3:0x28
v_cmp_ne_u32 s[22:23], 0, v20
v_cmp_ne_u32 s[24:25], 0, v21
v_cmp_ne_u32 s[26:27], 0, v22
v_cmp_ne_u32 s[30:31], 0, v23
s_or_b64 s[28:29], s[22:23], s[24:25]
s_or_b64 s[28:29], s[28:29], s[26:27]
s_or_b64 s[28:29], s[28:29], s[30:31]
s_cbranch_scc1 Lp_320
s_sleep 1
buffer_load_dwordx4 v[96:99], v1, s[8:11], s76 offen offset:0 sc1
buffer_load_dwordx4 v[100:103], v1, s[8:11], s76 offen offset:1024 sc1
buffer_load_dwordx4 v[104:107], v1, s[8:11], s76 offen offset:2048 sc1
Lp_320x:
s_waitcnt vmcnt(2)
ds_write_b128 v2, v[96:99] offset:0
v_bitop3_b32 v16, v96, v98, s50 bitop3:0x7e
v_cmp_gt_i32 s[16:17], 0, v16
s_waitcnt vmcnt(1)
ds_write_b128 v2, v[100:103] offset:1024
v_bitop3_b32 v17, v100, v102, s50 bitop3:0x7e
v_cmp_gt_i32 s[18:19], 0, v17
s_waitcnt vmcnt(0)
ds_write_b128 v2, v[104:107] offset:2048
v_bitop3_b32 v18, v104, v106, s50 bitop3:0x7e
v_cmp_gt_i32 s[20:21], 0, v18
s_or_b64 s[28:29], s[16:17], s[18:19]
s_or_b64 s[28:29], s[28:29], s[20:21]
s_cbranch_scc1 Lp_318
Lp_319:
v_smfmac_f32_16x16x64_bf16 v[108:111], v[96:99], v[112:119], v8
s_waitcnt lgkmcnt(0)
s_barrier
ds_read_b128 v[28:31], v3 offset:3072
ds_read_b128 v[32:35], v3 offset:4096
ds_read_b128 v[36:39], v3 offset:5120
v_smfmac_f32_16x16x64_bf16 v[108:111], v[100:103], v[120:127], v8
ds_read_b128 v[40:43], v3 offset:6144
ds_read_b128 v[44:47], v3 offset:7168
v_smfmac_f32_16x16x64_bf16 v[108:111], v[104:107], v[128:135], v8
ds_read_b128 v[48:51], v3 offset:8192
ds_read_b128 v[52:55], v3 offset:9216
s_waitcnt vmcnt(0)
s_waitcnt lgkmcnt(6)
v_smfmac_f32_16x16x64_bf16 v[108:111], v[28:31], v[136:143], v8
s_waitcnt lgkmcnt(5)
v_smfmac_f32_16x16x64_bf16 v[108:111], v[32:35], v[144:151], v8
s_waitcnt lgkmcnt(4)
v_smfmac_f32_16x16x64_bf16 v[108:111], v[36:39], v[152:159], v8
s_waitcnt lgkmcnt(3)
v_smfmac_f32_16x16x64_bf16 v[108:111], v[40:43], v[160:167], v8
s_waitcnt lgkmcnt(2)
v_smfmac_f32_16x16x64_bf16 v[108:111], v[44:47], v[168:175], v8
s_waitcnt lgkmcnt(1)
v_smfmac_f32_16x16x64_bf16 v[108:111], v[48:51], v[80:87], v8
s_waitcnt lgkmcnt(0)
v_smfmac_f32_16x16x64_bf16 v[108:111], v[52:55], v[88:95], v8
s_nop 7
v_pk_add_f32 v[108:109], v[108:109], v[110:111]
v_cvt_pk_bf16_f32 v108, v108, v109
v_xor_b32 v108, s50, v108
s_nop 1
v_mov_b32_dpp v109, v108 quad_perm:[1,0,3,2] row_mask:0xf bank_mask:0xf
v_perm_b32 v108, v109, v108, v6
buffer_store_dword v108, v12, s[8:11], s77 offen sc1
buffer_store_dword v108, v12, s[8:11], s78 offen sc1
s_cmp_ge_u32 s62, 60
s_cbranch_scc1 Lc_312
Lc_313:
s_add_u32 s62, s62, 1
s_branch Lvo_299
Lg_307:
s_mov_b64 exec, s[16:17]
buffer_load_dwordx4 v[68:71], v1, s[8:11], s32 offen offset:0 sc1
s_mov_b64 exec, s[18:19]
buffer_load_dwordx4 v[72:75], v1, s[8:11], s32 offen offset:1024 sc1
s_mov_b64 exec, s[20:21]
buffer_load_dwordx4 v[76:79], v1, s[8:11], s32 offen offset:2048 sc1
s_mov_b64 exec, -1
s_waitcnt vmcnt(0)
v_max3_u32 v52, v68, v69, v70
v_max3_u32 v53, v72, v73, v74
v_max3_u32 v54, v76, v77, v78
v_max_u32 v52, v52, v71
v_max_u32 v53, v53, v75
v_max_u32 v54, v54, v79
v_cmp_eq_u32 s[16:17], -1, v52
v_cmp_eq_u32 s[18:19], -1, v53
v_cmp_eq_u32 s[20:21], -1, v54
s_or_b64 s[28:29], s[16:17], s[18:19]
s_or_b64 s[28:29], s[28:29], s[20:21]
s_cbranch_scc0 Lg_308
s_cmp_eq_u32 s65, 0
s_cbranch_scc1 Lg_308
s_sub_u32 s65, s65, 1
s_branch Lg_307
Lg_309:
Lg_310:
s_mov_b64 exec, s[22:23]
buffer_load_dwordx4 v[112:115], v1, s[8:11], s33 offen offset:0 sc1
s_mov_b64 exec, s[24:25]
buffer_load_dwordx4 v[116:119], v1, s[8:11], s33 offen offset:1024 sc1
s_mov_b64 exec, s[26:27]
buffer_load_dwordx4 v[120:123], v1, s[8:11], s33 offen offset:2048 sc1
s_mov_b64 exec, -1
s_waitcnt vmcnt(0)
v_max3_u32 v52, v112, v113, v114
v_max3_u32 v53, v116, v117, v118
v_max3_u32 v54, v120, v121, v122
v_max_u32 v52, v52, v115
v_max_u32 v53, v53, v119
v_max_u32 v54, v54, v123
v_cmp_eq_u32 s[22:23], -1, v52
v_cmp_eq_u32 s[24:25], -1, v53
v_cmp_eq_u32 s[26:27], -1, v54
s_or_b64 s[28:29], s[22:23], s[24:25]
s_or_b64 s[28:29], s[28:29], s[26:27]
s_cbranch_scc0 Lg_311
s_cmp_eq_u32 s65, 0
s_cbranch_scc1 Lg_311
s_sub_u32 s65, s65, 1
s_branch Lg_310
Lp_320:
s_mov_b64 exec, s[22:23]
buffer_load_dwordx4 v[80:83], v10, s[8:11], s72 offen sc1
s_mov_b64 exec, s[24:25]
buffer_load_dwordx4 v[84:87], v10, s[8:11], s73 offen sc1
s_mov_b64 exec, s[26:27]
buffer_load_dwordx4 v[88:91], v10, s[8:11], s74 offen sc1
s_mov_b64 exec, s[30:31]
buffer_load_dwordx4 v[92:95], v10, s[8:11], s75 offen sc1
s_mov_b64 exec, -1
buffer_load_dwordx4 v[96:99], v1, s[8:11], s76 offen offset:0 sc1
buffer_load_dwordx4 v[100:103], v1, s[8:11], s76 offen offset:1024 sc1
buffer_load_dwordx4 v[104:107], v1, s[8:11], s76 offen offset:2048 sc1
s_waitcnt vmcnt(3)
v_bitop3_b32 v20, v80, s62, 1 bitop3:0x28
v_bitop3_b32 v21, v84, s62, 1 bitop3:0x28
v_bitop3_b32 v22, v88, s62, 1 bitop3:0x28
v_bitop3_b32 v23, v92, s62, 1 bitop3:0x28
v_cmp_ne_u32 s[22:23], 0, v20
v_cmp_ne_u32 s[24:25], 0, v21
v_cmp_ne_u32 s[26:27], 0, v22
v_cmp_ne_u32 s[30:31], 0, v23
s_or_b64 s[28:29], s[22:23], s[24:25]
s_or_b64 s[28:29], s[28:29], s[26:27]
s_or_b64 s[28:29], s[28:29], s[30:31]
s_cbranch_scc1 Lp_316
s_branch Lp_320x
Lp_316:
s_waitcnt vmcnt(0)
v_bitop3_b32 v16, v96, v98, s50 bitop3:0x7e
v_bitop3_b32 v19, v97, v99, s50 bitop3:0x7e
v_or_b32 v16, v16, v19
v_cmp_gt_i32 s[16:17], 0, v16
v_bitop3_b32 v17, v100, v102, s50 bitop3:0x7e
v_bitop3_b32 v19, v101, v103, s50 bitop3:0x7e
v_or_b32 v17, v17, v19
v_cmp_gt_i32 s[18:19], 0, v17
v_bitop3_b32 v18, v104, v106, s50 bitop3:0x7e
v_bitop3_b32 v19, v105, v107, s50 bitop3:0x7e
v_or_b32 v18, v18, v19
v_cmp_gt_i32 s[20:21], 0, v18
s_or_b64 s[28:29], s[16:17], s[18:19]
s_or_b64 s[28:29], s[28:29], s[20:21]
Lp_321:
s_mov_b64 exec, s[22:23]
buffer_load_dwordx4 v[80:83], v10, s[8:11], s72 offen sc1
s_mov_b64 exec, s[24:25]
buffer_load_dwordx4 v[84:87], v10, s[8:11], s73 offen sc1
s_mov_b64 exec, s[26:27]
buffer_load_dwordx4 v[88:91], v10, s[8:11], s74 offen sc1
s_mov_b64 exec, s[30:31]
buffer_load_dwordx4 v[92:95], v10, s[8:11], s75 offen sc1
s_mov_b64 exec, -1
s_mov_b64 exec, s[16:17]
buffer_load_dwordx4 v[96:99], v1, s[8:11], s76 offen offset:0 sc1
s_mov_b64 exec, s[18:19]
buffer_load_dwordx4 v[100:103], v1, s[8:11], s76 offen offset:1024 sc1
s_mov_b64 exec, s[20:21]
buffer_load_dwordx4 v[104:107], v1, s[8:11], s76 offen offset:2048 sc1
s_mov_b64 exec, -1
s_waitcnt vmcnt(0)
v_bitop3_b32 v16, v96, v98, s50 bitop3:0x7e
v_bitop3_b32 v19, v97, v99, s50 bitop3:0x7e
v_or_b32 v16, v16, v19
v_cmp_gt_i32 s[16:17], 0, v16
v_bitop3_b32 v17, v100, v102, s50 bitop3:0x7e
v_bitop3_b32 v19, v101, v103, s50 bitop3:0x7e
v_or_b32 v17, v17, v19
v_cmp_gt_i32 s[18:19], 0, v17
v_bitop3_b32 v18, v104, v106, s50 bitop3:0x7e
v_bitop3_b32 v19, v105, v107, s50 bitop3:0x7e
v_or_b32 v18, v18, v19
v_cmp_gt_i32 s[20:21], 0, v18
s_or_b64 s[28:29], s[16:17], s[18:19]
s_or_b64 s[28:29], s[28:29], s[20:21]
s_cselect_b32 s51, 1, 0
v_bitop3_b32 v20, v80, s62, 1 bitop3:0x28
v_bitop3_b32 v21, v84, s62, 1 bitop3:0x28
v_bitop3_b32 v22, v88, s62, 1 bitop3:0x28
v_bitop3_b32 v23, v92, s62, 1 bitop3:0x28
v_cmp_ne_u32 s[22:23], 0, v20
v_cmp_ne_u32 s[24:25], 0, v21
v_cmp_ne_u32 s[26:27], 0, v22
v_cmp_ne_u32 s[30:31], 0, v23
s_or_b64 s[28:29], s[22:23], s[24:25]
s_or_b64 s[28:29], s[28:29], s[26:27]
s_or_b64 s[28:29], s[28:29], s[30:31]
s_cbranch_scc0 Lp_317
s_cmp_eq_u32 s65, 0
s_cbranch_scc1 Lp_317
s_sub_u32 s65, s65, 1
s_branch Lp_321
Lp_317:
s_cmp_eq_u32 s51, 0
s_cbranch_scc1 Lp_323
Lp_318:
Lp_322:
s_mov_b64 exec, s[16:17]
buffer_load_dwordx4 v[96:99], v1, s[8:11], s76 offen offset:0 sc1
s_mov_b64 exec, s[18:19]
buffer_load_dwordx4 v[100:103], v1, s[8:11], s76 offen offset:1024 sc1
s_mov_b64 exec, s[20:21]
buffer_load_dwordx4 v[104:107], v1, s[8:11], s76 offen offset:2048 sc1
s_mov_b64 exec, -1
s_waitcnt vmcnt(0)
v_bitop3_b32 v16, v96, v98, s50 bitop3:0x7e
v_bitop3_b32 v19, v97, v99, s50 bitop3:0x7e
v_or_b32 v16, v16, v19
v_cmp_gt_i32 s[16:17], 0, v16
v_bitop3_b32 v17, v100, v102, s50 bitop3:0x7e
v_bitop3_b32 v19, v101, v103, s50 bitop3:0x7e
v_or_b32 v17, v17, v19
v_cmp_gt_i32 s[18:19], 0, v17
v_bitop3_b32 v18, v104, v106, s50 bitop3:0x7e
v_bitop3_b32 v19, v105, v107, s50 bitop3:0x7e
v_or_b32 v18, v18, v19
v_cmp_gt_i32 s[20:21], 0, v18
s_or_b64 s[28:29], s[16:17], s[18:19]
s_or_b64 s[28:29], s[28:29], s[20:21]
s_cbranch_scc0 Lp_323
s_cmp_eq_u32 s65, 0
s_cbranch_scc1 Lp_323
s_sub_u32 s65, s65, 1
s_branch Lp_322
Lp_323:
ds_write_b128 v2, v[96:99] offset:0
ds_write_b128 v2, v[100:103] offset:1024
ds_write_b128 v2, v[104:107] offset:2048
s_branch Lp_319
Lc_312:
s_lshl_b32 s52, s62, 5
s_add_u32 s52, s52, s63
s_mul_i32 s52, s52, 10240
s_add_u32 s52, s52, 165675008
s_add_u32 s53, s52, 4096
s_add_u32 s54, s52, 8192
buffer_store_dwordx4 v[56:59], v11, s[8:11], s52 offen sc1
buffer_store_dwordx4 v[60:63], v11, s[8:11], s53 offen sc1
buffer_store_dwordx2 v[64:65], v9, s[8:11], s54 offen sc1
s_cmp_lt_u32 s62, 63
s_cbranch_scc1 Lc_313
s_waitcnt vmcnt(0)
s_barrier
s_waitcnt vmcnt(0)
s_endpgm
Lw_295:
s_mov_b32 s62, 0
s_mov_b32 s36, 0x03030303
s_mov_b32 s37, s36
ds_read_b128 v[80:83], v4 offset:6144
ds_read_b128 v[84:87], v4 offset:7168
ds_read_b128 v[88:91], v4 offset:8192
ds_read_b128 v[92:95], v4 offset:9216
ds_read_b128 v[96:99], v4 offset:10240
ds_read_b128 v[100:103], v4 offset:11264
ds_read_b128 v[104:107], v4 offset:0
ds_read_b128 v[108:111], v4 offset:1024
s_bitcmp1_b32 s62, 0
s_cselect_b32 s50, 0x80008000, 0
s_add_u32 s67, s62, 1
s_and_b32 s67, s67, 3
s_lshl_b32 s67, s67, 1
s_lshl_b32 s78, s67, 15
s_add_u32 s67, s67, s64
s_mul_i32 s77, s67, 10240
s_lshl_b32 s67, s66, 8
s_add_u32 s77, s77, s67
s_add_u32 s78, s78, s67
s_add_u32 s77, s77, 191889408
s_add_u32 s78, s78, s59
s_cmp_ge_u32 s66, 24
s_cselect_b32 s67, 26624, 0
s_add_u32 s78, s78, s67
s_mov_b32 s82, s62
s_mul_i32 s83, s82, 1638400
s_add_u32 s83, s83, s47
s_cmp_eq_u32 s62, 63
s_cselect_b32 s83, 536870912, s83
v_mov_b64 v[56:57], 0
v_mov_b64 v[58:59], 0
v_mov_b64 v[60:61], 0
v_mov_b64 v[62:63], 0
v_mov_b64 v[64:65], 0
v_mov_b64 v[66:67], 0
v_mov_b64 v[156:157], 0
v_mov_b64 v[158:159], 0
v_mov_b64 v[160:161], 0
v_mov_b64 v[162:163], 0
v_mov_b64 v[164:165], 0
v_mov_b64 v[166:167], 0
v_mov_b64 v[168:169], 0
v_mov_b64 v[170:171], 0
v_mov_b64 v[172:173], 0
v_mov_b64 v[174:175], 0
s_cmp_ge_u32 s62, 3
s_cbranch_scc1 Lk_326
s_sub_u32 s61, s82, 12
s_max_i32 s61, s61, 0
s_lshr_b32 s61, s61, 2
s_add_u32 s61, s61, s82
s_cmp_gt_u32 s60, s61
s_cbranch_scc1 Lfd_328
v_and_b32 v14, 15, v0
v_lshlrev_b32 v14, 7, v14
Lf_327:
buffer_load_dword v13, v14, s[8:11], s81 offen sc1
s_waitcnt vmcnt(0)
v_min_u32_dpp v13, v13, v13 row_ror:8 row_mask:0xf bank_mask:0xf
s_nop 1
v_min_u32_dpp v13, v13, v13 row_ror:4 row_mask:0xf bank_mask:0xf
s_nop 1
v_min_u32_dpp v13, v13, v13 row_ror:2 row_mask:0xf bank_mask:0xf
s_nop 1
v_min_u32_dpp v13, v13, v13 row_ror:1 row_mask:0xf bank_mask:0xf
s_nop 0
v_readfirstlane_b32 s60, v13
s_nop 0
s_cmp_gt_u32 s60, s61
s_cbranch_scc1 Lfd_328
s_cmp_eq_u32 s65, 0
s_cbranch_scc1 Lfd_328
s_sub_u32 s65, s65, 1
s_branch Lf_327
Lfd_328:
Lk_326:
ds_read_b128 v[16:19], v3 offset:3072
ds_read_b128 v[24:27], v3 offset:4096
ds_read_b128 v[32:35], v3 offset:5120
s_waitcnt lgkmcnt(0)
s_branch Lvoent_325
Lvo_324:
s_barrier
ds_read_b128 v[80:83], v4 offset:6144
ds_read_b128 v[84:87], v4 offset:7168
ds_read_b128 v[88:91], v4 offset:8192
ds_read_b128 v[92:95], v4 offset:9216
ds_read_b128 v[96:99], v4 offset:10240
ds_read_b128 v[100:103], v4 offset:11264
ds_read_b128 v[104:107], v4 offset:0
ds_read_b128 v[108:111], v4 offset:1024
s_bitcmp1_b32 s62, 0
s_cselect_b32 s50, 0x80008000, 0
s_add_u32 s67, s62, 1
s_and_b32 s67, s67, 3
s_lshl_b32 s67, s67, 1
s_lshl_b32 s78, s67, 15
s_add_u32 s67, s67, s64
s_mul_i32 s77, s67, 10240
s_lshl_b32 s67, s66, 8
s_add_u32 s77, s77, s67
s_add_u32 s78, s78, s67
s_add_u32 s77, s77, 191889408
s_add_u32 s78, s78, s59
s_cmp_ge_u32 s66, 24
s_cselect_b32 s67, 26624, 0
s_add_u32 s78, s78, s67
s_mov_b32 s82, s62
s_mul_i32 s83, s82, 1638400
s_add_u32 s83, s83, s47
s_cmp_eq_u32 s62, 63
s_cselect_b32 s83, 536870912, s83
v_mov_b64 v[56:57], 0
v_mov_b64 v[58:59], 0
v_mov_b64 v[60:61], 0
v_mov_b64 v[62:63], 0
v_mov_b64 v[64:65], 0
v_mov_b64 v[66:67], 0
v_mov_b64 v[156:157], 0
v_mov_b64 v[158:159], 0
v_mov_b64 v[160:161], 0
v_mov_b64 v[162:163], 0
v_mov_b64 v[164:165], 0
v_mov_b64 v[166:167], 0
v_mov_b64 v[168:169], 0
v_mov_b64 v[170:171], 0
v_mov_b64 v[172:173], 0
v_mov_b64 v[174:175], 0
s_cmp_ge_u32 s62, 3
s_cbranch_scc1 Lk_329
s_sub_u32 s61, s82, 12
s_max_i32 s61, s61, 0
s_lshr_b32 s61, s61, 2
s_add_u32 s61, s61, s82
s_cmp_gt_u32 s60, s61
s_cbranch_scc1 Lfd_331
v_and_b32 v14, 15, v0
v_lshlrev_b32 v14, 7, v14
Lf_330:
buffer_load_dword v13, v14, s[8:11], s81 offen sc1
s_waitcnt vmcnt(0)
v_min_u32_dpp v13, v13, v13 row_ror:8 row_mask:0xf bank_mask:0xf
s_nop 1
v_min_u32_dpp v13, v13, v13 row_ror:4 row_mask:0xf bank_mask:0xf
s_nop 1
v_min_u32_dpp v13, v13, v13 row_ror:2 row_mask:0xf bank_mask:0xf
s_nop 1
v_min_u32_dpp v13, v13, v13 row_ror:1 row_mask:0xf bank_mask:0xf
s_nop 0
v_readfirstlane_b32 s60, v13
s_nop 0
s_cmp_gt_u32 s60, s61
s_cbranch_scc1 Lfd_331
s_cmp_eq_u32 s65, 0
s_cbranch_scc1 Lfd_331
s_sub_u32 s65, s65, 1
s_branch Lf_330
Lfd_331:
Lk_329:
s_sleep 1
s_waitcnt lgkmcnt(0)
buffer_load_dwordx4 v[68:71], v1, s[8:11], s32 offen offset:0 sc1
buffer_load_dwordx4 v[72:75], v1, s[8:11], s32 offen offset:1024 sc1
buffer_load_dwordx4 v[76:79], v1, s[8:11], s32 offen offset:2048 sc1
s_waitcnt vmcnt(0)
v_max3_u32 v52, v68, v69, v70
v_max3_u32 v53, v72, v73, v74
v_max3_u32 v54, v76, v77, v78
v_max_u32 v52, v52, v71
v_max_u32 v53, v53, v75
v_max_u32 v54, v54, v79
v_cmp_eq_u32 s[16:17], -1, v52
v_cmp_eq_u32 s[18:19], -1, v53
v_cmp_eq_u32 s[20:21], -1, v54
s_or_b64 s[28:29], s[16:17], s[18:19]
s_or_b64 s[28:29], s[28:29], s[20:21]
s_cbranch_scc1 Lg_332
Lg_333:
buffer_load_dwordx4 v[112:115], v1, s[8:11], s33 offen offset:0 sc1
buffer_load_dwordx4 v[116:119], v1, s[8:11], s33 offen offset:1024 sc1
buffer_load_dwordx4 v[120:123], v1, s[8:11], s33 offen offset:2048 sc1
v_lshlrev_b32 v16, 16, v68
v_and_b32 v17, 0xffff0000, v68
v_lshlrev_b32 v18, 16, v69
v_and_b32 v19, 0xffff0000, v69
v_lshlrev_b32 v20, 16, v70
v_and_b32 v21, 0xffff0000, v70
v_lshlrev_b32 v22, 16, v71
v_and_b32 v23, 0xffff0000, v71
v_lshlrev_b32 v24, 16, v72
v_and_b32 v25, 0xffff0000, v72
v_lshlrev_b32 v26, 16, v73
v_and_b32 v27, 0xffff0000, v73
v_lshlrev_b32 v28, 16, v74
v_and_b32 v29, 0xffff0000, v74
v_lshlrev_b32 v30, 16, v75
v_and_b32 v31, 0xffff0000, v75
v_lshlrev_b32 v32, 16, v76
v_and_b32 v33, 0xffff0000, v76
v_lshlrev_b32 v34, 16, v77
v_and_b32 v35, 0xffff0000, v77
v_lshlrev_b32 v36, 16, v78
v_and_b32 v37, 0xffff0000, v78
v_lshlrev_b32 v38, 16, v79
v_and_b32 v39, 0xffff0000, v79
s_waitcnt vmcnt(0)
v_max3_u32 v52, v112, v113, v114
v_max3_u32 v53, v116, v117, v118
v_max3_u32 v54, v120, v121, v122
v_max_u32 v52, v52, v115
v_max_u32 v53, v53, v119
v_max_u32 v54, v54, v123
v_cmp_eq_u32 s[22:23], -1, v52
v_cmp_eq_u32 s[24:25], -1, v53
v_cmp_eq_u32 s[26:27], -1, v54
s_or_b64 s[28:29], s[22:23], s[24:25]
s_or_b64 s[28:29], s[28:29], s[26:27]
s_cbranch_scc1 Lg_334
Lg_336:
v_dot2c_f32_bf16 v16, s100, v112
v_dot2c_f32_bf16 v17, s101, v112
v_dot2c_f32_bf16 v18, s100, v113
v_dot2c_f32_bf16 v19, s101, v113
v_dot2c_f32_bf16 v20, s100, v114
v_dot2c_f32_bf16 v21, s101, v114
v_dot2c_f32_bf16 v22, s100, v115
v_dot2c_f32_bf16 v23, s101, v115
v_cvt_pk_bf16_f32 v16, v16, v17
v_cvt_pk_bf16_f32 v17, v18, v19
v_cvt_pk_bf16_f32 v18, v20, v21
v_cvt_pk_bf16_f32 v19, v22, v23
ds_write_b128 v2, v[16:19] offset:0
v_dot2c_f32_bf16 v24, s100, v116
v_dot2c_f32_bf16 v25, s101, v116
v_dot2c_f32_bf16 v26, s100, v117
v_dot2c_f32_bf16 v27, s101, v117
v_dot2c_f32_bf16 v28, s100, v118
v_dot2c_f32_bf16 v29, s101, v118
v_dot2c_f32_bf16 v30, s100, v119
v_dot2c_f32_bf16 v31, s101, v119
v_cvt_pk_bf16_f32 v24, v24, v25
v_cvt_pk_bf16_f32 v25, v26, v27
v_cvt_pk_bf16_f32 v26, v28, v29
v_cvt_pk_bf16_f32 v27, v30, v31
ds_write_b128 v2, v[24:27] offset:1024
v_dot2c_f32_bf16 v32, s100, v120
v_dot2c_f32_bf16 v33, s101, v120
v_dot2c_f32_bf16 v34, s100, v121
v_dot2c_f32_bf16 v35, s101, v121
v_dot2c_f32_bf16 v36, s100, v122
v_dot2c_f32_bf16 v37, s101, v122
v_dot2c_f32_bf16 v38, s100, v123
v_dot2c_f32_bf16 v39, s101, v123
v_cvt_pk_bf16_f32 v32, v32, v33
v_cvt_pk_bf16_f32 v33, v34, v35
v_cvt_pk_bf16_f32 v34, v36, v37
v_cvt_pk_bf16_f32 v35, v38, v39
ds_write_b128 v2, v[32:35] offset:2048
Lvoent_325:
v_smfmac_f32_16x16x64_bf16 v[56:59], v[16:19], a[16:23], v8
v_smfmac_f32_16x16x64_bf16 v[60:63], v[16:19], a[72:79], v8
buffer_load_dwordx4 v[112:115], v1, s[8:11], s83 offen offset:0 sc1
v_smfmac_f32_16x16x64_bf16 v[64:67], v[16:19], a[128:135], v8
v_smfmac_f32_16x16x64_bf16 v[56:59], v[24:27], a[24:31], v8
s_waitcnt lgkmcnt(0)
s_barrier
ds_read_b128 v[20:23], v3 offset:0
v_mov_b64 v[16:17], 0
v_smfmac_f32_16x16x64_bf16 v[60:63], v[24:27], a[80:87], v8
ds_read_b128 v[28:31], v3 offset:1024
buffer_load_dwordx4 v[116:119], v1, s[8:11], s83 offen offset:1024 sc1
v_mov_b64 v[18:19], 0
v_smfmac_f32_16x16x64_bf16 v[64:67], v[24:27], a[136:143], v8
ds_read_b128 v[36:39], v3 offset:2048
v_smfmac_f32_16x16x64_bf16 v[56:59], v[32:35], v[80:87], v8
ds_read_b128 v[40:43], v3 offset:6144
v_mov_b64 v[24:25], 0
v_smfmac_f32_16x16x64_bf16 v[60:63], v[32:35], v[88:95], v8
ds_read_b128 v[44:47], v3 offset:7168
buffer_load_dwordx4 v[120:123], v1, s[8:11], s83 offen offset:2048 sc1
ds_read_b128 v[80:83], v4 offset:12288
v_mov_b64 v[26:27], 0
v_smfmac_f32_16x16x64_bf16 v[64:67], v[32:35], v[96:103], v8
ds_read_b128 v[48:51], v3 offset:9216
ds_read_b128 v[84:87], v4 offset:13312
s_waitcnt lgkmcnt(7)
v_smfmac_f32_16x16x64_bf16 v[56:59], v[20:23], a[0:7], v8
ds_read_b128 v[52:55], v3 offset:8192
s_waitcnt lgkmcnt(7)
v_mov_b64 v[32:33], 0
v_smfmac_f32_16x16x64_bf16 v[56:59], v[28:31], a[8:15], v8
buffer_load_dwordx4 v[124:127], v1, s[8:11], s83 offen offset:3072 sc1
ds_read_b128 v[88:91], v4 offset:2048
s_waitcnt lgkmcnt(7)
v_mov_b64 v[34:35], 0
v_smfmac_f32_16x16x64_bf16 v[56:59], v[36:39], v[104:111], v8
s_add_u32 s83, s83, 4096
ds_read_b128 v[92:95], v4 offset:3072
s_waitcnt lgkmcnt(7)
v_smfmac_f32_16x16x64_bf16 v[56:59], v[40:43], a[32:39], v8
ds_read_b128 v[96:99], v4 offset:14336
s_waitcnt lgkmcnt(7)
v_smfmac_f32_16x16x64_bf16 v[56:59], v[44:47], a[40:47], v8
buffer_load_dwordx4 v[128:131], v1, s[8:11], s83 offen offset:0 sc1
ds_read_b128 v[100:103], v4 offset:15360
s_waitcnt lgkmcnt(5)
v_smfmac_f32_16x16x64_bf16 v[56:59], v[48:51], v[80:87], v8
ds_read_b128 v[104:107], v4 offset:4096
s_waitcnt lgkmcnt(5)
v_smfmac_f32_16x16x64_bf16 v[56:59], v[52:55], a[48:55], v8
ds_read_b128 v[108:111], v4 offset:5120
v_smfmac_f32_16x16x64_bf16 v[60:63], v[20:23], a[56:63], v8
buffer_load_dwordx4 v[132:135], v1, s[8:11], s83 offen offset:1024 sc1
ds_read_b128 v[80:83], v4 offset:16384
v_smfmac_f32_16x16x64_bf16 v[60:63], v[28:31], a[64:71], v8
ds_read_b128 v[84:87], v4 offset:17408
s_waitcnt lgkmcnt(6)
v_add_f32 v56, v56, v58
v_smfmac_f32_16x16x64_bf16 v[60:63], v[36:39], v[88:95], v8
ds_read_b128 v[88:91], v4 offset:18432
v_add_f32 v57, v57, v59
v_smfmac_f32_16x16x64_bf16 v[60:63], v[40:43], a[88:95], v8
buffer_load_dwordx4 v[136:139], v1, s[8:11], s83 offen offset:2048 sc1
ds_read_b128 v[92:95], v4 offset:19456
v_cvt_pk_bf16_f32 v56, v56, v57
v_smfmac_f32_16x16x64_bf16 v[60:63], v[44:47], a[96:103], v8
s_waitcnt lgkmcnt(6)
v_smfmac_f32_16x16x64_bf16 v[60:63], v[48:51], v[96:103], v8
ds_read_b128 v[96:99], v4 offset:20480
v_mov_b32_dpp v57, v56 quad_perm:[1,0,3,2] row_mask:0xf bank_mask:0xf
v_smfmac_f32_16x16x64_bf16 v[60:63], v[52:55], a[104:111], v8
buffer_load_dwordx4 v[140:143], v1, s[8:11], s83 offen offset:3072 sc1
ds_read_b128 v[100:103], v4 offset:21504
v_perm_b32 v56, v57, v56, v6
v_smfmac_f32_16x16x64_bf16 v[64:67], v[20:23], a[112:119], v8
s_add_u32 s83, s83, 4096
ds_write_b32 v5, v56 offset:0
v_smfmac_f32_16x16x64_bf16 v[64:67], v[28:31], a[120:127], v8
s_waitcnt lgkmcnt(7)
v_add_f32 v60, v60, v62
v_smfmac_f32_16x16x64_bf16 v[64:67], v[36:39], v[104:111], v8
buffer_load_dwordx4 v[144:147], v1, s[8:11], s83 offen offset:0 sc1
ds_read_b128 v[104:107], v4 offset:24576
v_add_f32 v61, v61, v63
v_smfmac_f32_16x16x64_bf16 v[64:67], v[40:43], a[144:151], v8
s_waitcnt lgkmcnt(1)
s_barrier
ds_read_b128 v[68:71], v3 offset:12736
v_cvt_pk_bf16_f32 v60, v60, v61
v_smfmac_f32_16x16x64_bf16 v[64:67], v[44:47], a[152:159], v8
ds_read_b128 v[108:111], v4 offset:25600
v_mov_b64 v[20:21], 0
v_smfmac_f32_16x16x64_bf16 v[64:67], v[48:51], v[80:87], v8
buffer_load_dwordx4 v[148:151], v1, s[8:11], s83 offen offset:1024 sc1
ds_read_b128 v[80:83], v4 offset:22528
v_mov_b32_dpp v61, v60 quad_perm:[1,0,3,2] row_mask:0xf bank_mask:0xf
v_smfmac_f32_16x16x64_bf16 v[64:67], v[52:55], a[160:167], v8
ds_read_b128 v[84:87], v4 offset:23552
s_waitcnt lgkmcnt(3)
v_perm_b32 v60, v61, v60, v6
v_smfmac_f32_16x16x64_bf16 v[156:159], v[68:71], a[168:175], v8
ds_write_b32 v5, v60 offset:1024
v_mov_b64 v[22:23], 0
v_smfmac_f32_16x16x64_bf16 v[164:167], v[68:71], a[192:199], v8
buffer_load_dwordx4 v[152:155], v1, s[8:11], s83 offen offset:2048 sc1
v_add_f32 v64, v64, v66
v_add_f32 v65, v65, v67
v_smfmac_f32_16x16x64_bf16 v[160:163], v[68:71], v[88:95], v8
ds_read_b128 v[88:91], v4 offset:26624
v_cvt_pk_bf16_f32 v64, v64, v65
v_smfmac_f32_16x16x64_bf16 v[168:171], v[68:71], a[216:223], v8
s_waitcnt lgkmcnt(1)
s_barrier
ds_read_b128 v[72:75], v3 offset:13760
v_mov_b64 v[28:29], 0
v_smfmac_f32_16x16x64_bf16 v[172:175], v[68:71], a[240:247], v8
ds_read_b128 v[92:95], v4 offset:27648
v_mov_b32_dpp v65, v64 quad_perm:[1,0,3,2] row_mask:0xf bank_mask:0xf
v_perm_b32 v64, v65, v64, v6
v_smfmac_f32_16x16x64_bf16 v[24:27], v[68:71], v[184:191], v8
ds_write_b32 v5, v64 offset:2048
s_waitcnt lgkmcnt(2)
v_mov_b64 v[30:31], 0
v_smfmac_f32_16x16x64_bf16 v[156:159], v[72:75], a[176:183], v8
v_smfmac_f32_16x16x64_bf16 v[164:167], v[72:75], a[200:207], v8
v_smfmac_f32_16x16x64_bf16 v[160:163], v[72:75], v[96:103], v8
s_waitcnt lgkmcnt(0)
s_barrier
ds_read_b128 v[76:79], v3 offset:14784
v_smfmac_f32_16x16x64_bf16 v[168:171], v[72:75], a[224:231], v8
ds_read_b128 v[96:99], v4 offset:28672
v_smfmac_f32_16x16x64_bf16 v[16:19], v[68:71], v[104:111], v8
ds_read_b128 v[100:103], v4 offset:29696
v_smfmac_f32_16x16x64_bf16 v[32:35], v[68:71], v[208:215], v8
ds_read_b128 v[104:107], v4 offset:30720
s_waitcnt lgkmcnt(3)
v_smfmac_f32_16x16x64_bf16 v[156:159], v[76:79], a[184:191], v8
ds_read_b128 v[108:111], v4 offset:31744
v_smfmac_f32_16x16x64_bf16 v[160:163], v[76:79], v[80:87], v8
ds_read_b128 v[80:83], v4 offset:32768
v_smfmac_f32_16x16x64_bf16 v[164:167], v[76:79], a[208:215], v8
ds_read_b128 v[84:87], v4 offset:33792
v_add_f32 v156, v156, v158
v_add_f32 v157, v157, v159
v_smfmac_f32_16x16x64_bf16 v[168:171], v[76:79], a[232:239], v8
v_cvt_pk_bf16_f32 v56, v156, v157
v_add_f32 v160, v160, v162
v_smfmac_f32_16x16x64_bf16 v[172:175], v[72:75], a[248:255], v8
buffer_load_dwordx4 v[156:159], v1, s[8:11], s83 offen offset:3072 sc1
s_add_u32 s83, s83, 4096
v_add_f32 v161, v161, v163
v_add_f32 v164, v164, v166
v_smfmac_f32_16x16x64_bf16 v[16:19], v[72:75], v[88:95], v8
ds_read_b128 v[88:91], v4 offset:34816
v_cvt_pk_bf16_f32 v57, v160, v161
v_add_f32 v165, v165, v167
v_smfmac_f32_16x16x64_bf16 v[172:175], v[76:79], v[176:183], v8
buffer_load_dwordx4 v[160:163], v1, s[8:11], s83 offen offset:0 sc1
ds_read_b128 v[92:95], v4 offset:35840
v_cvt_pk_bf16_f32 v58, v164, v165
v_add_f32 v168, v168, v170
v_smfmac_f32_16x16x64_bf16 v[24:27], v[72:75], v[192:199], v8
buffer_load_dwordx4 v[164:167], v1, s[8:11], s83 offen offset:1024 sc1
s_waitcnt lgkmcnt(6)
v_add_f32 v169, v169, v171
v_permlane16_swap_b32 v56, v57
v_smfmac_f32_16x16x64_bf16 v[16:19], v[76:79], v[96:103], v8
v_cvt_pk_bf16_f32 v59, v168, v169
v_add_f32 v172, v172, v174
v_smfmac_f32_16x16x64_bf16 v[32:35], v[72:75], v[216:223], v8
buffer_load_dwordx4 v[168:171], v1, s[8:11], s83 offen offset:2048 sc1
v_permlane16_swap_b32 v58, v59
v_add_f32 v173, v173, v175
v_smfmac_f32_16x16x64_bf16 v[24:27], v[76:79], v[200:207], v8
v_permlane32_swap_b32 v56, v58
v_permlane32_swap_b32 v57, v59
v_smfmac_f32_16x16x64_bf16 v[20:23], v[68:71], v[232:239], v8
v_bfi_b32 v56, 1, s62, v56
v_cvt_pk_bf16_f32 v60, v172, v173
v_smfmac_f32_16x16x64_bf16 v[32:35], v[76:79], v[224:231], v8
buffer_store_dwordx4 v[56:59], v11, s[8:11], s44 offen sc1
s_waitcnt lgkmcnt(4)
v_add_f32 v16, v16, v18
v_add_f32 v17, v17, v19
v_smfmac_f32_16x16x64_bf16 v[28:31], v[68:71], v[104:111], v8
buffer_load_dwordx4 v[172:175], v1, s[8:11], s83 offen offset:3072 sc1
v_cvt_pk_bf16_f32 v61, v16, v17
v_add_f32 v24, v24, v26
v_smfmac_f32_16x16x64_bf16 v[20:23], v[72:75], v[240:247], v8
s_waitcnt lgkmcnt(2)
v_add_f32 v25, v25, v27
v_add_f32 v32, v32, v34
v_smfmac_f32_16x16x64_bf16 v[28:31], v[72:75], v[80:87], v8
v_cvt_pk_bf16_f32 v62, v24, v25
v_add_f32 v33, v33, v35
v_smfmac_f32_16x16x64_bf16 v[20:23], v[76:79], v[248:255], v8
s_waitcnt lgkmcnt(0)
v_cvt_pk_bf16_f32 v63, v32, v33
v_permlane16_swap_b32 v60, v61
v_smfmac_f32_16x16x64_bf16 v[28:31], v[76:79], v[88:95], v8
v_permlane16_swap_b32 v62, v63
s_nop 1
v_permlane32_swap_b32 v60, v62
v_permlane32_swap_b32 v61, v63
v_pk_add_f32 v[20:21], v[20:21], v[22:23]
v_bfi_b32 v60, 1, s62, v60
v_cvt_pk_bf16_f32 v64, v20, v21
v_pk_add_f32 v[28:29], v[28:29], v[30:31]
buffer_store_dwordx4 v[60:63], v11, s[8:11], s45 offen sc1
v_cvt_pk_bf16_f32 v65, v28, v29
s_nop 1
v_permlane16_swap_b32 v64, v65
v_bfi_b32 v64, 1, s62, v64
buffer_store_dwordx2 v[64:65], v9, s[8:11], s46 offen sc1
s_cmp_eq_u32 s62, 63
s_cbranch_scc1 Lc_337
s_add_u32 s67, s62, 1
s_and_b32 s67, s67, 3
s_lshl_b32 s67, s67, 1
s_lshl_b32 s68, s67, 15
s_add_u32 s67, s67, s64
s_mul_i32 s67, s67, 10240
s_add_u32 s33, s68, s58
s_add_u32 s32, s67, s80
s_add_u32 s32, s32, 191889408
s_sleep 4
buffer_load_dwordx4 v[80:83], v10, s[8:11], s72 offen sc1
buffer_load_dwordx4 v[84:87], v10, s[8:11], s73 offen sc1
buffer_load_dwordx4 v[88:91], v10, s[8:11], s74 offen sc1
buffer_load_dwordx4 v[92:95], v10, s[8:11], s75 offen sc1
v_mov_b32 v108, 0
v_mov_b32 v109, 0
v_mov_b32 v110, 0
v_mov_b32 v111, 0
s_waitcnt vmcnt(0)
v_bitop3_b32 v20, v80, s62, 1 bitop3:0x28
v_bitop3_b32 v21, v84, s62, 1 bitop3:0x28
v_bitop3_b32 v22, v88, s62, 1 bitop3:0x28
v_bitop3_b32 v23, v92, s62, 1 bitop3:0x28
v_cmp_ne_u32 s[22:23], 0, v20
v_cmp_ne_u32 s[24:25], 0, v21
v_cmp_ne_u32 s[26:27], 0, v22
v_cmp_ne_u32 s[30:31], 0, v23
s_or_b64 s[28:29], s[22:23], s[24:25]
s_or_b64 s[28:29], s[28:29], s[26:27]
s_or_b64 s[28:29], s[28:29], s[30:31]
s_cbranch_scc1 Lp_345
s_sleep 1
buffer_load_dwordx4 v[96:99], v1, s[8:11], s76 offen offset:0 sc1
buffer_load_dwordx4 v[100:103], v1, s[8:11], s76 offen offset:1024 sc1
buffer_load_dwordx4 v[104:107], v1, s[8:11], s76 offen offset:2048 sc1
Lp_345x:
s_waitcnt vmcnt(2)
ds_write_b128 v2, v[96:99] offset:0
v_bitop3_b32 v16, v96, v98, s50 bitop3:0x7e
v_cmp_gt_i32 s[16:17], 0, v16
s_waitcnt vmcnt(1)
ds_write_b128 v2, v[100:103] offset:1024
v_bitop3_b32 v17, v100, v102, s50 bitop3:0x7e
v_cmp_gt_i32 s[18:19], 0, v17
s_waitcnt vmcnt(0)
ds_write_b128 v2, v[104:107] offset:2048
v_bitop3_b32 v18, v104, v106, s50 bitop3:0x7e
v_cmp_gt_i32 s[20:21], 0, v18
s_or_b64 s[28:29], s[16:17], s[18:19]
s_or_b64 s[28:29], s[28:29], s[20:21]
s_cbranch_scc1 Lp_343
Lp_344:
v_smfmac_f32_16x16x64_bf16 v[108:111], v[96:99], v[136:143], v8
s_waitcnt lgkmcnt(0)
s_barrier
ds_read_b128 v[16:19], v3 offset:0
ds_read_b128 v[20:23], v3 offset:1024
ds_read_b128 v[24:27], v3 offset:2048
v_smfmac_f32_16x16x64_bf16 v[108:111], v[100:103], v[144:151], v8
ds_read_b128 v[40:43], v3 offset:6144
ds_read_b128 v[44:47], v3 offset:7168
v_smfmac_f32_16x16x64_bf16 v[108:111], v[104:107], v[152:159], v8
ds_read_b128 v[48:51], v3 offset:8192
ds_read_b128 v[52:55], v3 offset:9216
s_waitcnt vmcnt(0)
s_waitcnt lgkmcnt(6)
v_smfmac_f32_16x16x64_bf16 v[108:111], v[16:19], v[112:119], v8
s_waitcnt lgkmcnt(5)
v_smfmac_f32_16x16x64_bf16 v[108:111], v[20:23], v[120:127], v8
s_waitcnt lgkmcnt(4)
v_smfmac_f32_16x16x64_bf16 v[108:111], v[24:27], v[128:135], v8
s_waitcnt lgkmcnt(3)
v_smfmac_f32_16x16x64_bf16 v[108:111], v[40:43], v[160:167], v8
s_waitcnt lgkmcnt(2)
v_smfmac_f32_16x16x64_bf16 v[108:111], v[44:47], v[168:175], v8
s_waitcnt lgkmcnt(1)
v_smfmac_f32_16x16x64_bf16 v[108:111], v[48:51], v[80:87], v8
s_waitcnt lgkmcnt(0)
v_smfmac_f32_16x16x64_bf16 v[108:111], v[52:55], v[88:95], v8
s_nop 7
v_pk_add_f32 v[108:109], v[108:109], v[110:111]
v_cvt_pk_bf16_f32 v108, v108, v109
v_xor_b32 v108, s50, v108
s_nop 1
v_mov_b32_dpp v109, v108 quad_perm:[1,0,3,2] row_mask:0xf bank_mask:0xf
v_perm_b32 v108, v109, v108, v6
buffer_store_dword v108, v12, s[8:11], s77 offen sc1
buffer_store_dword v108, v12, s[8:11], s78 offen sc1
s_cmp_ge_u32 s62, 60
s_cbranch_scc1 Lc_337
Lc_338:
s_add_u32 s62, s62, 1
s_branch Lvo_324
Lg_332:
s_mov_b64 exec, s[16:17]
buffer_load_dwordx4 v[68:71], v1, s[8:11], s32 offen offset:0 sc1
s_mov_b64 exec, s[18:19]
buffer_load_dwordx4 v[72:75], v1, s[8:11], s32 offen offset:1024 sc1
s_mov_b64 exec, s[20:21]
buffer_load_dwordx4 v[76:79], v1, s[8:11], s32 offen offset:2048 sc1
s_mov_b64 exec, -1
s_waitcnt vmcnt(0)
v_max3_u32 v52, v68, v69, v70
v_max3_u32 v53, v72, v73, v74
v_max3_u32 v54, v76, v77, v78
v_max_u32 v52, v52, v71
v_max_u32 v53, v53, v75
v_max_u32 v54, v54, v79
v_cmp_eq_u32 s[16:17], -1, v52
v_cmp_eq_u32 s[18:19], -1, v53
v_cmp_eq_u32 s[20:21], -1, v54
s_or_b64 s[28:29], s[16:17], s[18:19]
s_or_b64 s[28:29], s[28:29], s[20:21]
s_cbranch_scc0 Lg_333
s_cmp_eq_u32 s65, 0
s_cbranch_scc1 Lg_333
s_sub_u32 s65, s65, 1
s_branch Lg_332
Lg_334:
Lg_335:
s_mov_b64 exec, s[22:23]
buffer_load_dwordx4 v[112:115], v1, s[8:11], s33 offen offset:0 sc1
s_mov_b64 exec, s[24:25]
buffer_load_dwordx4 v[116:119], v1, s[8:11], s33 offen offset:1024 sc1
s_mov_b64 exec, s[26:27]
buffer_load_dwordx4 v[120:123], v1, s[8:11], s33 offen offset:2048 sc1
s_mov_b64 exec, -1
s_waitcnt vmcnt(0)
v_max3_u32 v52, v112, v113, v114
v_max3_u32 v53, v116, v117, v118
v_max3_u32 v54, v120, v121, v122
v_max_u32 v52, v52, v115
v_max_u32 v53, v53, v119
v_max_u32 v54, v54, v123
v_cmp_eq_u32 s[22:23], -1, v52
v_cmp_eq_u32 s[24:25], -1, v53
v_cmp_eq_u32 s[26:27], -1, v54
s_or_b64 s[28:29], s[22:23], s[24:25]
s_or_b64 s[28:29], s[28:29], s[26:27]
s_cbranch_scc0 Lg_336
s_cmp_eq_u32 s65, 0
s_cbranch_scc1 Lg_336
s_sub_u32 s65, s65, 1
s_branch Lg_335
Lp_345:
s_mov_b64 exec, s[22:23]
buffer_load_dwordx4 v[80:83], v10, s[8:11], s72 offen sc1
s_mov_b64 exec, s[24:25]
buffer_load_dwordx4 v[84:87], v10, s[8:11], s73 offen sc1
s_mov_b64 exec, s[26:27]
buffer_load_dwordx4 v[88:91], v10, s[8:11], s74 offen sc1
s_mov_b64 exec, s[30:31]
buffer_load_dwordx4 v[92:95], v10, s[8:11], s75 offen sc1
s_mov_b64 exec, -1
buffer_load_dwordx4 v[96:99], v1, s[8:11], s76 offen offset:0 sc1
buffer_load_dwordx4 v[100:103], v1, s[8:11], s76 offen offset:1024 sc1
buffer_load_dwordx4 v[104:107], v1, s[8:11], s76 offen offset:2048 sc1
s_waitcnt vmcnt(3)
v_bitop3_b32 v20, v80, s62, 1 bitop3:0x28
v_bitop3_b32 v21, v84, s62, 1 bitop3:0x28
v_bitop3_b32 v22, v88, s62, 1 bitop3:0x28
v_bitop3_b32 v23, v92, s62, 1 bitop3:0x28
v_cmp_ne_u32 s[22:23], 0, v20
v_cmp_ne_u32 s[24:25], 0, v21
v_cmp_ne_u32 s[26:27], 0, v22
v_cmp_ne_u32 s[30:31], 0, v23
s_or_b64 s[28:29], s[22:23], s[24:25]
s_or_b64 s[28:29], s[28:29], s[26:27]
s_or_b64 s[28:29], s[28:29], s[30:31]
s_cbranch_scc1 Lp_341
s_branch Lp_345x
Lp_341:
s_waitcnt vmcnt(0)
v_bitop3_b32 v16, v96, v98, s50 bitop3:0x7e
v_bitop3_b32 v19, v97, v99, s50 bitop3:0x7e
v_or_b32 v16, v16, v19
v_cmp_gt_i32 s[16:17], 0, v16
v_bitop3_b32 v17, v100, v102, s50 bitop3:0x7e
v_bitop3_b32 v19, v101, v103, s50 bitop3:0x7e
v_or_b32 v17, v17, v19
v_cmp_gt_i32 s[18:19], 0, v17
v_bitop3_b32 v18, v104, v106, s50 bitop3:0x7e
v_bitop3_b32 v19, v105, v107, s50 bitop3:0x7e
v_or_b32 v18, v18, v19
v_cmp_gt_i32 s[20:21], 0, v18
s_or_b64 s[28:29], s[16:17], s[18:19]
s_or_b64 s[28:29], s[28:29], s[20:21]
Lp_346:
s_mov_b64 exec, s[22:23]
buffer_load_dwordx4 v[80:83], v10, s[8:11], s72 offen sc1
s_mov_b64 exec, s[24:25]
buffer_load_dwordx4 v[84:87], v10, s[8:11], s73 offen sc1
s_mov_b64 exec, s[26:27]
buffer_load_dwordx4 v[88:91], v10, s[8:11], s74 offen sc1
s_mov_b64 exec, s[30:31]
buffer_load_dwordx4 v[92:95], v10, s[8:11], s75 offen sc1
s_mov_b64 exec, -1
s_mov_b64 exec, s[16:17]
buffer_load_dwordx4 v[96:99], v1, s[8:11], s76 offen offset:0 sc1
s_mov_b64 exec, s[18:19]
buffer_load_dwordx4 v[100:103], v1, s[8:11], s76 offen offset:1024 sc1
s_mov_b64 exec, s[20:21]
buffer_load_dwordx4 v[104:107], v1, s[8:11], s76 offen offset:2048 sc1
s_mov_b64 exec, -1
s_waitcnt vmcnt(0)
v_bitop3_b32 v16, v96, v98, s50 bitop3:0x7e
v_bitop3_b32 v19, v97, v99, s50 bitop3:0x7e
v_or_b32 v16, v16, v19
v_cmp_gt_i32 s[16:17], 0, v16
v_bitop3_b32 v17, v100, v102, s50 bitop3:0x7e
v_bitop3_b32 v19, v101, v103, s50 bitop3:0x7e
v_or_b32 v17, v17, v19
v_cmp_gt_i32 s[18:19], 0, v17
v_bitop3_b32 v18, v104, v106, s50 bitop3:0x7e
v_bitop3_b32 v19, v105, v107, s50 bitop3:0x7e
v_or_b32 v18, v18, v19
v_cmp_gt_i32 s[20:21], 0, v18
s_or_b64 s[28:29], s[16:17], s[18:19]
s_or_b64 s[28:29], s[28:29], s[20:21]
s_cselect_b32 s51, 1, 0
v_bitop3_b32 v20, v80, s62, 1 bitop3:0x28
v_bitop3_b32 v21, v84, s62, 1 bitop3:0x28
v_bitop3_b32 v22, v88, s62, 1 bitop3:0x28
v_bitop3_b32 v23, v92, s62, 1 bitop3:0x28
v_cmp_ne_u32 s[22:23], 0, v20
v_cmp_ne_u32 s[24:25], 0, v21
v_cmp_ne_u32 s[26:27], 0, v22
v_cmp_ne_u32 s[30:31], 0, v23
s_or_b64 s[28:29], s[22:23], s[24:25]
s_or_b64 s[28:29], s[28:29], s[26:27]
s_or_b64 s[28:29], s[28:29], s[30:31]
s_cbranch_scc0 Lp_342
s_cmp_eq_u32 s65, 0
s_cbranch_scc1 Lp_342
s_sub_u32 s65, s65, 1
s_branch Lp_346
Lp_342:
s_cmp_eq_u32 s51, 0
s_cbranch_scc1 Lp_348
Lp_343:
Lp_347:
s_mov_b64 exec, s[16:17]
buffer_load_dwordx4 v[96:99], v1, s[8:11], s76 offen offset:0 sc1
s_mov_b64 exec, s[18:19]
buffer_load_dwordx4 v[100:103], v1, s[8:11], s76 offen offset:1024 sc1
s_mov_b64 exec, s[20:21]
buffer_load_dwordx4 v[104:107], v1, s[8:11], s76 offen offset:2048 sc1
s_mov_b64 exec, -1
s_waitcnt vmcnt(0)
v_bitop3_b32 v16, v96, v98, s50 bitop3:0x7e
v_bitop3_b32 v19, v97, v99, s50 bitop3:0x7e
v_or_b32 v16, v16, v19
v_cmp_gt_i32 s[16:17], 0, v16
v_bitop3_b32 v17, v100, v102, s50 bitop3:0x7e
v_bitop3_b32 v19, v101, v103, s50 bitop3:0x7e
v_or_b32 v17, v17, v19
v_cmp_gt_i32 s[18:19], 0, v17
v_bitop3_b32 v18, v104, v106, s50 bitop3:0x7e
v_bitop3_b32 v19, v105, v107, s50 bitop3:0x7e
v_or_b32 v18, v18, v19
v_cmp_gt_i32 s[20:21], 0, v18
s_or_b64 s[28:29], s[16:17], s[18:19]
s_or_b64 s[28:29], s[28:29], s[20:21]
s_cbranch_scc0 Lp_348
s_cmp_eq_u32 s65, 0
s_cbranch_scc1 Lp_348
s_sub_u32 s65, s65, 1
s_branch Lp_347
Lp_348:
ds_write_b128 v2, v[96:99] offset:0
ds_write_b128 v2, v[100:103] offset:1024
ds_write_b128 v2, v[104:107] offset:2048
s_branch Lp_344
Lc_337:
s_lshl_b32 s52, s62, 5
s_add_u32 s52, s52, s63
s_mul_i32 s52, s52, 10240
s_add_u32 s52, s52, 165675008
s_add_u32 s53, s52, 4096
s_add_u32 s54, s52, 8192
buffer_store_dwordx4 v[56:59], v11, s[8:11], s52 offen sc1
buffer_store_dwordx4 v[60:63], v11, s[8:11], s53 offen sc1
buffer_store_dwordx2 v[64:65], v9, s[8:11], s54 offen sc1
s_cmp_lt_u32 s62, 63
s_cbranch_scc1 Lc_338
s_waitcnt vmcnt(0)
s_barrier
s_waitcnt vmcnt(0)
s_endpgm
Lw_296:
s_mov_b32 s62, 0
s_mov_b32 s36, 0x03030303
s_mov_b32 s37, s36
ds_read_b128 v[80:83], v4 offset:0
ds_read_b128 v[84:87], v4 offset:1024
ds_read_b128 v[88:91], v4 offset:2048
ds_read_b128 v[92:95], v4 offset:3072
ds_read_b128 v[96:99], v4 offset:4096
ds_read_b128 v[100:103], v4 offset:5120
ds_read_b128 v[104:107], v4 offset:6144
ds_read_b128 v[108:111], v4 offset:7168
s_bitcmp1_b32 s62, 0
s_cselect_b32 s50, 0x80008000, 0
s_add_u32 s67, s62, 1
s_and_b32 s67, s67, 3
s_lshl_b32 s67, s67, 1
s_lshl_b32 s78, s67, 15
s_add_u32 s67, s67, s64
s_mul_i32 s77, s67, 10240
s_lshl_b32 s67, s66, 8
s_add_u32 s77, s77, s67
s_add_u32 s78, s78, s67
s_add_u32 s77, s77, 191889408
s_add_u32 s78, s78, s59
s_cmp_ge_u32 s66, 24
s_cselect_b32 s67, 26624, 0
s_add_u32 s78, s78, s67
s_mov_b32 s82, s62
s_mul_i32 s83, s82, 1638400
s_add_u32 s83, s83, s47
s_cmp_eq_u32 s62, 63
s_cselect_b32 s83, 536870912, s83
v_mov_b64 v[56:57], 0
v_mov_b64 v[58:59], 0
v_mov_b64 v[60:61], 0
v_mov_b64 v[62:63], 0
v_mov_b64 v[64:65], 0
v_mov_b64 v[66:67], 0
v_mov_b64 v[156:157], 0
v_mov_b64 v[158:159], 0
v_mov_b64 v[160:161], 0
v_mov_b64 v[162:163], 0
v_mov_b64 v[164:165], 0
v_mov_b64 v[166:167], 0
v_mov_b64 v[168:169], 0
v_mov_b64 v[170:171], 0
v_mov_b64 v[172:173], 0
v_mov_b64 v[174:175], 0
s_cmp_ge_u32 s62, 3
s_cbranch_scc1 Lk_351
s_sub_u32 s61, s82, 12
s_max_i32 s61, s61, 0
s_lshr_b32 s61, s61, 2
s_add_u32 s61, s61, s82
s_cmp_gt_u32 s60, s61
s_cbranch_scc1 Lfd_353
v_and_b32 v14, 15, v0
v_lshlrev_b32 v14, 7, v14
Lf_352:
buffer_load_dword v13, v14, s[8:11], s81 offen sc1
s_waitcnt vmcnt(0)
v_min_u32_dpp v13, v13, v13 row_ror:8 row_mask:0xf bank_mask:0xf
s_nop 1
v_min_u32_dpp v13, v13, v13 row_ror:4 row_mask:0xf bank_mask:0xf
s_nop 1
v_min_u32_dpp v13, v13, v13 row_ror:2 row_mask:0xf bank_mask:0xf
s_nop 1
v_min_u32_dpp v13, v13, v13 row_ror:1 row_mask:0xf bank_mask:0xf
s_nop 0
v_readfirstlane_b32 s60, v13
s_nop 0
s_cmp_gt_u32 s60, s61
s_cbranch_scc1 Lfd_353
s_cmp_eq_u32 s65, 0
s_cbranch_scc1 Lfd_353
s_sub_u32 s65, s65, 1
s_branch Lf_352
Lfd_353:
Lk_351:
ds_read_b128 v[16:19], v3 offset:6144
ds_read_b128 v[24:27], v3 offset:7168
s_waitcnt lgkmcnt(0)
s_branch Lvoent_350
Lvo_349:
s_barrier
ds_read_b128 v[80:83], v4 offset:0
ds_read_b128 v[84:87], v4 offset:1024
ds_read_b128 v[88:91], v4 offset:2048
ds_read_b128 v[92:95], v4 offset:3072
ds_read_b128 v[96:99], v4 offset:4096
ds_read_b128 v[100:103], v4 offset:5120
ds_read_b128 v[104:107], v4 offset:6144
ds_read_b128 v[108:111], v4 offset:7168
s_bitcmp1_b32 s62, 0
s_cselect_b32 s50, 0x80008000, 0
s_add_u32 s67, s62, 1
s_and_b32 s67, s67, 3
s_lshl_b32 s67, s67, 1
s_lshl_b32 s78, s67, 15
s_add_u32 s67, s67, s64
s_mul_i32 s77, s67, 10240
s_lshl_b32 s67, s66, 8
s_add_u32 s77, s77, s67
s_add_u32 s78, s78, s67
s_add_u32 s77, s77, 191889408
s_add_u32 s78, s78, s59
s_cmp_ge_u32 s66, 24
s_cselect_b32 s67, 26624, 0
s_add_u32 s78, s78, s67
s_mov_b32 s82, s62
s_mul_i32 s83, s82, 1638400
s_add_u32 s83, s83, s47
s_cmp_eq_u32 s62, 63
s_cselect_b32 s83, 536870912, s83
v_mov_b64 v[56:57], 0
v_mov_b64 v[58:59], 0
v_mov_b64 v[60:61], 0
v_mov_b64 v[62:63], 0
v_mov_b64 v[64:65], 0
v_mov_b64 v[66:67], 0
v_mov_b64 v[156:157], 0
v_mov_b64 v[158:159], 0
v_mov_b64 v[160:161], 0
v_mov_b64 v[162:163], 0
v_mov_b64 v[164:165], 0
v_mov_b64 v[166:167], 0
v_mov_b64 v[168:169], 0
v_mov_b64 v[170:171], 0
v_mov_b64 v[172:173], 0
v_mov_b64 v[174:175], 0
s_cmp_ge_u32 s62, 3
s_cbranch_scc1 Lk_354
s_sub_u32 s61, s82, 12
s_max_i32 s61, s61, 0
s_lshr_b32 s61, s61, 2
s_add_u32 s61, s61, s82
s_cmp_gt_u32 s60, s61
s_cbranch_scc1 Lfd_356
v_and_b32 v14, 15, v0
v_lshlrev_b32 v14, 7, v14
Lf_355:
buffer_load_dword v13, v14, s[8:11], s81 offen sc1
s_waitcnt vmcnt(0)
v_min_u32_dpp v13, v13, v13 row_ror:8 row_mask:0xf bank_mask:0xf
s_nop 1
v_min_u32_dpp v13, v13, v13 row_ror:4 row_mask:0xf bank_mask:0xf
s_nop 1
v_min_u32_dpp v13, v13, v13 row_ror:2 row_mask:0xf bank_mask:0xf
s_nop 1
v_min_u32_dpp v13, v13, v13 row_ror:1 row_mask:0xf bank_mask:0xf
s_nop 0
v_readfirstlane_b32 s60, v13
s_nop 0
s_cmp_gt_u32 s60, s61
s_cbranch_scc1 Lfd_356
s_cmp_eq_u32 s65, 0
s_cbranch_scc1 Lfd_356
s_sub_u32 s65, s65, 1
s_branch Lf_355
Lfd_356:
Lk_354:
s_sleep 1
s_waitcnt lgkmcnt(0)
buffer_load_dwordx4 v[68:71], v1, s[8:11], s32 offen offset:0 sc1
buffer_load_dwordx4 v[72:75], v1, s[8:11], s32 offen offset:1024 sc1
s_waitcnt vmcnt(0)
v_max3_u32 v52, v68, v69, v70
v_max3_u32 v53, v72, v73, v74
v_max_u32 v52, v52, v71
v_max_u32 v53, v53, v75
v_cmp_eq_u32 s[16:17], -1, v52
v_cmp_eq_u32 s[18:19], -1, v53
s_nop 0
s_or_b64 s[28:29], s[16:17], s[18:19]
s_cbranch_scc1 Lg_357
Lg_358:
buffer_load_dwordx4 v[112:115], v1, s[8:11], s33 offen offset:0 sc1
buffer_load_dwordx4 v[116:119], v1, s[8:11], s33 offen offset:1024 sc1
v_lshlrev_b32 v16, 16, v68
v_and_b32 v17, 0xffff0000, v68
v_lshlrev_b32 v18, 16, v69
v_and_b32 v19, 0xffff0000, v69
v_lshlrev_b32 v20, 16, v70
v_and_b32 v21, 0xffff0000, v70
v_lshlrev_b32 v22, 16, v71
v_and_b32 v23, 0xffff0000, v71
v_lshlrev_b32 v24, 16, v72
v_and_b32 v25, 0xffff0000, v72
v_lshlrev_b32 v26, 16, v73
v_and_b32 v27, 0xffff0000, v73
v_lshlrev_b32 v28, 16, v74
v_and_b32 v29, 0xffff0000, v74
v_lshlrev_b32 v30, 16, v75
v_and_b32 v31, 0xffff0000, v75
s_waitcnt vmcnt(0)
v_max3_u32 v52, v112, v113, v114
v_max3_u32 v53, v116, v117, v118
v_max_u32 v52, v52, v115
v_max_u32 v53, v53, v119
v_cmp_eq_u32 s[22:23], -1, v52
v_cmp_eq_u32 s[24:25], -1, v53
s_nop 0
s_or_b64 s[28:29], s[22:23], s[24:25]
s_cbranch_scc1 Lg_359
Lg_361:
v_dot2c_f32_bf16 v16, s100, v112
v_dot2c_f32_bf16 v17, s101, v112
v_dot2c_f32_bf16 v18, s100, v113
v_dot2c_f32_bf16 v19, s101, v113
v_dot2c_f32_bf16 v20, s100, v114
v_dot2c_f32_bf16 v21, s101, v114
v_dot2c_f32_bf16 v22, s100, v115
v_dot2c_f32_bf16 v23, s101, v115
v_cvt_pk_bf16_f32 v16, v16, v17
v_cvt_pk_bf16_f32 v17, v18, v19
v_cvt_pk_bf16_f32 v18, v20, v21
v_cvt_pk_bf16_f32 v19, v22, v23
ds_write_b128 v2, v[16:19] offset:0
v_dot2c_f32_bf16 v24, s100, v116
v_dot2c_f32_bf16 v25, s101, v116
v_dot2c_f32_bf16 v26, s100, v117
v_dot2c_f32_bf16 v27, s101, v117
v_dot2c_f32_bf16 v28, s100, v118
v_dot2c_f32_bf16 v29, s101, v118
v_dot2c_f32_bf16 v30, s100, v119
v_dot2c_f32_bf16 v31, s101, v119
v_cvt_pk_bf16_f32 v24, v24, v25
v_cvt_pk_bf16_f32 v25, v26, v27
v_cvt_pk_bf16_f32 v26, v28, v29
v_cvt_pk_bf16_f32 v27, v30, v31
ds_write_b128 v2, v[24:27] offset:1024
Lvoent_350:
v_smfmac_f32_16x16x64_bf16 v[56:59], v[16:19], a[32:39], v8
v_smfmac_f32_16x16x64_bf16 v[60:63], v[16:19], a[88:95], v8
buffer_load_dwordx4 v[112:115], v1, s[8:11], s83 offen offset:0 sc1
v_smfmac_f32_16x16x64_bf16 v[64:67], v[16:19], a[144:151], v8
v_smfmac_f32_16x16x64_bf16 v[56:59], v[24:27], a[40:47], v8
s_waitcnt lgkmcnt(0)
s_barrier
ds_read_b128 v[20:23], v3 offset:2048
v_mov_b64 v[16:17], 0
v_smfmac_f32_16x16x64_bf16 v[60:63], v[24:27], a[96:103], v8
ds_read_b128 v[28:31], v3 offset:0
buffer_load_dwordx4 v[116:119], v1, s[8:11], s83 offen offset:1024 sc1
v_mov_b64 v[18:19], 0
v_smfmac_f32_16x16x64_bf16 v[64:67], v[24:27], a[152:159], v8
ds_read_b128 v[32:35], v3 offset:1024
s_waitcnt lgkmcnt(2)
v_smfmac_f32_16x16x64_bf16 v[56:59], v[20:23], v[80:87], v8
ds_read_b128 v[36:39], v3 offset:5120
v_mov_b64 v[24:25], 0
v_smfmac_f32_16x16x64_bf16 v[60:63], v[20:23], v[88:95], v8
ds_read_b128 v[40:43], v3 offset:3072
buffer_load_dwordx4 v[120:123], v1, s[8:11], s83 offen offset:2048 sc1
ds_read_b128 v[80:83], v4 offset:12288
v_mov_b64 v[26:27], 0
v_smfmac_f32_16x16x64_bf16 v[64:67], v[20:23], v[96:103], v8
ds_read_b128 v[44:47], v3 offset:4096
ds_read_b128 v[84:87], v4 offset:13312
s_waitcnt lgkmcnt(6)
v_smfmac_f32_16x16x64_bf16 v[56:59], v[28:31], a[0:7], v8
ds_read_b128 v[48:51], v3 offset:9216
s_waitcnt lgkmcnt(6)
v_mov_b64 v[20:21], 0
v_smfmac_f32_16x16x64_bf16 v[56:59], v[32:35], a[8:15], v8
ds_read_b128 v[52:55], v3 offset:8192
buffer_load_dwordx4 v[124:127], v1, s[8:11], s83 offen offset:3072 sc1
s_waitcnt lgkmcnt(6)
v_mov_b64 v[22:23], 0
v_smfmac_f32_16x16x64_bf16 v[56:59], v[36:39], v[104:111], v8
s_add_u32 s83, s83, 4096
ds_read_b128 v[88:91], v4 offset:8192
s_waitcnt lgkmcnt(6)
v_smfmac_f32_16x16x64_bf16 v[56:59], v[40:43], a[16:23], v8
ds_read_b128 v[92:95], v4 offset:9216
s_waitcnt lgkmcnt(5)
v_smfmac_f32_16x16x64_bf16 v[56:59], v[44:47], a[24:31], v8
buffer_load_dwordx4 v[128:131], v1, s[8:11], s83 offen offset:0 sc1
ds_read_b128 v[96:99], v4 offset:14336
s_waitcnt lgkmcnt(4)
v_smfmac_f32_16x16x64_bf16 v[56:59], v[48:51], v[80:87], v8
ds_read_b128 v[100:103], v4 offset:15360
s_waitcnt lgkmcnt(4)
v_smfmac_f32_16x16x64_bf16 v[56:59], v[52:55], a[48:55], v8
ds_read_b128 v[104:107], v4 offset:10240
v_smfmac_f32_16x16x64_bf16 v[60:63], v[28:31], a[56:63], v8
buffer_load_dwordx4 v[132:135], v1, s[8:11], s83 offen offset:1024 sc1
ds_read_b128 v[108:111], v4 offset:11264
v_smfmac_f32_16x16x64_bf16 v[60:63], v[32:35], a[64:71], v8
ds_read_b128 v[80:83], v4 offset:16384
s_waitcnt lgkmcnt(5)
v_add_f32 v56, v56, v58
v_smfmac_f32_16x16x64_bf16 v[60:63], v[36:39], v[88:95], v8
ds_read_b128 v[84:87], v4 offset:17408
v_add_f32 v57, v57, v59
v_smfmac_f32_16x16x64_bf16 v[60:63], v[40:43], a[72:79], v8
buffer_load_dwordx4 v[136:139], v1, s[8:11], s83 offen offset:2048 sc1
ds_read_b128 v[88:91], v4 offset:18432
v_cvt_pk_bf16_f32 v56, v56, v57
v_smfmac_f32_16x16x64_bf16 v[60:63], v[44:47], a[80:87], v8
ds_read_b128 v[92:95], v4 offset:19456
s_waitcnt lgkmcnt(6)
v_smfmac_f32_16x16x64_bf16 v[60:63], v[48:51], v[96:103], v8
ds_read_b128 v[96:99], v4 offset:20480
v_mov_b32_dpp v57, v56 quad_perm:[1,0,3,2] row_mask:0xf bank_mask:0xf
v_smfmac_f32_16x16x64_bf16 v[60:63], v[52:55], a[104:111], v8
buffer_load_dwordx4 v[140:143], v1, s[8:11], s83 offen offset:3072 sc1
ds_read_b128 v[100:103], v4 offset:21504
v_perm_b32 v56, v57, v56, v6
v_smfmac_f32_16x16x64_bf16 v[64:67], v[28:31], a[112:119], v8
s_add_u32 s83, s83, 4096
ds_write_b32 v5, v56 offset:0
v_smfmac_f32_16x16x64_bf16 v[64:67], v[32:35], a[120:127], v8
s_waitcnt lgkmcnt(7)
v_add_f32 v60, v60, v62
v_smfmac_f32_16x16x64_bf16 v[64:67], v[36:39], v[104:111], v8
buffer_load_dwordx4 v[144:147], v1, s[8:11], s83 offen offset:0 sc1
ds_read_b128 v[104:107], v4 offset:24576
v_add_f32 v61, v61, v63
v_smfmac_f32_16x16x64_bf16 v[64:67], v[40:43], a[128:135], v8
s_waitcnt lgkmcnt(1)
s_barrier
ds_read_b128 v[68:71], v3 offset:12736
v_cvt_pk_bf16_f32 v60, v60, v61
v_smfmac_f32_16x16x64_bf16 v[64:67], v[44:47], a[136:143], v8
ds_read_b128 v[108:111], v4 offset:25600
v_mov_b64 v[28:29], 0
v_smfmac_f32_16x16x64_bf16 v[64:67], v[48:51], v[80:87], v8
buffer_load_dwordx4 v[148:151], v1, s[8:11], s83 offen offset:1024 sc1
ds_read_b128 v[80:83], v4 offset:22528
v_mov_b32_dpp v61, v60 quad_perm:[1,0,3,2] row_mask:0xf bank_mask:0xf
v_smfmac_f32_16x16x64_bf16 v[64:67], v[52:55], a[160:167], v8
ds_read_b128 v[84:87], v4 offset:23552
s_waitcnt lgkmcnt(3)
v_perm_b32 v60, v61, v60, v6
v_smfmac_f32_16x16x64_bf16 v[156:159], v[68:71], a[168:175], v8
ds_write_b32 v5, v60 offset:1024
v_mov_b64 v[30:31], 0
v_smfmac_f32_16x16x64_bf16 v[164:167], v[68:71], a[192:199], v8
buffer_load_dwordx4 v[152:155], v1, s[8:11], s83 offen offset:2048 sc1
v_add_f32 v64, v64, v66
v_add_f32 v65, v65, v67
v_smfmac_f32_16x16x64_bf16 v[160:163], v[68:71], v[88:95], v8
ds_read_b128 v[88:91], v4 offset:26624
v_cvt_pk_bf16_f32 v64, v64, v65
v_smfmac_f32_16x16x64_bf16 v[168:171], v[68:71], a[216:223], v8
s_waitcnt lgkmcnt(1)
s_barrier
ds_read_b128 v[72:75], v3 offset:13760
v_mov_b64 v[32:33], 0
v_smfmac_f32_16x16x64_bf16 v[172:175], v[68:71], a[240:247], v8
ds_read_b128 v[92:95], v4 offset:27648
v_mov_b32_dpp v65, v64 quad_perm:[1,0,3,2] row_mask:0xf bank_mask:0xf
v_perm_b32 v64, v65, v64, v6
v_smfmac_f32_16x16x64_bf16 v[24:27], v[68:71], v[184:191], v8
ds_write_b32 v5, v64 offset:2048
s_waitcnt lgkmcnt(2)
v_mov_b64 v[34:35], 0
v_smfmac_f32_16x16x64_bf16 v[156:159], v[72:75], a[176:183], v8
v_smfmac_f32_16x16x64_bf16 v[164:167], v[72:75], a[200:207], v8
v_smfmac_f32_16x16x64_bf16 v[160:163], v[72:75], v[96:103], v8
s_waitcnt lgkmcnt(0)
s_barrier
ds_read_b128 v[76:79], v3 offset:14784
v_smfmac_f32_16x16x64_bf16 v[168:171], v[72:75], a[224:231], v8
ds_read_b128 v[96:99], v4 offset:28672
v_smfmac_f32_16x16x64_bf16 v[16:19], v[68:71], v[104:111], v8
ds_read_b128 v[100:103], v4 offset:29696
v_smfmac_f32_16x16x64_bf16 v[20:23], v[68:71], v[208:215], v8
ds_read_b128 v[104:107], v4 offset:30720
s_waitcnt lgkmcnt(3)
v_smfmac_f32_16x16x64_bf16 v[156:159], v[76:79], a[184:191], v8
ds_read_b128 v[108:111], v4 offset:31744
v_smfmac_f32_16x16x64_bf16 v[160:163], v[76:79], v[80:87], v8
ds_read_b128 v[80:83], v4 offset:32768
v_smfmac_f32_16x16x64_bf16 v[164:167], v[76:79], a[208:215], v8
ds_read_b128 v[84:87], v4 offset:33792
v_add_f32 v156, v156, v158
v_add_f32 v157, v157, v159
v_smfmac_f32_16x16x64_bf16 v[168:171], v[76:79], a[232:239], v8
v_cvt_pk_bf16_f32 v56, v156, v157
v_add_f32 v160, v160, v162
v_smfmac_f32_16x16x64_bf16 v[172:175], v[72:75], a[248:255], v8
buffer_load_dwordx4 v[156:159], v1, s[8:11], s83 offen offset:3072 sc1
s_add_u32 s83, s83, 4096
v_add_f32 v161, v161, v163
v_add_f32 v164, v164, v166
v_smfmac_f32_16x16x64_bf16 v[16:19], v[72:75], v[88:95], v8
ds_read_b128 v[88:91], v4 offset:34816
v_cvt_pk_bf16_f32 v57, v160, v161
v_add_f32 v165, v165, v167
v_smfmac_f32_16x16x64_bf16 v[172:175], v[76:79], v[176:183], v8
buffer_load_dwordx4 v[160:163], v1, s[8:11], s83 offen offset:0 sc1
ds_read_b128 v[92:95], v4 offset:35840
v_cvt_pk_bf16_f32 v58, v164, v165
v_add_f32 v168, v168, v170
v_smfmac_f32_16x16x64_bf16 v[24:27], v[72:75], v[192:199], v8
buffer_load_dwordx4 v[164:167], v1, s[8:11], s83 offen offset:1024 sc1
s_waitcnt lgkmcnt(6)
v_add_f32 v169, v169, v171
v_permlane16_swap_b32 v56, v57
v_smfmac_f32_16x16x64_bf16 v[16:19], v[76:79], v[96:103], v8
v_cvt_pk_bf16_f32 v59, v168, v169
v_add_f32 v172, v172, v174
v_smfmac_f32_16x16x64_bf16 v[20:23], v[72:75], v[216:223], v8
buffer_load_dwordx4 v[168:171], v1, s[8:11], s83 offen offset:2048 sc1
v_permlane16_swap_b32 v58, v59
v_add_f32 v173, v173, v175
v_smfmac_f32_16x16x64_bf16 v[24:27], v[76:79], v[200:207], v8
v_permlane32_swap_b32 v56, v58
v_permlane32_swap_b32 v57, v59
v_smfmac_f32_16x16x64_bf16 v[28:31], v[68:71], v[232:239], v8
v_bfi_b32 v56, 1, s62, v56
v_cvt_pk_bf16_f32 v60, v172, v173
v_smfmac_f32_16x16x64_bf16 v[20:23], v[76:79], v[224:231], v8
buffer_store_dwordx4 v[56:59], v11, s[8:11], s44 offen sc1
s_waitcnt lgkmcnt(4)
v_add_f32 v16, v16, v18
v_add_f32 v17, v17, v19
v_smfmac_f32_16x16x64_bf16 v[32:35], v[68:71], v[104:111], v8
buffer_load_dwordx4 v[172:175], v1, s[8:11], s83 offen offset:3072 sc1
v_cvt_pk_bf16_f32 v61, v16, v17
v_add_f32 v24, v24, v26
v_smfmac_f32_16x16x64_bf16 v[28:31], v[72:75], v[240:247], v8
s_waitcnt lgkmcnt(2)
v_add_f32 v25, v25, v27
v_add_f32 v20, v20, v22
v_smfmac_f32_16x16x64_bf16 v[32:35], v[72:75], v[80:87], v8
v_cvt_pk_bf16_f32 v62, v24, v25
v_add_f32 v21, v21, v23
v_smfmac_f32_16x16x64_bf16 v[28:31], v[76:79], v[248:255], v8
s_waitcnt lgkmcnt(0)
v_cvt_pk_bf16_f32 v63, v20, v21
v_permlane16_swap_b32 v60, v61
v_smfmac_f32_16x16x64_bf16 v[32:35], v[76:79], v[88:95], v8
v_permlane16_swap_b32 v62, v63
s_nop 1
v_permlane32_swap_b32 v60, v62
v_permlane32_swap_b32 v61, v63
v_pk_add_f32 v[28:29], v[28:29], v[30:31]
v_bfi_b32 v60, 1, s62, v60
v_cvt_pk_bf16_f32 v64, v28, v29
v_pk_add_f32 v[32:33], v[32:33], v[34:35]
buffer_store_dwordx4 v[60:63], v11, s[8:11], s45 offen sc1
v_cvt_pk_bf16_f32 v65, v32, v33
s_nop 1
v_permlane16_swap_b32 v64, v65
v_bfi_b32 v64, 1, s62, v64
buffer_store_dwordx2 v[64:65], v9, s[8:11], s46 offen sc1
s_cmp_eq_u32 s62, 63
s_cbranch_scc1 Lc_362
s_add_u32 s67, s62, 1
s_and_b32 s67, s67, 3
s_lshl_b32 s67, s67, 1
s_lshl_b32 s68, s67, 15
s_add_u32 s67, s67, s64
s_mul_i32 s67, s67, 10240
s_add_u32 s33, s68, s58
s_add_u32 s32, s67, s80
s_add_u32 s32, s32, 191889408
s_sleep 4
buffer_load_dwordx4 v[80:83], v10, s[8:11], s72 offen sc1
buffer_load_dwordx4 v[84:87], v10, s[8:11], s73 offen sc1
buffer_load_dwordx4 v[88:91], v10, s[8:11], s74 offen sc1
buffer_load_dwordx4 v[92:95], v10, s[8:11], s75 offen sc1
v_mov_b32 v108, 0
v_mov_b32 v109, 0
v_mov_b32 v110, 0
v_mov_b32 v111, 0
s_waitcnt vmcnt(0)
v_bitop3_b32 v20, v80, v82, s62 bitop3:0x7e
v_and_b32 v20, 1, v20
v_bitop3_b32 v21, v84, v86, s62 bitop3:0x7e
v_and_b32 v21, 1, v21
v_bitop3_b32 v22, v88, v90, s62 bitop3:0x7e
v_and_b32 v22, 1, v22
v_bitop3_b32 v23, v92, v94, s62 bitop3:0x7e
v_and_b32 v23, 1, v23
v_cmp_ne_u32 s[22:23], 0, v20
v_cmp_ne_u32 s[24:25], 0, v21
v_cmp_ne_u32 s[26:27], 0, v22
v_cmp_ne_u32 s[30:31], 0, v23
s_or_b64 s[28:29], s[22:23], s[24:25]
s_or_b64 s[28:29], s[28:29], s[26:27]
s_or_b64 s[28:29], s[28:29], s[30:31]
s_cbranch_scc1 Lp_370
s_sleep 1
buffer_load_dwordx4 v[96:99], v1, s[8:11], s76 offen offset:0 sc1
buffer_load_dwordx4 v[100:103], v1, s[8:11], s76 offen offset:1024 sc1
Lp_370x:
s_waitcnt vmcnt(1)
ds_write_b128 v2, v[96:99] offset:0
v_bitop3_b32 v16, v96, v98, s50 bitop3:0x7e
v_cmp_gt_i32 s[16:17], 0, v16
s_waitcnt vmcnt(0)
ds_write_b128 v2, v[100:103] offset:1024
v_bitop3_b32 v17, v100, v102, s50 bitop3:0x7e
v_cmp_gt_i32 s[18:19], 0, v17
s_nop 0
s_or_b64 s[28:29], s[16:17], s[18:19]
s_cbranch_scc1 Lp_368
Lp_369:
v_smfmac_f32_16x16x64_bf16 v[108:111], v[96:99], v[160:167], v8
s_waitcnt lgkmcnt(0)
s_barrier
ds_read_b128 v[16:19], v3 offset:0
ds_read_b128 v[20:23], v3 offset:1024
ds_read_b128 v[24:27], v3 offset:2048
v_smfmac_f32_16x16x64_bf16 v[108:111], v[100:103], v[168:175], v8
ds_read_b128 v[28:31], v3 offset:3072
ds_read_b128 v[32:35], v3 offset:4096
ds_read_b128 v[36:39], v3 offset:5120
ds_read_b128 v[48:51], v3 offset:8192
ds_read_b128 v[52:55], v3 offset:9216
s_waitcnt vmcnt(0)
s_waitcnt lgkmcnt(7)
v_smfmac_f32_16x16x64_bf16 v[108:111], v[16:19], v[112:119], v8
s_waitcnt lgkmcnt(6)
v_smfmac_f32_16x16x64_bf16 v[108:111], v[20:23], v[120:127], v8
s_waitcnt lgkmcnt(5)
v_smfmac_f32_16x16x64_bf16 v[108:111], v[24:27], v[128:135], v8
s_waitcnt lgkmcnt(4)
v_smfmac_f32_16x16x64_bf16 v[108:111], v[28:31], v[136:143], v8
s_waitcnt lgkmcnt(3)
v_smfmac_f32_16x16x64_bf16 v[108:111], v[32:35], v[144:151], v8
s_waitcnt lgkmcnt(2)
v_smfmac_f32_16x16x64_bf16 v[108:111], v[36:39], v[152:159], v8
s_waitcnt lgkmcnt(1)
v_smfmac_f32_16x16x64_bf16 v[108:111], v[48:51], v[80:87], v8
s_waitcnt lgkmcnt(0)
v_smfmac_f32_16x16x64_bf16 v[108:111], v[52:55], v[88:95], v8
s_nop 7
v_pk_add_f32 v[108:109], v[108:109], v[110:111]
v_cvt_pk_bf16_f32 v108, v108, v109
v_xor_b32 v108, s50, v108
s_nop 1
v_mov_b32_dpp v109, v108 quad_perm:[1,0,3,2] row_mask:0xf bank_mask:0xf
v_perm_b32 v108, v109, v108, v6
buffer_store_dword v108, v12, s[8:11], s77 offen sc1
buffer_store_dword v108, v12, s[8:11], s78 offen sc1
s_cmp_ge_u32 s62, 60
s_cbranch_scc1 Lc_362
Lc_363:
s_add_u32 s62, s62, 1
s_branch Lvo_349
Lg_357:
s_mov_b64 exec, s[16:17]
buffer_load_dwordx4 v[68:71], v1, s[8:11], s32 offen offset:0 sc1
s_mov_b64 exec, s[18:19]
buffer_load_dwordx4 v[72:75], v1, s[8:11], s32 offen offset:1024 sc1
s_mov_b64 exec, -1
s_waitcnt vmcnt(0)
v_max3_u32 v52, v68, v69, v70
v_max3_u32 v53, v72, v73, v74
v_max_u32 v52, v52, v71
v_max_u32 v53, v53, v75
v_cmp_eq_u32 s[16:17], -1, v52
v_cmp_eq_u32 s[18:19], -1, v53
s_nop 0
s_or_b64 s[28:29], s[16:17], s[18:19]
s_cbranch_scc0 Lg_358
s_cmp_eq_u32 s65, 0
s_cbranch_scc1 Lg_358
s_sub_u32 s65, s65, 1
s_branch Lg_357
Lg_359:
Lg_360:
s_mov_b64 exec, s[22:23]
buffer_load_dwordx4 v[112:115], v1, s[8:11], s33 offen offset:0 sc1
s_mov_b64 exec, s[24:25]
buffer_load_dwordx4 v[116:119], v1, s[8:11], s33 offen offset:1024 sc1
s_mov_b64 exec, -1
s_waitcnt vmcnt(0)
v_max3_u32 v52, v112, v113, v114
v_max3_u32 v53, v116, v117, v118
v_max_u32 v52, v52, v115
v_max_u32 v53, v53, v119
v_cmp_eq_u32 s[22:23], -1, v52
v_cmp_eq_u32 s[24:25], -1, v53
s_nop 0
s_or_b64 s[28:29], s[22:23], s[24:25]
s_cbranch_scc0 Lg_361
s_cmp_eq_u32 s65, 0
s_cbranch_scc1 Lg_361
s_sub_u32 s65, s65, 1
s_branch Lg_360
Lp_370:
s_mov_b64 exec, s[22:23]
buffer_load_dwordx4 v[80:83], v10, s[8:11], s72 offen sc1
s_mov_b64 exec, s[24:25]
buffer_load_dwordx4 v[84:87], v10, s[8:11], s73 offen sc1
s_mov_b64 exec, s[26:27]
buffer_load_dwordx4 v[88:91], v10, s[8:11], s74 offen sc1
s_mov_b64 exec, s[30:31]
buffer_load_dwordx4 v[92:95], v10, s[8:11], s75 offen sc1
s_mov_b64 exec, -1
buffer_load_dwordx4 v[96:99], v1, s[8:11], s76 offen offset:0 sc1
buffer_load_dwordx4 v[100:103], v1, s[8:11], s76 offen offset:1024 sc1
s_waitcnt vmcnt(2)
v_bitop3_b32 v20, v80, v82, s62 bitop3:0x7e
v_and_b32 v20, 1, v20
v_bitop3_b32 v21, v84, v86, s62 bitop3:0x7e
v_and_b32 v21, 1, v21
v_bitop3_b32 v22, v88, v90, s62 bitop3:0x7e
v_and_b32 v22, 1, v22
v_bitop3_b32 v23, v92, v94, s62 bitop3:0x7e
v_and_b32 v23, 1, v23
v_cmp_ne_u32 s[22:23], 0, v20
v_cmp_ne_u32 s[24:25], 0, v21
v_cmp_ne_u32 s[26:27], 0, v22
v_cmp_ne_u32 s[30:31], 0, v23
s_or_b64 s[28:29], s[22:23], s[24:25]
s_or_b64 s[28:29], s[28:29], s[26:27]
s_or_b64 s[28:29], s[28:29], s[30:31]
s_cbranch_scc1 Lp_366
s_branch Lp_370x
Lp_366:
s_waitcnt vmcnt(0)
v_bitop3_b32 v16, v96, v98, s50 bitop3:0x7e
v_bitop3_b32 v19, v97, v99, s50 bitop3:0x7e
v_or_b32 v16, v16, v19
v_cmp_gt_i32 s[16:17], 0, v16
v_bitop3_b32 v17, v100, v102, s50 bitop3:0x7e
v_bitop3_b32 v19, v101, v103, s50 bitop3:0x7e
v_or_b32 v17, v17, v19
v_cmp_gt_i32 s[18:19], 0, v17
s_nop 0
s_or_b64 s[28:29], s[16:17], s[18:19]
Lp_371:
s_mov_b64 exec, s[22:23]
buffer_load_dwordx4 v[80:83], v10, s[8:11], s72 offen sc1
s_mov_b64 exec, s[24:25]
buffer_load_dwordx4 v[84:87], v10, s[8:11], s73 offen sc1
s_mov_b64 exec, s[26:27]
buffer_load_dwordx4 v[88:91], v10, s[8:11], s74 offen sc1
s_mov_b64 exec, s[30:31]
buffer_load_dwordx4 v[92:95], v10, s[8:11], s75 offen sc1
s_mov_b64 exec, -1
s_mov_b64 exec, s[16:17]
buffer_load_dwordx4 v[96:99], v1, s[8:11], s76 offen offset:0 sc1
s_mov_b64 exec, s[18:19]
buffer_load_dwordx4 v[100:103], v1, s[8:11], s76 offen offset:1024 sc1
s_mov_b64 exec, -1
s_waitcnt vmcnt(0)
v_bitop3_b32 v16, v96, v98, s50 bitop3:0x7e
v_bitop3_b32 v19, v97, v99, s50 bitop3:0x7e
v_or_b32 v16, v16, v19
v_cmp_gt_i32 s[16:17], 0, v16
v_bitop3_b32 v17, v100, v102, s50 bitop3:0x7e
v_bitop3_b32 v19, v101, v103, s50 bitop3:0x7e
v_or_b32 v17, v17, v19
v_cmp_gt_i32 s[18:19], 0, v17
s_nop 0
s_or_b64 s[28:29], s[16:17], s[18:19]
s_cselect_b32 s51, 1, 0
v_bitop3_b32 v20, v80, v82, s62 bitop3:0x7e
v_and_b32 v20, 1, v20
v_bitop3_b32 v21, v84, v86, s62 bitop3:0x7e
v_and_b32 v21, 1, v21
v_bitop3_b32 v22, v88, v90, s62 bitop3:0x7e
v_and_b32 v22, 1, v22
v_bitop3_b32 v23, v92, v94, s62 bitop3:0x7e
v_and_b32 v23, 1, v23
v_cmp_ne_u32 s[22:23], 0, v20
v_cmp_ne_u32 s[24:25], 0, v21
v_cmp_ne_u32 s[26:27], 0, v22
v_cmp_ne_u32 s[30:31], 0, v23
s_or_b64 s[28:29], s[22:23], s[24:25]
s_or_b64 s[28:29], s[28:29], s[26:27]
s_or_b64 s[28:29], s[28:29], s[30:31]
s_cbranch_scc0 Lp_367
s_cmp_eq_u32 s65, 0
s_cbranch_scc1 Lp_367
s_sub_u32 s65, s65, 1
s_branch Lp_371
Lp_367:
s_cmp_eq_u32 s51, 0
s_cbranch_scc1 Lp_373
Lp_368:
Lp_372:
s_mov_b64 exec, s[16:17]
buffer_load_dwordx4 v[96:99], v1, s[8:11], s76 offen offset:0 sc1
s_mov_b64 exec, s[18:19]
buffer_load_dwordx4 v[100:103], v1, s[8:11], s76 offen offset:1024 sc1
s_mov_b64 exec, -1
s_waitcnt vmcnt(0)
v_bitop3_b32 v16, v96, v98, s50 bitop3:0x7e
v_bitop3_b32 v19, v97, v99, s50 bitop3:0x7e
v_or_b32 v16, v16, v19
v_cmp_gt_i32 s[16:17], 0, v16
v_bitop3_b32 v17, v100, v102, s50 bitop3:0x7e
v_bitop3_b32 v19, v101, v103, s50 bitop3:0x7e
v_or_b32 v17, v17, v19
v_cmp_gt_i32 s[18:19], 0, v17
s_nop 0
s_or_b64 s[28:29], s[16:17], s[18:19]
s_cbranch_scc0 Lp_373
s_cmp_eq_u32 s65, 0
s_cbranch_scc1 Lp_373
s_sub_u32 s65, s65, 1
s_branch Lp_372
Lp_373:
ds_write_b128 v2, v[96:99] offset:0
ds_write_b128 v2, v[100:103] offset:1024
s_branch Lp_369
Lc_362:
s_lshl_b32 s52, s62, 5
s_add_u32 s52, s52, s63
s_mul_i32 s52, s52, 10240
s_add_u32 s52, s52, 165675008
s_add_u32 s53, s52, 4096
s_add_u32 s54, s52, 8192
buffer_store_dwordx4 v[56:59], v11, s[8:11], s52 offen sc1
buffer_store_dwordx4 v[60:63], v11, s[8:11], s53 offen sc1
buffer_store_dwordx2 v[64:65], v9, s[8:11], s54 offen sc1
s_cmp_lt_u32 s62, 63
s_cbranch_scc1 Lc_363
s_waitcnt vmcnt(0)
s_barrier
s_waitcnt vmcnt(0)
s_endpgm
Lw_297:
s_mov_b32 s62, 0
s_mov_b32 s36, 0x03030303
s_mov_b32 s37, s36
ds_read_b128 v[80:83], v4 offset:0
ds_read_b128 v[84:87], v4 offset:1024
ds_read_b128 v[88:91], v4 offset:2048
ds_read_b128 v[92:95], v4 offset:3072
ds_read_b128 v[96:99], v4 offset:4096
ds_read_b128 v[100:103], v4 offset:5120
ds_read_b128 v[104:107], v4 offset:6144
ds_read_b128 v[108:111], v4 offset:7168
s_bitcmp1_b32 s62, 0
s_cselect_b32 s50, 0x80008000, 0
v_mov_b64 v[56:57], 0
v_mov_b64 v[58:59], 0
v_mov_b64 v[60:61], 0
v_mov_b64 v[62:63], 0
v_mov_b64 v[64:65], 0
v_mov_b64 v[66:67], 0
v_mov_b64 v[156:157], 0
v_mov_b64 v[158:159], 0
v_mov_b64 v[160:161], 0
v_mov_b64 v[162:163], 0
v_mov_b64 v[164:165], 0
v_mov_b64 v[166:167], 0
v_mov_b64 v[168:169], 0
v_mov_b64 v[170:171], 0
v_mov_b64 v[172:173], 0
v_mov_b64 v[174:175], 0
ds_read_b128 v[16:19], v3 offset:6144
ds_read_b128 v[24:27], v3 offset:7168
s_waitcnt lgkmcnt(0)
s_branch Lvoent_375
Lvo_374:
s_barrier
ds_read_b128 v[80:83], v4 offset:0
ds_read_b128 v[84:87], v4 offset:1024
ds_read_b128 v[88:91], v4 offset:2048
ds_read_b128 v[92:95], v4 offset:3072
ds_read_b128 v[96:99], v4 offset:4096
ds_read_b128 v[100:103], v4 offset:5120
ds_read_b128 v[104:107], v4 offset:6144
ds_read_b128 v[108:111], v4 offset:7168
s_bitcmp1_b32 s62, 0
s_cselect_b32 s50, 0x80008000, 0
v_mov_b64 v[56:57], 0
v_mov_b64 v[58:59], 0
v_mov_b64 v[60:61], 0
v_mov_b64 v[62:63], 0
v_mov_b64 v[64:65], 0
v_mov_b64 v[66:67], 0
v_mov_b64 v[156:157], 0
v_mov_b64 v[158:159], 0
v_mov_b64 v[160:161], 0
v_mov_b64 v[162:163], 0
v_mov_b64 v[164:165], 0
v_mov_b64 v[166:167], 0
v_mov_b64 v[168:169], 0
v_mov_b64 v[170:171], 0
v_mov_b64 v[172:173], 0
v_mov_b64 v[174:175], 0
s_sleep 1
s_waitcnt lgkmcnt(0)
buffer_load_dwordx4 v[68:71], v1, s[8:11], s32 offen offset:0 sc1
buffer_load_dwordx4 v[72:75], v1, s[8:11], s32 offen offset:1024 sc1
s_waitcnt vmcnt(0)
v_max3_u32 v52, v68, v69, v70
v_max3_u32 v53, v72, v73, v74
v_max_u32 v52, v52, v71
v_max_u32 v53, v53, v75
v_cmp_eq_u32 s[16:17], -1, v52
v_cmp_eq_u32 s[18:19], -1, v53
s_nop 0
s_or_b64 s[28:29], s[16:17], s[18:19]
s_cbranch_scc1 Lg_376
Lg_377:
buffer_load_dwordx4 v[112:115], v1, s[8:11], s33 offen offset:0 sc1
buffer_load_dwordx4 v[116:119], v1, s[8:11], s33 offen offset:1024 sc1
v_lshlrev_b32 v16, 16, v68
v_and_b32 v17, 0xffff0000, v68
v_lshlrev_b32 v18, 16, v69
v_and_b32 v19, 0xffff0000, v69
v_lshlrev_b32 v20, 16, v70
v_and_b32 v21, 0xffff0000, v70
v_lshlrev_b32 v22, 16, v71
v_and_b32 v23, 0xffff0000, v71
v_lshlrev_b32 v24, 16, v72
v_and_b32 v25, 0xffff0000, v72
v_lshlrev_b32 v26, 16, v73
v_and_b32 v27, 0xffff0000, v73
v_lshlrev_b32 v28, 16, v74
v_and_b32 v29, 0xffff0000, v74
v_lshlrev_b32 v30, 16, v75
v_and_b32 v31, 0xffff0000, v75
s_waitcnt vmcnt(0)
v_max3_u32 v52, v112, v113, v114
v_max3_u32 v53, v116, v117, v118
v_max_u32 v52, v52, v115
v_max_u32 v53, v53, v119
v_cmp_eq_u32 s[22:23], -1, v52
v_cmp_eq_u32 s[24:25], -1, v53
s_nop 0
s_or_b64 s[28:29], s[22:23], s[24:25]
s_cbranch_scc1 Lg_378
Lg_380:
v_dot2c_f32_bf16 v16, s100, v112
v_dot2c_f32_bf16 v17, s101, v112
v_dot2c_f32_bf16 v18, s100, v113
v_dot2c_f32_bf16 v19, s101, v113
v_dot2c_f32_bf16 v20, s100, v114
v_dot2c_f32_bf16 v21, s101, v114
v_dot2c_f32_bf16 v22, s100, v115
v_dot2c_f32_bf16 v23, s101, v115
v_cvt_pk_bf16_f32 v16, v16, v17
v_cvt_pk_bf16_f32 v17, v18, v19
v_cvt_pk_bf16_f32 v18, v20, v21
v_cvt_pk_bf16_f32 v19, v22, v23
ds_write_b128 v2, v[16:19] offset:0
v_dot2c_f32_bf16 v24, s100, v116
v_dot2c_f32_bf16 v25, s101, v116
v_dot2c_f32_bf16 v26, s100, v117
v_dot2c_f32_bf16 v27, s101, v117
v_dot2c_f32_bf16 v28, s100, v118
v_dot2c_f32_bf16 v29, s101, v118
v_dot2c_f32_bf16 v30, s100, v119
v_dot2c_f32_bf16 v31, s101, v119
v_cvt_pk_bf16_f32 v24, v24, v25
v_cvt_pk_bf16_f32 v25, v26, v27
v_cvt_pk_bf16_f32 v26, v28, v29
v_cvt_pk_bf16_f32 v27, v30, v31
ds_write_b128 v2, v[24:27] offset:1024
Lvoent_375:
v_smfmac_f32_16x16x64_bf16 v[56:59], v[16:19], a[32:39], v8
v_smfmac_f32_16x16x64_bf16 v[60:63], v[16:19], a[88:95], v8
v_smfmac_f32_16x16x64_bf16 v[64:67], v[16:19], a[144:151], v8
v_smfmac_f32_16x16x64_bf16 v[56:59], v[24:27], a[40:47], v8
s_waitcnt lgkmcnt(0)
s_barrier
ds_read_b128 v[20:23], v3 offset:2048
v_mov_b64 v[16:17], 0
v_smfmac_f32_16x16x64_bf16 v[60:63], v[24:27], a[96:103], v8
ds_read_b128 v[28:31], v3 offset:0
v_mov_b64 v[18:19], 0
v_smfmac_f32_16x16x64_bf16 v[64:67], v[24:27], a[152:159], v8
ds_read_b128 v[32:35], v3 offset:1024
s_waitcnt lgkmcnt(2)
v_smfmac_f32_16x16x64_bf16 v[56:59], v[20:23], v[80:87], v8
ds_read_b128 v[36:39], v3 offset:5120
v_mov_b64 v[24:25], 0
v_smfmac_f32_16x16x64_bf16 v[60:63], v[20:23], v[88:95], v8
ds_read_b128 v[40:43], v3 offset:3072
ds_read_b128 v[80:83], v4 offset:12288
v_mov_b64 v[26:27], 0
v_smfmac_f32_16x16x64_bf16 v[64:67], v[20:23], v[96:103], v8
ds_read_b128 v[44:47], v3 offset:4096
ds_read_b128 v[84:87], v4 offset:13312
s_waitcnt lgkmcnt(6)
v_smfmac_f32_16x16x64_bf16 v[56:59], v[28:31], a[0:7], v8
ds_read_b128 v[48:51], v3 offset:9216
s_waitcnt lgkmcnt(6)
v_mov_b64 v[20:21], 0
v_smfmac_f32_16x16x64_bf16 v[56:59], v[32:35], a[8:15], v8
ds_read_b128 v[52:55], v3 offset:8192
s_waitcnt lgkmcnt(6)
v_mov_b64 v[22:23], 0
v_smfmac_f32_16x16x64_bf16 v[56:59], v[36:39], v[104:111], v8
ds_read_b128 v[88:91], v4 offset:8192
s_waitcnt lgkmcnt(6)
v_smfmac_f32_16x16x64_bf16 v[56:59], v[40:43], a[16:23], v8
ds_read_b128 v[92:95], v4 offset:9216
s_waitcnt lgkmcnt(5)
v_smfmac_f32_16x16x64_bf16 v[56:59], v[44:47], a[24:31], v8
ds_read_b128 v[96:99], v4 offset:14336
s_waitcnt lgkmcnt(4)
v_smfmac_f32_16x16x64_bf16 v[56:59], v[48:51], v[80:87], v8
ds_read_b128 v[100:103], v4 offset:15360
s_waitcnt lgkmcnt(4)
v_smfmac_f32_16x16x64_bf16 v[56:59], v[52:55], a[48:55], v8
ds_read_b128 v[104:107], v4 offset:10240
v_smfmac_f32_16x16x64_bf16 v[60:63], v[28:31], a[56:63], v8
ds_read_b128 v[108:111], v4 offset:11264
v_smfmac_f32_16x16x64_bf16 v[60:63], v[32:35], a[64:71], v8
ds_read_b128 v[80:83], v4 offset:16384
s_waitcnt lgkmcnt(5)
v_add_f32 v56, v56, v58
v_smfmac_f32_16x16x64_bf16 v[60:63], v[36:39], v[88:95], v8
ds_read_b128 v[84:87], v4 offset:17408
v_add_f32 v57, v57, v59
v_smfmac_f32_16x16x64_bf16 v[60:63], v[40:43], a[72:79], v8
ds_read_b128 v[88:91], v4 offset:18432
v_cvt_pk_bf16_f32 v56, v56, v57
v_smfmac_f32_16x16x64_bf16 v[60:63], v[44:47], a[80:87], v8
ds_read_b128 v[92:95], v4 offset:19456
s_waitcnt lgkmcnt(6)
v_smfmac_f32_16x16x64_bf16 v[60:63], v[48:51], v[96:103], v8
ds_read_b128 v[96:99], v4 offset:20480
v_mov_b32_dpp v57, v56 quad_perm:[1,0,3,2] row_mask:0xf bank_mask:0xf
v_smfmac_f32_16x16x64_bf16 v[60:63], v[52:55], a[104:111], v8
ds_read_b128 v[100:103], v4 offset:21504
v_perm_b32 v56, v57, v56, v6
v_smfmac_f32_16x16x64_bf16 v[64:67], v[28:31], a[112:119], v8
ds_write_b32 v5, v56 offset:0
v_smfmac_f32_16x16x64_bf16 v[64:67], v[32:35], a[120:127], v8
s_waitcnt lgkmcnt(7)
v_add_f32 v60, v60, v62
v_smfmac_f32_16x16x64_bf16 v[64:67], v[36:39], v[104:111], v8
ds_read_b128 v[104:107], v4 offset:24576
v_add_f32 v61, v61, v63
v_smfmac_f32_16x16x64_bf16 v[64:67], v[40:43], a[128:135], v8
s_waitcnt lgkmcnt(1)
s_barrier
ds_read_b128 v[68:71], v3 offset:12736
v_cvt_pk_bf16_f32 v60, v60, v61
v_smfmac_f32_16x16x64_bf16 v[64:67], v[44:47], a[136:143], v8
ds_read_b128 v[108:111], v4 offset:25600
v_mov_b64 v[28:29], 0
v_smfmac_f32_16x16x64_bf16 v[64:67], v[48:51], v[80:87], v8
ds_read_b128 v[80:83], v4 offset:22528
v_mov_b32_dpp v61, v60 quad_perm:[1,0,3,2] row_mask:0xf bank_mask:0xf
v_smfmac_f32_16x16x64_bf16 v[64:67], v[52:55], a[160:167], v8
ds_read_b128 v[84:87], v4 offset:23552
s_waitcnt lgkmcnt(3)
v_perm_b32 v60, v61, v60, v6
v_smfmac_f32_16x16x64_bf16 v[156:159], v[68:71], a[168:175], v8
ds_write_b32 v5, v60 offset:1024
v_mov_b64 v[30:31], 0
v_smfmac_f32_16x16x64_bf16 v[164:167], v[68:71], a[192:199], v8
v_add_f32 v64, v64, v66
v_add_f32 v65, v65, v67
v_smfmac_f32_16x16x64_bf16 v[160:163], v[68:71], v[88:95], v8
ds_read_b128 v[88:91], v4 offset:26624
v_cvt_pk_bf16_f32 v64, v64, v65
v_smfmac_f32_16x16x64_bf16 v[168:171], v[68:71], a[216:223], v8
s_waitcnt lgkmcnt(1)
s_barrier
ds_read_b128 v[72:75], v3 offset:13760
v_mov_b64 v[32:33], 0
v_smfmac_f32_16x16x64_bf16 v[172:175], v[68:71], a[240:247], v8
ds_read_b128 v[92:95], v4 offset:27648
v_mov_b32_dpp v65, v64 quad_perm:[1,0,3,2] row_mask:0xf bank_mask:0xf
v_perm_b32 v64, v65, v64, v6
v_smfmac_f32_16x16x64_bf16 v[24:27], v[68:71], v[184:191], v8
ds_write_b32 v5, v64 offset:2048
s_waitcnt lgkmcnt(2)
v_mov_b64 v[34:35], 0
v_smfmac_f32_16x16x64_bf16 v[156:159], v[72:75], a[176:183], v8
v_smfmac_f32_16x16x64_bf16 v[164:167], v[72:75], a[200:207], v8
v_smfmac_f32_16x16x64_bf16 v[160:163], v[72:75], v[96:103], v8
s_waitcnt lgkmcnt(0)
s_barrier
ds_read_b128 v[76:79], v3 offset:14784
v_smfmac_f32_16x16x64_bf16 v[168:171], v[72:75], a[224:231], v8
ds_read_b128 v[96:99], v4 offset:28672
v_smfmac_f32_16x16x64_bf16 v[16:19], v[68:71], v[104:111], v8
ds_read_b128 v[100:103], v4 offset:29696
v_smfmac_f32_16x16x64_bf16 v[20:23], v[68:71], v[208:215], v8
ds_read_b128 v[104:107], v4 offset:30720
s_waitcnt lgkmcnt(3)
v_smfmac_f32_16x16x64_bf16 v[156:159], v[76:79], a[184:191], v8
ds_read_b128 v[108:111], v4 offset:31744
v_smfmac_f32_16x16x64_bf16 v[160:163], v[76:79], v[80:87], v8
ds_read_b128 v[80:83], v4 offset:32768
v_smfmac_f32_16x16x64_bf16 v[164:167], v[76:79], a[208:215], v8
ds_read_b128 v[84:87], v4 offset:33792
v_add_f32 v156, v156, v158
v_add_f32 v157, v157, v159
v_smfmac_f32_16x16x64_bf16 v[168:171], v[76:79], a[232:239], v8
v_cvt_pk_bf16_f32 v56, v156, v157
v_add_f32 v160, v160, v162
v_smfmac_f32_16x16x64_bf16 v[172:175], v[72:75], a[248:255], v8
v_add_f32 v161, v161, v163
v_add_f32 v164, v164, v166
v_smfmac_f32_16x16x64_bf16 v[16:19], v[72:75], v[88:95], v8
ds_read_b128 v[88:91], v4 offset:34816
v_cvt_pk_bf16_f32 v57, v160, v161
v_add_f32 v165, v165, v167
v_smfmac_f32_16x16x64_bf16 v[172:175], v[76:79], v[176:183], v8
ds_read_b128 v[92:95], v4 offset:35840
v_cvt_pk_bf16_f32 v58, v164, v165
v_add_f32 v168, v168, v170
v_smfmac_f32_16x16x64_bf16 v[24:27], v[72:75], v[192:199], v8
s_waitcnt lgkmcnt(6)
v_add_f32 v169, v169, v171
v_permlane16_swap_b32 v56, v57
v_smfmac_f32_16x16x64_bf16 v[16:19], v[76:79], v[96:103], v8
v_cvt_pk_bf16_f32 v59, v168, v169
v_add_f32 v172, v172, v174
v_smfmac_f32_16x16x64_bf16 v[20:23], v[72:75], v[216:223], v8
v_permlane16_swap_b32 v58, v59
v_add_f32 v173, v173, v175
v_smfmac_f32_16x16x64_bf16 v[24:27], v[76:79], v[200:207], v8
v_permlane32_swap_b32 v56, v58
v_permlane32_swap_b32 v57, v59
v_smfmac_f32_16x16x64_bf16 v[28:31], v[68:71], v[232:239], v8
v_bfi_b32 v56, 1, s62, v56
v_cvt_pk_bf16_f32 v60, v172, v173
v_smfmac_f32_16x16x64_bf16 v[20:23], v[76:79], v[224:231], v8
buffer_store_dwordx4 v[56:59], v11, s[8:11], s44 offen sc1
s_waitcnt lgkmcnt(4)
v_add_f32 v16, v16, v18
v_add_f32 v17, v17, v19
v_smfmac_f32_16x16x64_bf16 v[32:35], v[68:71], v[104:111], v8
v_cvt_pk_bf16_f32 v61, v16, v17
v_add_f32 v24, v24, v26
v_smfmac_f32_16x16x64_bf16 v[28:31], v[72:75], v[240:247], v8
s_waitcnt lgkmcnt(2)
v_add_f32 v25, v25, v27
v_add_f32 v20, v20, v22
v_smfmac_f32_16x16x64_bf16 v[32:35], v[72:75], v[80:87], v8
v_cvt_pk_bf16_f32 v62, v24, v25
v_add_f32 v21, v21, v23
v_smfmac_f32_16x16x64_bf16 v[28:31], v[76:79], v[248:255], v8
s_waitcnt lgkmcnt(0)
v_cvt_pk_bf16_f32 v63, v20, v21
v_permlane16_swap_b32 v60, v61
v_smfmac_f32_16x16x64_bf16 v[32:35], v[76:79], v[88:95], v8
v_permlane16_swap_b32 v62, v63
s_nop 1
v_permlane32_swap_b32 v60, v62
v_permlane32_swap_b32 v61, v63
v_pk_add_f32 v[28:29], v[28:29], v[30:31]
v_bfi_b32 v60, 1, s62, v60
v_cvt_pk_bf16_f32 v64, v28, v29
v_pk_add_f32 v[32:33], v[32:33], v[34:35]
buffer_store_dwordx4 v[60:63], v11, s[8:11], s45 offen sc1
v_cvt_pk_bf16_f32 v65, v32, v33
s_nop 1
v_permlane16_swap_b32 v64, v65
v_bfi_b32 v64, 1, s62, v64
buffer_store_dwordx2 v[64:65], v9, s[8:11], s46 offen sc1
s_cmp_eq_u32 s62, 63
s_cbranch_scc1 Lc_381
s_add_u32 s67, s62, 1
s_and_b32 s67, s67, 3
s_lshl_b32 s67, s67, 1
s_lshl_b32 s68, s67, 15
s_add_u32 s67, s67, s64
s_mul_i32 s67, s67, 10240
s_add_u32 s33, s68, s58
s_add_u32 s32, s67, s80
s_add_u32 s32, s32, 191889408
s_sleep 9
buffer_load_dwordx4 v[96:99], v1, s[8:11], s76 offen offset:0 sc1
buffer_load_dwordx4 v[100:103], v1, s[8:11], s76 offen offset:1024 sc1
s_waitcnt vmcnt(1)
ds_write_b128 v2, v[96:99] offset:0
v_bitop3_b32 v16, v96, v98, s50 bitop3:0x7e
v_cmp_gt_i32 s[16:17], 0, v16
s_waitcnt vmcnt(0)
ds_write_b128 v2, v[100:103] offset:1024
v_bitop3_b32 v17, v100, v102, s50 bitop3:0x7e
v_cmp_gt_i32 s[18:19], 0, v17
s_nop 0
s_or_b64 s[28:29], s[16:17], s[18:19]
s_cbranch_scc1 Lp_387
Lp_388:
s_waitcnt lgkmcnt(0)
s_barrier
s_waitcnt vmcnt(0)
s_cmp_ge_u32 s62, 60
s_cbranch_scc1 Lc_381
Lc_382:
s_add_u32 s62, s62, 1
s_branch Lvo_374
Lg_376:
s_mov_b64 exec, s[16:17]
buffer_load_dwordx4 v[68:71], v1, s[8:11], s32 offen offset:0 sc1
s_mov_b64 exec, s[18:19]
buffer_load_dwordx4 v[72:75], v1, s[8:11], s32 offen offset:1024 sc1
s_mov_b64 exec, -1
s_waitcnt vmcnt(0)
v_max3_u32 v52, v68, v69, v70
v_max3_u32 v53, v72, v73, v74
v_max_u32 v52, v52, v71
v_max_u32 v53, v53, v75
v_cmp_eq_u32 s[16:17], -1, v52
v_cmp_eq_u32 s[18:19], -1, v53
s_nop 0
s_or_b64 s[28:29], s[16:17], s[18:19]
s_cbranch_scc0 Lg_377
s_cmp_eq_u32 s65, 0
s_cbranch_scc1 Lg_377
s_sub_u32 s65, s65, 1
s_branch Lg_376
Lg_378:
Lg_379:
s_mov_b64 exec, s[22:23]
buffer_load_dwordx4 v[112:115], v1, s[8:11], s33 offen offset:0 sc1
s_mov_b64 exec, s[24:25]
buffer_load_dwordx4 v[116:119], v1, s[8:11], s33 offen offset:1024 sc1
s_mov_b64 exec, -1
s_waitcnt vmcnt(0)
v_max3_u32 v52, v112, v113, v114
v_max3_u32 v53, v116, v117, v118
v_max_u32 v52, v52, v115
v_max_u32 v53, v53, v119
v_cmp_eq_u32 s[22:23], -1, v52
v_cmp_eq_u32 s[24:25], -1, v53
s_nop 0
s_or_b64 s[28:29], s[22:23], s[24:25]
s_cbranch_scc0 Lg_380
s_cmp_eq_u32 s65, 0
s_cbranch_scc1 Lg_380
s_sub_u32 s65, s65, 1
s_branch Lg_379
Lp_387:
Lp_390:
s_mov_b64 exec, s[16:17]
buffer_load_dwordx4 v[96:99], v1, s[8:11], s76 offen offset:0 sc1
s_mov_b64 exec, s[18:19]
buffer_load_dwordx4 v[100:103], v1, s[8:11], s76 offen offset:1024 sc1
s_mov_b64 exec, -1
s_waitcnt vmcnt(0)
v_bitop3_b32 v16, v96, v98, s50 bitop3:0x7e
v_bitop3_b32 v19, v97, v99, s50 bitop3:0x7e
v_or_b32 v16, v16, v19
v_cmp_gt_i32 s[16:17], 0, v16
v_bitop3_b32 v17, v100, v102, s50 bitop3:0x7e
v_bitop3_b32 v19, v101, v103, s50 bitop3:0x7e
v_or_b32 v17, v17, v19
v_cmp_gt_i32 s[18:19], 0, v17
s_nop 0
s_or_b64 s[28:29], s[16:17], s[18:19]
s_cbranch_scc0 Lp_391
s_cmp_eq_u32 s65, 0
s_cbranch_scc1 Lp_391
s_sub_u32 s65, s65, 1
s_branch Lp_390
Lp_391:
ds_write_b128 v2, v[96:99] offset:0
ds_write_b128 v2, v[100:103] offset:1024
s_branch Lp_388
Lc_381:
s_lshl_b32 s52, s62, 5
s_add_u32 s52, s52, s63
s_mul_i32 s52, s52, 10240
s_add_u32 s52, s52, 165675008
s_add_u32 s53, s52, 4096
s_add_u32 s54, s52, 8192
buffer_store_dwordx4 v[56:59], v11, s[8:11], s52 offen sc1
buffer_store_dwordx4 v[60:63], v11, s[8:11], s53 offen sc1
buffer_store_dwordx2 v[64:65], v9, s[8:11], s54 offen sc1
s_cmp_lt_u32 s62, 63
s_cbranch_scc1 Lc_382
s_waitcnt vmcnt(0)
s_barrier
s_waitcnt vmcnt(0)
s_endpgm
Lw_298:
s_mov_b32 s62, 0
s_mov_b32 s36, 0x03030303
s_mov_b32 s37, s36
ds_read_b128 v[80:83], v4 offset:12288
ds_read_b128 v[84:87], v4 offset:13312
ds_read_b128 v[88:91], v4 offset:14336
ds_read_b128 v[92:95], v4 offset:15360
ds_read_b128 v[96:99], v4 offset:16384
ds_read_b128 v[100:103], v4 offset:17408
ds_read_b128 v[104:107], v4 offset:0
ds_read_b128 v[108:111], v4 offset:1024
s_bitcmp1_b32 s62, 0
s_cselect_b32 s50, 0x80008000, 0
s_lshl_b32 s48, s5, 7
s_add_u32 s48, s48, 193026048
s_cmp_gt_u32 s62, 60
s_cselect_b32 s48, s48, 536870912
v_mov_b32 v14, s62
v_min_u32 v13, 1, v0
v_lshlrev_b32 v13, 30, v13
v_mov_b32 v15, -1
s_and_b32 s35, s63, 15
s_add_u32 s67, s62, 2
s_and_b32 s67, s67, 3
s_lshl_b32 s67, s67, 1
s_lshl_b32 s53, s67, 15
s_add_u32 s67, s67, s64
s_mul_i32 s52, s67, 10240
s_lshl_b32 s67, s35, 8
s_add_u32 s52, s52, s67
s_add_u32 s53, s53, s67
s_add_u32 s52, s52, 191889408
s_add_u32 s53, s53, s59
s_cmp_ge_u32 s35, 24
s_cselect_b32 s67, 26624, 0
s_add_u32 s53, s53, s67
s_add_u32 s35, s35, 16
s_add_u32 s67, s62, 2
s_and_b32 s67, s67, 3
s_lshl_b32 s67, s67, 1
s_lshl_b32 s55, s67, 15
s_add_u32 s67, s67, s64
s_mul_i32 s54, s67, 10240
s_lshl_b32 s67, s35, 8
s_add_u32 s54, s54, s67
s_add_u32 s55, s55, s67
s_add_u32 s54, s54, 191889408
s_add_u32 s55, s55, s59
s_cmp_ge_u32 s35, 24
s_cselect_b32 s67, 26624, 0
s_add_u32 s55, s55, s67
s_add_u32 s35, s35, 16
s_add_u32 s67, s62, 2
s_and_b32 s67, s67, 3
s_lshl_b32 s67, s67, 1
s_lshl_b32 s57, s67, 15
s_add_u32 s67, s67, s64
s_mul_i32 s56, s67, 10240
s_lshl_b32 s67, s35, 8
s_add_u32 s56, s56, s67
s_add_u32 s57, s57, s67
s_add_u32 s56, s56, 191889408
s_add_u32 s57, s57, s59
s_cmp_ge_u32 s35, 24
s_cselect_b32 s67, 26624, 0
s_add_u32 s57, s57, s67
s_cmp_ge_u32 s35, 40
s_cselect_b32 s56, 536870912, s56
s_cselect_b32 s57, 536870912, s57
v_mov_b64 v[56:57], 0
v_mov_b64 v[58:59], 0
v_mov_b64 v[60:61], 0
v_mov_b64 v[62:63], 0
v_mov_b64 v[64:65], 0
v_mov_b64 v[66:67], 0
v_mov_b64 v[156:157], 0
v_mov_b64 v[158:159], 0
v_mov_b64 v[160:161], 0
v_mov_b64 v[162:163], 0
v_mov_b64 v[164:165], 0
v_mov_b64 v[166:167], 0
v_mov_b64 v[168:169], 0
v_mov_b64 v[170:171], 0
v_mov_b64 v[172:173], 0
v_mov_b64 v[174:175], 0
ds_read_b128 v[16:19], v3 offset:8192
ds_read_b128 v[24:27], v3 offset:9216
s_waitcnt lgkmcnt(0)
s_branch Lvoent_393
Lvo_392:
s_barrier
ds_read_b128 v[80:83], v4 offset:12288
ds_read_b128 v[84:87], v4 offset:13312
ds_read_b128 v[88:91], v4 offset:14336
ds_read_b128 v[92:95], v4 offset:15360
ds_read_b128 v[96:99], v4 offset:16384
ds_read_b128 v[100:103], v4 offset:17408
ds_read_b128 v[104:107], v4 offset:0
ds_read_b128 v[108:111], v4 offset:1024
s_bitcmp1_b32 s62, 0
s_cselect_b32 s50, 0x80008000, 0
s_lshl_b32 s48, s5, 7
s_add_u32 s48, s48, 193026048
s_cmp_gt_u32 s62, 60
s_cselect_b32 s48, s48, 536870912
v_mov_b32 v14, s62
v_min_u32 v13, 1, v0
v_lshlrev_b32 v13, 30, v13
v_mov_b32 v15, -1
s_and_b32 s35, s63, 15
s_add_u32 s67, s62, 2
s_and_b32 s67, s67, 3
s_lshl_b32 s67, s67, 1
s_lshl_b32 s53, s67, 15
s_add_u32 s67, s67, s64
s_mul_i32 s52, s67, 10240
s_lshl_b32 s67, s35, 8
s_add_u32 s52, s52, s67
s_add_u32 s53, s53, s67
s_add_u32 s52, s52, 191889408
s_add_u32 s53, s53, s59
s_cmp_ge_u32 s35, 24
s_cselect_b32 s67, 26624, 0
s_add_u32 s53, s53, s67
s_add_u32 s35, s35, 16
s_add_u32 s67, s62, 2
s_and_b32 s67, s67, 3
s_lshl_b32 s67, s67, 1
s_lshl_b32 s55, s67, 15
s_add_u32 s67, s67, s64
s_mul_i32 s54, s67, 10240
s_lshl_b32 s67, s35, 8
s_add_u32 s54, s54, s67
s_add_u32 s55, s55, s67
s_add_u32 s54, s54, 191889408
s_add_u32 s55, s55, s59
s_cmp_ge_u32 s35, 24
s_cselect_b32 s67, 26624, 0
s_add_u32 s55, s55, s67
s_add_u32 s35, s35, 16
s_add_u32 s67, s62, 2
s_and_b32 s67, s67, 3
s_lshl_b32 s67, s67, 1
s_lshl_b32 s57, s67, 15
s_add_u32 s67, s67, s64
s_mul_i32 s56, s67, 10240
s_lshl_b32 s67, s35, 8
s_add_u32 s56, s56, s67
s_add_u32 s57, s57, s67
s_add_u32 s56, s56, 191889408
s_add_u32 s57, s57, s59
s_cmp_ge_u32 s35, 24
s_cselect_b32 s67, 26624, 0
s_add_u32 s57, s57, s67
s_cmp_ge_u32 s35, 40
s_cselect_b32 s56, 536870912, s56
s_cselect_b32 s57, 536870912, s57
v_mov_b64 v[56:57], 0
v_mov_b64 v[58:59], 0
v_mov_b64 v[60:61], 0
v_mov_b64 v[62:63], 0
v_mov_b64 v[64:65], 0
v_mov_b64 v[66:67], 0
v_mov_b64 v[156:157], 0
v_mov_b64 v[158:159], 0
v_mov_b64 v[160:161], 0
v_mov_b64 v[162:163], 0
v_mov_b64 v[164:165], 0
v_mov_b64 v[166:167], 0
v_mov_b64 v[168:169], 0
v_mov_b64 v[170:171], 0
v_mov_b64 v[172:173], 0
v_mov_b64 v[174:175], 0
s_sleep 1
s_waitcnt lgkmcnt(0)
buffer_load_dwordx4 v[68:71], v1, s[8:11], s32 offen offset:0 sc1
buffer_load_dwordx4 v[72:75], v1, s[8:11], s32 offen offset:1024 sc1
s_waitcnt vmcnt(0)
v_max3_u32 v52, v68, v69, v70
v_max3_u32 v53, v72, v73, v74
v_max_u32 v52, v52, v71
v_max_u32 v53, v53, v75
v_cmp_eq_u32 s[16:17], -1, v52
v_cmp_eq_u32 s[18:19], -1, v53
s_nop 0
s_or_b64 s[28:29], s[16:17], s[18:19]
s_cbranch_scc1 Lg_394
Lg_395:
buffer_load_dwordx4 v[112:115], v1, s[8:11], s33 offen offset:0 sc1
buffer_load_dwordx4 v[116:119], v1, s[8:11], s33 offen offset:1024 sc1
v_lshlrev_b32 v16, 16, v68
v_and_b32 v17, 0xffff0000, v68
v_lshlrev_b32 v18, 16, v69
v_and_b32 v19, 0xffff0000, v69
v_lshlrev_b32 v20, 16, v70
v_and_b32 v21, 0xffff0000, v70
v_lshlrev_b32 v22, 16, v71
v_and_b32 v23, 0xffff0000, v71
v_lshlrev_b32 v24, 16, v72
v_and_b32 v25, 0xffff0000, v72
v_lshlrev_b32 v26, 16, v73
v_and_b32 v27, 0xffff0000, v73
v_lshlrev_b32 v28, 16, v74
v_and_b32 v29, 0xffff0000, v74
v_lshlrev_b32 v30, 16, v75
v_and_b32 v31, 0xffff0000, v75
s_waitcnt vmcnt(0)
v_max3_u32 v52, v112, v113, v114
v_max3_u32 v53, v116, v117, v118
v_max_u32 v52, v52, v115
v_max_u32 v53, v53, v119
v_cmp_eq_u32 s[22:23], -1, v52
v_cmp_eq_u32 s[24:25], -1, v53
s_nop 0
s_or_b64 s[28:29], s[22:23], s[24:25]
s_cbranch_scc1 Lg_396
Lg_398:
v_dot2c_f32_bf16 v16, s100, v112
v_dot2c_f32_bf16 v17, s101, v112
v_dot2c_f32_bf16 v18, s100, v113
v_dot2c_f32_bf16 v19, s101, v113
v_dot2c_f32_bf16 v20, s100, v114
v_dot2c_f32_bf16 v21, s101, v114
v_dot2c_f32_bf16 v22, s100, v115
v_dot2c_f32_bf16 v23, s101, v115
v_cvt_pk_bf16_f32 v16, v16, v17
v_cvt_pk_bf16_f32 v17, v18, v19
v_cvt_pk_bf16_f32 v18, v20, v21
v_cvt_pk_bf16_f32 v19, v22, v23
ds_write_b128 v2, v[16:19] offset:0
v_dot2c_f32_bf16 v24, s100, v116
v_dot2c_f32_bf16 v25, s101, v116
v_dot2c_f32_bf16 v26, s100, v117
v_dot2c_f32_bf16 v27, s101, v117
v_dot2c_f32_bf16 v28, s100, v118
v_dot2c_f32_bf16 v29, s101, v118
v_dot2c_f32_bf16 v30, s100, v119
v_dot2c_f32_bf16 v31, s101, v119
v_cvt_pk_bf16_f32 v24, v24, v25
v_cvt_pk_bf16_f32 v25, v26, v27
v_cvt_pk_bf16_f32 v26, v28, v29
v_cvt_pk_bf16_f32 v27, v30, v31
ds_write_b128 v2, v[24:27] offset:1024
Lvoent_393:
v_smfmac_f32_16x16x64_bf16 v[56:59], v[16:19], a[48:55], v8
v_smfmac_f32_16x16x64_bf16 v[60:63], v[16:19], a[104:111], v8
buffer_store_dword v15, v12, s[8:11], s52 offen sc1
v_smfmac_f32_16x16x64_bf16 v[64:67], v[16:19], a[160:167], v8
v_smfmac_f32_16x16x64_bf16 v[56:59], v[24:27], v[80:87], v8
s_waitcnt lgkmcnt(0)
s_barrier
ds_read_b128 v[20:23], v3 offset:0
v_mov_b64 v[16:17], 0
v_smfmac_f32_16x16x64_bf16 v[60:63], v[24:27], v[88:95], v8
ds_read_b128 v[28:31], v3 offset:1024
ds_read_b128 v[80:83], v4 offset:6144
v_mov_b64 v[18:19], 0
v_smfmac_f32_16x16x64_bf16 v[64:67], v[24:27], v[96:103], v8
ds_read_b128 v[32:35], v3 offset:3072
buffer_store_dword v15, v12, s[8:11], s53 offen sc1
ds_read_b128 v[84:87], v4 offset:7168
s_waitcnt lgkmcnt(4)
v_smfmac_f32_16x16x64_bf16 v[56:59], v[20:23], a[0:7], v8
ds_read_b128 v[36:39], v3 offset:2048
v_mov_b64 v[24:25], 0
v_smfmac_f32_16x16x64_bf16 v[60:63], v[20:23], a[56:63], v8
ds_read_b128 v[40:43], v3 offset:4096
v_mov_b64 v[26:27], 0
v_smfmac_f32_16x16x64_bf16 v[64:67], v[20:23], a[112:119], v8
ds_read_b128 v[44:47], v3 offset:6144
s_waitcnt lgkmcnt(6)
v_smfmac_f32_16x16x64_bf16 v[56:59], v[28:31], a[8:15], v8
ds_read_b128 v[48:51], v3 offset:5120
buffer_store_dword v15, v12, s[8:11], s54 offen sc1
s_waitcnt lgkmcnt(5)
v_mov_b64 v[20:21], 0
v_smfmac_f32_16x16x64_bf16 v[56:59], v[32:35], a[16:23], v8
ds_read_b128 v[52:55], v3 offset:7168
s_waitcnt lgkmcnt(4)
v_mov_b64 v[22:23], 0
v_smfmac_f32_16x16x64_bf16 v[56:59], v[36:39], v[104:111], v8
ds_read_b128 v[88:91], v4 offset:2048
s_waitcnt lgkmcnt(4)
v_smfmac_f32_16x16x64_bf16 v[56:59], v[40:43], a[24:31], v8
ds_read_b128 v[92:95], v4 offset:3072
s_waitcnt lgkmcnt(4)
v_smfmac_f32_16x16x64_bf16 v[56:59], v[44:47], a[32:39], v8
buffer_store_dword v15, v12, s[8:11], s55 offen sc1
ds_read_b128 v[96:99], v4 offset:8192
s_waitcnt lgkmcnt(4)
v_smfmac_f32_16x16x64_bf16 v[56:59], v[48:51], v[80:87], v8
ds_read_b128 v[100:103], v4 offset:9216
s_waitcnt lgkmcnt(4)
v_smfmac_f32_16x16x64_bf16 v[56:59], v[52:55], a[40:47], v8
ds_read_b128 v[104:107], v4 offset:4096
v_smfmac_f32_16x16x64_bf16 v[60:63], v[28:31], a[64:71], v8
ds_read_b128 v[108:111], v4 offset:5120
v_smfmac_f32_16x16x64_bf16 v[60:63], v[32:35], a[72:79], v8
buffer_store_dword v15, v12, s[8:11], s56 offen sc1
ds_read_b128 v[80:83], v4 offset:10240
s_waitcnt lgkmcnt(5)
v_add_f32 v56, v56, v58
v_smfmac_f32_16x16x64_bf16 v[60:63], v[36:39], v[88:95], v8
ds_read_b128 v[84:87], v4 offset:11264
v_add_f32 v57, v57, v59
v_smfmac_f32_16x16x64_bf16 v[60:63], v[40:43], a[80:87], v8
ds_read_b128 v[88:91], v4 offset:18432
v_cvt_pk_bf16_f32 v56, v56, v57
v_smfmac_f32_16x16x64_bf16 v[60:63], v[44:47], a[88:95], v8
ds_read_b128 v[92:95], v4 offset:19456
s_waitcnt lgkmcnt(6)
v_smfmac_f32_16x16x64_bf16 v[60:63], v[48:51], v[96:103], v8
buffer_store_dword v15, v12, s[8:11], s57 offen sc1
ds_read_b128 v[96:99], v4 offset:20480
v_mov_b32_dpp v57, v56 quad_perm:[1,0,3,2] row_mask:0xf bank_mask:0xf
v_smfmac_f32_16x16x64_bf16 v[60:63], v[52:55], a[96:103], v8
ds_read_b128 v[100:103], v4 offset:21504
v_perm_b32 v56, v57, v56, v6
v_smfmac_f32_16x16x64_bf16 v[64:67], v[28:31], a[120:127], v8
ds_write_b32 v5, v56 offset:0
v_smfmac_f32_16x16x64_bf16 v[64:67], v[32:35], a[128:135], v8
s_waitcnt lgkmcnt(7)
v_add_f32 v60, v60, v62
v_smfmac_f32_16x16x64_bf16 v[64:67], v[36:39], v[104:111], v8
ds_read_b128 v[104:107], v4 offset:24576
v_add_f32 v61, v61, v63
v_smfmac_f32_16x16x64_bf16 v[64:67], v[40:43], a[136:143], v8
buffer_store_dword v14, v13, s[8:11], s48 offen sc1
s_waitcnt lgkmcnt(1)
s_barrier
ds_read_b128 v[68:71], v3 offset:12736
v_cvt_pk_bf16_f32 v60, v60, v61
v_smfmac_f32_16x16x64_bf16 v[64:67], v[44:47], a[144:151], v8
ds_read_b128 v[108:111], v4 offset:25600
v_mov_b64 v[28:29], 0
v_smfmac_f32_16x16x64_bf16 v[64:67], v[48:51], v[80:87], v8
ds_read_b128 v[80:83], v4 offset:22528
v_mov_b32_dpp v61, v60 quad_perm:[1,0,3,2] row_mask:0xf bank_mask:0xf
v_smfmac_f32_16x16x64_bf16 v[64:67], v[52:55], a[152:159], v8
ds_read_b128 v[84:87], v4 offset:23552
s_waitcnt lgkmcnt(3)
v_perm_b32 v60, v61, v60, v6
v_smfmac_f32_16x16x64_bf16 v[156:159], v[68:71], a[168:175], v8
ds_write_b32 v5, v60 offset:1024
v_mov_b64 v[30:31], 0
v_smfmac_f32_16x16x64_bf16 v[164:167], v[68:71], a[192:199], v8
v_add_f32 v64, v64, v66
v_add_f32 v65, v65, v67
v_smfmac_f32_16x16x64_bf16 v[160:163], v[68:71], v[88:95], v8
ds_read_b128 v[88:91], v4 offset:26624
v_cvt_pk_bf16_f32 v64, v64, v65
v_smfmac_f32_16x16x64_bf16 v[168:171], v[68:71], a[216:223], v8
s_waitcnt lgkmcnt(1)
s_barrier
ds_read_b128 v[72:75], v3 offset:13760
v_mov_b64 v[32:33], 0
v_smfmac_f32_16x16x64_bf16 v[172:175], v[68:71], a[240:247], v8
ds_read_b128 v[92:95], v4 offset:27648
v_mov_b32_dpp v65, v64 quad_perm:[1,0,3,2] row_mask:0xf bank_mask:0xf
v_perm_b32 v64, v65, v64, v6
v_smfmac_f32_16x16x64_bf16 v[24:27], v[68:71], v[184:191], v8
ds_write_b32 v5, v64 offset:2048
s_waitcnt lgkmcnt(2)
v_mov_b64 v[34:35], 0
v_smfmac_f32_16x16x64_bf16 v[156:159], v[72:75], a[176:183], v8
v_smfmac_f32_16x16x64_bf16 v[164:167], v[72:75], a[200:207], v8
v_smfmac_f32_16x16x64_bf16 v[160:163], v[72:75], v[96:103], v8
s_waitcnt lgkmcnt(0)
s_barrier
ds_read_b128 v[76:79], v3 offset:14784
v_smfmac_f32_16x16x64_bf16 v[168:171], v[72:75], a[224:231], v8
ds_read_b128 v[96:99], v4 offset:28672
v_smfmac_f32_16x16x64_bf16 v[16:19], v[68:71], v[104:111], v8
ds_read_b128 v[100:103], v4 offset:29696
v_smfmac_f32_16x16x64_bf16 v[20:23], v[68:71], v[208:215], v8
ds_read_b128 v[104:107], v4 offset:30720
s_waitcnt lgkmcnt(3)
v_smfmac_f32_16x16x64_bf16 v[156:159], v[76:79], a[184:191], v8
ds_read_b128 v[108:111], v4 offset:31744
v_smfmac_f32_16x16x64_bf16 v[160:163], v[76:79], v[80:87], v8
ds_read_b128 v[80:83], v4 offset:32768
v_smfmac_f32_16x16x64_bf16 v[164:167], v[76:79], a[208:215], v8
ds_read_b128 v[84:87], v4 offset:33792
v_add_f32 v156, v156, v158
v_add_f32 v157, v157, v159
v_smfmac_f32_16x16x64_bf16 v[168:171], v[76:79], a[232:239], v8
v_cvt_pk_bf16_f32 v56, v156, v157
v_add_f32 v160, v160, v162
v_smfmac_f32_16x16x64_bf16 v[172:175], v[72:75], a[248:255], v8
v_add_f32 v161, v161, v163
v_add_f32 v164, v164, v166
v_smfmac_f32_16x16x64_bf16 v[16:19], v[72:75], v[88:95], v8
ds_read_b128 v[88:91], v4 offset:34816
v_cvt_pk_bf16_f32 v57, v160, v161
v_add_f32 v165, v165, v167
v_smfmac_f32_16x16x64_bf16 v[172:175], v[76:79], v[176:183], v8
ds_read_b128 v[92:95], v4 offset:35840
v_cvt_pk_bf16_f32 v58, v164, v165
v_add_f32 v168, v168, v170
v_smfmac_f32_16x16x64_bf16 v[24:27], v[72:75], v[192:199], v8
s_waitcnt lgkmcnt(6)
v_add_f32 v169, v169, v171
v_permlane16_swap_b32 v56, v57
v_smfmac_f32_16x16x64_bf16 v[16:19], v[76:79], v[96:103], v8
v_cvt_pk_bf16_f32 v59, v168, v169
v_add_f32 v172, v172, v174
v_smfmac_f32_16x16x64_bf16 v[20:23], v[72:75], v[216:223], v8
v_permlane16_swap_b32 v58, v59
v_add_f32 v173, v173, v175
v_smfmac_f32_16x16x64_bf16 v[24:27], v[76:79], v[200:207], v8
v_permlane32_swap_b32 v56, v58
v_permlane32_swap_b32 v57, v59
v_smfmac_f32_16x16x64_bf16 v[28:31], v[68:71], v[232:239], v8
v_bfi_b32 v56, 1, s62, v56
v_cvt_pk_bf16_f32 v60, v172, v173
v_smfmac_f32_16x16x64_bf16 v[20:23], v[76:79], v[224:231], v8
buffer_store_dwordx4 v[56:59], v11, s[8:11], s44 offen sc1
s_waitcnt lgkmcnt(4)
v_add_f32 v16, v16, v18
v_add_f32 v17, v17, v19
v_smfmac_f32_16x16x64_bf16 v[32:35], v[68:71], v[104:111], v8
v_cvt_pk_bf16_f32 v61, v16, v17
v_add_f32 v24, v24, v26
v_smfmac_f32_16x16x64_bf16 v[28:31], v[72:75], v[240:247], v8
s_waitcnt lgkmcnt(2)
v_add_f32 v25, v25, v27
v_add_f32 v20, v20, v22
v_smfmac_f32_16x16x64_bf16 v[32:35], v[72:75], v[80:87], v8
v_cvt_pk_bf16_f32 v62, v24, v25
v_add_f32 v21, v21, v23
v_smfmac_f32_16x16x64_bf16 v[28:31], v[76:79], v[248:255], v8
s_waitcnt lgkmcnt(0)
v_cvt_pk_bf16_f32 v63, v20, v21
v_permlane16_swap_b32 v60, v61
v_smfmac_f32_16x16x64_bf16 v[32:35], v[76:79], v[88:95], v8
v_permlane16_swap_b32 v62, v63
s_nop 1
v_permlane32_swap_b32 v60, v62
v_permlane32_swap_b32 v61, v63
v_pk_add_f32 v[28:29], v[28:29], v[30:31]
v_bfi_b32 v60, 1, s62, v60
v_cvt_pk_bf16_f32 v64, v28, v29
v_pk_add_f32 v[32:33], v[32:33], v[34:35]
buffer_store_dwordx4 v[60:63], v11, s[8:11], s45 offen sc1
v_cvt_pk_bf16_f32 v65, v32, v33
s_nop 1
v_permlane16_swap_b32 v64, v65
v_bfi_b32 v64, 1, s62, v64
buffer_store_dwordx2 v[64:65], v9, s[8:11], s46 offen sc1
s_cmp_eq_u32 s62, 63
s_cbranch_scc1 Lc_399
s_add_u32 s67, s62, 1
s_and_b32 s67, s67, 3
s_lshl_b32 s67, s67, 1
s_lshl_b32 s68, s67, 15
s_add_u32 s67, s67, s64
s_mul_i32 s67, s67, 10240
s_add_u32 s33, s68, s58
s_add_u32 s32, s67, s80
s_add_u32 s32, s32, 191889408
s_sleep 9
buffer_load_dwordx4 v[96:99], v1, s[8:11], s76 offen offset:0 sc1
buffer_load_dwordx4 v[100:103], v1, s[8:11], s76 offen offset:1024 sc1
s_waitcnt vmcnt(1)
ds_write_b128 v2, v[96:99] offset:0
v_bitop3_b32 v16, v96, v98, s50 bitop3:0x7e
v_bitop3_b32 v19, v97, v99, s50 bitop3:0x7e
v_or_b32 v16, v16, v19
v_cmp_gt_i32 s[16:17], 0, v16
s_waitcnt vmcnt(0)
ds_write_b128 v2, v[100:103] offset:1024
v_bitop3_b32 v17, v100, v102, s50 bitop3:0x7e
v_bitop3_b32 v19, v101, v103, s50 bitop3:0x7e
v_or_b32 v17, v17, v19
v_cmp_gt_i32 s[18:19], 0, v17
s_nop 0
s_or_b64 s[28:29], s[16:17], s[18:19]
s_cbranch_scc1 Lp_405
Lp_406:
s_waitcnt lgkmcnt(0)
s_barrier
s_waitcnt vmcnt(0)
s_cmp_ge_u32 s62, 60
s_cbranch_scc1 Lc_399
Lc_400:
s_add_u32 s62, s62, 1
s_branch Lvo_392
Lg_394:
s_mov_b64 exec, s[16:17]
buffer_load_dwordx4 v[68:71], v1, s[8:11], s32 offen offset:0 sc1
s_mov_b64 exec, s[18:19]
buffer_load_dwordx4 v[72:75], v1, s[8:11], s32 offen offset:1024 sc1
s_mov_b64 exec, -1
s_waitcnt vmcnt(0)
v_max3_u32 v52, v68, v69, v70
v_max3_u32 v53, v72, v73, v74
v_max_u32 v52, v52, v71
v_max_u32 v53, v53, v75
v_cmp_eq_u32 s[16:17], -1, v52
v_cmp_eq_u32 s[18:19], -1, v53
s_nop 0
s_or_b64 s[28:29], s[16:17], s[18:19]
s_cbranch_scc0 Lg_395
s_cmp_eq_u32 s65, 0
s_cbranch_scc1 Lg_395
s_sub_u32 s65, s65, 1
s_branch Lg_394
Lg_396:
Lg_397:
s_mov_b64 exec, s[22:23]
buffer_load_dwordx4 v[112:115], v1, s[8:11], s33 offen offset:0 sc1
s_mov_b64 exec, s[24:25]
buffer_load_dwordx4 v[116:119], v1, s[8:11], s33 offen offset:1024 sc1
s_mov_b64 exec, -1
s_waitcnt vmcnt(0)
v_max3_u32 v52, v112, v113, v114
v_max3_u32 v53, v116, v117, v118
v_max_u32 v52, v52, v115
v_max_u32 v53, v53, v119
v_cmp_eq_u32 s[22:23], -1, v52
v_cmp_eq_u32 s[24:25], -1, v53
s_nop 0
s_or_b64 s[28:29], s[22:23], s[24:25]
s_cbranch_scc0 Lg_398
s_cmp_eq_u32 s65, 0
s_cbranch_scc1 Lg_398
s_sub_u32 s65, s65, 1
s_branch Lg_397
Lp_405:
Lp_408:
s_mov_b64 exec, s[16:17]
buffer_load_dwordx4 v[96:99], v1, s[8:11], s76 offen offset:0 sc1
s_mov_b64 exec, s[18:19]
buffer_load_dwordx4 v[100:103], v1, s[8:11], s76 offen offset:1024 sc1
s_mov_b64 exec, -1
s_waitcnt vmcnt(0)
v_bitop3_b32 v16, v96, v98, s50 bitop3:0x7e
v_bitop3_b32 v19, v97, v99, s50 bitop3:0x7e
v_or_b32 v16, v16, v19
v_cmp_gt_i32 s[16:17], 0, v16
v_bitop3_b32 v17, v100, v102, s50 bitop3:0x7e
v_bitop3_b32 v19, v101, v103, s50 bitop3:0x7e
v_or_b32 v17, v17, v19
v_cmp_gt_i32 s[18:19], 0, v17
s_nop 0
s_or_b64 s[28:29], s[16:17], s[18:19]
s_cbranch_scc0 Lp_409
s_cmp_eq_u32 s65, 0
s_cbranch_scc1 Lp_409
s_sub_u32 s65, s65, 1
s_branch Lp_408
Lp_409:
ds_write_b128 v2, v[96:99] offset:0
ds_write_b128 v2, v[100:103] offset:1024
s_branch Lp_406
Lc_399:
s_lshl_b32 s52, s62, 5
s_add_u32 s52, s52, s63
s_mul_i32 s52, s52, 10240
s_add_u32 s52, s52, 165675008
s_add_u32 s53, s52, 4096
s_add_u32 s54, s52, 8192
buffer_store_dwordx4 v[56:59], v11, s[8:11], s52 offen sc1
buffer_store_dwordx4 v[60:63], v11, s[8:11], s53 offen sc1
buffer_store_dwordx2 v[64:65], v9, s[8:11], s54 offen sc1
s_cmp_lt_u32 s62, 63
s_cbranch_scc1 Lc_400
s_waitcnt vmcnt(0)
s_barrier
s_waitcnt vmcnt(0)
s_lshl_b32 s67, s5, 7
s_add_u32 s67, s67, 193026048
s_add_u32 s68, s62, 1
v_mov_b32 v13, s68
v_mov_b32 v14, 0
s_mov_b64 exec, 1
buffer_store_dword v13, v14, s[8:11], s67 offen sc1
s_mov_b64 exec, -1
s_waitcnt vmcnt(0)
s_endpgm
L_gemm:
s_sub_u32 s62, s5, 64
s_mov_b32 s65, 2097152
s_mov_b32 s20, s36
s_mov_b32 s21, s37
s_mov_b32 s22, 2621440
s_mov_b32 s23, 0x20000
s_mov_b32 s28, s56
s_mov_b32 s29, s57
s_mov_b32 s30, 2621440
s_mov_b32 s31, 0x20000
s_mov_b32 s16, s40
s_mov_b32 s17, s41
s_mov_b32 s18, 0
s_mov_b32 s19, 0x20000
v_lshlrev_b32 v1, 4, v0
v_mov_b32 v4, 1
v_cmp_eq_u32 vcc, 0, v0
v_mov_b32 v5, 0x40000000
s_nop 0
v_cndmask_b32 v3, v5, 0, vcc
s_lshr_b32 s67, s62, 5
s_and_b32 s68, s62, 31
s_mul_i32 s63, s67, 13
s_add_u32 s63, s63, s68
s_cmp_ge_u32 s68, 13
s_cbranch_scc1 Lyu_410
s_mul_i32 s67, s63, 43
s_lshr_b32 s67, s67, 10
s_mul_i32 s68, s67, 24
s_sub_u32 s68, s63, s68
s_lshl_b32 s68, s68, 2
s_add_u32 s68, s68, s3
s_lshl_b32 s70, s68, 7
s_mov_b32 s16, s40
s_mov_b32 s17, s41
s_cmp_eq_u32 s67, 1
s_cselect_b32 s16, s42, s16
s_cselect_b32 s17, s43, s17
s_cmp_eq_u32 s67, 2
s_cselect_b32 s16, s44, s16
s_cselect_b32 s17, s45, s17
s_cmp_eq_u32 s67, 3
s_cselect_b32 s16, s52, s16
s_cselect_b32 s17, s53, s17
s_cselect_b32 s74, 3, 12
s_cselect_b32 s69, 0, 0x80008000
v_mov_b32 v9, s69
s_mul_i32 s74, s74, 1024
s_mul_i32 s18, s74, 640
s_lshl_b32 s75, s63, 9
s_lshl_b32 s69, s3, 7
s_add_u32 s75, s75, s69
s_add_u32 s75, s75, 192937984
s_mul_i32 s69, s68, 171
s_lshr_b32 s69, s69, 9
s_mul_i32 s80, s69, 3
s_sub_u32 s80, s68, s80
s_lshl_b32 s80, s80, 11
s_mul_i32 s76, s69, 12288
s_add_u32 s76, s76, s80
s_mov_b32 s69, 4194304
s_cmp_eq_u32 s67, 1
s_cselect_b32 s69, 29360128, s69
s_cmp_eq_u32 s67, 2
s_cselect_b32 s69, 197132288, s69
s_cmp_eq_u32 s67, 3
s_cselect_b32 s69, 197525504, s69
s_add_u32 s76, s76, s69
s_cmp_ge_u32 s67, 2
s_cselect_b32 s77, 40, 32
s_mul_i32 s77, s77, 12288
s_lshl_b32 s81, s74, 5
s_sub_u32 s69, s67, 1
s_cmp_lt_u32 s69, 2
s_cselect_b32 s87, 16, 0xffff
s_cselect_b32 s88, 76, 64
s_mov_b32 s85, 0
s_mov_b32 s86, 0
s_cmp_lg_u32 s88, 64
s_cbranch_scc1 Lu_412
Lrp_415:
v_mov_b32 v6, 176
buffer_load_dword v5, v6, s[12:15], 0 offen sc1
s_waitcnt vmcnt(0)
Lrc_416:
v_readfirstlane_b32 s67, v5
s_nop 0
s_sub_u32 s67, s67, 1
s_cmp_eq_u32 s67, s34
s_cbranch_scc1 Lro_417
s_sub_u32 s65, s65, 1
s_cmp_eq_u32 s65, 0
s_cbranch_scc1 Lro_417
s_cmp_gt_u32 s67, 7
s_cbranch_scc1 Lrp_415
s_mov_b32 s34, s67
s_waitcnt vmcnt(0) lgkmcnt(0)
s_barrier
s_branch L_restart
Lro_417:
s_mov_b32 s92, 160
Lgp_418:
buffer_load_dword v5, v3, s[12:15], s92 offen sc1
s_waitcnt vmcnt(0)
v_readfirstlane_b32 s93, v5
s_nop 0
s_cmp_ge_u32 s93, 10
s_cbranch_scc1 Lgd_419
s_sleep 8
s_cmp_eq_u32 s65, 0
s_cbranch_scc1 Lgd_419
s_sub_u32 s65, s65, 1
s_branch Lgp_418
Lgd_419:
s_mov_b32 s92, 192963584
Lls_413:
buffer_load_dword v5, v3, s[8:11], s92 offen sc1
s_waitcnt vmcnt(0)
v_readfirstlane_b32 s93, v5
s_nop 0
s_cmp_ge_u32 s93, 1
s_cbranch_scc1 Lld_414
s_sleep 32
s_cmp_eq_u32 s65, 0
s_cbranch_scc1 Lld_414
s_sub_u32 s65, s65, 1
s_branch Lls_413
Lld_414:
Lu_412:
s_mul_i32 s95, s3, 10240
s_mov_b32 s79, s95
v_lshrrev_b32 v20, 3, v0
v_and_b32 v21, 6, v20
v_and_b32 v2, 7, v0
v_xor_b32 v2, v2, v21
v_lshlrev_b32 v2, 4, v2
v_mad_u32_u24 v2, v20, s74, v2
s_lshl_b32 s71, s74, 3
s_mul_i32 s72, s3, 20480
s_add_u32 s72, s72, 81920
s_mul_i32 s73, s81, 0
s_add_u32 s73, s73, s70
s_add_u32 m0, s72, 0
s_nop 0
buffer_load_dwordx4 v2, s[16:19], s73 offen lds
s_add_u32 m0, s72, 1024
s_add_u32 s73, s73, s71
buffer_load_dwordx4 v2, s[16:19], s73 offen lds
s_add_u32 m0, s72, 2048
s_add_u32 s73, s73, s71
buffer_load_dwordx4 v2, s[16:19], s73 offen lds
s_add_u32 m0, s72, 3072
s_add_u32 s73, s73, s71
buffer_load_dwordx4 v2, s[16:19], s73 offen lds
s_mul_i32 s73, s81, 1
s_add_u32 s73, s73, s70
s_add_u32 m0, s72, 4096
s_nop 0
buffer_load_dwordx4 v2, s[16:19], s73 offen lds
s_add_u32 m0, s72, 5120
s_add_u32 s73, s73, s71
buffer_load_dwordx4 v2, s[16:19], s73 offen lds
s_add_u32 m0, s72, 6144
s_add_u32 s73, s73, s71
buffer_load_dwordx4 v2, s[16:19], s73 offen lds
s_add_u32 m0, s72, 7168
s_add_u32 s73, s73, s71
buffer_load_dwordx4 v2, s[16:19], s73 offen lds
s_mul_i32 s73, s81, 2
s_add_u32 s73, s73, s70
s_add_u32 m0, s72, 8192
s_nop 0
buffer_load_dwordx4 v2, s[16:19], s73 offen lds
s_add_u32 m0, s72, 9216
s_add_u32 s73, s73, s71
buffer_load_dwordx4 v2, s[16:19], s73 offen lds
s_add_u32 m0, s72, 10240
s_add_u32 s73, s73, s71
buffer_load_dwordx4 v2, s[16:19], s73 offen lds
s_add_u32 m0, s72, 11264
s_add_u32 s73, s73, s71
buffer_load_dwordx4 v2, s[16:19], s73 offen lds
s_mul_i32 s73, s81, 3
s_add_u32 s73, s73, s70
s_add_u32 m0, s72, 12288
s_nop 0
buffer_load_dwordx4 v2, s[16:19], s73 offen lds
s_add_u32 m0, s72, 13312
s_add_u32 s73, s73, s71
buffer_load_dwordx4 v2, s[16:19], s73 offen lds
s_add_u32 m0, s72, 14336
s_add_u32 s73, s73, s71
buffer_load_dwordx4 v2, s[16:19], s73 offen lds
s_add_u32 m0, s72, 15360
s_add_u32 s73, s73, s71
buffer_load_dwordx4 v2, s[16:19], s73 offen lds
s_mul_i32 s73, s81, 4
s_add_u32 s73, s73, s70
s_add_u32 m0, s72, 16384
s_nop 0
buffer_load_dwordx4 v2, s[16:19], s73 offen lds
s_add_u32 m0, s72, 17408
s_add_u32 s73, s73, s71
buffer_load_dwordx4 v2, s[16:19], s73 offen lds
s_add_u32 m0, s72, 18432
s_add_u32 s73, s73, s71
buffer_load_dwordx4 v2, s[16:19], s73 offen lds
s_add_u32 m0, s72, 19456
s_add_u32 s73, s73, s71
buffer_load_dwordx4 v2, s[16:19], s73 offen lds
v_mov_b32 v20, 0
v_bfe_u32 v21, v0, 1, 1
s_mov_b32 s67, 1
v_mad_i32_i24 v20, v21, s67, v20
v_bfe_u32 v21, v0, 3, 2
s_mov_b32 s67, 2
v_mad_i32_i24 v20, v21, s67, v20
v_mov_b32 v10, 0
v_bfe_u32 v21, v0, 0, 1
s_mov_b32 s67, 8
v_mad_i32_i24 v10, v21, s67, v10
v_bfe_u32 v21, v0, 2, 4
s_mov_b32 s67, 128
v_mad_i32_i24 v10, v21, s67, v10
v_lshl_add_u32 v10, v20, 4, v10
v_add_u32 v10, s72, v10
v_xor_b32 v11, 32, v10
v_xor_b32 v12, 64, v10
v_xor_b32 v13, 96, v10
s_waitcnt vmcnt(16)
ds_read_b64_tr_b16 a[0:1], v10 offset:0
ds_read_b64_tr_b16 a[2:3], v10 offset:2048
ds_read_b64_tr_b16 a[4:5], v11 offset:0
ds_read_b64_tr_b16 a[6:7], v11 offset:2048
ds_read_b64_tr_b16 a[8:9], v12 offset:0
ds_read_b64_tr_b16 a[10:11], v12 offset:2048
ds_read_b64_tr_b16 a[12:13], v13 offset:0
ds_read_b64_tr_b16 a[14:15], v13 offset:2048
s_waitcnt lgkmcnt(0)
s_mul_i32 s73, s81, 5
s_add_u32 s73, s73, s70
s_add_u32 m0, s72, 0
s_nop 0
buffer_load_dwordx4 v2, s[16:19], s73 offen lds
s_add_u32 m0, s72, 1024
s_add_u32 s73, s73, s71
buffer_load_dwordx4 v2, s[16:19], s73 offen lds
s_add_u32 m0, s72, 2048
s_add_u32 s73, s73, s71
buffer_load_dwordx4 v2, s[16:19], s73 offen lds
s_add_u32 m0, s72, 3072
s_add_u32 s73, s73, s71
buffer_load_dwordx4 v2, s[16:19], s73 offen lds
s_waitcnt vmcnt(16)
ds_read_b64_tr_b16 a[16:17], v10 offset:4096
ds_read_b64_tr_b16 a[18:19], v10 offset:6144
ds_read_b64_tr_b16 a[20:21], v11 offset:4096
ds_read_b64_tr_b16 a[22:23], v11 offset:6144
ds_read_b64_tr_b16 a[24:25], v12 offset:4096
ds_read_b64_tr_b16 a[26:27], v12 offset:6144
ds_read_b64_tr_b16 a[28:29], v13 offset:4096
ds_read_b64_tr_b16 a[30:31], v13 offset:6144
s_waitcnt lgkmcnt(0)
s_mul_i32 s73, s81, 6
s_add_u32 s73, s73, s70
s_add_u32 m0, s72, 4096
s_nop 0
buffer_load_dwordx4 v2, s[16:19], s73 offen lds
s_add_u32 m0, s72, 5120
s_add_u32 s73, s73, s71
buffer_load_dwordx4 v2, s[16:19], s73 offen lds
s_add_u32 m0, s72, 6144
s_add_u32 s73, s73, s71
buffer_load_dwordx4 v2, s[16:19], s73 offen lds
s_add_u32 m0, s72, 7168
s_add_u32 s73, s73, s71
buffer_load_dwordx4 v2, s[16:19], s73 offen lds
s_waitcnt vmcnt(16)
ds_read_b64_tr_b16 a[32:33], v10 offset:8192
ds_read_b64_tr_b16 a[34:35], v10 offset:10240
ds_read_b64_tr_b16 a[36:37], v11 offset:8192
ds_read_b64_tr_b16 a[38:39], v11 offset:10240
ds_read_b64_tr_b16 a[40:41], v12 offset:8192
ds_read_b64_tr_b16 a[42:43], v12 offset:10240
ds_read_b64_tr_b16 a[44:45], v13 offset:8192
ds_read_b64_tr_b16 a[46:47], v13 offset:10240
s_waitcnt lgkmcnt(0)
s_mul_i32 s73, s81, 7
s_add_u32 s73, s73, s70
s_add_u32 m0, s72, 8192
s_nop 0
buffer_load_dwordx4 v2, s[16:19], s73 offen lds
s_add_u32 m0, s72, 9216
s_add_u32 s73, s73, s71
buffer_load_dwordx4 v2, s[16:19], s73 offen lds
s_add_u32 m0, s72, 10240
s_add_u32 s73, s73, s71
buffer_load_dwordx4 v2, s[16:19], s73 offen lds
s_add_u32 m0, s72, 11264
s_add_u32 s73, s73, s71
buffer_load_dwordx4 v2, s[16:19], s73 offen lds
s_waitcnt vmcnt(16)
ds_read_b64_tr_b16 a[48:49], v10 offset:12288
ds_read_b64_tr_b16 a[50:51], v10 offset:14336
ds_read_b64_tr_b16 a[52:53], v11 offset:12288
ds_read_b64_tr_b16 a[54:55], v11 offset:14336
ds_read_b64_tr_b16 a[56:57], v12 offset:12288
ds_read_b64_tr_b16 a[58:59], v12 offset:14336
ds_read_b64_tr_b16 a[60:61], v13 offset:12288
ds_read_b64_tr_b16 a[62:63], v13 offset:14336
s_waitcnt lgkmcnt(0)
s_mul_i32 s73, s81, 8
s_add_u32 s73, s73, s70
s_add_u32 m0, s72, 12288
s_nop 0
buffer_load_dwordx4 v2, s[16:19], s73 offen lds
s_add_u32 m0, s72, 13312
s_add_u32 s73, s73, s71
buffer_load_dwordx4 v2, s[16:19], s73 offen lds
s_add_u32 m0, s72, 14336
s_add_u32 s73, s73, s71
buffer_load_dwordx4 v2, s[16:19], s73 offen lds
s_add_u32 m0, s72, 15360
s_add_u32 s73, s73, s71
buffer_load_dwordx4 v2, s[16:19], s73 offen lds
s_waitcnt vmcnt(16)
ds_read_b64_tr_b16 a[64:65], v10 offset:16384
ds_read_b64_tr_b16 a[66:67], v10 offset:18432
ds_read_b64_tr_b16 a[68:69], v11 offset:16384
ds_read_b64_tr_b16 a[70:71], v11 offset:18432
ds_read_b64_tr_b16 a[72:73], v12 offset:16384
ds_read_b64_tr_b16 a[74:75], v12 offset:18432
ds_read_b64_tr_b16 a[76:77], v13 offset:16384
ds_read_b64_tr_b16 a[78:79], v13 offset:18432
s_waitcnt lgkmcnt(0)
s_mul_i32 s73, s81, 9
s_add_u32 s73, s73, s70
s_add_u32 m0, s72, 16384
s_nop 0
buffer_load_dwordx4 v2, s[16:19], s73 offen lds
s_add_u32 m0, s72, 17408
s_add_u32 s73, s73, s71
buffer_load_dwordx4 v2, s[16:19], s73 offen lds
s_add_u32 m0, s72, 18432
s_add_u32 s73, s73, s71
buffer_load_dwordx4 v2, s[16:19], s73 offen lds
s_add_u32 m0, s72, 19456
s_add_u32 s73, s73, s71
buffer_load_dwordx4 v2, s[16:19], s73 offen lds
s_waitcnt vmcnt(16)
ds_read_b64_tr_b16 a[80:81], v10 offset:0
ds_read_b64_tr_b16 a[82:83], v10 offset:2048
ds_read_b64_tr_b16 a[84:85], v11 offset:0
ds_read_b64_tr_b16 a[86:87], v11 offset:2048
ds_read_b64_tr_b16 a[88:89], v12 offset:0
ds_read_b64_tr_b16 a[90:91], v12 offset:2048
ds_read_b64_tr_b16 a[92:93], v13 offset:0
ds_read_b64_tr_b16 a[94:95], v13 offset:2048
s_waitcnt lgkmcnt(0)
s_mul_i32 s73, s81, 10
s_add_u32 s73, s73, s70
s_add_u32 m0, s72, 0
s_nop 0
buffer_load_dwordx4 v2, s[16:19], s73 offen lds
s_add_u32 m0, s72, 1024
s_add_u32 s73, s73, s71
buffer_load_dwordx4 v2, s[16:19], s73 offen lds
s_add_u32 m0, s72, 2048
s_add_u32 s73, s73, s71
buffer_load_dwordx4 v2, s[16:19], s73 offen lds
s_add_u32 m0, s72, 3072
s_add_u32 s73, s73, s71
buffer_load_dwordx4 v2, s[16:19], s73 offen lds
s_waitcnt vmcnt(16)
ds_read_b64_tr_b16 a[96:97], v10 offset:4096
ds_read_b64_tr_b16 a[98:99], v10 offset:6144
ds_read_b64_tr_b16 a[100:101], v11 offset:4096
ds_read_b64_tr_b16 a[102:103], v11 offset:6144
ds_read_b64_tr_b16 a[104:105], v12 offset:4096
ds_read_b64_tr_b16 a[106:107], v12 offset:6144
ds_read_b64_tr_b16 a[108:109], v13 offset:4096
ds_read_b64_tr_b16 a[110:111], v13 offset:6144
s_waitcnt lgkmcnt(0)
s_mul_i32 s73, s81, 11
s_add_u32 s73, s73, s70
s_add_u32 m0, s72, 4096
s_nop 0
buffer_load_dwordx4 v2, s[16:19], s73 offen lds
s_add_u32 m0, s72, 5120
s_add_u32 s73, s73, s71
buffer_load_dwordx4 v2, s[16:19], s73 offen lds
s_add_u32 m0, s72, 6144
s_add_u32 s73, s73, s71
buffer_load_dwordx4 v2, s[16:19], s73 offen lds
s_add_u32 m0, s72, 7168
s_add_u32 s73, s73, s71
buffer_load_dwordx4 v2, s[16:19], s73 offen lds
s_waitcnt vmcnt(16)
ds_read_b64_tr_b16 a[112:113], v10 offset:8192
ds_read_b64_tr_b16 a[114:115], v10 offset:10240
ds_read_b64_tr_b16 a[116:117], v11 offset:8192
ds_read_b64_tr_b16 a[118:119], v11 offset:10240
ds_read_b64_tr_b16 a[120:121], v12 offset:8192
ds_read_b64_tr_b16 a[122:123], v12 offset:10240
ds_read_b64_tr_b16 a[124:125], v13 offset:8192
ds_read_b64_tr_b16 a[126:127], v13 offset:10240
s_waitcnt lgkmcnt(0)
s_mul_i32 s73, s81, 12
s_add_u32 s73, s73, s70
s_add_u32 m0, s72, 8192
s_nop 0
buffer_load_dwordx4 v2, s[16:19], s73 offen lds
s_add_u32 m0, s72, 9216
s_add_u32 s73, s73, s71
buffer_load_dwordx4 v2, s[16:19], s73 offen lds
s_add_u32 m0, s72, 10240
s_add_u32 s73, s73, s71
buffer_load_dwordx4 v2, s[16:19], s73 offen lds
s_add_u32 m0, s72, 11264
s_add_u32 s73, s73, s71
buffer_load_dwordx4 v2, s[16:19], s73 offen lds
s_waitcnt vmcnt(16)
ds_read_b64_tr_b16 a[128:129], v10 offset:12288
ds_read_b64_tr_b16 a[130:131], v10 offset:14336
ds_read_b64_tr_b16 a[132:133], v11 offset:12288
ds_read_b64_tr_b16 a[134:135], v11 offset:14336
ds_read_b64_tr_b16 a[136:137], v12 offset:12288
ds_read_b64_tr_b16 a[138:139], v12 offset:14336
ds_read_b64_tr_b16 a[140:141], v13 offset:12288
ds_read_b64_tr_b16 a[142:143], v13 offset:14336
s_waitcnt lgkmcnt(0)
s_mul_i32 s73, s81, 13
s_add_u32 s73, s73, s70
s_add_u32 m0, s72, 12288
s_nop 0
buffer_load_dwordx4 v2, s[16:19], s73 offen lds
s_add_u32 m0, s72, 13312
s_add_u32 s73, s73, s71
buffer_load_dwordx4 v2, s[16:19], s73 offen lds
s_add_u32 m0, s72, 14336
s_add_u32 s73, s73, s71
buffer_load_dwordx4 v2, s[16:19], s73 offen lds
s_add_u32 m0, s72, 15360
s_add_u32 s73, s73, s71
buffer_load_dwordx4 v2, s[16:19], s73 offen lds
s_waitcnt vmcnt(16)
ds_read_b64_tr_b16 a[144:145], v10 offset:16384
ds_read_b64_tr_b16 a[146:147], v10 offset:18432
ds_read_b64_tr_b16 a[148:149], v11 offset:16384
ds_read_b64_tr_b16 a[150:151], v11 offset:18432
ds_read_b64_tr_b16 a[152:153], v12 offset:16384
ds_read_b64_tr_b16 a[154:155], v12 offset:18432
ds_read_b64_tr_b16 a[156:157], v13 offset:16384
ds_read_b64_tr_b16 a[158:159], v13 offset:18432
s_waitcnt lgkmcnt(0)
s_mul_i32 s73, s81, 14
s_add_u32 s73, s73, s70
s_add_u32 m0, s72, 16384
s_nop 0
buffer_load_dwordx4 v2, s[16:19], s73 offen lds
s_add_u32 m0, s72, 17408
s_add_u32 s73, s73, s71
buffer_load_dwordx4 v2, s[16:19], s73 offen lds
s_add_u32 m0, s72, 18432
s_add_u32 s73, s73, s71
buffer_load_dwordx4 v2, s[16:19], s73 offen lds
s_add_u32 m0, s72, 19456
s_add_u32 s73, s73, s71
buffer_load_dwordx4 v2, s[16:19], s73 offen lds
s_waitcnt vmcnt(16)
ds_read_b64_tr_b16 a[160:161], v10 offset:0
ds_read_b64_tr_b16 a[162:163], v10 offset:2048
ds_read_b64_tr_b16 a[164:165], v11 offset:0
ds_read_b64_tr_b16 a[166:167], v11 offset:2048
ds_read_b64_tr_b16 a[168:169], v12 offset:0
ds_read_b64_tr_b16 a[170:171], v12 offset:2048
ds_read_b64_tr_b16 a[172:173], v13 offset:0
ds_read_b64_tr_b16 a[174:175], v13 offset:2048
s_waitcnt lgkmcnt(0)
s_mul_i32 s73, s81, 15
s_add_u32 s73, s73, s70
s_add_u32 m0, s72, 0
s_nop 0
buffer_load_dwordx4 v2, s[16:19], s73 offen lds
s_add_u32 m0, s72, 1024
s_add_u32 s73, s73, s71
buffer_load_dwordx4 v2, s[16:19], s73 offen lds
s_add_u32 m0, s72, 2048
s_add_u32 s73, s73, s71
buffer_load_dwordx4 v2, s[16:19], s73 offen lds
s_add_u32 m0, s72, 3072
s_add_u32 s73, s73, s71
buffer_load_dwordx4 v2, s[16:19], s73 offen lds
s_waitcnt vmcnt(16)
ds_read_b64_tr_b16 a[176:177], v10 offset:4096
ds_read_b64_tr_b16 a[178:179], v10 offset:6144
ds_read_b64_tr_b16 a[180:181], v11 offset:4096
ds_read_b64_tr_b16 a[182:183], v11 offset:6144
ds_read_b64_tr_b16 a[184:185], v12 offset:4096
ds_read_b64_tr_b16 a[186:187], v12 offset:6144
ds_read_b64_tr_b16 a[188:189], v13 offset:4096
ds_read_b64_tr_b16 a[190:191], v13 offset:6144
s_waitcnt lgkmcnt(0)
s_mul_i32 s73, s81, 16
s_add_u32 s73, s73, s70
s_add_u32 m0, s72, 4096
s_nop 0
buffer_load_dwordx4 v2, s[16:19], s73 offen lds
s_add_u32 m0, s72, 5120
s_add_u32 s73, s73, s71
buffer_load_dwordx4 v2, s[16:19], s73 offen lds
s_add_u32 m0, s72, 6144
s_add_u32 s73, s73, s71
buffer_load_dwordx4 v2, s[16:19], s73 offen lds
s_add_u32 m0, s72, 7168
s_add_u32 s73, s73, s71
buffer_load_dwordx4 v2, s[16:19], s73 offen lds
s_waitcnt vmcnt(16)
ds_read_b64_tr_b16 a[192:193], v10 offset:8192
ds_read_b64_tr_b16 a[194:195], v10 offset:10240
ds_read_b64_tr_b16 a[196:197], v11 offset:8192
ds_read_b64_tr_b16 a[198:199], v11 offset:10240
ds_read_b64_tr_b16 a[200:201], v12 offset:8192
ds_read_b64_tr_b16 a[202:203], v12 offset:10240
ds_read_b64_tr_b16 a[204:205], v13 offset:8192
ds_read_b64_tr_b16 a[206:207], v13 offset:10240
s_waitcnt lgkmcnt(0)
s_mul_i32 s73, s81, 17
s_add_u32 s73, s73, s70
s_add_u32 m0, s72, 8192
s_nop 0
buffer_load_dwordx4 v2, s[16:19], s73 offen lds
s_add_u32 m0, s72, 9216
s_add_u32 s73, s73, s71
buffer_load_dwordx4 v2, s[16:19], s73 offen lds
s_add_u32 m0, s72, 10240
s_add_u32 s73, s73, s71
buffer_load_dwordx4 v2, s[16:19], s73 offen lds
s_add_u32 m0, s72, 11264
s_add_u32 s73, s73, s71
buffer_load_dwordx4 v2, s[16:19], s73 offen lds
s_waitcnt vmcnt(16)
ds_read_b64_tr_b16 a[208:209], v10 offset:12288
ds_read_b64_tr_b16 a[210:211], v10 offset:14336
ds_read_b64_tr_b16 a[212:213], v11 offset:12288
ds_read_b64_tr_b16 a[214:215], v11 offset:14336
ds_read_b64_tr_b16 a[216:217], v12 offset:12288
ds_read_b64_tr_b16 a[218:219], v12 offset:14336
ds_read_b64_tr_b16 a[220:221], v13 offset:12288
ds_read_b64_tr_b16 a[222:223], v13 offset:14336
s_waitcnt lgkmcnt(0)
s_mul_i32 s73, s81, 18
s_add_u32 s73, s73, s70
s_add_u32 m0, s72, 12288
s_nop 0
buffer_load_dwordx4 v2, s[16:19], s73 offen lds
s_add_u32 m0, s72, 13312
s_add_u32 s73, s73, s71
buffer_load_dwordx4 v2, s[16:19], s73 offen lds
s_add_u32 m0, s72, 14336
s_add_u32 s73, s73, s71
buffer_load_dwordx4 v2, s[16:19], s73 offen lds
s_add_u32 m0, s72, 15360
s_add_u32 s73, s73, s71
buffer_load_dwordx4 v2, s[16:19], s73 offen lds
s_waitcnt vmcnt(16)
ds_read_b64_tr_b16 a[224:225], v10 offset:16384
ds_read_b64_tr_b16 a[226:227], v10 offset:18432
ds_read_b64_tr_b16 a[228:229], v11 offset:16384
ds_read_b64_tr_b16 a[230:231], v11 offset:18432
ds_read_b64_tr_b16 a[232:233], v12 offset:16384
ds_read_b64_tr_b16 a[234:235], v12 offset:18432
ds_read_b64_tr_b16 a[236:237], v13 offset:16384
ds_read_b64_tr_b16 a[238:239], v13 offset:18432
s_waitcnt lgkmcnt(0)
s_mul_i32 s73, s81, 19
s_add_u32 s73, s73, s70
s_add_u32 m0, s72, 16384
s_nop 0
buffer_load_dwordx4 v2, s[16:19], s73 offen lds
s_add_u32 m0, s72, 17408
s_add_u32 s73, s73, s71
buffer_load_dwordx4 v2, s[16:19], s73 offen lds
s_add_u32 m0, s72, 18432
s_add_u32 s73, s73, s71
buffer_load_dwordx4 v2, s[16:19], s73 offen lds
s_add_u32 m0, s72, 19456
s_add_u32 s73, s73, s71
buffer_load_dwordx4 v2, s[16:19], s73 offen lds
s_waitcnt vmcnt(16)
ds_read_b64_tr_b16 a[240:241], v10 offset:0
ds_read_b64_tr_b16 a[242:243], v10 offset:2048
ds_read_b64_tr_b16 a[244:245], v11 offset:0
ds_read_b64_tr_b16 a[246:247], v11 offset:2048
ds_read_b64_tr_b16 a[248:249], v12 offset:0
ds_read_b64_tr_b16 a[250:251], v12 offset:2048
ds_read_b64_tr_b16 a[252:253], v13 offset:0
ds_read_b64_tr_b16 a[254:255], v13 offset:2048
s_waitcnt lgkmcnt(0)
s_waitcnt vmcnt(12)
ds_read_b64_tr_b16 v[192:193], v10 offset:4096
ds_read_b64_tr_b16 v[194:195], v10 offset:6144
ds_read_b64_tr_b16 v[196:197], v11 offset:4096
ds_read_b64_tr_b16 v[198:199], v11 offset:6144
ds_read_b64_tr_b16 v[200:201], v12 offset:4096
ds_read_b64_tr_b16 v[202:203], v12 offset:6144
ds_read_b64_tr_b16 v[204:205], v13 offset:4096
ds_read_b64_tr_b16 v[206:207], v13 offset:6144
s_waitcnt lgkmcnt(0)
s_waitcnt vmcnt(8)
ds_read_b64_tr_b16 v[208:209], v10 offset:8192
ds_read_b64_tr_b16 v[210:211], v10 offset:10240
ds_read_b64_tr_b16 v[212:213], v11 offset:8192
ds_read_b64_tr_b16 v[214:215], v11 offset:10240
ds_read_b64_tr_b16 v[216:217], v12 offset:8192
ds_read_b64_tr_b16 v[218:219], v12 offset:10240
ds_read_b64_tr_b16 v[220:221], v13 offset:8192
ds_read_b64_tr_b16 v[222:223], v13 offset:10240
s_waitcnt lgkmcnt(0)
s_waitcnt vmcnt(4)
ds_read_b64_tr_b16 v[224:225], v10 offset:12288
ds_read_b64_tr_b16 v[226:227], v10 offset:14336
ds_read_b64_tr_b16 v[228:229], v11 offset:12288
ds_read_b64_tr_b16 v[230:231], v11 offset:14336
ds_read_b64_tr_b16 v[232:233], v12 offset:12288
ds_read_b64_tr_b16 v[234:235], v12 offset:14336
ds_read_b64_tr_b16 v[236:237], v13 offset:12288
ds_read_b64_tr_b16 v[238:239], v13 offset:14336
s_waitcnt lgkmcnt(0)
s_waitcnt vmcnt(0)
ds_read_b64_tr_b16 v[240:241], v10 offset:16384
ds_read_b64_tr_b16 v[242:243], v10 offset:18432
ds_read_b64_tr_b16 v[244:245], v11 offset:16384
ds_read_b64_tr_b16 v[246:247], v11 offset:18432
ds_read_b64_tr_b16 v[248:249], v12 offset:16384
ds_read_b64_tr_b16 v[250:251], v12 offset:18432
ds_read_b64_tr_b16 v[252:253], v13 offset:16384
ds_read_b64_tr_b16 v[254:255], v13 offset:18432
Lrp_421:
v_mov_b32 v6, 176
buffer_load_dword v5, v6, s[12:15], 0 offen sc1
s_waitcnt vmcnt(0)
Lrc_422:
v_readfirstlane_b32 s67, v5
s_nop 0
s_sub_u32 s67, s67, 1
s_cmp_eq_u32 s67, s34
s_cbranch_scc1 Lro_423
s_sub_u32 s65, s65, 1
s_cmp_eq_u32 s65, 0
s_cbranch_scc1 Lro_423
s_cmp_gt_u32 s67, 7
s_cbranch_scc1 Lrp_421
s_mov_b32 s34, s67
s_waitcnt vmcnt(0) lgkmcnt(0)
s_barrier
s_branch L_restart
Lro_423:
s_cmp_lg_u32 s3, 0
s_cbranch_scc1 Lxw_420
s_mov_b32 s92, 160
Lgp_424:
buffer_load_dword v5, v3, s[12:15], s92 offen sc1
s_waitcnt vmcnt(0)
v_readfirstlane_b32 s93, v5
s_nop 0
s_cmp_ge_u32 s93, 10
s_cbranch_scc1 Lgd_425
s_sleep 8
s_cmp_eq_u32 s65, 0
s_cbranch_scc1 Lgd_425
s_sub_u32 s65, s65, 1
s_branch Lgp_424
Lgd_425:
v_lshlrev_b32 v6, 7, v0
s_mov_b32 s92, 193015808
Lgp_426:
buffer_load_dword v5, v6, s[8:11], s92 offen sc1
s_waitcnt vmcnt(0)
v_cmp_ne_u32 vcc, 1, v5
s_cbranch_vccz Lgd_427
s_sleep 4
s_cmp_eq_u32 s65, 0
s_cbranch_scc1 Lgd_427
s_sub_u32 s65, s65, 1
s_branch Lgp_426
Lgd_427:
Lxw_420:
s_waitcnt lgkmcnt(0)
s_barrier
s_cmp_eq_u32 s87, 0
s_cbranch_scc1 Lnm_428
s_mov_b32 s90, s85
s_add_u32 s85, s85, 1
s_sub_u32 s87, s87, 1
Lnb_429:
s_mul_i32 s78, s90, 40960
s_add_u32 s78, s78, s95
s_add_u32 m0, s79, 0
s_add_u32 s73, s78, 0
buffer_load_dwordx4 v1, s[8:11], s73 offen offset:0 sc1 lds
buffer_load_dwordx4 v1, s[8:11], s73 offen offset:1024 sc1 lds
buffer_load_dwordx4 v1, s[8:11], s73 offen offset:2048 sc1 lds
buffer_load_dwordx4 v1, s[8:11], s73 offen offset:3072 sc1 lds
s_add_u32 m0, s79, 4096
s_add_u32 s73, s78, 4096
buffer_load_dwordx4 v1, s[8:11], s73 offen offset:0 sc1 lds
buffer_load_dwordx4 v1, s[8:11], s73 offen offset:1024 sc1 lds
buffer_load_dwordx4 v1, s[8:11], s73 offen offset:2048 sc1 lds
buffer_load_dwordx4 v1, s[8:11], s73 offen offset:3072 sc1 lds
s_add_u32 m0, s79, 8192
s_add_u32 s73, s78, 8192
buffer_load_dwordx4 v1, s[8:11], s73 offen offset:0 sc1 lds
buffer_load_dwordx4 v1, s[8:11], s73 offen offset:1024 sc1 lds
s_add_u32 s79, s79, 40960
s_cmp_ge_u32 s79, 163840
s_cselect_b32 s73, 163840, 0
s_sub_u32 s79, s79, s73
s_cmp_eq_u32 s87, 0
s_cbranch_scc1 Lnm_430
s_mov_b32 s91, s85
s_add_u32 s85, s85, 1
s_sub_u32 s87, s87, 1
Lnb_431:
s_mul_i32 s78, s91, 40960
s_add_u32 s78, s78, s95
s_add_u32 m0, s79, 0
s_add_u32 s73, s78, 0
buffer_load_dwordx4 v1, s[8:11], s73 offen offset:0 sc1 lds
buffer_load_dwordx4 v1, s[8:11], s73 offen offset:1024 sc1 lds
buffer_load_dwordx4 v1, s[8:11], s73 offen offset:2048 sc1 lds
buffer_load_dwordx4 v1, s[8:11], s73 offen offset:3072 sc1 lds
s_add_u32 m0, s79, 4096
s_add_u32 s73, s78, 4096
buffer_load_dwordx4 v1, s[8:11], s73 offen offset:0 sc1 lds
buffer_load_dwordx4 v1, s[8:11], s73 offen offset:1024 sc1 lds
buffer_load_dwordx4 v1, s[8:11], s73 offen offset:2048 sc1 lds
buffer_load_dwordx4 v1, s[8:11], s73 offen offset:3072 sc1 lds
s_add_u32 m0, s79, 8192
s_add_u32 s73, s78, 8192
buffer_load_dwordx4 v1, s[8:11], s73 offen offset:0 sc1 lds
buffer_load_dwordx4 v1, s[8:11], s73 offen offset:1024 sc1 lds
s_add_u32 s79, s79, 40960
s_cmp_ge_u32 s79, 163840
s_cselect_b32 s73, 163840, 0
s_sub_u32 s79, s79, s73
s_waitcnt lgkmcnt(0)
s_waitcnt vmcnt(0)
s_barrier
s_cmp_eq_u32 s87, 0
s_cbranch_scc1 Lnm_432
s_mov_b32 s94, s85
s_add_u32 s85, s85, 1
s_sub_u32 s87, s87, 1
Lnb_433:
s_mul_i32 s78, s94, 40960
s_add_u32 s78, s78, s95
s_add_u32 m0, s79, 0
s_add_u32 s73, s78, 0
buffer_load_dwordx4 v1, s[8:11], s73 offen offset:0 sc1 lds
buffer_load_dwordx4 v1, s[8:11], s73 offen offset:1024 sc1 lds
buffer_load_dwordx4 v1, s[8:11], s73 offen offset:2048 sc1 lds
buffer_load_dwordx4 v1, s[8:11], s73 offen offset:3072 sc1 lds
s_add_u32 m0, s79, 4096
s_add_u32 s73, s78, 4096
buffer_load_dwordx4 v1, s[8:11], s73 offen offset:0 sc1 lds
buffer_load_dwordx4 v1, s[8:11], s73 offen offset:1024 sc1 lds
buffer_load_dwordx4 v1, s[8:11], s73 offen offset:2048 sc1 lds
buffer_load_dwordx4 v1, s[8:11], s73 offen offset:3072 sc1 lds
s_add_u32 m0, s79, 8192
s_add_u32 s73, s78, 8192
buffer_load_dwordx4 v1, s[8:11], s73 offen offset:0 sc1 lds
buffer_load_dwordx4 v1, s[8:11], s73 offen offset:1024 sc1 lds
v_mov_b32 v7, v1
s_mov_b32 s82, 0
v_min_u32 v16, 9, v0
v_lshlrev_b32 v16, 7, v16
ds_read_b128 v[128:131], v7 offset:0
ds_read_b128 v[132:135], v7 offset:20480
ds_read_b128 v[136:139], v7 offset:1024
ds_read_b128 v[140:143], v7 offset:21504
s_mov_b32 s66, 0
s_mov_b32 s64, s76
s_mov_b32 s76, 536870912
s_mov_b32 s7, s75
s_mov_b32 s75, 536870912
s_mov_b32 s89, 0
Lx_434:
s_waitcnt lgkmcnt(3)
v_mfma_f32_16x16x32_bf16 v[64:67], a[0:3], v[128:131], 0
ds_read_b128 v[144:147], v7 offset:2048
s_mul_i32 s84, s89, s77
v_mfma_f32_16x16x32_bf16 v[72:75], a[4:7], v[128:131], 0
s_add_u32 s84, s84, s76
v_mfma_f32_16x16x32_bf16 v[80:83], a[8:11], v[128:131], 0
s_add_u32 s83, s84, 6144
v_mfma_f32_16x16x32_bf16 v[88:91], a[12:15], v[128:131], 0
s_waitcnt lgkmcnt(3)
v_mfma_f32_16x16x32_bf16 v[68:71], a[0:3], v[132:135], 0
ds_read_b128 v[148:151], v7 offset:22528
v_mfma_f32_16x16x32_bf16 v[76:79], a[4:7], v[132:135], 0
v_cvt_pk_bf16_f32 v160, v96, v97
v_mfma_f32_16x16x32_bf16 v[84:87], a[8:11], v[132:135], 0
v_cvt_pk_bf16_f32 v161, v98, v99
v_mfma_f32_16x16x32_bf16 v[92:95], a[12:15], v[132:135], 0
v_cvt_pk_bf16_f32 v162, v104, v105
s_waitcnt lgkmcnt(3)
v_mfma_f32_16x16x32_bf16 v[64:67], a[16:19], v[136:139], v[64:67]
ds_read_b128 v[152:155], v7 offset:3072
v_cvt_pk_bf16_f32 v163, v106, v107
v_mfma_f32_16x16x32_bf16 v[72:75], a[20:23], v[136:139], v[72:75]
v_mfma_f32_16x16x32_bf16 v[80:83], a[24:27], v[136:139], v[80:83]
v_pk_max_i16 v160, v160, v9
v_mfma_f32_16x16x32_bf16 v[88:91], a[28:31], v[136:139], v[88:91]
v_pk_max_i16 v161, v161, v9
s_waitcnt lgkmcnt(3)
v_mfma_f32_16x16x32_bf16 v[68:71], a[16:19], v[140:143], v[68:71]
ds_read_b128 v[156:159], v7 offset:23552
v_pk_max_i16 v162, v162, v9
v_mfma_f32_16x16x32_bf16 v[76:79], a[20:23], v[140:143], v[76:79]
v_pk_max_i16 v163, v163, v9
v_mfma_f32_16x16x32_bf16 v[84:87], a[24:27], v[140:143], v[84:87]
buffer_store_dwordx4 v[160:163], v1, s[8:11], s84 offen offset:0 sc1
v_mfma_f32_16x16x32_bf16 v[92:95], a[28:31], v[140:143], v[92:95]
v_cvt_pk_bf16_f32 v164, v112, v113
s_waitcnt lgkmcnt(3)
v_mfma_f32_16x16x32_bf16 v[64:67], a[32:35], v[144:147], v[64:67]
ds_read_b128 v[128:131], v7 offset:4096
v_cvt_pk_bf16_f32 v165, v114, v115
v_mfma_f32_16x16x32_bf16 v[72:75], a[36:39], v[144:147], v[72:75]
v_cvt_pk_bf16_f32 v166, v120, v121
v_mfma_f32_16x16x32_bf16 v[80:83], a[40:43], v[144:147], v[80:83]
v_cvt_pk_bf16_f32 v167, v122, v123
v_mfma_f32_16x16x32_bf16 v[88:91], a[44:47], v[144:147], v[88:91]
s_waitcnt lgkmcnt(3)
v_mfma_f32_16x16x32_bf16 v[68:71], a[32:35], v[148:151], v[68:71]
ds_read_b128 v[132:135], v7 offset:24576
v_pk_max_i16 v164, v164, v9
v_mfma_f32_16x16x32_bf16 v[76:79], a[36:39], v[148:151], v[76:79]
v_pk_max_i16 v165, v165, v9
v_mfma_f32_16x16x32_bf16 v[84:87], a[40:43], v[148:151], v[84:87]
v_pk_max_i16 v166, v166, v9
v_mfma_f32_16x16x32_bf16 v[92:95], a[44:47], v[148:151], v[92:95]
v_pk_max_i16 v167, v167, v9
s_waitcnt lgkmcnt(3)
v_mfma_f32_16x16x32_bf16 v[64:67], a[48:51], v[152:155], v[64:67]
ds_read_b128 v[136:139], v7 offset:5120
buffer_store_dwordx4 v[164:167], v1, s[8:11], s84 offen offset:1024 sc1
v_mfma_f32_16x16x32_bf16 v[72:75], a[52:55], v[152:155], v[72:75]
v_cvt_pk_bf16_f32 v168, v100, v101
v_mfma_f32_16x16x32_bf16 v[80:83], a[56:59], v[152:155], v[80:83]
v_cvt_pk_bf16_f32 v169, v102, v103
v_mfma_f32_16x16x32_bf16 v[88:91], a[60:63], v[152:155], v[88:91]
v_cvt_pk_bf16_f32 v170, v108, v109
s_waitcnt lgkmcnt(3)
v_mfma_f32_16x16x32_bf16 v[68:71], a[48:51], v[156:159], v[68:71]
ds_read_b128 v[140:143], v7 offset:25600
v_cvt_pk_bf16_f32 v171, v110, v111
v_mfma_f32_16x16x32_bf16 v[76:79], a[52:55], v[156:159], v[76:79]
v_mfma_f32_16x16x32_bf16 v[84:87], a[56:59], v[156:159], v[84:87]
v_pk_max_i16 v168, v168, v9
v_mfma_f32_16x16x32_bf16 v[92:95], a[60:63], v[156:159], v[92:95]
v_pk_max_i16 v169, v169, v9
s_waitcnt lgkmcnt(3)
v_mfma_f32_16x16x32_bf16 v[64:67], a[64:67], v[128:131], v[64:67]
ds_read_b128 v[144:147], v7 offset:6144
v_pk_max_i16 v170, v170, v9
v_mfma_f32_16x16x32_bf16 v[72:75], a[68:71], v[128:131], v[72:75]
v_pk_max_i16 v171, v171, v9
v_mfma_f32_16x16x32_bf16 v[80:83], a[72:75], v[128:131], v[80:83]
buffer_store_dwordx4 v[168:171], v1, s[8:11], s83 offen offset:0 sc1
v_mfma_f32_16x16x32_bf16 v[88:91], a[76:79], v[128:131], v[88:91]
v_cvt_pk_bf16_f32 v172, v116, v117
s_waitcnt lgkmcnt(3)
v_mfma_f32_16x16x32_bf16 v[68:71], a[64:67], v[132:135], v[68:71]
ds_read_b128 v[148:151], v7 offset:26624
v_cvt_pk_bf16_f32 v173, v118, v119
v_mfma_f32_16x16x32_bf16 v[76:79], a[68:71], v[132:135], v[76:79]
v_cvt_pk_bf16_f32 v174, v124, v125
v_mfma_f32_16x16x32_bf16 v[84:87], a[72:75], v[132:135], v[84:87]
v_cvt_pk_bf16_f32 v175, v126, v127
v_mfma_f32_16x16x32_bf16 v[92:95], a[76:79], v[132:135], v[92:95]
s_waitcnt lgkmcnt(3)
v_mfma_f32_16x16x32_bf16 v[64:67], a[80:83], v[136:139], v[64:67]
ds_read_b128 v[152:155], v7 offset:7168
v_pk_max_i16 v172, v172, v9
v_mfma_f32_16x16x32_bf16 v[72:75], a[84:87], v[136:139], v[72:75]
v_pk_max_i16 v173, v173, v9
v_mfma_f32_16x16x32_bf16 v[80:83], a[88:91], v[136:139], v[80:83]
v_pk_max_i16 v174, v174, v9
v_mfma_f32_16x16x32_bf16 v[88:91], a[92:95], v[136:139], v[88:91]
v_pk_max_i16 v175, v175, v9
s_waitcnt lgkmcnt(3)
v_mfma_f32_16x16x32_bf16 v[68:71], a[80:83], v[140:143], v[68:71]
ds_read_b128 v[156:159], v7 offset:27648
buffer_store_dwordx4 v[172:175], v1, s[8:11], s83 offen offset:1024 sc1
v_mfma_f32_16x16x32_bf16 v[76:79], a[84:87], v[140:143], v[76:79]
s_sub_u32 s93, s89, 12
v_mfma_f32_16x16x32_bf16 v[84:87], a[88:91], v[140:143], v[84:87]
s_max_i32 s93, s93, 0
v_mfma_f32_16x16x32_bf16 v[92:95], a[92:95], v[140:143], v[92:95]
s_lshr_b32 s93, s93, 2
s_waitcnt lgkmcnt(3)
v_mfma_f32_16x16x32_bf16 v[64:67], a[96:99], v[144:147], v[64:67]
ds_read_b128 v[128:131], v7 offset:8192
s_add_u32 s93, s93, s89
v_mfma_f32_16x16x32_bf16 v[72:75], a[100:103], v[144:147], v[72:75]
v_mfma_f32_16x16x32_bf16 v[80:83], a[104:107], v[144:147], v[80:83]
s_mul_i32 s92, s89, 5
v_mfma_f32_16x16x32_bf16 v[88:91], a[108:111], v[144:147], v[88:91]
s_sub_u32 s92, s92, 304
s_waitcnt lgkmcnt(3)
v_mfma_f32_16x16x32_bf16 v[68:71], a[96:99], v[148:151], v[68:71]
ds_read_b128 v[132:135], v7 offset:28672
s_min_u32 s92, s92, s89
v_mfma_f32_16x16x32_bf16 v[76:79], a[100:103], v[148:151], v[76:79]
s_cmp_lt_u32 s89, 64
v_mfma_f32_16x16x32_bf16 v[84:87], a[104:107], v[148:151], v[84:87]
s_cselect_b32 s93, s93, s92
v_mfma_f32_16x16x32_bf16 v[92:95], a[108:111], v[148:151], v[92:95]
s_add_u32 s93, s93, 1
s_waitcnt lgkmcnt(3)
v_mfma_f32_16x16x32_bf16 v[64:67], a[112:115], v[152:155], v[64:67]
ds_read_b128 v[136:139], v7 offset:9216
v_mov_b32 v8, s93
v_mfma_f32_16x16x32_bf16 v[72:75], a[116:119], v[152:155], v[72:75]
s_add_u32 s79, s79, 40960
v_mfma_f32_16x16x32_bf16 v[80:83], a[120:123], v[152:155], v[80:83]
s_cmp_ge_u32 s79, 163840
v_mfma_f32_16x16x32_bf16 v[88:91], a[124:127], v[152:155], v[88:91]
s_waitcnt lgkmcnt(3)
v_mfma_f32_16x16x32_bf16 v[68:71], a[112:115], v[156:159], v[68:71]
ds_read_b128 v[140:143], v7 offset:29696
s_cselect_b32 s73, 163840, 0
v_mfma_f32_16x16x32_bf16 v[76:79], a[116:119], v[156:159], v[76:79]
s_sub_u32 s79, s79, s73
v_mfma_f32_16x16x32_bf16 v[84:87], a[120:123], v[156:159], v[84:87]
s_add_u32 s82, s82, 40960
v_mfma_f32_16x16x32_bf16 v[92:95], a[124:127], v[156:159], v[92:95]
s_cmp_ge_u32 s82, 163840
s_waitcnt lgkmcnt(3)
v_mfma_f32_16x16x32_bf16 v[64:67], a[128:131], v[128:131], v[64:67]
ds_read_b128 v[144:147], v7 offset:10240
s_cselect_b32 s82, 0, s82
v_mfma_f32_16x16x32_bf16 v[72:75], a[132:135], v[128:131], v[72:75]
s_mov_b32 s73, 536870912
v_mfma_f32_16x16x32_bf16 v[80:83], a[136:139], v[128:131], v[80:83]
s_cmp_eq_u32 s87, 0
v_mfma_f32_16x16x32_bf16 v[88:91], a[140:143], v[128:131], v[88:91]
s_cselect_b32 s73, 193024000, s73
s_waitcnt lgkmcnt(3)
v_mfma_f32_16x16x32_bf16 v[68:71], a[128:131], v[132:135], v[68:71]
ds_read_b128 v[148:151], v7 offset:30720
buffer_load_dword v17, v16, s[8:11], s73 offen sc1
v_mfma_f32_16x16x32_bf16 v[76:79], a[132:135], v[132:135], v[76:79]
v_mfma_f32_16x16x32_bf16 v[84:87], a[136:139], v[132:135], v[84:87]
v_mfma_f32_16x16x32_bf16 v[92:95], a[140:143], v[132:135], v[92:95]
s_waitcnt lgkmcnt(3)
v_mfma_f32_16x16x32_bf16 v[64:67], a[144:147], v[136:139], v[64:67]
ds_read_b128 v[152:155], v7 offset:11264
v_mfma_f32_16x16x32_bf16 v[72:75], a[148:151], v[136:139], v[72:75]
v_mfma_f32_16x16x32_bf16 v[80:83], a[152:155], v[136:139], v[80:83]
v_mfma_f32_16x16x32_bf16 v[88:91], a[156:159], v[136:139], v[88:91]
s_waitcnt lgkmcnt(3)
v_mfma_f32_16x16x32_bf16 v[68:71], a[144:147], v[140:143], v[68:71]
ds_read_b128 v[156:159], v7 offset:31744
v_mfma_f32_16x16x32_bf16 v[76:79], a[148:151], v[140:143], v[76:79]
v_mfma_f32_16x16x32_bf16 v[84:87], a[152:155], v[140:143], v[84:87]
v_mfma_f32_16x16x32_bf16 v[92:95], a[156:159], v[140:143], v[92:95]
s_waitcnt lgkmcnt(3)
v_mfma_f32_16x16x32_bf16 v[64:67], a[160:163], v[144:147], v[64:67]
ds_read_b128 v[128:131], v7 offset:12288
v_mfma_f32_16x16x32_bf16 v[72:75], a[164:167], v[144:147], v[72:75]
v_mfma_f32_16x16x32_bf16 v[80:83], a[168:171], v[144:147], v[80:83]
v_mfma_f32_16x16x32_bf16 v[88:91], a[172:175], v[144:147], v[88:91]
s_waitcnt lgkmcnt(3)
v_mfma_f32_16x16x32_bf16 v[68:71], a[160:163], v[148:151], v[68:71]
ds_read_b128 v[132:135], v7 offset:32768
v_mfma_f32_16x16x32_bf16 v[76:79], a[164:167], v[148:151], v[76:79]
v_mfma_f32_16x16x32_bf16 v[84:87], a[168:171], v[148:151], v[84:87]
v_mfma_f32_16x16x32_bf16 v[92:95], a[172:175], v[148:151], v[92:95]
s_waitcnt lgkmcnt(3)
v_mfma_f32_16x16x32_bf16 v[64:67], a[176:179], v[152:155], v[64:67]
ds_read_b128 v[136:139], v7 offset:13312
v_mfma_f32_16x16x32_bf16 v[72:75], a[180:183], v[152:155], v[72:75]
v_mfma_f32_16x16x32_bf16 v[80:83], a[184:187], v[152:155], v[80:83]
s_waitcnt vmcnt(0)
buffer_store_dword v8, v3, s[8:11], s75 offen sc1
s_mov_b32 s76, s64
s_mov_b32 s75, s7
s_mov_b32 s89, s90
s_mov_b32 s90, s91
s_mov_b32 s91, s94
s_cmp_eq_u32 s87, 0
s_cbranch_scc1 Lnm_439
s_mov_b32 s94, s85
s_add_u32 s85, s85, 1
s_sub_u32 s87, s87, 1
Lnb_440:
s_mul_i32 s78, s94, 40960
s_add_u32 s78, s78, s95
v_mfma_f32_16x16x32_bf16 v[88:91], a[188:191], v[152:155], v[88:91]
s_waitcnt lgkmcnt(3)
v_mfma_f32_16x16x32_bf16 v[68:71], a[176:179], v[156:159], v[68:71]
ds_read_b128 v[140:143], v7 offset:33792
v_mfma_f32_16x16x32_bf16 v[76:79], a[180:183], v[156:159], v[76:79]
v_mfma_f32_16x16x32_bf16 v[84:87], a[184:187], v[156:159], v[84:87]
v_mfma_f32_16x16x32_bf16 v[92:95], a[188:191], v[156:159], v[92:95]
s_waitcnt lgkmcnt(3)
v_mfma_f32_16x16x32_bf16 v[64:67], a[192:195], v[128:131], v[64:67]
ds_read_b128 v[144:147], v7 offset:14336
v_mfma_f32_16x16x32_bf16 v[72:75], a[196:199], v[128:131], v[72:75]
v_mfma_f32_16x16x32_bf16 v[80:83], a[200:203], v[128:131], v[80:83]
v_mfma_f32_16x16x32_bf16 v[88:91], a[204:207], v[128:131], v[88:91]
s_waitcnt lgkmcnt(3)
v_mfma_f32_16x16x32_bf16 v[68:71], a[192:195], v[132:135], v[68:71]
ds_read_b128 v[148:151], v7 offset:34816
v_mfma_f32_16x16x32_bf16 v[76:79], a[196:199], v[132:135], v[76:79]
v_mfma_f32_16x16x32_bf16 v[84:87], a[200:203], v[132:135], v[84:87]
v_mfma_f32_16x16x32_bf16 v[92:95], a[204:207], v[132:135], v[92:95]
s_waitcnt lgkmcnt(3)
v_mfma_f32_16x16x32_bf16 v[64:67], a[208:211], v[136:139], v[64:67]
ds_read_b128 v[152:155], v7 offset:15360
v_mfma_f32_16x16x32_bf16 v[72:75], a[212:215], v[136:139], v[72:75]
v_mfma_f32_16x16x32_bf16 v[80:83], a[216:219], v[136:139], v[80:83]
v_mfma_f32_16x16x32_bf16 v[88:91], a[220:223], v[136:139], v[88:91]
s_waitcnt lgkmcnt(3)
v_mfma_f32_16x16x32_bf16 v[68:71], a[208:211], v[140:143], v[68:71]
ds_read_b128 v[156:159], v7 offset:35840
v_mfma_f32_16x16x32_bf16 v[76:79], a[212:215], v[140:143], v[76:79]
v_mfma_f32_16x16x32_bf16 v[84:87], a[216:219], v[140:143], v[84:87]
v_mfma_f32_16x16x32_bf16 v[92:95], a[220:223], v[140:143], v[92:95]
s_waitcnt lgkmcnt(3)
v_mfma_f32_16x16x32_bf16 v[64:67], a[224:227], v[144:147], v[64:67]
ds_read_b128 v[128:131], v7 offset:16384
v_mfma_f32_16x16x32_bf16 v[72:75], a[228:231], v[144:147], v[72:75]
v_mfma_f32_16x16x32_bf16 v[80:83], a[232:235], v[144:147], v[80:83]
v_mfma_f32_16x16x32_bf16 v[88:91], a[236:239], v[144:147], v[88:91]
s_waitcnt lgkmcnt(3)
v_mfma_f32_16x16x32_bf16 v[68:71], a[224:227], v[148:151], v[68:71]
ds_read_b128 v[132:135], v7 offset:36864
v_mfma_f32_16x16x32_bf16 v[76:79], a[228:231], v[148:151], v[76:79]
v_mfma_f32_16x16x32_bf16 v[84:87], a[232:235], v[148:151], v[84:87]
v_mfma_f32_16x16x32_bf16 v[92:95], a[236:239], v[148:151], v[92:95]
s_waitcnt lgkmcnt(3)
v_mfma_f32_16x16x32_bf16 v[64:67], a[240:243], v[152:155], v[64:67]
ds_read_b128 v[136:139], v7 offset:17408
v_mfma_f32_16x16x32_bf16 v[72:75], a[244:247], v[152:155], v[72:75]
v_mfma_f32_16x16x32_bf16 v[80:83], a[248:251], v[152:155], v[80:83]
v_mfma_f32_16x16x32_bf16 v[88:91], a[252:255], v[152:155], v[88:91]
s_waitcnt lgkmcnt(3)
v_mfma_f32_16x16x32_bf16 v[68:71], a[240:243], v[156:159], v[68:71]
ds_read_b128 v[140:143], v7 offset:37888
v_mfma_f32_16x16x32_bf16 v[76:79], a[244:247], v[156:159], v[76:79]
v_mfma_f32_16x16x32_bf16 v[84:87], a[248:251], v[156:159], v[84:87]
v_mfma_f32_16x16x32_bf16 v[92:95], a[252:255], v[156:159], v[92:95]
s_waitcnt lgkmcnt(3)
v_mfma_f32_16x16x32_bf16 v[64:67], v[192:195], v[128:131], v[64:67]
ds_read_b128 v[144:147], v7 offset:18432
v_mfma_f32_16x16x32_bf16 v[72:75], v[196:199], v[128:131], v[72:75]
v_mfma_f32_16x16x32_bf16 v[80:83], v[200:203], v[128:131], v[80:83]
v_mfma_f32_16x16x32_bf16 v[88:91], v[204:207], v[128:131], v[88:91]
s_waitcnt lgkmcnt(3)
v_mfma_f32_16x16x32_bf16 v[68:71], v[192:195], v[132:135], v[68:71]
ds_read_b128 v[148:151], v7 offset:38912
v_mfma_f32_16x16x32_bf16 v[76:79], v[196:199], v[132:135], v[76:79]
v_mfma_f32_16x16x32_bf16 v[84:87], v[200:203], v[132:135], v[84:87]
v_mfma_f32_16x16x32_bf16 v[92:95], v[204:207], v[132:135], v[92:95]
s_waitcnt lgkmcnt(3)
v_mfma_f32_16x16x32_bf16 v[64:67], v[208:211], v[136:139], v[64:67]
ds_read_b128 v[152:155], v7 offset:19456
v_mfma_f32_16x16x32_bf16 v[72:75], v[212:215], v[136:139], v[72:75]
v_mfma_f32_16x16x32_bf16 v[80:83], v[216:219], v[136:139], v[80:83]
v_mfma_f32_16x16x32_bf16 v[88:91], v[220:223], v[136:139], v[88:91]
s_waitcnt lgkmcnt(3)
v_mfma_f32_16x16x32_bf16 v[68:71], v[208:211], v[140:143], v[68:71]
ds_read_b128 v[156:159], v7 offset:39936
v_mfma_f32_16x16x32_bf16 v[76:79], v[212:215], v[140:143], v[76:79]
v_mfma_f32_16x16x32_bf16 v[84:87], v[216:219], v[140:143], v[84:87]
v_mfma_f32_16x16x32_bf16 v[92:95], v[220:223], v[140:143], v[92:95]
s_barrier
v_add_u32 v7, s82, v1
s_waitcnt lgkmcnt(3)
v_mfma_f32_16x16x32_bf16 v[64:67], v[224:227], v[144:147], v[64:67]
ds_read_b128 v[128:131], v7 offset:0
s_add_u32 m0, s79, 0
v_mfma_f32_16x16x32_bf16 v[72:75], v[228:231], v[144:147], v[72:75]
s_add_u32 s73, s78, 0
v_mfma_f32_16x16x32_bf16 v[80:83], v[232:235], v[144:147], v[80:83]
buffer_load_dwordx4 v1, s[8:11], s73 offen offset:0 sc1 lds
v_mfma_f32_16x16x32_bf16 v[88:91], v[236:239], v[144:147], v[88:91]
buffer_load_dwordx4 v1, s[8:11], s73 offen offset:1024 sc1 lds
s_waitcnt lgkmcnt(3)
v_mfma_f32_16x16x32_bf16 v[68:71], v[224:227], v[148:151], v[68:71]
ds_read_b128 v[132:135], v7 offset:20480
buffer_load_dwordx4 v1, s[8:11], s73 offen offset:2048 sc1 lds
v_mfma_f32_16x16x32_bf16 v[76:79], v[228:231], v[148:151], v[76:79]
buffer_load_dwordx4 v1, s[8:11], s73 offen offset:3072 sc1 lds
v_mfma_f32_16x16x32_bf16 v[84:87], v[232:235], v[148:151], v[84:87]
s_add_u32 m0, s79, 4096
v_mfma_f32_16x16x32_bf16 v[92:95], v[236:239], v[148:151], v[92:95]
s_add_u32 s73, s78, 4096
s_waitcnt lgkmcnt(3)
v_mfma_f32_16x16x32_bf16 v[64:67], v[240:243], v[152:155], v[64:67]
ds_read_b128 v[136:139], v7 offset:1024
buffer_load_dwordx4 v1, s[8:11], s73 offen offset:0 sc1 lds
v_mfma_f32_16x16x32_bf16 v[72:75], v[244:247], v[152:155], v[72:75]
buffer_load_dwordx4 v1, s[8:11], s73 offen offset:1024 sc1 lds
v_mfma_f32_16x16x32_bf16 v[80:83], v[248:251], v[152:155], v[80:83]
buffer_load_dwordx4 v1, s[8:11], s73 offen offset:2048 sc1 lds
v_mfma_f32_16x16x32_bf16 v[88:91], v[252:255], v[152:155], v[88:91]
buffer_load_dwordx4 v1, s[8:11], s73 offen offset:3072 sc1 lds
s_waitcnt lgkmcnt(3)
v_mfma_f32_16x16x32_bf16 v[68:71], v[240:243], v[156:159], v[68:71]
ds_read_b128 v[140:143], v7 offset:21504
s_add_u32 m0, s79, 8192
v_mfma_f32_16x16x32_bf16 v[76:79], v[244:247], v[156:159], v[76:79]
s_add_u32 s73, s78, 8192
v_mfma_f32_16x16x32_bf16 v[84:87], v[248:251], v[156:159], v[84:87]
buffer_load_dwordx4 v1, s[8:11], s73 offen offset:0 sc1 lds
v_mfma_f32_16x16x32_bf16 v[92:95], v[252:255], v[156:159], v[92:95]
buffer_load_dwordx4 v1, s[8:11], s73 offen offset:1024 sc1 lds
s_add_u32 s66, s66, 1
s_cmp_ge_u32 s66, s88
s_cbranch_scc1 Lx_435
s_waitcnt lgkmcnt(3)
v_mfma_f32_16x16x32_bf16 v[96:99], a[0:3], v[128:131], 0
ds_read_b128 v[144:147], v7 offset:2048
s_mul_i32 s84, s89, s77
v_mfma_f32_16x16x32_bf16 v[104:107], a[4:7], v[128:131], 0
s_add_u32 s84, s84, s76
v_mfma_f32_16x16x32_bf16 v[112:115], a[8:11], v[128:131], 0
s_add_u32 s83, s84, 6144
v_mfma_f32_16x16x32_bf16 v[120:123], a[12:15], v[128:131], 0
s_waitcnt lgkmcnt(3)
v_mfma_f32_16x16x32_bf16 v[100:103], a[0:3], v[132:135], 0
ds_read_b128 v[148:151], v7 offset:22528
v_mfma_f32_16x16x32_bf16 v[108:111], a[4:7], v[132:135], 0
v_cvt_pk_bf16_f32 v160, v64, v65
v_mfma_f32_16x16x32_bf16 v[116:119], a[8:11], v[132:135], 0
v_cvt_pk_bf16_f32 v161, v66, v67
v_mfma_f32_16x16x32_bf16 v[124:127], a[12:15], v[132:135], 0
v_cvt_pk_bf16_f32 v162, v72, v73
s_waitcnt lgkmcnt(3)
v_mfma_f32_16x16x32_bf16 v[96:99], a[16:19], v[136:139], v[96:99]
ds_read_b128 v[152:155], v7 offset:3072
v_cvt_pk_bf16_f32 v163, v74, v75
v_mfma_f32_16x16x32_bf16 v[104:107], a[20:23], v[136:139], v[104:107]
v_mfma_f32_16x16x32_bf16 v[112:115], a[24:27], v[136:139], v[112:115]
v_pk_max_i16 v160, v160, v9
v_mfma_f32_16x16x32_bf16 v[120:123], a[28:31], v[136:139], v[120:123]
v_pk_max_i16 v161, v161, v9
s_waitcnt lgkmcnt(3)
v_mfma_f32_16x16x32_bf16 v[100:103], a[16:19], v[140:143], v[100:103]
ds_read_b128 v[156:159], v7 offset:23552
v_pk_max_i16 v162, v162, v9
v_mfma_f32_16x16x32_bf16 v[108:111], a[20:23], v[140:143], v[108:111]
v_pk_max_i16 v163, v163, v9
v_mfma_f32_16x16x32_bf16 v[116:119], a[24:27], v[140:143], v[116:119]
buffer_store_dwordx4 v[160:163], v1, s[8:11], s84 offen offset:0 sc1
v_mfma_f32_16x16x32_bf16 v[124:127], a[28:31], v[140:143], v[124:127]
v_cvt_pk_bf16_f32 v164, v80, v81
s_waitcnt lgkmcnt(3)
v_mfma_f32_16x16x32_bf16 v[96:99], a[32:35], v[144:147], v[96:99]
ds_read_b128 v[128:131], v7 offset:4096
v_cvt_pk_bf16_f32 v165, v82, v83
v_mfma_f32_16x16x32_bf16 v[104:107], a[36:39], v[144:147], v[104:107]
v_cvt_pk_bf16_f32 v166, v88, v89
v_mfma_f32_16x16x32_bf16 v[112:115], a[40:43], v[144:147], v[112:115]
v_cvt_pk_bf16_f32 v167, v90, v91
v_mfma_f32_16x16x32_bf16 v[120:123], a[44:47], v[144:147], v[120:123]
s_waitcnt lgkmcnt(3)
v_mfma_f32_16x16x32_bf16 v[100:103], a[32:35], v[148:151], v[100:103]
ds_read_b128 v[132:135], v7 offset:24576
v_pk_max_i16 v164, v164, v9
v_mfma_f32_16x16x32_bf16 v[108:111], a[36:39], v[148:151], v[108:111]
v_pk_max_i16 v165, v165, v9
v_mfma_f32_16x16x32_bf16 v[116:119], a[40:43], v[148:151], v[116:119]
v_pk_max_i16 v166, v166, v9
v_mfma_f32_16x16x32_bf16 v[124:127], a[44:47], v[148:151], v[124:127]
v_pk_max_i16 v167, v167, v9
s_waitcnt lgkmcnt(3)
v_mfma_f32_16x16x32_bf16 v[96:99], a[48:51], v[152:155], v[96:99]
ds_read_b128 v[136:139], v7 offset:5120
buffer_store_dwordx4 v[164:167], v1, s[8:11], s84 offen offset:1024 sc1
v_mfma_f32_16x16x32_bf16 v[104:107], a[52:55], v[152:155], v[104:107]
v_cvt_pk_bf16_f32 v168, v68, v69
v_mfma_f32_16x16x32_bf16 v[112:115], a[56:59], v[152:155], v[112:115]
v_cvt_pk_bf16_f32 v169, v70, v71
v_mfma_f32_16x16x32_bf16 v[120:123], a[60:63], v[152:155], v[120:123]
v_cvt_pk_bf16_f32 v170, v76, v77
s_waitcnt lgkmcnt(3)
v_mfma_f32_16x16x32_bf16 v[100:103], a[48:51], v[156:159], v[100:103]
ds_read_b128 v[140:143], v7 offset:25600
v_cvt_pk_bf16_f32 v171, v78, v79
v_mfma_f32_16x16x32_bf16 v[108:111], a[52:55], v[156:159], v[108:111]
v_mfma_f32_16x16x32_bf16 v[116:119], a[56:59], v[156:159], v[116:119]
v_pk_max_i16 v168, v168, v9
v_mfma_f32_16x16x32_bf16 v[124:127], a[60:63], v[156:159], v[124:127]
v_pk_max_i16 v169, v169, v9
s_waitcnt lgkmcnt(3)
v_mfma_f32_16x16x32_bf16 v[96:99], a[64:67], v[128:131], v[96:99]
ds_read_b128 v[144:147], v7 offset:6144
v_pk_max_i16 v170, v170, v9
v_mfma_f32_16x16x32_bf16 v[104:107], a[68:71], v[128:131], v[104:107]
v_pk_max_i16 v171, v171, v9
v_mfma_f32_16x16x32_bf16 v[112:115], a[72:75], v[128:131], v[112:115]
buffer_store_dwordx4 v[168:171], v1, s[8:11], s83 offen offset:0 sc1
v_mfma_f32_16x16x32_bf16 v[120:123], a[76:79], v[128:131], v[120:123]
v_cvt_pk_bf16_f32 v172, v84, v85
s_waitcnt lgkmcnt(3)
v_mfma_f32_16x16x32_bf16 v[100:103], a[64:67], v[132:135], v[100:103]
ds_read_b128 v[148:151], v7 offset:26624
v_cvt_pk_bf16_f32 v173, v86, v87
v_mfma_f32_16x16x32_bf16 v[108:111], a[68:71], v[132:135], v[108:111]
v_cvt_pk_bf16_f32 v174, v92, v93
v_mfma_f32_16x16x32_bf16 v[116:119], a[72:75], v[132:135], v[116:119]
v_cvt_pk_bf16_f32 v175, v94, v95
v_mfma_f32_16x16x32_bf16 v[124:127], a[76:79], v[132:135], v[124:127]
s_waitcnt lgkmcnt(3)
v_mfma_f32_16x16x32_bf16 v[96:99], a[80:83], v[136:139], v[96:99]
ds_read_b128 v[152:155], v7 offset:7168
v_pk_max_i16 v172, v172, v9
v_mfma_f32_16x16x32_bf16 v[104:107], a[84:87], v[136:139], v[104:107]
v_pk_max_i16 v173, v173, v9
v_mfma_f32_16x16x32_bf16 v[112:115], a[88:91], v[136:139], v[112:115]
v_pk_max_i16 v174, v174, v9
v_mfma_f32_16x16x32_bf16 v[120:123], a[92:95], v[136:139], v[120:123]
v_pk_max_i16 v175, v175, v9
s_waitcnt lgkmcnt(3)
v_mfma_f32_16x16x32_bf16 v[100:103], a[80:83], v[140:143], v[100:103]
ds_read_b128 v[156:159], v7 offset:27648
buffer_store_dwordx4 v[172:175], v1, s[8:11], s83 offen offset:1024 sc1
v_mfma_f32_16x16x32_bf16 v[108:111], a[84:87], v[140:143], v[108:111]
s_sub_u32 s93, s89, 12
v_mfma_f32_16x16x32_bf16 v[116:119], a[88:91], v[140:143], v[116:119]
s_max_i32 s93, s93, 0
v_mfma_f32_16x16x32_bf16 v[124:127], a[92:95], v[140:143], v[124:127]
s_lshr_b32 s93, s93, 2
s_waitcnt lgkmcnt(3)
v_mfma_f32_16x16x32_bf16 v[96:99], a[96:99], v[144:147], v[96:99]
ds_read_b128 v[128:131], v7 offset:8192
s_add_u32 s93, s93, s89
v_mfma_f32_16x16x32_bf16 v[104:107], a[100:103], v[144:147], v[104:107]
v_mfma_f32_16x16x32_bf16 v[112:115], a[104:107], v[144:147], v[112:115]
s_mul_i32 s92, s89, 5
v_mfma_f32_16x16x32_bf16 v[120:123], a[108:111], v[144:147], v[120:123]
s_sub_u32 s92, s92, 304
s_waitcnt lgkmcnt(3)
v_mfma_f32_16x16x32_bf16 v[100:103], a[96:99], v[148:151], v[100:103]
ds_read_b128 v[132:135], v7 offset:28672
s_min_u32 s92, s92, s89
v_mfma_f32_16x16x32_bf16 v[108:111], a[100:103], v[148:151], v[108:111]
s_cmp_lt_u32 s89, 64
v_mfma_f32_16x16x32_bf16 v[116:119], a[104:107], v[148:151], v[116:119]
s_cselect_b32 s93, s93, s92
v_mfma_f32_16x16x32_bf16 v[124:127], a[108:111], v[148:151], v[124:127]
s_add_u32 s93, s93, 1
s_waitcnt lgkmcnt(3)
v_mfma_f32_16x16x32_bf16 v[96:99], a[112:115], v[152:155], v[96:99]
ds_read_b128 v[136:139], v7 offset:9216
v_mov_b32 v8, s93
v_mfma_f32_16x16x32_bf16 v[104:107], a[116:119], v[152:155], v[104:107]
s_add_u32 s79, s79, 40960
v_mfma_f32_16x16x32_bf16 v[112:115], a[120:123], v[152:155], v[112:115]
s_cmp_ge_u32 s79, 163840
v_mfma_f32_16x16x32_bf16 v[120:123], a[124:127], v[152:155], v[120:123]
s_waitcnt lgkmcnt(3)
v_mfma_f32_16x16x32_bf16 v[100:103], a[112:115], v[156:159], v[100:103]
ds_read_b128 v[140:143], v7 offset:29696
s_cselect_b32 s73, 163840, 0
v_mfma_f32_16x16x32_bf16 v[108:111], a[116:119], v[156:159], v[108:111]
s_sub_u32 s79, s79, s73
v_mfma_f32_16x16x32_bf16 v[116:119], a[120:123], v[156:159], v[116:119]
s_add_u32 s82, s82, 40960
v_mfma_f32_16x16x32_bf16 v[124:127], a[124:127], v[156:159], v[124:127]
s_cmp_ge_u32 s82, 163840
s_waitcnt lgkmcnt(3)
v_mfma_f32_16x16x32_bf16 v[96:99], a[128:131], v[128:131], v[96:99]
ds_read_b128 v[144:147], v7 offset:10240
s_cselect_b32 s82, 0, s82
v_mfma_f32_16x16x32_bf16 v[104:107], a[132:135], v[128:131], v[104:107]
s_mov_b32 s73, 536870912
v_mfma_f32_16x16x32_bf16 v[112:115], a[136:139], v[128:131], v[112:115]
s_cmp_eq_u32 s87, 0
v_mfma_f32_16x16x32_bf16 v[120:123], a[140:143], v[128:131], v[120:123]
s_cselect_b32 s73, 193024000, s73
s_waitcnt lgkmcnt(3)
v_mfma_f32_16x16x32_bf16 v[100:103], a[128:131], v[132:135], v[100:103]
ds_read_b128 v[148:151], v7 offset:30720
buffer_load_dword v17, v16, s[8:11], s73 offen sc1
v_mfma_f32_16x16x32_bf16 v[108:111], a[132:135], v[132:135], v[108:111]
v_mfma_f32_16x16x32_bf16 v[116:119], a[136:139], v[132:135], v[116:119]
v_mfma_f32_16x16x32_bf16 v[124:127], a[140:143], v[132:135], v[124:127]
s_waitcnt lgkmcnt(3)
v_mfma_f32_16x16x32_bf16 v[96:99], a[144:147], v[136:139], v[96:99]
ds_read_b128 v[152:155], v7 offset:11264
v_mfma_f32_16x16x32_bf16 v[104:107], a[148:151], v[136:139], v[104:107]
v_mfma_f32_16x16x32_bf16 v[112:115], a[152:155], v[136:139], v[112:115]
v_mfma_f32_16x16x32_bf16 v[120:123], a[156:159], v[136:139], v[120:123]
s_waitcnt lgkmcnt(3)
v_mfma_f32_16x16x32_bf16 v[100:103], a[144:147], v[140:143], v[100:103]
ds_read_b128 v[156:159], v7 offset:31744
v_mfma_f32_16x16x32_bf16 v[108:111], a[148:151], v[140:143], v[108:111]
v_mfma_f32_16x16x32_bf16 v[116:119], a[152:155], v[140:143], v[116:119]
v_mfma_f32_16x16x32_bf16 v[124:127], a[156:159], v[140:143], v[124:127]
s_waitcnt lgkmcnt(3)
v_mfma_f32_16x16x32_bf16 v[96:99], a[160:163], v[144:147], v[96:99]
ds_read_b128 v[128:131], v7 offset:12288
v_mfma_f32_16x16x32_bf16 v[104:107], a[164:167], v[144:147], v[104:107]
v_mfma_f32_16x16x32_bf16 v[112:115], a[168:171], v[144:147], v[112:115]
v_mfma_f32_16x16x32_bf16 v[120:123], a[172:175], v[144:147], v[120:123]
s_waitcnt lgkmcnt(3)
v_mfma_f32_16x16x32_bf16 v[100:103], a[160:163], v[148:151], v[100:103]
ds_read_b128 v[132:135], v7 offset:32768
v_mfma_f32_16x16x32_bf16 v[108:111], a[164:167], v[148:151], v[108:111]
v_mfma_f32_16x16x32_bf16 v[116:119], a[168:171], v[148:151], v[116:119]
v_mfma_f32_16x16x32_bf16 v[124:127], a[172:175], v[148:151], v[124:127]
s_waitcnt lgkmcnt(3)
v_mfma_f32_16x16x32_bf16 v[96:99], a[176:179], v[152:155], v[96:99]
ds_read_b128 v[136:139], v7 offset:13312
v_mfma_f32_16x16x32_bf16 v[104:107], a[180:183], v[152:155], v[104:107]
v_mfma_f32_16x16x32_bf16 v[112:115], a[184:187], v[152:155], v[112:115]
s_waitcnt vmcnt(0)
buffer_store_dword v8, v3, s[8:11], s75 offen sc1
s_mov_b32 s76, s64
s_mov_b32 s75, s7
s_mov_b32 s89, s90
s_mov_b32 s90, s91
s_mov_b32 s91, s94
s_cmp_eq_u32 s87, 0
s_cbranch_scc1 Lnm_441
s_mov_b32 s94, s85
s_add_u32 s85, s85, 1
s_sub_u32 s87, s87, 1
Lnb_442:
s_mul_i32 s78, s94, 40960
s_add_u32 s78, s78, s95
v_mfma_f32_16x16x32_bf16 v[120:123], a[188:191], v[152:155], v[120:123]
s_waitcnt lgkmcnt(3)
v_mfma_f32_16x16x32_bf16 v[100:103], a[176:179], v[156:159], v[100:103]
ds_read_b128 v[140:143], v7 offset:33792
v_mfma_f32_16x16x32_bf16 v[108:111], a[180:183], v[156:159], v[108:111]
v_mfma_f32_16x16x32_bf16 v[116:119], a[184:187], v[156:159], v[116:119]
v_mfma_f32_16x16x32_bf16 v[124:127], a[188:191], v[156:159], v[124:127]
s_waitcnt lgkmcnt(3)
v_mfma_f32_16x16x32_bf16 v[96:99], a[192:195], v[128:131], v[96:99]
ds_read_b128 v[144:147], v7 offset:14336
v_mfma_f32_16x16x32_bf16 v[104:107], a[196:199], v[128:131], v[104:107]
v_mfma_f32_16x16x32_bf16 v[112:115], a[200:203], v[128:131], v[112:115]
v_mfma_f32_16x16x32_bf16 v[120:123], a[204:207], v[128:131], v[120:123]
s_waitcnt lgkmcnt(3)
v_mfma_f32_16x16x32_bf16 v[100:103], a[192:195], v[132:135], v[100:103]
ds_read_b128 v[148:151], v7 offset:34816
v_mfma_f32_16x16x32_bf16 v[108:111], a[196:199], v[132:135], v[108:111]
v_mfma_f32_16x16x32_bf16 v[116:119], a[200:203], v[132:135], v[116:119]
v_mfma_f32_16x16x32_bf16 v[124:127], a[204:207], v[132:135], v[124:127]
s_waitcnt lgkmcnt(3)
v_mfma_f32_16x16x32_bf16 v[96:99], a[208:211], v[136:139], v[96:99]
ds_read_b128 v[152:155], v7 offset:15360
v_mfma_f32_16x16x32_bf16 v[104:107], a[212:215], v[136:139], v[104:107]
v_mfma_f32_16x16x32_bf16 v[112:115], a[216:219], v[136:139], v[112:115]
v_mfma_f32_16x16x32_bf16 v[120:123], a[220:223], v[136:139], v[120:123]
s_waitcnt lgkmcnt(3)
v_mfma_f32_16x16x32_bf16 v[100:103], a[208:211], v[140:143], v[100:103]
ds_read_b128 v[156:159], v7 offset:35840
v_mfma_f32_16x16x32_bf16 v[108:111], a[212:215], v[140:143], v[108:111]
v_mfma_f32_16x16x32_bf16 v[116:119], a[216:219], v[140:143], v[116:119]
v_mfma_f32_16x16x32_bf16 v[124:127], a[220:223], v[140:143], v[124:127]
s_waitcnt lgkmcnt(3)
v_mfma_f32_16x16x32_bf16 v[96:99], a[224:227], v[144:147], v[96:99]
ds_read_b128 v[128:131], v7 offset:16384
v_mfma_f32_16x16x32_bf16 v[104:107], a[228:231], v[144:147], v[104:107]
v_mfma_f32_16x16x32_bf16 v[112:115], a[232:235], v[144:147], v[112:115]
v_mfma_f32_16x16x32_bf16 v[120:123], a[236:239], v[144:147], v[120:123]
s_waitcnt lgkmcnt(3)
v_mfma_f32_16x16x32_bf16 v[100:103], a[224:227], v[148:151], v[100:103]
ds_read_b128 v[132:135], v7 offset:36864
v_mfma_f32_16x16x32_bf16 v[108:111], a[228:231], v[148:151], v[108:111]
v_mfma_f32_16x16x32_bf16 v[116:119], a[232:235], v[148:151], v[116:119]
v_mfma_f32_16x16x32_bf16 v[124:127], a[236:239], v[148:151], v[124:127]
s_waitcnt lgkmcnt(3)
v_mfma_f32_16x16x32_bf16 v[96:99], a[240:243], v[152:155], v[96:99]
ds_read_b128 v[136:139], v7 offset:17408
v_mfma_f32_16x16x32_bf16 v[104:107], a[244:247], v[152:155], v[104:107]
v_mfma_f32_16x16x32_bf16 v[112:115], a[248:251], v[152:155], v[112:115]
v_mfma_f32_16x16x32_bf16 v[120:123], a[252:255], v[152:155], v[120:123]
s_waitcnt lgkmcnt(3)
v_mfma_f32_16x16x32_bf16 v[100:103], a[240:243], v[156:159], v[100:103]
ds_read_b128 v[140:143], v7 offset:37888
v_mfma_f32_16x16x32_bf16 v[108:111], a[244:247], v[156:159], v[108:111]
v_mfma_f32_16x16x32_bf16 v[116:119], a[248:251], v[156:159], v[116:119]
v_mfma_f32_16x16x32_bf16 v[124:127], a[252:255], v[156:159], v[124:127]
s_waitcnt lgkmcnt(3)
v_mfma_f32_16x16x32_bf16 v[96:99], v[192:195], v[128:131], v[96:99]
ds_read_b128 v[144:147], v7 offset:18432
v_mfma_f32_16x16x32_bf16 v[104:107], v[196:199], v[128:131], v[104:107]
v_mfma_f32_16x16x32_bf16 v[112:115], v[200:203], v[128:131], v[112:115]
v_mfma_f32_16x16x32_bf16 v[120:123], v[204:207], v[128:131], v[120:123]
s_waitcnt lgkmcnt(3)
v_mfma_f32_16x16x32_bf16 v[100:103], v[192:195], v[132:135], v[100:103]
ds_read_b128 v[148:151], v7 offset:38912
v_mfma_f32_16x16x32_bf16 v[108:111], v[196:199], v[132:135], v[108:111]
v_mfma_f32_16x16x32_bf16 v[116:119], v[200:203], v[132:135], v[116:119]
v_mfma_f32_16x16x32_bf16 v[124:127], v[204:207], v[132:135], v[124:127]
s_waitcnt lgkmcnt(3)
v_mfma_f32_16x16x32_bf16 v[96:99], v[208:211], v[136:139], v[96:99]
ds_read_b128 v[152:155], v7 offset:19456
v_mfma_f32_16x16x32_bf16 v[104:107], v[212:215], v[136:139], v[104:107]
v_mfma_f32_16x16x32_bf16 v[112:115], v[216:219], v[136:139], v[112:115]
v_mfma_f32_16x16x32_bf16 v[120:123], v[220:223], v[136:139], v[120:123]
s_waitcnt lgkmcnt(3)
v_mfma_f32_16x16x32_bf16 v[100:103], v[208:211], v[140:143], v[100:103]
ds_read_b128 v[156:159], v7 offset:39936
v_mfma_f32_16x16x32_bf16 v[108:111], v[212:215], v[140:143], v[108:111]
v_mfma_f32_16x16x32_bf16 v[116:119], v[216:219], v[140:143], v[116:119]
v_mfma_f32_16x16x32_bf16 v[124:127], v[220:223], v[140:143], v[124:127]
s_barrier
v_add_u32 v7, s82, v1
s_waitcnt lgkmcnt(3)
v_mfma_f32_16x16x32_bf16 v[96:99], v[224:227], v[144:147], v[96:99]
ds_read_b128 v[128:131], v7 offset:0
s_add_u32 m0, s79, 0
v_mfma_f32_16x16x32_bf16 v[104:107], v[228:231], v[144:147], v[104:107]
s_add_u32 s73, s78, 0
v_mfma_f32_16x16x32_bf16 v[112:115], v[232:235], v[144:147], v[112:115]
buffer_load_dwordx4 v1, s[8:11], s73 offen offset:0 sc1 lds
v_mfma_f32_16x16x32_bf16 v[120:123], v[236:239], v[144:147], v[120:123]
buffer_load_dwordx4 v1, s[8:11], s73 offen offset:1024 sc1 lds
s_waitcnt lgkmcnt(3)
v_mfma_f32_16x16x32_bf16 v[100:103], v[224:227], v[148:151], v[100:103]
ds_read_b128 v[132:135], v7 offset:20480
buffer_load_dwordx4 v1, s[8:11], s73 offen offset:2048 sc1 lds
v_mfma_f32_16x16x32_bf16 v[108:111], v[228:231], v[148:151], v[108:111]
buffer_load_dwordx4 v1, s[8:11], s73 offen offset:3072 sc1 lds
v_mfma_f32_16x16x32_bf16 v[116:119], v[232:235], v[148:151], v[116:119]
s_add_u32 m0, s79, 4096
v_mfma_f32_16x16x32_bf16 v[124:127], v[236:239], v[148:151], v[124:127]
s_add_u32 s73, s78, 4096
s_waitcnt lgkmcnt(3)
v_mfma_f32_16x16x32_bf16 v[96:99], v[240:243], v[152:155], v[96:99]
ds_read_b128 v[136:139], v7 offset:1024
buffer_load_dwordx4 v1, s[8:11], s73 offen offset:0 sc1 lds
v_mfma_f32_16x16x32_bf16 v[104:107], v[244:247], v[152:155], v[104:107]
buffer_load_dwordx4 v1, s[8:11], s73 offen offset:1024 sc1 lds
v_mfma_f32_16x16x32_bf16 v[112:115], v[248:251], v[152:155], v[112:115]
buffer_load_dwordx4 v1, s[8:11], s73 offen offset:2048 sc1 lds
v_mfma_f32_16x16x32_bf16 v[120:123], v[252:255], v[152:155], v[120:123]
buffer_load_dwordx4 v1, s[8:11], s73 offen offset:3072 sc1 lds
s_waitcnt lgkmcnt(3)
v_mfma_f32_16x16x32_bf16 v[100:103], v[240:243], v[156:159], v[100:103]
ds_read_b128 v[140:143], v7 offset:21504
s_add_u32 m0, s79, 8192
v_mfma_f32_16x16x32_bf16 v[108:111], v[244:247], v[156:159], v[108:111]
s_add_u32 s73, s78, 8192
v_mfma_f32_16x16x32_bf16 v[116:119], v[248:251], v[156:159], v[116:119]
buffer_load_dwordx4 v1, s[8:11], s73 offen offset:0 sc1 lds
v_mfma_f32_16x16x32_bf16 v[124:127], v[252:255], v[156:159], v[124:127]
buffer_load_dwordx4 v1, s[8:11], s73 offen offset:1024 sc1 lds
s_add_u32 s66, s66, 1
s_cmp_ge_u32 s66, s88
s_cbranch_scc1 Lx_436
s_branch Lx_434
Lx_436:
s_mul_i32 s84, s89, s77
s_add_u32 s84, s84, s76
s_add_u32 s83, s84, 6144
s_sub_u32 s93, s89, 12
s_max_i32 s93, s93, 0
s_lshr_b32 s93, s93, 2
s_add_u32 s93, s93, s89
s_mul_i32 s92, s89, 5
s_sub_u32 s92, s92, 304
s_min_u32 s92, s92, s89
s_cmp_lt_u32 s89, 64
s_cselect_b32 s93, s93, s92
s_add_u32 s93, s93, 1
v_mov_b32 v8, s93
v_cvt_pk_bf16_f32 v160, v96, v97
v_cvt_pk_bf16_f32 v161, v98, v99
v_cvt_pk_bf16_f32 v162, v104, v105
v_cvt_pk_bf16_f32 v163, v106, v107
v_pk_max_i16 v160, v160, v9
v_pk_max_i16 v161, v161, v9
v_pk_max_i16 v162, v162, v9
v_pk_max_i16 v163, v163, v9
buffer_store_dwordx4 v[160:163], v1, s[8:11], s84 offen offset:0 sc1
v_cvt_pk_bf16_f32 v164, v112, v113
v_cvt_pk_bf16_f32 v165, v114, v115
v_cvt_pk_bf16_f32 v166, v120, v121
v_cvt_pk_bf16_f32 v167, v122, v123
v_pk_max_i16 v164, v164, v9
v_pk_max_i16 v165, v165, v9
v_pk_max_i16 v166, v166, v9
v_pk_max_i16 v167, v167, v9
buffer_store_dwordx4 v[164:167], v1, s[8:11], s84 offen offset:1024 sc1
v_cvt_pk_bf16_f32 v168, v100, v101
v_cvt_pk_bf16_f32 v169, v102, v103
v_cvt_pk_bf16_f32 v170, v108, v109
v_cvt_pk_bf16_f32 v171, v110, v111
v_pk_max_i16 v168, v168, v9
v_pk_max_i16 v169, v169, v9
v_pk_max_i16 v170, v170, v9
v_pk_max_i16 v171, v171, v9
buffer_store_dwordx4 v[168:171], v1, s[8:11], s83 offen offset:0 sc1
v_cvt_pk_bf16_f32 v172, v116, v117
v_cvt_pk_bf16_f32 v173, v118, v119
v_cvt_pk_bf16_f32 v174, v124, v125
v_cvt_pk_bf16_f32 v175, v126, v127
v_pk_max_i16 v172, v172, v9
v_pk_max_i16 v173, v173, v9
v_pk_max_i16 v174, v174, v9
v_pk_max_i16 v175, v175, v9
buffer_store_dwordx4 v[172:175], v1, s[8:11], s83 offen offset:1024 sc1
s_waitcnt vmcnt(0)
buffer_store_dword v8, v3, s[8:11], s75 offen sc1
s_branch Lx_437
Lx_435:
s_mul_i32 s84, s89, s77
s_add_u32 s84, s84, s76
s_add_u32 s83, s84, 6144
s_sub_u32 s93, s89, 12
s_max_i32 s93, s93, 0
s_lshr_b32 s93, s93, 2
s_add_u32 s93, s93, s89
s_mul_i32 s92, s89, 5
s_sub_u32 s92, s92, 304
s_min_u32 s92, s92, s89
s_cmp_lt_u32 s89, 64
s_cselect_b32 s93, s93, s92
s_add_u32 s93, s93, 1
v_mov_b32 v8, s93
v_cvt_pk_bf16_f32 v160, v64, v65
v_cvt_pk_bf16_f32 v161, v66, v67
v_cvt_pk_bf16_f32 v162, v72, v73
v_cvt_pk_bf16_f32 v163, v74, v75
v_pk_max_i16 v160, v160, v9
v_pk_max_i16 v161, v161, v9
v_pk_max_i16 v162, v162, v9
v_pk_max_i16 v163, v163, v9
buffer_store_dwordx4 v[160:163], v1, s[8:11], s84 offen offset:0 sc1
v_cvt_pk_bf16_f32 v164, v80, v81
v_cvt_pk_bf16_f32 v165, v82, v83
v_cvt_pk_bf16_f32 v166, v88, v89
v_cvt_pk_bf16_f32 v167, v90, v91
v_pk_max_i16 v164, v164, v9
v_pk_max_i16 v165, v165, v9
v_pk_max_i16 v166, v166, v9
v_pk_max_i16 v167, v167, v9
buffer_store_dwordx4 v[164:167], v1, s[8:11], s84 offen offset:1024 sc1
v_cvt_pk_bf16_f32 v168, v68, v69
v_cvt_pk_bf16_f32 v169, v70, v71
v_cvt_pk_bf16_f32 v170, v76, v77
v_cvt_pk_bf16_f32 v171, v78, v79
v_pk_max_i16 v168, v168, v9
v_pk_max_i16 v169, v169, v9
v_pk_max_i16 v170, v170, v9
v_pk_max_i16 v171, v171, v9
buffer_store_dwordx4 v[168:171], v1, s[8:11], s83 offen offset:0 sc1
v_cvt_pk_bf16_f32 v172, v84, v85
v_cvt_pk_bf16_f32 v173, v86, v87
v_cvt_pk_bf16_f32 v174, v92, v93
v_cvt_pk_bf16_f32 v175, v94, v95
v_pk_max_i16 v172, v172, v9
v_pk_max_i16 v173, v173, v9
v_pk_max_i16 v174, v174, v9
v_pk_max_i16 v175, v175, v9
buffer_store_dwordx4 v[172:175], v1, s[8:11], s83 offen offset:1024 sc1
s_waitcnt vmcnt(0)
buffer_store_dword v8, v3, s[8:11], s75 offen sc1
Lx_437:
s_cmp_lt_u32 s63, 24
s_cselect_b32 s68, 0, 48
s_sub_u32 s68, s63, s68
s_cmp_eq_u32 s88, 64
s_cbranch_scc1 L_f2
Lx_438:
v_min_u32 v6, 9, v0
v_lshlrev_b32 v6, 7, v6
s_lshl_b32 s92, s86, 2
s_add_u32 s92, s92, 4
s_mov_b32 s93, 193024000
Lmp_443:
buffer_load_dword v5, v6, s[8:11], s93 offen sc1
s_waitcnt vmcnt(0)
v_cmp_gt_u32 vcc, s92, v5
s_cbranch_vccz Lmd_444
s_sleep 2
s_cmp_eq_u32 s65, 0
s_cbranch_scc1 Lmd_444
s_sub_u32 s65, s65, 1
s_branch Lmp_443
Lmd_444:
s_add_u32 s89, s86, 64
s_mul_i32 s78, s89, 40960
s_add_u32 s78, s78, s95
s_mov_b32 s79, s95
s_waitcnt lgkmcnt(0)
s_barrier
s_add_u32 m0, s79, 0
s_add_u32 s73, s78, 0
buffer_load_dwordx4 v1, s[8:11], s73 offen offset:0 sc1 lds
buffer_load_dwordx4 v1, s[8:11], s73 offen offset:1024 sc1 lds
buffer_load_dwordx4 v1, s[8:11], s73 offen offset:2048 sc1 lds
buffer_load_dwordx4 v1, s[8:11], s73 offen offset:3072 sc1 lds
s_add_u32 m0, s79, 4096
s_add_u32 s73, s78, 4096
buffer_load_dwordx4 v1, s[8:11], s73 offen offset:0 sc1 lds
buffer_load_dwordx4 v1, s[8:11], s73 offen offset:1024 sc1 lds
buffer_load_dwordx4 v1, s[8:11], s73 offen offset:2048 sc1 lds
buffer_load_dwordx4 v1, s[8:11], s73 offen offset:3072 sc1 lds
s_add_u32 m0, s79, 8192
s_add_u32 s73, s78, 8192
buffer_load_dwordx4 v1, s[8:11], s73 offen offset:0 sc1 lds
buffer_load_dwordx4 v1, s[8:11], s73 offen offset:1024 sc1 lds
v_mov_b32 v7, v1
s_waitcnt vmcnt(0)
s_barrier
ds_read_b128 v[128:131], v7 offset:0
ds_read_b128 v[132:135], v7 offset:20480
ds_read_b128 v[136:139], v7 offset:1024
ds_read_b128 v[140:143], v7 offset:21504
s_waitcnt lgkmcnt(3)
v_mfma_f32_16x16x32_bf16 v[64:67], a[0:3], v[128:131], 0
ds_read_b128 v[144:147], v7 offset:2048
v_mfma_f32_16x16x32_bf16 v[72:75], a[4:7], v[128:131], 0
v_mfma_f32_16x16x32_bf16 v[80:83], a[8:11], v[128:131], 0
v_mfma_f32_16x16x32_bf16 v[88:91], a[12:15], v[128:131], 0
s_waitcnt lgkmcnt(3)
v_mfma_f32_16x16x32_bf16 v[68:71], a[0:3], v[132:135], 0
ds_read_b128 v[148:151], v7 offset:22528
v_mfma_f32_16x16x32_bf16 v[76:79], a[4:7], v[132:135], 0
v_mfma_f32_16x16x32_bf16 v[84:87], a[8:11], v[132:135], 0
v_mfma_f32_16x16x32_bf16 v[92:95], a[12:15], v[132:135], 0
s_waitcnt lgkmcnt(3)
v_mfma_f32_16x16x32_bf16 v[64:67], a[16:19], v[136:139], v[64:67]
ds_read_b128 v[152:155], v7 offset:3072
v_mfma_f32_16x16x32_bf16 v[72:75], a[20:23], v[136:139], v[72:75]
v_mfma_f32_16x16x32_bf16 v[80:83], a[24:27], v[136:139], v[80:83]
v_mfma_f32_16x16x32_bf16 v[88:91], a[28:31], v[136:139], v[88:91]
s_waitcnt lgkmcnt(3)
v_mfma_f32_16x16x32_bf16 v[68:71], a[16:19], v[140:143], v[68:71]
ds_read_b128 v[156:159], v7 offset:23552
v_mfma_f32_16x16x32_bf16 v[76:79], a[20:23], v[140:143], v[76:79]
v_mfma_f32_16x16x32_bf16 v[84:87], a[24:27], v[140:143], v[84:87]
v_mfma_f32_16x16x32_bf16 v[92:95], a[28:31], v[140:143], v[92:95]
s_waitcnt lgkmcnt(3)
v_mfma_f32_16x16x32_bf16 v[64:67], a[32:35], v[144:147], v[64:67]
ds_read_b128 v[128:131], v7 offset:4096
v_mfma_f32_16x16x32_bf16 v[72:75], a[36:39], v[144:147], v[72:75]
v_mfma_f32_16x16x32_bf16 v[80:83], a[40:43], v[144:147], v[80:83]
v_mfma_f32_16x16x32_bf16 v[88:91], a[44:47], v[144:147], v[88:91]
s_waitcnt lgkmcnt(3)
v_mfma_f32_16x16x32_bf16 v[68:71], a[32:35], v[148:151], v[68:71]
ds_read_b128 v[132:135], v7 offset:24576
v_mfma_f32_16x16x32_bf16 v[76:79], a[36:39], v[148:151], v[76:79]
v_mfma_f32_16x16x32_bf16 v[84:87], a[40:43], v[148:151], v[84:87]
v_mfma_f32_16x16x32_bf16 v[92:95], a[44:47], v[148:151], v[92:95]
s_waitcnt lgkmcnt(3)
v_mfma_f32_16x16x32_bf16 v[64:67], a[48:51], v[152:155], v[64:67]
ds_read_b128 v[136:139], v7 offset:5120
v_mfma_f32_16x16x32_bf16 v[72:75], a[52:55], v[152:155], v[72:75]
v_mfma_f32_16x16x32_bf16 v[80:83], a[56:59], v[152:155], v[80:83]
v_mfma_f32_16x16x32_bf16 v[88:91], a[60:63], v[152:155], v[88:91]
s_waitcnt lgkmcnt(3)
v_mfma_f32_16x16x32_bf16 v[68:71], a[48:51], v[156:159], v[68:71]
ds_read_b128 v[140:143], v7 offset:25600
v_mfma_f32_16x16x32_bf16 v[76:79], a[52:55], v[156:159], v[76:79]
v_mfma_f32_16x16x32_bf16 v[84:87], a[56:59], v[156:159], v[84:87]
v_mfma_f32_16x16x32_bf16 v[92:95], a[60:63], v[156:159], v[92:95]
s_waitcnt lgkmcnt(3)
v_mfma_f32_16x16x32_bf16 v[64:67], a[64:67], v[128:131], v[64:67]
ds_read_b128 v[144:147], v7 offset:6144
v_mfma_f32_16x16x32_bf16 v[72:75], a[68:71], v[128:131], v[72:75]
v_mfma_f32_16x16x32_bf16 v[80:83], a[72:75], v[128:131], v[80:83]
v_mfma_f32_16x16x32_bf16 v[88:91], a[76:79], v[128:131], v[88:91]
s_waitcnt lgkmcnt(3)
v_mfma_f32_16x16x32_bf16 v[68:71], a[64:67], v[132:135], v[68:71]
ds_read_b128 v[148:151], v7 offset:26624
v_mfma_f32_16x16x32_bf16 v[76:79], a[68:71], v[132:135], v[76:79]
v_mfma_f32_16x16x32_bf16 v[84:87], a[72:75], v[132:135], v[84:87]
v_mfma_f32_16x16x32_bf16 v[92:95], a[76:79], v[132:135], v[92:95]
s_waitcnt lgkmcnt(3)
v_mfma_f32_16x16x32_bf16 v[64:67], a[80:83], v[136:139], v[64:67]
ds_read_b128 v[152:155], v7 offset:7168
v_mfma_f32_16x16x32_bf16 v[72:75], a[84:87], v[136:139], v[72:75]
v_mfma_f32_16x16x32_bf16 v[80:83], a[88:91], v[136:139], v[80:83]
v_mfma_f32_16x16x32_bf16 v[88:91], a[92:95], v[136:139], v[88:91]
s_waitcnt lgkmcnt(3)
v_mfma_f32_16x16x32_bf16 v[68:71], a[80:83], v[140:143], v[68:71]
ds_read_b128 v[156:159], v7 offset:27648
v_mfma_f32_16x16x32_bf16 v[76:79], a[84:87], v[140:143], v[76:79]
v_mfma_f32_16x16x32_bf16 v[84:87], a[88:91], v[140:143], v[84:87]
v_mfma_f32_16x16x32_bf16 v[92:95], a[92:95], v[140:143], v[92:95]
s_waitcnt lgkmcnt(3)
v_mfma_f32_16x16x32_bf16 v[64:67], a[96:99], v[144:147], v[64:67]
ds_read_b128 v[128:131], v7 offset:8192
v_mfma_f32_16x16x32_bf16 v[72:75], a[100:103], v[144:147], v[72:75]
v_mfma_f32_16x16x32_bf16 v[80:83], a[104:107], v[144:147], v[80:83]
v_mfma_f32_16x16x32_bf16 v[88:91], a[108:111], v[144:147], v[88:91]
s_waitcnt lgkmcnt(3)
v_mfma_f32_16x16x32_bf16 v[68:71], a[96:99], v[148:151], v[68:71]
ds_read_b128 v[132:135], v7 offset:28672
v_mfma_f32_16x16x32_bf16 v[76:79], a[100:103], v[148:151], v[76:79]
v_mfma_f32_16x16x32_bf16 v[84:87], a[104:107], v[148:151], v[84:87]
v_mfma_f32_16x16x32_bf16 v[92:95], a[108:111], v[148:151], v[92:95]
s_waitcnt lgkmcnt(3)
v_mfma_f32_16x16x32_bf16 v[64:67], a[112:115], v[152:155], v[64:67]
ds_read_b128 v[136:139], v7 offset:9216
v_mfma_f32_16x16x32_bf16 v[72:75], a[116:119], v[152:155], v[72:75]
v_mfma_f32_16x16x32_bf16 v[80:83], a[120:123], v[152:155], v[80:83]
v_mfma_f32_16x16x32_bf16 v[88:91], a[124:127], v[152:155], v[88:91]
s_waitcnt lgkmcnt(3)
v_mfma_f32_16x16x32_bf16 v[68:71], a[112:115], v[156:159], v[68:71]
ds_read_b128 v[140:143], v7 offset:29696
v_mfma_f32_16x16x32_bf16 v[76:79], a[116:119], v[156:159], v[76:79]
v_mfma_f32_16x16x32_bf16 v[84:87], a[120:123], v[156:159], v[84:87]
v_mfma_f32_16x16x32_bf16 v[92:95], a[124:127], v[156:159], v[92:95]
s_waitcnt lgkmcnt(3)
v_mfma_f32_16x16x32_bf16 v[64:67], a[128:131], v[128:131], v[64:67]
ds_read_b128 v[144:147], v7 offset:10240
v_mfma_f32_16x16x32_bf16 v[72:75], a[132:135], v[128:131], v[72:75]
v_mfma_f32_16x16x32_bf16 v[80:83], a[136:139], v[128:131], v[80:83]
v_mfma_f32_16x16x32_bf16 v[88:91], a[140:143], v[128:131], v[88:91]
s_waitcnt lgkmcnt(3)
v_mfma_f32_16x16x32_bf16 v[68:71], a[128:131], v[132:135], v[68:71]
ds_read_b128 v[148:151], v7 offset:30720
v_mfma_f32_16x16x32_bf16 v[76:79], a[132:135], v[132:135], v[76:79]
v_mfma_f32_16x16x32_bf16 v[84:87], a[136:139], v[132:135], v[84:87]
v_mfma_f32_16x16x32_bf16 v[92:95], a[140:143], v[132:135], v[92:95]
s_waitcnt lgkmcnt(3)
v_mfma_f32_16x16x32_bf16 v[64:67], a[144:147], v[136:139], v[64:67]
ds_read_b128 v[152:155], v7 offset:11264
v_mfma_f32_16x16x32_bf16 v[72:75], a[148:151], v[136:139], v[72:75]
v_mfma_f32_16x16x32_bf16 v[80:83], a[152:155], v[136:139], v[80:83]
v_mfma_f32_16x16x32_bf16 v[88:91], a[156:159], v[136:139], v[88:91]
s_waitcnt lgkmcnt(3)
v_mfma_f32_16x16x32_bf16 v[68:71], a[144:147], v[140:143], v[68:71]
ds_read_b128 v[156:159], v7 offset:31744
v_mfma_f32_16x16x32_bf16 v[76:79], a[148:151], v[140:143], v[76:79]
v_mfma_f32_16x16x32_bf16 v[84:87], a[152:155], v[140:143], v[84:87]
v_mfma_f32_16x16x32_bf16 v[92:95], a[156:159], v[140:143], v[92:95]
s_waitcnt lgkmcnt(3)
v_mfma_f32_16x16x32_bf16 v[64:67], a[160:163], v[144:147], v[64:67]
ds_read_b128 v[128:131], v7 offset:12288
v_mfma_f32_16x16x32_bf16 v[72:75], a[164:167], v[144:147], v[72:75]
v_mfma_f32_16x16x32_bf16 v[80:83], a[168:171], v[144:147], v[80:83]
v_mfma_f32_16x16x32_bf16 v[88:91], a[172:175], v[144:147], v[88:91]
s_waitcnt lgkmcnt(3)
v_mfma_f32_16x16x32_bf16 v[68:71], a[160:163], v[148:151], v[68:71]
ds_read_b128 v[132:135], v7 offset:32768
v_mfma_f32_16x16x32_bf16 v[76:79], a[164:167], v[148:151], v[76:79]
v_mfma_f32_16x16x32_bf16 v[84:87], a[168:171], v[148:151], v[84:87]
v_mfma_f32_16x16x32_bf16 v[92:95], a[172:175], v[148:151], v[92:95]
s_waitcnt lgkmcnt(3)
v_mfma_f32_16x16x32_bf16 v[64:67], a[176:179], v[152:155], v[64:67]
ds_read_b128 v[136:139], v7 offset:13312
v_mfma_f32_16x16x32_bf16 v[72:75], a[180:183], v[152:155], v[72:75]
v_mfma_f32_16x16x32_bf16 v[80:83], a[184:187], v[152:155], v[80:83]
v_mfma_f32_16x16x32_bf16 v[88:91], a[188:191], v[152:155], v[88:91]
s_waitcnt lgkmcnt(3)
v_mfma_f32_16x16x32_bf16 v[68:71], a[176:179], v[156:159], v[68:71]
ds_read_b128 v[140:143], v7 offset:33792
v_mfma_f32_16x16x32_bf16 v[76:79], a[180:183], v[156:159], v[76:79]
v_mfma_f32_16x16x32_bf16 v[84:87], a[184:187], v[156:159], v[84:87]
v_mfma_f32_16x16x32_bf16 v[92:95], a[188:191], v[156:159], v[92:95]
s_waitcnt lgkmcnt(3)
v_mfma_f32_16x16x32_bf16 v[64:67], a[192:195], v[128:131], v[64:67]
ds_read_b128 v[144:147], v7 offset:14336
v_mfma_f32_16x16x32_bf16 v[72:75], a[196:199], v[128:131], v[72:75]
v_mfma_f32_16x16x32_bf16 v[80:83], a[200:203], v[128:131], v[80:83]
v_mfma_f32_16x16x32_bf16 v[88:91], a[204:207], v[128:131], v[88:91]
s_waitcnt lgkmcnt(3)
v_mfma_f32_16x16x32_bf16 v[68:71], a[192:195], v[132:135], v[68:71]
ds_read_b128 v[148:151], v7 offset:34816
v_mfma_f32_16x16x32_bf16 v[76:79], a[196:199], v[132:135], v[76:79]
v_mfma_f32_16x16x32_bf16 v[84:87], a[200:203], v[132:135], v[84:87]
v_mfma_f32_16x16x32_bf16 v[92:95], a[204:207], v[132:135], v[92:95]
s_waitcnt lgkmcnt(3)
v_mfma_f32_16x16x32_bf16 v[64:67], a[208:211], v[136:139], v[64:67]
ds_read_b128 v[152:155], v7 offset:15360
v_mfma_f32_16x16x32_bf16 v[72:75], a[212:215], v[136:139], v[72:75]
v_mfma_f32_16x16x32_bf16 v[80:83], a[216:219], v[136:139], v[80:83]
v_mfma_f32_16x16x32_bf16 v[88:91], a[220:223], v[136:139], v[88:91]
s_waitcnt lgkmcnt(3)
v_mfma_f32_16x16x32_bf16 v[68:71], a[208:211], v[140:143], v[68:71]
ds_read_b128 v[156:159], v7 offset:35840
v_mfma_f32_16x16x32_bf16 v[76:79], a[212:215], v[140:143], v[76:79]
v_mfma_f32_16x16x32_bf16 v[84:87], a[216:219], v[140:143], v[84:87]
v_mfma_f32_16x16x32_bf16 v[92:95], a[220:223], v[140:143], v[92:95]
s_waitcnt lgkmcnt(3)
v_mfma_f32_16x16x32_bf16 v[64:67], a[224:227], v[144:147], v[64:67]
ds_read_b128 v[128:131], v7 offset:16384
v_mfma_f32_16x16x32_bf16 v[72:75], a[228:231], v[144:147], v[72:75]
v_mfma_f32_16x16x32_bf16 v[80:83], a[232:235], v[144:147], v[80:83]
v_mfma_f32_16x16x32_bf16 v[88:91], a[236:239], v[144:147], v[88:91]
s_waitcnt lgkmcnt(3)
v_mfma_f32_16x16x32_bf16 v[68:71], a[224:227], v[148:151], v[68:71]
ds_read_b128 v[132:135], v7 offset:36864
v_mfma_f32_16x16x32_bf16 v[76:79], a[228:231], v[148:151], v[76:79]
v_mfma_f32_16x16x32_bf16 v[84:87], a[232:235], v[148:151], v[84:87]
v_mfma_f32_16x16x32_bf16 v[92:95], a[236:239], v[148:151], v[92:95]
s_waitcnt lgkmcnt(3)
v_mfma_f32_16x16x32_bf16 v[64:67], a[240:243], v[152:155], v[64:67]
ds_read_b128 v[136:139], v7 offset:17408
v_mfma_f32_16x16x32_bf16 v[72:75], a[244:247], v[152:155], v[72:75]
v_mfma_f32_16x16x32_bf16 v[80:83], a[248:251], v[152:155], v[80:83]
v_mfma_f32_16x16x32_bf16 v[88:91], a[252:255], v[152:155], v[88:91]
s_waitcnt lgkmcnt(3)
v_mfma_f32_16x16x32_bf16 v[68:71], a[240:243], v[156:159], v[68:71]
ds_read_b128 v[140:143], v7 offset:37888
v_mfma_f32_16x16x32_bf16 v[76:79], a[244:247], v[156:159], v[76:79]
v_mfma_f32_16x16x32_bf16 v[84:87], a[248:251], v[156:159], v[84:87]
v_mfma_f32_16x16x32_bf16 v[92:95], a[252:255], v[156:159], v[92:95]
s_waitcnt lgkmcnt(3)
v_mfma_f32_16x16x32_bf16 v[64:67], v[192:195], v[128:131], v[64:67]
ds_read_b128 v[144:147], v7 offset:18432
v_mfma_f32_16x16x32_bf16 v[72:75], v[196:199], v[128:131], v[72:75]
v_mfma_f32_16x16x32_bf16 v[80:83], v[200:203], v[128:131], v[80:83]
v_mfma_f32_16x16x32_bf16 v[88:91], v[204:207], v[128:131], v[88:91]
s_waitcnt lgkmcnt(3)
v_mfma_f32_16x16x32_bf16 v[68:71], v[192:195], v[132:135], v[68:71]
ds_read_b128 v[148:151], v7 offset:38912
v_mfma_f32_16x16x32_bf16 v[76:79], v[196:199], v[132:135], v[76:79]
v_mfma_f32_16x16x32_bf16 v[84:87], v[200:203], v[132:135], v[84:87]
v_mfma_f32_16x16x32_bf16 v[92:95], v[204:207], v[132:135], v[92:95]
s_waitcnt lgkmcnt(3)
v_mfma_f32_16x16x32_bf16 v[64:67], v[208:211], v[136:139], v[64:67]
ds_read_b128 v[152:155], v7 offset:19456
v_mfma_f32_16x16x32_bf16 v[72:75], v[212:215], v[136:139], v[72:75]
v_mfma_f32_16x16x32_bf16 v[80:83], v[216:219], v[136:139], v[80:83]
v_mfma_f32_16x16x32_bf16 v[88:91], v[220:223], v[136:139], v[88:91]
s_waitcnt lgkmcnt(3)
v_mfma_f32_16x16x32_bf16 v[68:71], v[208:211], v[140:143], v[68:71]
ds_read_b128 v[156:159], v7 offset:39936
v_mfma_f32_16x16x32_bf16 v[76:79], v[212:215], v[140:143], v[76:79]
v_mfma_f32_16x16x32_bf16 v[84:87], v[216:219], v[140:143], v[84:87]
v_mfma_f32_16x16x32_bf16 v[92:95], v[220:223], v[140:143], v[92:95]
s_waitcnt lgkmcnt(3)
v_mfma_f32_16x16x32_bf16 v[64:67], v[224:227], v[144:147], v[64:67]
v_mfma_f32_16x16x32_bf16 v[72:75], v[228:231], v[144:147], v[72:75]
v_mfma_f32_16x16x32_bf16 v[80:83], v[232:235], v[144:147], v[80:83]
v_mfma_f32_16x16x32_bf16 v[88:91], v[236:239], v[144:147], v[88:91]
s_waitcnt lgkmcnt(2)
v_mfma_f32_16x16x32_bf16 v[68:71], v[224:227], v[148:151], v[68:71]
v_mfma_f32_16x16x32_bf16 v[76:79], v[228:231], v[148:151], v[76:79]
v_mfma_f32_16x16x32_bf16 v[84:87], v[232:235], v[148:151], v[84:87]
v_mfma_f32_16x16x32_bf16 v[92:95], v[236:239], v[148:151], v[92:95]
s_waitcnt lgkmcnt(1)
v_mfma_f32_16x16x32_bf16 v[64:67], v[240:243], v[152:155], v[64:67]
v_mfma_f32_16x16x32_bf16 v[72:75], v[244:247], v[152:155], v[72:75]
v_mfma_f32_16x16x32_bf16 v[80:83], v[248:251], v[152:155], v[80:83]
v_mfma_f32_16x16x32_bf16 v[88:91], v[252:255], v[152:155], v[88:91]
s_waitcnt lgkmcnt(0)
v_mfma_f32_16x16x32_bf16 v[68:71], v[240:243], v[156:159], v[68:71]
v_mfma_f32_16x16x32_bf16 v[76:79], v[244:247], v[156:159], v[76:79]
v_mfma_f32_16x16x32_bf16 v[84:87], v[248:251], v[156:159], v[84:87]
v_mfma_f32_16x16x32_bf16 v[92:95], v[252:255], v[156:159], v[92:95]
s_mul_i32 s84, s89, s77
s_add_u32 s84, s84, s76
s_add_u32 s83, s84, 6144
s_sub_u32 s93, s89, 12
s_max_i32 s93, s93, 0
s_lshr_b32 s93, s93, 2
s_add_u32 s93, s93, s89
s_mul_i32 s92, s89, 5
s_sub_u32 s92, s92, 304
s_min_u32 s92, s92, s89
s_cmp_lt_u32 s89, 64
s_cselect_b32 s93, s93, s92
s_add_u32 s93, s93, 1
v_mov_b32 v8, s93
v_cvt_pk_bf16_f32 v160, v64, v65
v_cvt_pk_bf16_f32 v161, v66, v67
v_cvt_pk_bf16_f32 v162, v72, v73
v_cvt_pk_bf16_f32 v163, v74, v75
v_pk_max_i16 v160, v160, v9
v_pk_max_i16 v161, v161, v9
v_pk_max_i16 v162, v162, v9
v_pk_max_i16 v163, v163, v9
buffer_store_dwordx4 v[160:163], v1, s[8:11], s84 offen offset:0 sc1
v_cvt_pk_bf16_f32 v164, v80, v81
v_cvt_pk_bf16_f32 v165, v82, v83
v_cvt_pk_bf16_f32 v166, v88, v89
v_cvt_pk_bf16_f32 v167, v90, v91
v_pk_max_i16 v164, v164, v9
v_pk_max_i16 v165, v165, v9
v_pk_max_i16 v166, v166, v9
v_pk_max_i16 v167, v167, v9
buffer_store_dwordx4 v[164:167], v1, s[8:11], s84 offen offset:1024 sc1
v_cvt_pk_bf16_f32 v168, v68, v69
v_cvt_pk_bf16_f32 v169, v70, v71
v_cvt_pk_bf16_f32 v170, v76, v77
v_cvt_pk_bf16_f32 v171, v78, v79
v_pk_max_i16 v168, v168, v9
v_pk_max_i16 v169, v169, v9
v_pk_max_i16 v170, v170, v9
v_pk_max_i16 v171, v171, v9
buffer_store_dwordx4 v[168:171], v1, s[8:11], s83 offen offset:0 sc1
v_cvt_pk_bf16_f32 v172, v84, v85
v_cvt_pk_bf16_f32 v173, v86, v87
v_cvt_pk_bf16_f32 v174, v92, v93
v_cvt_pk_bf16_f32 v175, v94, v95
v_pk_max_i16 v172, v172, v9
v_pk_max_i16 v173, v173, v9
v_pk_max_i16 v174, v174, v9
v_pk_max_i16 v175, v175, v9
buffer_store_dwordx4 v[172:175], v1, s[8:11], s83 offen offset:1024 sc1
s_waitcnt vmcnt(0)
buffer_store_dword v8, v3, s[8:11], s75 offen sc1
s_add_u32 s66, s66, 1
s_add_u32 s86, s86, 1
s_cmp_lt_u32 s86, 15
s_cbranch_scc1 Lx_438
s_waitcnt vmcnt(0)
s_endpgm
Lnm_428:
v_min_u32 v6, 9, v0
v_lshlrev_b32 v6, 7, v6
s_lshl_b32 s92, s86, 2
s_add_u32 s92, s92, 4
s_mov_b32 s93, 193024000
Lmp_445:
buffer_load_dword v5, v6, s[8:11], s93 offen sc1
s_waitcnt vmcnt(0)
v_cmp_gt_u32 vcc, s92, v5
s_cbranch_vccz Lmd_446
s_sleep 2
s_cmp_eq_u32 s65, 0
s_cbranch_scc1 Lmd_446
s_sub_u32 s65, s65, 1
s_branch Lmp_445
Lmd_446:
s_add_u32 s90, s86, 64
s_add_u32 s86, s86, 1
s_cmp_lt_u32 s86, 12
s_cselect_b32 s87, 4, 0xffff
s_branch Lnb_429
Lnm_430:
v_min_u32 v6, 9, v0
v_lshlrev_b32 v6, 7, v6
s_lshl_b32 s92, s86, 2
s_add_u32 s92, s92, 4
s_mov_b32 s93, 193024000
Lmp_447:
buffer_load_dword v5, v6, s[8:11], s93 offen sc1
s_waitcnt vmcnt(0)
v_cmp_gt_u32 vcc, s92, v5
s_cbranch_vccz Lmd_448
s_sleep 2
s_cmp_eq_u32 s65, 0
s_cbranch_scc1 Lmd_448
s_sub_u32 s65, s65, 1
s_branch Lmp_447
Lmd_448:
s_add_u32 s91, s86, 64
s_add_u32 s86, s86, 1
s_cmp_lt_u32 s86, 12
s_cselect_b32 s87, 4, 0xffff
s_branch Lnb_431
Lnm_432:
v_min_u32 v6, 9, v0
v_lshlrev_b32 v6, 7, v6
s_lshl_b32 s92, s86, 2
s_add_u32 s92, s92, 4
s_mov_b32 s93, 193024000
Lmp_449:
buffer_load_dword v5, v6, s[8:11], s93 offen sc1
s_waitcnt vmcnt(0)
v_cmp_gt_u32 vcc, s92, v5
s_cbranch_vccz Lmd_450
s_sleep 2
s_cmp_eq_u32 s65, 0
s_cbranch_scc1 Lmd_450
s_sub_u32 s65, s65, 1
s_branch Lmp_449
Lmd_450:
s_add_u32 s94, s86, 64
s_add_u32 s86, s86, 1
s_cmp_lt_u32 s86, 12
s_cselect_b32 s87, 4, 0xffff
s_branch Lnb_433
Lnm_439:
v_min_u32 v6, 9, v0
v_lshlrev_b32 v6, 7, v6
s_lshl_b32 s92, s86, 2
s_add_u32 s92, s92, 4
s_mov_b32 s93, 193024000
v_cmp_gt_u32 vcc, s92, v17
s_cbranch_vccz Lmd_452
Lmp_451:
buffer_load_dword v5, v6, s[8:11], s93 offen sc1
s_waitcnt vmcnt(0)
v_cmp_gt_u32 vcc, s92, v5
s_cbranch_vccz Lmd_452
s_sleep 2
s_cmp_eq_u32 s65, 0
s_cbranch_scc1 Lmd_452
s_sub_u32 s65, s65, 1
s_branch Lmp_451
Lmd_452:
s_add_u32 s94, s86, 64
s_add_u32 s86, s86, 1
s_cmp_lt_u32 s86, 12
s_cselect_b32 s87, 4, 0xffff
s_branch Lnb_440
Lnm_441:
v_min_u32 v6, 9, v0
v_lshlrev_b32 v6, 7, v6
s_lshl_b32 s92, s86, 2
s_add_u32 s92, s92, 4
s_mov_b32 s93, 193024000
v_cmp_gt_u32 vcc, s92, v17
s_cbranch_vccz Lmd_454
Lmp_453:
buffer_load_dword v5, v6, s[8:11], s93 offen sc1
s_waitcnt vmcnt(0)
v_cmp_gt_u32 vcc, s92, v5
s_cbranch_vccz Lmd_454
s_sleep 2
s_cmp_eq_u32 s65, 0
s_cbranch_scc1 Lmd_454
s_sub_u32 s65, s65, 1
s_branch Lmp_453
Lmd_454:
s_add_u32 s94, s86, 64
s_add_u32 s86, s86, 1
s_cmp_lt_u32 s86, 12
s_cselect_b32 s87, 4, 0xffff
s_branch Lnb_442
Lyu_410:
s_sub_u32 s68, s68, 13
s_min_u32 s69, s67, 4
s_cmp_lt_u32 s67, 4
s_cselect_b32 s70, 7, 6
s_mul_i32 s63, s67, 6
s_add_u32 s63, s63, s69
s_add_u32 s63, s63, s68
s_cmp_ge_u32 s68, s70
s_cbranch_scc1 Lfu_411
s_cmp_ge_u32 s63, 32
s_cselect_b32 s16, s54, s46
s_cselect_b32 s17, s55, s47
s_cselect_b32 s18, 1, 4
s_mul_i32 s18, s18, 1966080
s_and_b32 s67, s63, 31
s_mul_i32 s70, s67, 245760
s_lshl_b32 s67, s3, 7
s_add_u32 s70, s70, s67
s_mul_i32 s75, s3, 40
s_add_u32 s75, s75, s63
s_lshl_b32 s75, s75, 7
s_add_u32 s75, s75, 192978944
s_lshl_b32 s76, s63, 10
s_mul_i32 s67, s3, 163840
s_add_u32 s76, s76, s67
s_add_u32 s76, s76, 60817408
s_mul_i32 s89, s63, 10240
s_lshl_b32 s67, s3, 10
s_add_u32 s89, s89, s67
s_add_u32 s89, s89, 165675008
s_mul_i32 s77, s63, 12288
s_and_b32 s67, s3, 1
s_mul_i32 s80, s67, 6144
s_add_u32 s77, s77, s80
s_add_u32 s77, s77, 197132288
s_mul_i32 s79, s63, 384
s_add_u32 s79, s79, 192962560
s_mov_b32 s78, 0
v_mov_b32 v16, 0
v_bfe_u32 v17, v0, 0, 4
s_mov_b32 s67, 16
v_mad_i32_i24 v16, v17, s67, v16
v_bfe_u32 v17, v0, 4, 1
s_mov_b32 s67, 8
v_mad_i32_i24 v16, v17, s67, v16
v_bfe_u32 v17, v0, 5, 1
s_mov_b32 s67, 327680
v_mad_i32_i24 v16, v17, s67, v16
s_mov_b32 s74, 1280
s_cmp_lt_u32 s63, 32
s_cbranch_scc1 Lu_455
Lrp_458:
v_mov_b32 v6, 176
buffer_load_dword v5, v6, s[12:15], 0 offen sc1
s_waitcnt vmcnt(0)
Lrc_459:
v_readfirstlane_b32 s67, v5
s_nop 0
s_sub_u32 s67, s67, 1
s_cmp_eq_u32 s67, s34
s_cbranch_scc1 Lro_460
s_sub_u32 s65, s65, 1
s_cmp_eq_u32 s65, 0
s_cbranch_scc1 Lro_460
s_cmp_gt_u32 s67, 7
s_cbranch_scc1 Lrp_458
s_mov_b32 s34, s67
s_waitcnt vmcnt(0) lgkmcnt(0)
s_barrier
s_branch L_restart
Lro_460:
s_mov_b32 s92, 160
Lgp_461:
buffer_load_dword v5, v3, s[12:15], s92 offen sc1
s_waitcnt vmcnt(0)
v_readfirstlane_b32 s93, v5
s_nop 0
s_cmp_ge_u32 s93, 10
s_cbranch_scc1 Lgd_462
s_sleep 8
s_cmp_eq_u32 s65, 0
s_cbranch_scc1 Lgd_462
s_sub_u32 s65, s65, 1
s_branch Lgp_461
Lgd_462:
s_mov_b32 s92, 192963584
Lls_456:
buffer_load_dword v5, v3, s[8:11], s92 offen sc1
s_waitcnt vmcnt(0)
v_readfirstlane_b32 s93, v5
s_nop 0
s_cmp_ge_u32 s93, 1
s_cbranch_scc1 Lld_457
s_sleep 32
s_cmp_eq_u32 s65, 0
s_cbranch_scc1 Lld_457
s_sub_u32 s65, s65, 1
s_branch Lls_456
Lld_457:
Lu_455:
s_cmp_ge_u32 s3, 2
s_cbranch_scc1 Ly2_463
v_lshrrev_b32 v20, 3, v0
v_and_b32 v21, 6, v20
v_and_b32 v2, 7, v0
v_xor_b32 v2, v2, v21
v_lshlrev_b32 v2, 4, v2
v_mad_u32_u24 v2, v20, s74, v2
s_lshl_b32 s71, s74, 3
s_mul_i32 s72, s3, 20480
s_add_u32 s72, s72, 81920
s_add_u32 s73, s70, 0
s_add_u32 m0, s72, 0
s_nop 0
buffer_load_dwordx4 v2, s[16:19], s73 offen lds
s_add_u32 m0, s72, 1024
s_add_u32 s73, s73, s71
buffer_load_dwordx4 v2, s[16:19], s73 offen lds
s_add_u32 m0, s72, 2048
s_add_u32 s73, s73, s71
buffer_load_dwordx4 v2, s[16:19], s73 offen lds
s_add_u32 m0, s72, 3072
s_add_u32 s73, s73, s71
buffer_load_dwordx4 v2, s[16:19], s73 offen lds
s_add_u32 s73, s70, 40960
s_add_u32 m0, s72, 4096
s_nop 0
buffer_load_dwordx4 v2, s[16:19], s73 offen lds
s_add_u32 m0, s72, 5120
s_add_u32 s73, s73, s71
buffer_load_dwordx4 v2, s[16:19], s73 offen lds
s_add_u32 m0, s72, 6144
s_add_u32 s73, s73, s71
buffer_load_dwordx4 v2, s[16:19], s73 offen lds
s_add_u32 m0, s72, 7168
s_add_u32 s73, s73, s71
buffer_load_dwordx4 v2, s[16:19], s73 offen lds
s_add_u32 s73, s70, 81920
s_add_u32 m0, s72, 8192
s_nop 0
buffer_load_dwordx4 v2, s[16:19], s73 offen lds
s_add_u32 m0, s72, 9216
s_add_u32 s73, s73, s71
buffer_load_dwordx4 v2, s[16:19], s73 offen lds
s_add_u32 m0, s72, 10240
s_add_u32 s73, s73, s71
buffer_load_dwordx4 v2, s[16:19], s73 offen lds
s_add_u32 m0, s72, 11264
s_add_u32 s73, s73, s71
buffer_load_dwordx4 v2, s[16:19], s73 offen lds
s_add_u32 s73, s70, 122880
s_add_u32 m0, s72, 12288
s_nop 0
buffer_load_dwordx4 v2, s[16:19], s73 offen lds
s_add_u32 m0, s72, 13312
s_add_u32 s73, s73, s71
buffer_load_dwordx4 v2, s[16:19], s73 offen lds
s_add_u32 m0, s72, 14336
s_add_u32 s73, s73, s71
buffer_load_dwordx4 v2, s[16:19], s73 offen lds
s_add_u32 m0, s72, 15360
s_add_u32 s73, s73, s71
buffer_load_dwordx4 v2, s[16:19], s73 offen lds
s_add_u32 s73, s70, 163840
s_add_u32 m0, s72, 16384
s_nop 0
buffer_load_dwordx4 v2, s[16:19], s73 offen lds
s_add_u32 m0, s72, 17408
s_add_u32 s73, s73, s71
buffer_load_dwordx4 v2, s[16:19], s73 offen lds
s_add_u32 m0, s72, 18432
s_add_u32 s73, s73, s71
buffer_load_dwordx4 v2, s[16:19], s73 offen lds
s_add_u32 m0, s72, 19456
s_add_u32 s73, s73, s71
buffer_load_dwordx4 v2, s[16:19], s73 offen lds
v_mov_b32 v20, 0
v_bfe_u32 v21, v0, 1, 1
s_mov_b32 s67, 1
v_mad_i32_i24 v20, v21, s67, v20
v_bfe_u32 v21, v0, 3, 2
s_mov_b32 s67, 2
v_mad_i32_i24 v20, v21, s67, v20
v_mov_b32 v10, 0
v_bfe_u32 v21, v0, 0, 1
s_mov_b32 s67, 8
v_mad_i32_i24 v10, v21, s67, v10
v_bfe_u32 v21, v0, 2, 4
s_mov_b32 s67, 128
v_mad_i32_i24 v10, v21, s67, v10
v_lshl_add_u32 v10, v20, 4, v10
v_add_u32 v10, s72, v10
v_xor_b32 v11, 32, v10
v_xor_b32 v12, 64, v10
v_xor_b32 v13, 96, v10
s_waitcnt vmcnt(16)
ds_read_b64_tr_b16 a[0:1], v10 offset:0
ds_read_b64_tr_b16 a[2:3], v10 offset:2048
ds_read_b64_tr_b16 a[24:25], v11 offset:0
ds_read_b64_tr_b16 a[26:27], v11 offset:2048
ds_read_b64_tr_b16 a[48:49], v12 offset:0
ds_read_b64_tr_b16 a[50:51], v12 offset:2048
ds_read_b64_tr_b16 a[72:73], v13 offset:0
ds_read_b64_tr_b16 a[74:75], v13 offset:2048
s_waitcnt lgkmcnt(0)
s_add_u32 s73, s70, 204800
s_add_u32 m0, s72, 0
s_nop 0
buffer_load_dwordx4 v2, s[16:19], s73 offen lds
s_add_u32 m0, s72, 1024
s_add_u32 s73, s73, s71
buffer_load_dwordx4 v2, s[16:19], s73 offen lds
s_add_u32 m0, s72, 2048
s_add_u32 s73, s73, s71
buffer_load_dwordx4 v2, s[16:19], s73 offen lds
s_add_u32 m0, s72, 3072
s_add_u32 s73, s73, s71
buffer_load_dwordx4 v2, s[16:19], s73 offen lds
s_waitcnt vmcnt(16)
ds_read_b64_tr_b16 a[4:5], v10 offset:4096
ds_read_b64_tr_b16 a[6:7], v10 offset:6144
ds_read_b64_tr_b16 a[28:29], v11 offset:4096
ds_read_b64_tr_b16 a[30:31], v11 offset:6144
ds_read_b64_tr_b16 a[52:53], v12 offset:4096
ds_read_b64_tr_b16 a[54:55], v12 offset:6144
ds_read_b64_tr_b16 a[76:77], v13 offset:4096
ds_read_b64_tr_b16 a[78:79], v13 offset:6144
s_waitcnt lgkmcnt(0)
s_add_u32 s73, s70, 512
s_add_u32 m0, s72, 4096
s_nop 0
buffer_load_dwordx4 v2, s[16:19], s73 offen lds
s_add_u32 m0, s72, 5120
s_add_u32 s73, s73, s71
buffer_load_dwordx4 v2, s[16:19], s73 offen lds
s_add_u32 m0, s72, 6144
s_add_u32 s73, s73, s71
buffer_load_dwordx4 v2, s[16:19], s73 offen lds
s_add_u32 m0, s72, 7168
s_add_u32 s73, s73, s71
buffer_load_dwordx4 v2, s[16:19], s73 offen lds
s_waitcnt vmcnt(16)
ds_read_b64_tr_b16 a[8:9], v10 offset:8192
ds_read_b64_tr_b16 a[10:11], v10 offset:10240
ds_read_b64_tr_b16 a[32:33], v11 offset:8192
ds_read_b64_tr_b16 a[34:35], v11 offset:10240
ds_read_b64_tr_b16 a[56:57], v12 offset:8192
ds_read_b64_tr_b16 a[58:59], v12 offset:10240
ds_read_b64_tr_b16 a[80:81], v13 offset:8192
ds_read_b64_tr_b16 a[82:83], v13 offset:10240
s_waitcnt lgkmcnt(0)
s_add_u32 s73, s70, 41472
s_add_u32 m0, s72, 8192
s_nop 0
buffer_load_dwordx4 v2, s[16:19], s73 offen lds
s_add_u32 m0, s72, 9216
s_add_u32 s73, s73, s71
buffer_load_dwordx4 v2, s[16:19], s73 offen lds
s_add_u32 m0, s72, 10240
s_add_u32 s73, s73, s71
buffer_load_dwordx4 v2, s[16:19], s73 offen lds
s_add_u32 m0, s72, 11264
s_add_u32 s73, s73, s71
buffer_load_dwordx4 v2, s[16:19], s73 offen lds
s_waitcnt vmcnt(16)
ds_read_b64_tr_b16 a[12:13], v10 offset:12288
ds_read_b64_tr_b16 a[14:15], v10 offset:14336
ds_read_b64_tr_b16 a[36:37], v11 offset:12288
ds_read_b64_tr_b16 a[38:39], v11 offset:14336
ds_read_b64_tr_b16 a[60:61], v12 offset:12288
ds_read_b64_tr_b16 a[62:63], v12 offset:14336
ds_read_b64_tr_b16 a[84:85], v13 offset:12288
ds_read_b64_tr_b16 a[86:87], v13 offset:14336
s_waitcnt lgkmcnt(0)
s_add_u32 s73, s70, 82432
s_add_u32 m0, s72, 12288
s_nop 0
buffer_load_dwordx4 v2, s[16:19], s73 offen lds
s_add_u32 m0, s72, 13312
s_add_u32 s73, s73, s71
buffer_load_dwordx4 v2, s[16:19], s73 offen lds
s_add_u32 m0, s72, 14336
s_add_u32 s73, s73, s71
buffer_load_dwordx4 v2, s[16:19], s73 offen lds
s_add_u32 m0, s72, 15360
s_add_u32 s73, s73, s71
buffer_load_dwordx4 v2, s[16:19], s73 offen lds
s_waitcnt vmcnt(16)
ds_read_b64_tr_b16 a[16:17], v10 offset:16384
ds_read_b64_tr_b16 a[18:19], v10 offset:18432
ds_read_b64_tr_b16 a[40:41], v11 offset:16384
ds_read_b64_tr_b16 a[42:43], v11 offset:18432
ds_read_b64_tr_b16 a[64:65], v12 offset:16384
ds_read_b64_tr_b16 a[66:67], v12 offset:18432
ds_read_b64_tr_b16 a[88:89], v13 offset:16384
ds_read_b64_tr_b16 a[90:91], v13 offset:18432
s_waitcnt lgkmcnt(0)
s_add_u32 s73, s70, 123392
s_add_u32 m0, s72, 16384
s_nop 0
buffer_load_dwordx4 v2, s[16:19], s73 offen lds
s_add_u32 m0, s72, 17408
s_add_u32 s73, s73, s71
buffer_load_dwordx4 v2, s[16:19], s73 offen lds
s_add_u32 m0, s72, 18432
s_add_u32 s73, s73, s71
buffer_load_dwordx4 v2, s[16:19], s73 offen lds
s_add_u32 m0, s72, 19456
s_add_u32 s73, s73, s71
buffer_load_dwordx4 v2, s[16:19], s73 offen lds
s_waitcnt vmcnt(16)
ds_read_b64_tr_b16 a[20:21], v10 offset:0
ds_read_b64_tr_b16 a[22:23], v10 offset:2048
ds_read_b64_tr_b16 a[44:45], v11 offset:0
ds_read_b64_tr_b16 a[46:47], v11 offset:2048
ds_read_b64_tr_b16 a[68:69], v12 offset:0
ds_read_b64_tr_b16 a[70:71], v12 offset:2048
ds_read_b64_tr_b16 a[92:93], v13 offset:0
ds_read_b64_tr_b16 a[94:95], v13 offset:2048
s_waitcnt lgkmcnt(0)
s_add_u32 s73, s70, 164352
s_add_u32 m0, s72, 0
s_nop 0
buffer_load_dwordx4 v2, s[16:19], s73 offen lds
s_add_u32 m0, s72, 1024
s_add_u32 s73, s73, s71
buffer_load_dwordx4 v2, s[16:19], s73 offen lds
s_add_u32 m0, s72, 2048
s_add_u32 s73, s73, s71
buffer_load_dwordx4 v2, s[16:19], s73 offen lds
s_add_u32 m0, s72, 3072
s_add_u32 s73, s73, s71
buffer_load_dwordx4 v2, s[16:19], s73 offen lds
s_waitcnt vmcnt(16)
ds_read_b64_tr_b16 a[96:97], v10 offset:4096
ds_read_b64_tr_b16 a[98:99], v10 offset:6144
ds_read_b64_tr_b16 a[120:121], v11 offset:4096
ds_read_b64_tr_b16 a[122:123], v11 offset:6144
ds_read_b64_tr_b16 a[144:145], v12 offset:4096
ds_read_b64_tr_b16 a[146:147], v12 offset:6144
ds_read_b64_tr_b16 a[168:169], v13 offset:4096
ds_read_b64_tr_b16 a[170:171], v13 offset:6144
s_waitcnt lgkmcnt(0)
s_add_u32 s73, s70, 205312
s_add_u32 m0, s72, 4096
s_nop 0
buffer_load_dwordx4 v2, s[16:19], s73 offen lds
s_add_u32 m0, s72, 5120
s_add_u32 s73, s73, s71
buffer_load_dwordx4 v2, s[16:19], s73 offen lds
s_add_u32 m0, s72, 6144
s_add_u32 s73, s73, s71
buffer_load_dwordx4 v2, s[16:19], s73 offen lds
s_add_u32 m0, s72, 7168
s_add_u32 s73, s73, s71
buffer_load_dwordx4 v2, s[16:19], s73 offen lds
s_waitcnt vmcnt(16)
ds_read_b64_tr_b16 a[100:101], v10 offset:8192
ds_read_b64_tr_b16 a[102:103], v10 offset:10240
ds_read_b64_tr_b16 a[124:125], v11 offset:8192
ds_read_b64_tr_b16 a[126:127], v11 offset:10240
ds_read_b64_tr_b16 a[148:149], v12 offset:8192
ds_read_b64_tr_b16 a[150:151], v12 offset:10240
ds_read_b64_tr_b16 a[172:173], v13 offset:8192
ds_read_b64_tr_b16 a[174:175], v13 offset:10240
s_waitcnt lgkmcnt(0)
s_add_u32 s73, s70, 1024
s_add_u32 m0, s72, 8192
s_nop 0
buffer_load_dwordx4 v2, s[16:19], s73 offen lds
s_add_u32 m0, s72, 9216
s_add_u32 s73, s73, s71
buffer_load_dwordx4 v2, s[16:19], s73 offen lds
s_add_u32 m0, s72, 10240
s_add_u32 s73, s73, s71
buffer_load_dwordx4 v2, s[16:19], s73 offen lds
s_add_u32 m0, s72, 11264
s_add_u32 s73, s73, s71
buffer_load_dwordx4 v2, s[16:19], s73 offen lds
s_waitcnt vmcnt(16)
ds_read_b64_tr_b16 a[104:105], v10 offset:12288
ds_read_b64_tr_b16 a[106:107], v10 offset:14336
ds_read_b64_tr_b16 a[128:129], v11 offset:12288
ds_read_b64_tr_b16 a[130:131], v11 offset:14336
ds_read_b64_tr_b16 a[152:153], v12 offset:12288
ds_read_b64_tr_b16 a[154:155], v12 offset:14336
ds_read_b64_tr_b16 a[176:177], v13 offset:12288
ds_read_b64_tr_b16 a[178:179], v13 offset:14336
s_waitcnt lgkmcnt(0)
s_add_u32 s73, s70, 41984
s_add_u32 m0, s72, 12288
s_nop 0
buffer_load_dwordx4 v2, s[16:19], s73 offen lds
s_add_u32 m0, s72, 13312
s_add_u32 s73, s73, s71
buffer_load_dwordx4 v2, s[16:19], s73 offen lds
s_add_u32 m0, s72, 14336
s_add_u32 s73, s73, s71
buffer_load_dwordx4 v2, s[16:19], s73 offen lds
s_add_u32 m0, s72, 15360
s_add_u32 s73, s73, s71
buffer_load_dwordx4 v2, s[16:19], s73 offen lds
s_waitcnt vmcnt(16)
ds_read_b64_tr_b16 a[108:109], v10 offset:16384
ds_read_b64_tr_b16 a[110:111], v10 offset:18432
ds_read_b64_tr_b16 a[132:133], v11 offset:16384
ds_read_b64_tr_b16 a[134:135], v11 offset:18432
ds_read_b64_tr_b16 a[156:157], v12 offset:16384
ds_read_b64_tr_b16 a[158:159], v12 offset:18432
ds_read_b64_tr_b16 a[180:181], v13 offset:16384
ds_read_b64_tr_b16 a[182:183], v13 offset:18432
s_waitcnt lgkmcnt(0)
s_add_u32 s73, s70, 82944
s_add_u32 m0, s72, 16384
s_nop 0
buffer_load_dwordx4 v2, s[16:19], s73 offen lds
s_add_u32 m0, s72, 17408
s_add_u32 s73, s73, s71
buffer_load_dwordx4 v2, s[16:19], s73 offen lds
s_add_u32 m0, s72, 18432
s_add_u32 s73, s73, s71
buffer_load_dwordx4 v2, s[16:19], s73 offen lds
s_add_u32 m0, s72, 19456
s_add_u32 s73, s73, s71
buffer_load_dwordx4 v2, s[16:19], s73 offen lds
s_waitcnt vmcnt(16)
ds_read_b64_tr_b16 a[112:113], v10 offset:0
ds_read_b64_tr_b16 a[114:115], v10 offset:2048
ds_read_b64_tr_b16 a[136:137], v11 offset:0
ds_read_b64_tr_b16 a[138:139], v11 offset:2048
ds_read_b64_tr_b16 a[160:161], v12 offset:0
ds_read_b64_tr_b16 a[162:163], v12 offset:2048
ds_read_b64_tr_b16 a[184:185], v13 offset:0
ds_read_b64_tr_b16 a[186:187], v13 offset:2048
s_waitcnt lgkmcnt(0)
s_add_u32 s73, s70, 123904
s_add_u32 m0, s72, 0
s_nop 0
buffer_load_dwordx4 v2, s[16:19], s73 offen lds
s_add_u32 m0, s72, 1024
s_add_u32 s73, s73, s71
buffer_load_dwordx4 v2, s[16:19], s73 offen lds
s_add_u32 m0, s72, 2048
s_add_u32 s73, s73, s71
buffer_load_dwordx4 v2, s[16:19], s73 offen lds
s_add_u32 m0, s72, 3072
s_add_u32 s73, s73, s71
buffer_load_dwordx4 v2, s[16:19], s73 offen lds
s_waitcnt vmcnt(16)
ds_read_b64_tr_b16 a[116:117], v10 offset:4096
ds_read_b64_tr_b16 a[118:119], v10 offset:6144
ds_read_b64_tr_b16 a[140:141], v11 offset:4096
ds_read_b64_tr_b16 a[142:143], v11 offset:6144
ds_read_b64_tr_b16 a[164:165], v12 offset:4096
ds_read_b64_tr_b16 a[166:167], v12 offset:6144
ds_read_b64_tr_b16 a[188:189], v13 offset:4096
ds_read_b64_tr_b16 a[190:191], v13 offset:6144
s_waitcnt lgkmcnt(0)
s_add_u32 s73, s70, 164864
s_add_u32 m0, s72, 4096
s_nop 0
buffer_load_dwordx4 v2, s[16:19], s73 offen lds
s_add_u32 m0, s72, 5120
s_add_u32 s73, s73, s71
buffer_load_dwordx4 v2, s[16:19], s73 offen lds
s_add_u32 m0, s72, 6144
s_add_u32 s73, s73, s71
buffer_load_dwordx4 v2, s[16:19], s73 offen lds
s_add_u32 m0, s72, 7168
s_add_u32 s73, s73, s71
buffer_load_dwordx4 v2, s[16:19], s73 offen lds
s_waitcnt vmcnt(16)
ds_read_b64_tr_b16 a[192:193], v10 offset:8192
ds_read_b64_tr_b16 a[194:195], v10 offset:10240
ds_read_b64_tr_b16 a[216:217], v11 offset:8192
ds_read_b64_tr_b16 a[218:219], v11 offset:10240
ds_read_b64_tr_b16 a[240:241], v12 offset:8192
ds_read_b64_tr_b16 a[242:243], v12 offset:10240
ds_read_b64_tr_b16 v[232:233], v13 offset:8192
ds_read_b64_tr_b16 v[234:235], v13 offset:10240
s_waitcnt lgkmcnt(0)
s_add_u32 s73, s70, 205824
s_add_u32 m0, s72, 8192
s_nop 0
buffer_load_dwordx4 v2, s[16:19], s73 offen lds
s_add_u32 m0, s72, 9216
s_add_u32 s73, s73, s71
buffer_load_dwordx4 v2, s[16:19], s73 offen lds
s_add_u32 m0, s72, 10240
s_add_u32 s73, s73, s71
buffer_load_dwordx4 v2, s[16:19], s73 offen lds
s_add_u32 m0, s72, 11264
s_add_u32 s73, s73, s71
buffer_load_dwordx4 v2, s[16:19], s73 offen lds
s_waitcnt vmcnt(16)
ds_read_b64_tr_b16 a[196:197], v10 offset:12288
ds_read_b64_tr_b16 a[198:199], v10 offset:14336
ds_read_b64_tr_b16 a[220:221], v11 offset:12288
ds_read_b64_tr_b16 a[222:223], v11 offset:14336
ds_read_b64_tr_b16 a[244:245], v12 offset:12288
ds_read_b64_tr_b16 a[246:247], v12 offset:14336
ds_read_b64_tr_b16 v[236:237], v13 offset:12288
ds_read_b64_tr_b16 v[238:239], v13 offset:14336
s_waitcnt lgkmcnt(0)
s_waitcnt vmcnt(12)
ds_read_b64_tr_b16 a[200:201], v10 offset:16384
ds_read_b64_tr_b16 a[202:203], v10 offset:18432
ds_read_b64_tr_b16 a[224:225], v11 offset:16384
ds_read_b64_tr_b16 a[226:227], v11 offset:18432
ds_read_b64_tr_b16 a[248:249], v12 offset:16384
ds_read_b64_tr_b16 a[250:251], v12 offset:18432
ds_read_b64_tr_b16 v[240:241], v13 offset:16384
ds_read_b64_tr_b16 v[242:243], v13 offset:18432
s_waitcnt lgkmcnt(0)
s_waitcnt vmcnt(8)
ds_read_b64_tr_b16 a[204:205], v10 offset:0
ds_read_b64_tr_b16 a[206:207], v10 offset:2048
ds_read_b64_tr_b16 a[228:229], v11 offset:0
ds_read_b64_tr_b16 a[230:231], v11 offset:2048
ds_read_b64_tr_b16 a[252:253], v12 offset:0
ds_read_b64_tr_b16 a[254:255], v12 offset:2048
ds_read_b64_tr_b16 v[244:245], v13 offset:0
ds_read_b64_tr_b16 v[246:247], v13 offset:2048
s_waitcnt lgkmcnt(0)
s_waitcnt vmcnt(4)
ds_read_b64_tr_b16 a[208:209], v10 offset:4096
ds_read_b64_tr_b16 a[210:211], v10 offset:6144
ds_read_b64_tr_b16 a[232:233], v11 offset:4096
ds_read_b64_tr_b16 a[234:235], v11 offset:6144
ds_read_b64_tr_b16 v[224:225], v12 offset:4096
ds_read_b64_tr_b16 v[226:227], v12 offset:6144
ds_read_b64_tr_b16 v[248:249], v13 offset:4096
ds_read_b64_tr_b16 v[250:251], v13 offset:6144
s_waitcnt lgkmcnt(0)
s_waitcnt vmcnt(0)
ds_read_b64_tr_b16 a[212:213], v10 offset:8192
ds_read_b64_tr_b16 a[214:215], v10 offset:10240
ds_read_b64_tr_b16 a[236:237], v11 offset:8192
ds_read_b64_tr_b16 a[238:239], v11 offset:10240
ds_read_b64_tr_b16 v[228:229], v12 offset:8192
ds_read_b64_tr_b16 v[230:231], v12 offset:10240
ds_read_b64_tr_b16 v[252:253], v13 offset:8192
ds_read_b64_tr_b16 v[254:255], v13 offset:10240
s_waitcnt lgkmcnt(0)
Lrp_464:
v_mov_b32 v6, 176
buffer_load_dword v5, v6, s[12:15], 0 offen sc1
s_waitcnt vmcnt(0)
Lrc_465:
v_readfirstlane_b32 s67, v5
s_nop 0
s_sub_u32 s67, s67, 1
s_cmp_eq_u32 s67, s34
s_cbranch_scc1 Lro_466
s_sub_u32 s65, s65, 1
s_cmp_eq_u32 s65, 0
s_cbranch_scc1 Lro_466
s_cmp_gt_u32 s67, 7
s_cbranch_scc1 Lrp_464
s_mov_b32 s34, s67
s_waitcnt vmcnt(0) lgkmcnt(0)
s_barrier
s_branch L_restart
Lro_466:
s_mov_b32 s66, -1
s_mov_b32 s94, 0
s_mov_b32 s95, 0
s_mov_b32 s85, 1
s_mov_b32 s86, 0
s_mov_b32 s87, 15
v_mov_b32 v8, 0
v_mov_b32 v17, 24576
v_min_u32 v6, 2, v0
v_lshlrev_b32 v6, 7, v6
Ly_467:
s_add_u32 s66, s66, 1
s_mov_b32 s84, s94
s_mov_b32 s88, s95
s_and_b32 s81, s66, 1
s_mul_i32 s81, s81, 12288
v_add_u32 v7, s81, v1
s_mul_i32 s90, s84, 1638400
s_add_u32 s90, s90, s76
s_sub_u32 s91, s84, 64
s_mul_i32 s91, s91, 1310720
s_add_u32 s91, s91, s89
s_barrier
ds_read_b128 v[64:67], v7 offset:0
ds_read_b128 v[88:91], v7 offset:6144
ds_read_b128 v[68:71], v7 offset:1024
ds_read_b128 v[92:95], v7 offset:7168
ds_read_b128 v[72:75], v7 offset:2048
ds_read_b128 v[96:99], v7 offset:8192
ds_read_b128 v[76:79], v7 offset:3072
ds_read_b128 v[100:103], v7 offset:9216
ds_read_b128 v[80:83], v7 offset:4096
ds_read_b128 v[104:107], v7 offset:10240
ds_read_b128 v[84:87], v7 offset:5120
ds_read_b128 v[108:111], v7 offset:11264
s_add_u32 s95, s88, 1
s_cmp_lg_u32 s87, 0
s_cbranch_scc1 Lyn_473
s_add_u32 s94, s86, 64
s_add_u32 s86, s86, 1
s_cmp_lt_u32 s85, 64
s_cselect_b32 s87, 4, 0
s_cmp_lt_u32 s63, 32
s_cbranch_scc1 Lyg_474
s_mov_b32 s94, 80
s_cmp_ge_u32 s85, 64
s_cbranch_scc1 Lyg_474
s_add_u32 s95, s95, 1
Lyn_473:
s_mov_b32 s94, s85
s_add_u32 s85, s85, 1
s_sub_u32 s87, s87, 1
Lyg_474:
s_cmp_ge_u32 s84, 64
s_cbranch_scc1 Ly_468
s_waitcnt lgkmcnt(11)
v_mfma_f32_16x16x32_bf16 v[112:115], v[64:67], a[0:3], 0
s_waitcnt lgkmcnt(10)
v_mfma_f32_16x16x32_bf16 v[116:119], v[88:91], a[0:3], 0
s_waitcnt lgkmcnt(9)
v_mfma_f32_16x16x32_bf16 v[112:115], v[68:71], a[4:7], v[112:115]
s_waitcnt lgkmcnt(8)
v_mfma_f32_16x16x32_bf16 v[116:119], v[92:95], a[4:7], v[116:119]
s_waitcnt lgkmcnt(7)
v_mfma_f32_16x16x32_bf16 v[112:115], v[72:75], a[8:11], v[112:115]
s_waitcnt lgkmcnt(6)
v_mfma_f32_16x16x32_bf16 v[116:119], v[96:99], a[8:11], v[116:119]
s_waitcnt lgkmcnt(5)
v_mfma_f32_16x16x32_bf16 v[112:115], v[76:79], a[12:15], v[112:115]
s_waitcnt lgkmcnt(4)
v_mfma_f32_16x16x32_bf16 v[116:119], v[100:103], a[12:15], v[116:119]
s_waitcnt lgkmcnt(3)
v_mfma_f32_16x16x32_bf16 v[112:115], v[80:83], a[16:19], v[112:115]
s_waitcnt lgkmcnt(2)
v_mfma_f32_16x16x32_bf16 v[116:119], v[104:107], a[16:19], v[116:119]
s_waitcnt lgkmcnt(1)
v_mfma_f32_16x16x32_bf16 v[112:115], v[84:87], a[20:23], v[112:115]
s_waitcnt lgkmcnt(0)
v_mfma_f32_16x16x32_bf16 v[116:119], v[108:111], a[20:23], v[116:119]
v_mfma_f32_16x16x32_bf16 v[120:123], v[64:67], a[24:27], 0
v_mfma_f32_16x16x32_bf16 v[124:127], v[88:91], a[24:27], 0
v_mfma_f32_16x16x32_bf16 v[120:123], v[68:71], a[28:31], v[120:123]
v_mfma_f32_16x16x32_bf16 v[124:127], v[92:95], a[28:31], v[124:127]
v_mfma_f32_16x16x32_bf16 v[120:123], v[72:75], a[32:35], v[120:123]
s_add_u32 s83, s90, 0
v_mfma_f32_16x16x32_bf16 v[124:127], v[96:99], a[32:35], v[124:127]
v_cvt_pk_bf16_f32 v128, v112, v113
v_mfma_f32_16x16x32_bf16 v[120:123], v[76:79], a[36:39], v[120:123]
v_cvt_pk_bf16_f32 v129, v114, v115
v_mfma_f32_16x16x32_bf16 v[124:127], v[100:103], a[36:39], v[124:127]
v_cvt_pk_bf16_f32 v130, v116, v117
v_mfma_f32_16x16x32_bf16 v[120:123], v[80:83], a[40:43], v[120:123]
v_cvt_pk_bf16_f32 v131, v118, v119
v_mfma_f32_16x16x32_bf16 v[124:127], v[104:107], a[40:43], v[124:127]
buffer_store_dwordx4 v[128:131], v1, s[8:11], s83 offen sc1
v_mfma_f32_16x16x32_bf16 v[120:123], v[84:87], a[44:47], v[120:123]
v_mfma_f32_16x16x32_bf16 v[124:127], v[108:111], a[44:47], v[124:127]
v_mfma_f32_16x16x32_bf16 v[112:115], v[64:67], a[48:51], 0
v_mfma_f32_16x16x32_bf16 v[116:119], v[88:91], a[48:51], 0
v_mfma_f32_16x16x32_bf16 v[112:115], v[68:71], a[52:55], v[112:115]
v_mfma_f32_16x16x32_bf16 v[116:119], v[92:95], a[52:55], v[116:119]
v_mfma_f32_16x16x32_bf16 v[112:115], v[72:75], a[56:59], v[112:115]
s_add_u32 s83, s90, 40960
v_mfma_f32_16x16x32_bf16 v[116:119], v[96:99], a[56:59], v[116:119]
v_cvt_pk_bf16_f32 v132, v120, v121
v_mfma_f32_16x16x32_bf16 v[112:115], v[76:79], a[60:63], v[112:115]
v_cvt_pk_bf16_f32 v133, v122, v123
v_mfma_f32_16x16x32_bf16 v[116:119], v[100:103], a[60:63], v[116:119]
v_cvt_pk_bf16_f32 v134, v124, v125
v_mfma_f32_16x16x32_bf16 v[112:115], v[80:83], a[64:67], v[112:115]
v_cvt_pk_bf16_f32 v135, v126, v127
v_mfma_f32_16x16x32_bf16 v[116:119], v[104:107], a[64:67], v[116:119]
buffer_store_dwordx4 v[132:135], v1, s[8:11], s83 offen sc1
v_mfma_f32_16x16x32_bf16 v[112:115], v[84:87], a[68:71], v[112:115]
v_mfma_f32_16x16x32_bf16 v[116:119], v[108:111], a[68:71], v[116:119]
v_mfma_f32_16x16x32_bf16 v[120:123], v[64:67], a[72:75], 0
v_mfma_f32_16x16x32_bf16 v[124:127], v[88:91], a[72:75], 0
v_mfma_f32_16x16x32_bf16 v[120:123], v[68:71], a[76:79], v[120:123]
v_mfma_f32_16x16x32_bf16 v[124:127], v[92:95], a[76:79], v[124:127]
v_mfma_f32_16x16x32_bf16 v[120:123], v[72:75], a[80:83], v[120:123]
s_add_u32 s83, s90, 81920
v_mfma_f32_16x16x32_bf16 v[124:127], v[96:99], a[80:83], v[124:127]
v_cvt_pk_bf16_f32 v136, v112, v113
v_mfma_f32_16x16x32_bf16 v[120:123], v[76:79], a[84:87], v[120:123]
v_cvt_pk_bf16_f32 v137, v114, v115
v_mfma_f32_16x16x32_bf16 v[124:127], v[100:103], a[84:87], v[124:127]
v_cvt_pk_bf16_f32 v138, v116, v117
v_mfma_f32_16x16x32_bf16 v[120:123], v[80:83], a[88:91], v[120:123]
v_cvt_pk_bf16_f32 v139, v118, v119
v_mfma_f32_16x16x32_bf16 v[124:127], v[104:107], a[88:91], v[124:127]
buffer_store_dwordx4 v[136:139], v1, s[8:11], s83 offen sc1
v_mfma_f32_16x16x32_bf16 v[120:123], v[84:87], a[92:95], v[120:123]
v_mfma_f32_16x16x32_bf16 v[124:127], v[108:111], a[92:95], v[124:127]
v_mfma_f32_16x16x32_bf16 v[112:115], v[64:67], a[96:99], 0
v_mfma_f32_16x16x32_bf16 v[116:119], v[88:91], a[96:99], 0
v_mfma_f32_16x16x32_bf16 v[112:115], v[68:71], a[100:103], v[112:115]
v_mfma_f32_16x16x32_bf16 v[116:119], v[92:95], a[100:103], v[116:119]
v_mfma_f32_16x16x32_bf16 v[112:115], v[72:75], a[104:107], v[112:115]
s_add_u32 s83, s90, 122880
v_mfma_f32_16x16x32_bf16 v[116:119], v[96:99], a[104:107], v[116:119]
v_cvt_pk_bf16_f32 v140, v120, v121
v_mfma_f32_16x16x32_bf16 v[112:115], v[76:79], a[108:111], v[112:115]
v_cvt_pk_bf16_f32 v141, v122, v123
v_mfma_f32_16x16x32_bf16 v[116:119], v[100:103], a[108:111], v[116:119]
v_cvt_pk_bf16_f32 v142, v124, v125
v_mfma_f32_16x16x32_bf16 v[112:115], v[80:83], a[112:115], v[112:115]
v_cvt_pk_bf16_f32 v143, v126, v127
v_mfma_f32_16x16x32_bf16 v[116:119], v[104:107], a[112:115], v[116:119]
buffer_store_dwordx4 v[140:143], v1, s[8:11], s83 offen sc1
v_mfma_f32_16x16x32_bf16 v[112:115], v[84:87], a[116:119], v[112:115]
v_mfma_f32_16x16x32_bf16 v[116:119], v[108:111], a[116:119], v[116:119]
v_mfma_f32_16x16x32_bf16 v[120:123], v[64:67], a[120:123], 0
v_mfma_f32_16x16x32_bf16 v[124:127], v[88:91], a[120:123], 0
v_mfma_f32_16x16x32_bf16 v[120:123], v[68:71], a[124:127], v[120:123]
v_mfma_f32_16x16x32_bf16 v[124:127], v[92:95], a[124:127], v[124:127]
v_mfma_f32_16x16x32_bf16 v[120:123], v[72:75], a[128:131], v[120:123]
s_add_u32 s83, s90, 655360
v_mfma_f32_16x16x32_bf16 v[124:127], v[96:99], a[128:131], v[124:127]
v_cvt_pk_bf16_f32 v128, v112, v113
v_mfma_f32_16x16x32_bf16 v[120:123], v[76:79], a[132:135], v[120:123]
v_cvt_pk_bf16_f32 v129, v114, v115
v_mfma_f32_16x16x32_bf16 v[124:127], v[100:103], a[132:135], v[124:127]
v_cvt_pk_bf16_f32 v130, v116, v117
v_mfma_f32_16x16x32_bf16 v[120:123], v[80:83], a[136:139], v[120:123]
v_cvt_pk_bf16_f32 v131, v118, v119
v_mfma_f32_16x16x32_bf16 v[124:127], v[104:107], a[136:139], v[124:127]
buffer_store_dwordx4 v[128:131], v1, s[8:11], s83 offen sc1
v_mfma_f32_16x16x32_bf16 v[120:123], v[84:87], a[140:143], v[120:123]
v_mfma_f32_16x16x32_bf16 v[124:127], v[108:111], a[140:143], v[124:127]
v_mfma_f32_16x16x32_bf16 v[112:115], v[64:67], a[144:147], 0
v_mfma_f32_16x16x32_bf16 v[116:119], v[88:91], a[144:147], 0
v_mfma_f32_16x16x32_bf16 v[112:115], v[68:71], a[148:151], v[112:115]
v_mfma_f32_16x16x32_bf16 v[116:119], v[92:95], a[148:151], v[116:119]
v_mfma_f32_16x16x32_bf16 v[112:115], v[72:75], a[152:155], v[112:115]
s_add_u32 s83, s90, 696320
v_mfma_f32_16x16x32_bf16 v[116:119], v[96:99], a[152:155], v[116:119]
v_cvt_pk_bf16_f32 v132, v120, v121
v_mfma_f32_16x16x32_bf16 v[112:115], v[76:79], a[156:159], v[112:115]
v_cvt_pk_bf16_f32 v133, v122, v123
v_mfma_f32_16x16x32_bf16 v[116:119], v[100:103], a[156:159], v[116:119]
v_cvt_pk_bf16_f32 v134, v124, v125
v_mfma_f32_16x16x32_bf16 v[112:115], v[80:83], a[160:163], v[112:115]
v_cvt_pk_bf16_f32 v135, v126, v127
v_mfma_f32_16x16x32_bf16 v[116:119], v[104:107], a[160:163], v[116:119]
buffer_store_dwordx4 v[132:135], v1, s[8:11], s83 offen sc1
v_mfma_f32_16x16x32_bf16 v[112:115], v[84:87], a[164:167], v[112:115]
v_mfma_f32_16x16x32_bf16 v[116:119], v[108:111], a[164:167], v[116:119]
v_mfma_f32_16x16x32_bf16 v[120:123], v[64:67], a[168:171], 0
s_waitcnt vmcnt(6)
v_mfma_f32_16x16x32_bf16 v[124:127], v[88:91], a[168:171], 0
buffer_store_dword v8, v3, s[8:11], s75 offen sc1
v_mfma_f32_16x16x32_bf16 v[120:123], v[68:71], a[172:175], v[120:123]
v_mfma_f32_16x16x32_bf16 v[124:127], v[92:95], a[172:175], v[124:127]
v_mfma_f32_16x16x32_bf16 v[120:123], v[72:75], a[176:179], v[120:123]
s_add_u32 s83, s90, 737280
v_mfma_f32_16x16x32_bf16 v[124:127], v[96:99], a[176:179], v[124:127]
v_cvt_pk_bf16_f32 v136, v112, v113
v_mfma_f32_16x16x32_bf16 v[120:123], v[76:79], a[180:183], v[120:123]
v_cvt_pk_bf16_f32 v137, v114, v115
v_mfma_f32_16x16x32_bf16 v[124:127], v[100:103], a[180:183], v[124:127]
v_cvt_pk_bf16_f32 v138, v116, v117
v_mfma_f32_16x16x32_bf16 v[120:123], v[80:83], a[184:187], v[120:123]
v_cvt_pk_bf16_f32 v139, v118, v119
v_mfma_f32_16x16x32_bf16 v[124:127], v[104:107], a[184:187], v[124:127]
buffer_store_dwordx4 v[136:139], v1, s[8:11], s83 offen sc1
v_mfma_f32_16x16x32_bf16 v[120:123], v[84:87], a[188:191], v[120:123]
v_mfma_f32_16x16x32_bf16 v[124:127], v[108:111], a[188:191], v[124:127]
v_mfma_f32_16x16x32_bf16 v[112:115], v[64:67], a[192:195], 0
v_mfma_f32_16x16x32_bf16 v[116:119], v[88:91], a[192:195], 0
v_mfma_f32_16x16x32_bf16 v[112:115], v[68:71], a[196:199], v[112:115]
v_mfma_f32_16x16x32_bf16 v[116:119], v[92:95], a[196:199], v[116:119]
v_mfma_f32_16x16x32_bf16 v[112:115], v[72:75], a[200:203], v[112:115]
s_add_u32 s83, s90, 778240
v_mfma_f32_16x16x32_bf16 v[116:119], v[96:99], a[200:203], v[116:119]
v_cvt_pk_bf16_f32 v140, v120, v121
v_mfma_f32_16x16x32_bf16 v[112:115], v[76:79], a[204:207], v[112:115]
v_cvt_pk_bf16_f32 v141, v122, v123
v_mfma_f32_16x16x32_bf16 v[116:119], v[100:103], a[204:207], v[116:119]
v_cvt_pk_bf16_f32 v142, v124, v125
v_mfma_f32_16x16x32_bf16 v[112:115], v[80:83], a[208:211], v[112:115]
v_cvt_pk_bf16_f32 v143, v126, v127
v_mfma_f32_16x16x32_bf16 v[116:119], v[104:107], a[208:211], v[116:119]
buffer_store_dwordx4 v[140:143], v1, s[8:11], s83 offen sc1
v_mfma_f32_16x16x32_bf16 v[112:115], v[84:87], a[212:215], v[112:115]
v_mfma_f32_16x16x32_bf16 v[116:119], v[108:111], a[212:215], v[116:119]
v_mfma_f32_16x16x32_bf16 v[120:123], v[64:67], a[216:219], 0
v_mfma_f32_16x16x32_bf16 v[124:127], v[88:91], a[216:219], 0
v_mfma_f32_16x16x32_bf16 v[120:123], v[68:71], a[220:223], v[120:123]
v_mfma_f32_16x16x32_bf16 v[124:127], v[92:95], a[220:223], v[124:127]
v_mfma_f32_16x16x32_bf16 v[120:123], v[72:75], a[224:227], v[120:123]
s_add_u32 s83, s90, 1310720
v_mfma_f32_16x16x32_bf16 v[124:127], v[96:99], a[224:227], v[124:127]
v_cvt_pk_bf16_f32 v128, v112, v113
v_mfma_f32_16x16x32_bf16 v[120:123], v[76:79], a[228:231], v[120:123]
v_cvt_pk_bf16_f32 v129, v114, v115
v_mfma_f32_16x16x32_bf16 v[124:127], v[100:103], a[228:231], v[124:127]
v_cvt_pk_bf16_f32 v130, v116, v117
v_mfma_f32_16x16x32_bf16 v[120:123], v[80:83], a[232:235], v[120:123]
v_cvt_pk_bf16_f32 v131, v118, v119
v_mfma_f32_16x16x32_bf16 v[124:127], v[104:107], a[232:235], v[124:127]
buffer_store_dwordx4 v[128:131], v1, s[8:11], s83 offen sc1
v_mfma_f32_16x16x32_bf16 v[120:123], v[84:87], a[236:239], v[120:123]
v_mfma_f32_16x16x32_bf16 v[124:127], v[108:111], a[236:239], v[124:127]
v_mfma_f32_16x16x32_bf16 v[112:115], v[64:67], a[240:243], 0
v_mfma_f32_16x16x32_bf16 v[116:119], v[88:91], a[240:243], 0
v_mfma_f32_16x16x32_bf16 v[112:115], v[68:71], a[244:247], v[112:115]
v_mfma_f32_16x16x32_bf16 v[116:119], v[92:95], a[244:247], v[116:119]
v_mfma_f32_16x16x32_bf16 v[112:115], v[72:75], a[248:251], v[112:115]
s_add_u32 s83, s90, 1351680
v_mfma_f32_16x16x32_bf16 v[116:119], v[96:99], a[248:251], v[116:119]
v_cvt_pk_bf16_f32 v132, v120, v121
v_mfma_f32_16x16x32_bf16 v[112:115], v[76:79], a[252:255], v[112:115]
v_cvt_pk_bf16_f32 v133, v122, v123
v_mfma_f32_16x16x32_bf16 v[116:119], v[100:103], a[252:255], v[116:119]
v_cvt_pk_bf16_f32 v134, v124, v125
v_mfma_f32_16x16x32_bf16 v[112:115], v[80:83], v[224:227], v[112:115]
v_cvt_pk_bf16_f32 v135, v126, v127
v_mfma_f32_16x16x32_bf16 v[116:119], v[104:107], v[224:227], v[116:119]
buffer_store_dwordx4 v[132:135], v1, s[8:11], s83 offen sc1
v_mfma_f32_16x16x32_bf16 v[112:115], v[84:87], v[228:231], v[112:115]
v_mfma_f32_16x16x32_bf16 v[116:119], v[108:111], v[228:231], v[116:119]
v_mfma_f32_16x16x32_bf16 v[120:123], v[64:67], v[232:235], 0
ds_read_b32 v18, v17
v_mfma_f32_16x16x32_bf16 v[124:127], v[88:91], v[232:235], 0
v_mfma_f32_16x16x32_bf16 v[120:123], v[68:71], v[236:239], v[120:123]
v_mfma_f32_16x16x32_bf16 v[124:127], v[92:95], v[236:239], v[124:127]
v_mfma_f32_16x16x32_bf16 v[120:123], v[72:75], v[240:243], v[120:123]
s_add_u32 s83, s90, 1392640
v_mfma_f32_16x16x32_bf16 v[124:127], v[96:99], v[240:243], v[124:127]
v_cvt_pk_bf16_f32 v136, v112, v113
v_mfma_f32_16x16x32_bf16 v[120:123], v[76:79], v[244:247], v[120:123]
v_cvt_pk_bf16_f32 v137, v114, v115
v_mfma_f32_16x16x32_bf16 v[124:127], v[100:103], v[244:247], v[124:127]
v_cvt_pk_bf16_f32 v138, v116, v117
v_mfma_f32_16x16x32_bf16 v[120:123], v[80:83], v[248:251], v[120:123]
v_cvt_pk_bf16_f32 v139, v118, v119
v_mfma_f32_16x16x32_bf16 v[124:127], v[104:107], v[248:251], v[124:127]
buffer_store_dwordx4 v[136:139], v1, s[8:11], s83 offen sc1
v_mfma_f32_16x16x32_bf16 v[120:123], v[84:87], v[252:255], v[120:123]
v_mfma_f32_16x16x32_bf16 v[124:127], v[108:111], v[252:255], v[124:127]
s_add_u32 s83, s90, 1433600
s_nop 2
v_cvt_pk_bf16_f32 v140, v120, v121
v_cvt_pk_bf16_f32 v141, v122, v123
s_nop 1
v_cvt_pk_bf16_f32 v142, v124, v125
v_cvt_pk_bf16_f32 v143, v126, v127
buffer_store_dwordx4 v[140:143], v1, s[8:11], s83 offen sc1
s_branch Ly_469
Ly_468:
s_waitcnt lgkmcnt(11)
v_mfma_f32_16x16x32_bf16 v[112:115], v[64:67], a[0:3], 0
s_waitcnt lgkmcnt(10)
v_mfma_f32_16x16x32_bf16 v[116:119], v[88:91], a[0:3], 0
s_waitcnt lgkmcnt(9)
v_mfma_f32_16x16x32_bf16 v[112:115], v[68:71], a[4:7], v[112:115]
s_waitcnt lgkmcnt(8)
v_mfma_f32_16x16x32_bf16 v[116:119], v[92:95], a[4:7], v[116:119]
s_waitcnt lgkmcnt(7)
v_mfma_f32_16x16x32_bf16 v[112:115], v[72:75], a[8:11], v[112:115]
s_waitcnt lgkmcnt(6)
v_mfma_f32_16x16x32_bf16 v[116:119], v[96:99], a[8:11], v[116:119]
s_waitcnt lgkmcnt(5)
v_mfma_f32_16x16x32_bf16 v[112:115], v[76:79], a[12:15], v[112:115]
s_waitcnt lgkmcnt(4)
v_mfma_f32_16x16x32_bf16 v[116:119], v[100:103], a[12:15], v[116:119]
s_waitcnt lgkmcnt(3)
v_mfma_f32_16x16x32_bf16 v[112:115], v[80:83], a[16:19], v[112:115]
s_waitcnt lgkmcnt(2)
v_mfma_f32_16x16x32_bf16 v[116:119], v[104:107], a[16:19], v[116:119]
s_waitcnt lgkmcnt(1)
v_mfma_f32_16x16x32_bf16 v[112:115], v[84:87], a[20:23], v[112:115]
s_waitcnt lgkmcnt(0)
v_mfma_f32_16x16x32_bf16 v[116:119], v[108:111], a[20:23], v[116:119]
v_mfma_f32_16x16x32_bf16 v[120:123], v[64:67], a[24:27], 0
v_mfma_f32_16x16x32_bf16 v[124:127], v[88:91], a[24:27], 0
v_mfma_f32_16x16x32_bf16 v[120:123], v[68:71], a[28:31], v[120:123]
v_mfma_f32_16x16x32_bf16 v[124:127], v[92:95], a[28:31], v[124:127]
v_mfma_f32_16x16x32_bf16 v[120:123], v[72:75], a[32:35], v[120:123]
s_add_u32 s82, s91, 0
v_mfma_f32_16x16x32_bf16 v[124:127], v[96:99], a[32:35], v[124:127]
s_add_u32 s83, s91, 655360
v_mfma_f32_16x16x32_bf16 v[120:123], v[76:79], a[36:39], v[120:123]
v_cvt_pk_bf16_f32 v128, v112, v113
v_mfma_f32_16x16x32_bf16 v[124:127], v[100:103], a[36:39], v[124:127]
v_cvt_pk_bf16_f32 v129, v114, v115
v_mfma_f32_16x16x32_bf16 v[120:123], v[80:83], a[40:43], v[120:123]
v_cvt_pk_bf16_f32 v130, v116, v117
v_mfma_f32_16x16x32_bf16 v[124:127], v[104:107], a[40:43], v[124:127]
v_cvt_pk_bf16_f32 v131, v118, v119
v_mfma_f32_16x16x32_bf16 v[120:123], v[84:87], a[44:47], v[120:123]
buffer_store_dwordx2 v[128:129], v16, s[8:11], s82 offen offset:0 sc1
v_mfma_f32_16x16x32_bf16 v[124:127], v[108:111], a[44:47], v[124:127]
buffer_store_dwordx2 v[130:131], v16, s[8:11], s83 offen offset:0 sc1
v_mfma_f32_16x16x32_bf16 v[112:115], v[64:67], a[48:51], 0
v_mfma_f32_16x16x32_bf16 v[116:119], v[88:91], a[48:51], 0
v_mfma_f32_16x16x32_bf16 v[112:115], v[68:71], a[52:55], v[112:115]
v_mfma_f32_16x16x32_bf16 v[116:119], v[92:95], a[52:55], v[116:119]
v_mfma_f32_16x16x32_bf16 v[112:115], v[72:75], a[56:59], v[112:115]
v_cvt_pk_bf16_f32 v132, v120, v121
v_mfma_f32_16x16x32_bf16 v[116:119], v[96:99], a[56:59], v[116:119]
v_cvt_pk_bf16_f32 v133, v122, v123
v_mfma_f32_16x16x32_bf16 v[112:115], v[76:79], a[60:63], v[112:115]
v_cvt_pk_bf16_f32 v134, v124, v125
v_mfma_f32_16x16x32_bf16 v[116:119], v[100:103], a[60:63], v[116:119]
v_cvt_pk_bf16_f32 v135, v126, v127
v_mfma_f32_16x16x32_bf16 v[112:115], v[80:83], a[64:67], v[112:115]
buffer_store_dwordx2 v[132:133], v16, s[8:11], s82 offen offset:256 sc1
v_mfma_f32_16x16x32_bf16 v[116:119], v[104:107], a[64:67], v[116:119]
buffer_store_dwordx2 v[134:135], v16, s[8:11], s83 offen offset:256 sc1
v_mfma_f32_16x16x32_bf16 v[112:115], v[84:87], a[68:71], v[112:115]
v_mfma_f32_16x16x32_bf16 v[116:119], v[108:111], a[68:71], v[116:119]
v_mfma_f32_16x16x32_bf16 v[120:123], v[64:67], a[72:75], 0
v_mfma_f32_16x16x32_bf16 v[124:127], v[88:91], a[72:75], 0
v_mfma_f32_16x16x32_bf16 v[120:123], v[68:71], a[76:79], v[120:123]
v_mfma_f32_16x16x32_bf16 v[124:127], v[92:95], a[76:79], v[124:127]
v_mfma_f32_16x16x32_bf16 v[120:123], v[72:75], a[80:83], v[120:123]
v_cvt_pk_bf16_f32 v136, v112, v113
v_mfma_f32_16x16x32_bf16 v[124:127], v[96:99], a[80:83], v[124:127]
v_cvt_pk_bf16_f32 v137, v114, v115
v_mfma_f32_16x16x32_bf16 v[120:123], v[76:79], a[84:87], v[120:123]
v_cvt_pk_bf16_f32 v138, v116, v117
v_mfma_f32_16x16x32_bf16 v[124:127], v[100:103], a[84:87], v[124:127]
v_cvt_pk_bf16_f32 v139, v118, v119
v_mfma_f32_16x16x32_bf16 v[120:123], v[80:83], a[88:91], v[120:123]
buffer_store_dwordx2 v[136:137], v16, s[8:11], s82 offen offset:512 sc1
v_mfma_f32_16x16x32_bf16 v[124:127], v[104:107], a[88:91], v[124:127]
buffer_store_dwordx2 v[138:139], v16, s[8:11], s83 offen offset:512 sc1
v_mfma_f32_16x16x32_bf16 v[120:123], v[84:87], a[92:95], v[120:123]
v_mfma_f32_16x16x32_bf16 v[124:127], v[108:111], a[92:95], v[124:127]
v_mfma_f32_16x16x32_bf16 v[112:115], v[64:67], a[96:99], 0
v_mfma_f32_16x16x32_bf16 v[116:119], v[88:91], a[96:99], 0
v_mfma_f32_16x16x32_bf16 v[112:115], v[68:71], a[100:103], v[112:115]
v_mfma_f32_16x16x32_bf16 v[116:119], v[92:95], a[100:103], v[116:119]
v_mfma_f32_16x16x32_bf16 v[112:115], v[72:75], a[104:107], v[112:115]
v_cvt_pk_bf16_f32 v140, v120, v121
v_mfma_f32_16x16x32_bf16 v[116:119], v[96:99], a[104:107], v[116:119]
v_cvt_pk_bf16_f32 v141, v122, v123
v_mfma_f32_16x16x32_bf16 v[112:115], v[76:79], a[108:111], v[112:115]
v_cvt_pk_bf16_f32 v142, v124, v125
v_mfma_f32_16x16x32_bf16 v[116:119], v[100:103], a[108:111], v[116:119]
v_cvt_pk_bf16_f32 v143, v126, v127
v_mfma_f32_16x16x32_bf16 v[112:115], v[80:83], a[112:115], v[112:115]
buffer_store_dwordx2 v[140:141], v16, s[8:11], s82 offen offset:768 sc1
v_mfma_f32_16x16x32_bf16 v[116:119], v[104:107], a[112:115], v[116:119]
buffer_store_dwordx2 v[142:143], v16, s[8:11], s83 offen offset:768 sc1
v_mfma_f32_16x16x32_bf16 v[112:115], v[84:87], a[116:119], v[112:115]
v_mfma_f32_16x16x32_bf16 v[116:119], v[108:111], a[116:119], v[116:119]
v_mfma_f32_16x16x32_bf16 v[120:123], v[64:67], a[120:123], 0
v_mfma_f32_16x16x32_bf16 v[124:127], v[88:91], a[120:123], 0
v_mfma_f32_16x16x32_bf16 v[120:123], v[68:71], a[124:127], v[120:123]
v_mfma_f32_16x16x32_bf16 v[124:127], v[92:95], a[124:127], v[124:127]
v_mfma_f32_16x16x32_bf16 v[120:123], v[72:75], a[128:131], v[120:123]
s_add_u32 s82, s91, 4096
v_mfma_f32_16x16x32_bf16 v[124:127], v[96:99], a[128:131], v[124:127]
s_add_u32 s83, s91, 659456
v_mfma_f32_16x16x32_bf16 v[120:123], v[76:79], a[132:135], v[120:123]
v_cvt_pk_bf16_f32 v128, v112, v113
v_mfma_f32_16x16x32_bf16 v[124:127], v[100:103], a[132:135], v[124:127]
v_cvt_pk_bf16_f32 v129, v114, v115
v_mfma_f32_16x16x32_bf16 v[120:123], v[80:83], a[136:139], v[120:123]
v_cvt_pk_bf16_f32 v130, v116, v117
v_mfma_f32_16x16x32_bf16 v[124:127], v[104:107], a[136:139], v[124:127]
v_cvt_pk_bf16_f32 v131, v118, v119
v_mfma_f32_16x16x32_bf16 v[120:123], v[84:87], a[140:143], v[120:123]
buffer_store_dwordx2 v[128:129], v16, s[8:11], s82 offen offset:0 sc1
v_mfma_f32_16x16x32_bf16 v[124:127], v[108:111], a[140:143], v[124:127]
buffer_store_dwordx2 v[130:131], v16, s[8:11], s83 offen offset:0 sc1
v_mfma_f32_16x16x32_bf16 v[112:115], v[64:67], a[144:147], 0
v_mfma_f32_16x16x32_bf16 v[116:119], v[88:91], a[144:147], 0
v_mfma_f32_16x16x32_bf16 v[112:115], v[68:71], a[148:151], v[112:115]
v_mfma_f32_16x16x32_bf16 v[116:119], v[92:95], a[148:151], v[116:119]
v_mfma_f32_16x16x32_bf16 v[112:115], v[72:75], a[152:155], v[112:115]
v_cvt_pk_bf16_f32 v132, v120, v121
v_mfma_f32_16x16x32_bf16 v[116:119], v[96:99], a[152:155], v[116:119]
v_cvt_pk_bf16_f32 v133, v122, v123
v_mfma_f32_16x16x32_bf16 v[112:115], v[76:79], a[156:159], v[112:115]
v_cvt_pk_bf16_f32 v134, v124, v125
v_mfma_f32_16x16x32_bf16 v[116:119], v[100:103], a[156:159], v[116:119]
v_cvt_pk_bf16_f32 v135, v126, v127
v_mfma_f32_16x16x32_bf16 v[112:115], v[80:83], a[160:163], v[112:115]
buffer_store_dwordx2 v[132:133], v16, s[8:11], s82 offen offset:256 sc1
v_mfma_f32_16x16x32_bf16 v[116:119], v[104:107], a[160:163], v[116:119]
buffer_store_dwordx2 v[134:135], v16, s[8:11], s83 offen offset:256 sc1
v_mfma_f32_16x16x32_bf16 v[112:115], v[84:87], a[164:167], v[112:115]
v_mfma_f32_16x16x32_bf16 v[116:119], v[108:111], a[164:167], v[116:119]
v_mfma_f32_16x16x32_bf16 v[120:123], v[64:67], a[168:171], 0
s_waitcnt vmcnt(12)
v_mfma_f32_16x16x32_bf16 v[124:127], v[88:91], a[168:171], 0
buffer_store_dword v8, v3, s[8:11], s75 offen sc1
v_mfma_f32_16x16x32_bf16 v[120:123], v[68:71], a[172:175], v[120:123]
v_mfma_f32_16x16x32_bf16 v[124:127], v[92:95], a[172:175], v[124:127]
v_mfma_f32_16x16x32_bf16 v[120:123], v[72:75], a[176:179], v[120:123]
v_cvt_pk_bf16_f32 v136, v112, v113
v_mfma_f32_16x16x32_bf16 v[124:127], v[96:99], a[176:179], v[124:127]
v_cvt_pk_bf16_f32 v137, v114, v115
v_mfma_f32_16x16x32_bf16 v[120:123], v[76:79], a[180:183], v[120:123]
v_cvt_pk_bf16_f32 v138, v116, v117
v_mfma_f32_16x16x32_bf16 v[124:127], v[100:103], a[180:183], v[124:127]
v_cvt_pk_bf16_f32 v139, v118, v119
v_mfma_f32_16x16x32_bf16 v[120:123], v[80:83], a[184:187], v[120:123]
buffer_store_dwordx2 v[136:137], v16, s[8:11], s82 offen offset:512 sc1
v_mfma_f32_16x16x32_bf16 v[124:127], v[104:107], a[184:187], v[124:127]
buffer_store_dwordx2 v[138:139], v16, s[8:11], s83 offen offset:512 sc1
v_mfma_f32_16x16x32_bf16 v[120:123], v[84:87], a[188:191], v[120:123]
v_mfma_f32_16x16x32_bf16 v[124:127], v[108:111], a[188:191], v[124:127]
v_mfma_f32_16x16x32_bf16 v[112:115], v[64:67], a[192:195], 0
v_mfma_f32_16x16x32_bf16 v[116:119], v[88:91], a[192:195], 0
v_mfma_f32_16x16x32_bf16 v[112:115], v[68:71], a[196:199], v[112:115]
v_mfma_f32_16x16x32_bf16 v[116:119], v[92:95], a[196:199], v[116:119]
v_mfma_f32_16x16x32_bf16 v[112:115], v[72:75], a[200:203], v[112:115]
v_cvt_pk_bf16_f32 v140, v120, v121
v_mfma_f32_16x16x32_bf16 v[116:119], v[96:99], a[200:203], v[116:119]
v_cvt_pk_bf16_f32 v141, v122, v123
v_mfma_f32_16x16x32_bf16 v[112:115], v[76:79], a[204:207], v[112:115]
v_cvt_pk_bf16_f32 v142, v124, v125
v_mfma_f32_16x16x32_bf16 v[116:119], v[100:103], a[204:207], v[116:119]
v_cvt_pk_bf16_f32 v143, v126, v127
v_mfma_f32_16x16x32_bf16 v[112:115], v[80:83], a[208:211], v[112:115]
buffer_store_dwordx2 v[140:141], v16, s[8:11], s82 offen offset:768 sc1
v_mfma_f32_16x16x32_bf16 v[116:119], v[104:107], a[208:211], v[116:119]
buffer_store_dwordx2 v[142:143], v16, s[8:11], s83 offen offset:768 sc1
v_mfma_f32_16x16x32_bf16 v[112:115], v[84:87], a[212:215], v[112:115]
v_mfma_f32_16x16x32_bf16 v[116:119], v[108:111], a[212:215], v[116:119]
v_mfma_f32_16x16x32_bf16 v[120:123], v[64:67], a[216:219], 0
v_mfma_f32_16x16x32_bf16 v[124:127], v[88:91], a[216:219], 0
v_mfma_f32_16x16x32_bf16 v[120:123], v[68:71], a[220:223], v[120:123]
v_mfma_f32_16x16x32_bf16 v[124:127], v[92:95], a[220:223], v[124:127]
v_mfma_f32_16x16x32_bf16 v[120:123], v[72:75], a[224:227], v[120:123]
s_add_u32 s82, s91, 8192
v_mfma_f32_16x16x32_bf16 v[124:127], v[96:99], a[224:227], v[124:127]
s_add_u32 s83, s91, 663552
v_mfma_f32_16x16x32_bf16 v[120:123], v[76:79], a[228:231], v[120:123]
v_cvt_pk_bf16_f32 v128, v112, v113
v_mfma_f32_16x16x32_bf16 v[124:127], v[100:103], a[228:231], v[124:127]
v_cvt_pk_bf16_f32 v129, v114, v115
v_mfma_f32_16x16x32_bf16 v[120:123], v[80:83], a[232:235], v[120:123]
v_cvt_pk_bf16_f32 v130, v116, v117
v_mfma_f32_16x16x32_bf16 v[124:127], v[104:107], a[232:235], v[124:127]
v_cvt_pk_bf16_f32 v131, v118, v119
v_mfma_f32_16x16x32_bf16 v[120:123], v[84:87], a[236:239], v[120:123]
buffer_store_dwordx2 v[128:129], v16, s[8:11], s82 offen offset:0 sc1
v_mfma_f32_16x16x32_bf16 v[124:127], v[108:111], a[236:239], v[124:127]
buffer_store_dwordx2 v[130:131], v16, s[8:11], s83 offen offset:0 sc1
v_mfma_f32_16x16x32_bf16 v[112:115], v[64:67], a[240:243], 0
v_mfma_f32_16x16x32_bf16 v[116:119], v[88:91], a[240:243], 0
v_mfma_f32_16x16x32_bf16 v[112:115], v[68:71], a[244:247], v[112:115]
v_mfma_f32_16x16x32_bf16 v[116:119], v[92:95], a[244:247], v[116:119]
v_mfma_f32_16x16x32_bf16 v[112:115], v[72:75], a[248:251], v[112:115]
v_cvt_pk_bf16_f32 v132, v120, v121
v_mfma_f32_16x16x32_bf16 v[116:119], v[96:99], a[248:251], v[116:119]
v_cvt_pk_bf16_f32 v133, v122, v123
v_mfma_f32_16x16x32_bf16 v[112:115], v[76:79], a[252:255], v[112:115]
v_cvt_pk_bf16_f32 v134, v124, v125
v_mfma_f32_16x16x32_bf16 v[116:119], v[100:103], a[252:255], v[116:119]
v_cvt_pk_bf16_f32 v135, v126, v127
v_mfma_f32_16x16x32_bf16 v[112:115], v[80:83], v[224:227], v[112:115]
buffer_store_dwordx2 v[132:133], v16, s[8:11], s82 offen offset:256 sc1
v_mfma_f32_16x16x32_bf16 v[116:119], v[104:107], v[224:227], v[116:119]
buffer_store_dwordx2 v[134:135], v16, s[8:11], s83 offen offset:256 sc1
v_mfma_f32_16x16x32_bf16 v[112:115], v[84:87], v[228:231], v[112:115]
v_mfma_f32_16x16x32_bf16 v[116:119], v[108:111], v[228:231], v[116:119]
v_mfma_f32_16x16x32_bf16 v[120:123], v[64:67], v[232:235], 0
ds_read_b32 v18, v17
v_mfma_f32_16x16x32_bf16 v[124:127], v[88:91], v[232:235], 0
v_mfma_f32_16x16x32_bf16 v[120:123], v[68:71], v[236:239], v[120:123]
v_mfma_f32_16x16x32_bf16 v[124:127], v[92:95], v[236:239], v[124:127]
v_mfma_f32_16x16x32_bf16 v[120:123], v[72:75], v[240:243], v[120:123]
v_cvt_pk_bf16_f32 v136, v112, v113
v_mfma_f32_16x16x32_bf16 v[124:127], v[96:99], v[240:243], v[124:127]
v_cvt_pk_bf16_f32 v137, v114, v115
v_mfma_f32_16x16x32_bf16 v[120:123], v[76:79], v[244:247], v[120:123]
v_cvt_pk_bf16_f32 v138, v116, v117
v_mfma_f32_16x16x32_bf16 v[124:127], v[100:103], v[244:247], v[124:127]
v_cvt_pk_bf16_f32 v139, v118, v119
v_mfma_f32_16x16x32_bf16 v[120:123], v[80:83], v[248:251], v[120:123]
buffer_store_dwordx2 v[136:137], v16, s[8:11], s82 offen offset:512 sc1
v_mfma_f32_16x16x32_bf16 v[124:127], v[104:107], v[248:251], v[124:127]
buffer_store_dwordx2 v[138:139], v16, s[8:11], s83 offen offset:512 sc1
v_mfma_f32_16x16x32_bf16 v[120:123], v[84:87], v[252:255], v[120:123]
v_mfma_f32_16x16x32_bf16 v[124:127], v[108:111], v[252:255], v[124:127]
s_nop 3
v_cvt_pk_bf16_f32 v140, v120, v121
v_cvt_pk_bf16_f32 v141, v122, v123
s_nop 1
v_cvt_pk_bf16_f32 v142, v124, v125
v_cvt_pk_bf16_f32 v143, v126, v127
buffer_store_dwordx2 v[140:141], v16, s[8:11], s82 offen offset:768 sc1
buffer_store_dwordx2 v[142:143], v16, s[8:11], s83 offen offset:768 sc1
Ly_469:
s_add_u32 s81, s88, 1
v_mov_b32 v8, s81
s_cmp_ge_u32 s94, 79
s_cbranch_scc1 Ly_470
s_waitcnt lgkmcnt(0)
v_readfirstlane_b32 s81, v18
s_cmp_lt_u32 s66, 10
s_cselect_b32 s81, 0, s81
s_cmp_lg_u32 s81, 0
s_cbranch_scc1 Ly_467
s_waitcnt vmcnt(0)
buffer_store_dword v8, v3, s[8:11], s75 offen sc1
s_branch Ly_467
Ly_470:
s_waitcnt vmcnt(0)
buffer_store_dword v8, v3, s[8:11], s75 offen sc1
s_sub_u32 s68, s63, 2
s_cmp_ge_u32 s63, 32
s_cbranch_scc1 L_f2
s_waitcnt vmcnt(0)
s_endpgm
Ly2_463:
v_lshrrev_b32 v20, 3, v0
v_and_b32 v21, 6, v20
v_and_b32 v2, 7, v0
v_xor_b32 v2, v2, v21
v_lshlrev_b32 v2, 4, v2
v_mad_u32_u24 v2, v20, s74, v2
s_lshl_b32 s71, s74, 3
s_mul_i32 s72, s3, 20480
s_add_u32 s72, s72, 81920
s_add_u32 s73, s70, 0
s_add_u32 m0, s72, 0
s_nop 0
buffer_load_dwordx4 v2, s[16:19], s73 offen lds
s_add_u32 m0, s72, 1024
s_add_u32 s73, s73, s71
buffer_load_dwordx4 v2, s[16:19], s73 offen lds
s_add_u32 m0, s72, 2048
s_add_u32 s73, s73, s71
buffer_load_dwordx4 v2, s[16:19], s73 offen lds
s_add_u32 m0, s72, 3072
s_add_u32 s73, s73, s71
buffer_load_dwordx4 v2, s[16:19], s73 offen lds
s_add_u32 s73, s70, 40960
s_add_u32 m0, s72, 4096
s_nop 0
buffer_load_dwordx4 v2, s[16:19], s73 offen lds
s_add_u32 m0, s72, 5120
s_add_u32 s73, s73, s71
buffer_load_dwordx4 v2, s[16:19], s73 offen lds
s_add_u32 m0, s72, 6144
s_add_u32 s73, s73, s71
buffer_load_dwordx4 v2, s[16:19], s73 offen lds
s_add_u32 m0, s72, 7168
s_add_u32 s73, s73, s71
buffer_load_dwordx4 v2, s[16:19], s73 offen lds
s_add_u32 s73, s70, 81920
s_add_u32 m0, s72, 8192
s_nop 0
buffer_load_dwordx4 v2, s[16:19], s73 offen lds
s_add_u32 m0, s72, 9216
s_add_u32 s73, s73, s71
buffer_load_dwordx4 v2, s[16:19], s73 offen lds
s_add_u32 m0, s72, 10240
s_add_u32 s73, s73, s71
buffer_load_dwordx4 v2, s[16:19], s73 offen lds
s_add_u32 m0, s72, 11264
s_add_u32 s73, s73, s71
buffer_load_dwordx4 v2, s[16:19], s73 offen lds
s_add_u32 s73, s70, 122880
s_add_u32 m0, s72, 12288
s_nop 0
buffer_load_dwordx4 v2, s[16:19], s73 offen lds
s_add_u32 m0, s72, 13312
s_add_u32 s73, s73, s71
buffer_load_dwordx4 v2, s[16:19], s73 offen lds
s_add_u32 m0, s72, 14336
s_add_u32 s73, s73, s71
buffer_load_dwordx4 v2, s[16:19], s73 offen lds
s_add_u32 m0, s72, 15360
s_add_u32 s73, s73, s71
buffer_load_dwordx4 v2, s[16:19], s73 offen lds
s_add_u32 s73, s70, 163840
s_add_u32 m0, s72, 16384
s_nop 0
buffer_load_dwordx4 v2, s[16:19], s73 offen lds
s_add_u32 m0, s72, 17408
s_add_u32 s73, s73, s71
buffer_load_dwordx4 v2, s[16:19], s73 offen lds
s_add_u32 m0, s72, 18432
s_add_u32 s73, s73, s71
buffer_load_dwordx4 v2, s[16:19], s73 offen lds
s_add_u32 m0, s72, 19456
s_add_u32 s73, s73, s71
buffer_load_dwordx4 v2, s[16:19], s73 offen lds
v_mov_b32 v20, 0
v_bfe_u32 v21, v0, 1, 1
s_mov_b32 s67, 1
v_mad_i32_i24 v20, v21, s67, v20
v_bfe_u32 v21, v0, 3, 2
s_mov_b32 s67, 2
v_mad_i32_i24 v20, v21, s67, v20
v_mov_b32 v10, 0
v_bfe_u32 v21, v0, 0, 1
s_mov_b32 s67, 8
v_mad_i32_i24 v10, v21, s67, v10
v_bfe_u32 v21, v0, 2, 4
s_mov_b32 s67, 128
v_mad_i32_i24 v10, v21, s67, v10
v_lshl_add_u32 v10, v20, 4, v10
v_add_u32 v10, s72, v10
v_xor_b32 v11, 32, v10
v_xor_b32 v12, 64, v10
v_xor_b32 v13, 96, v10
s_waitcnt vmcnt(16)
ds_read_b64_tr_b16 a[0:1], v10 offset:0
ds_read_b64_tr_b16 a[2:3], v10 offset:2048
ds_read_b64_tr_b16 a[24:25], v11 offset:0
ds_read_b64_tr_b16 a[26:27], v11 offset:2048
ds_read_b64_tr_b16 a[48:49], v12 offset:0
ds_read_b64_tr_b16 a[50:51], v12 offset:2048
ds_read_b64_tr_b16 a[72:73], v13 offset:0
ds_read_b64_tr_b16 a[74:75], v13 offset:2048
s_waitcnt lgkmcnt(0)
s_add_u32 s73, s70, 204800
s_add_u32 m0, s72, 0
s_nop 0
buffer_load_dwordx4 v2, s[16:19], s73 offen lds
s_add_u32 m0, s72, 1024
s_add_u32 s73, s73, s71
buffer_load_dwordx4 v2, s[16:19], s73 offen lds
s_add_u32 m0, s72, 2048
s_add_u32 s73, s73, s71
buffer_load_dwordx4 v2, s[16:19], s73 offen lds
s_add_u32 m0, s72, 3072
s_add_u32 s73, s73, s71
buffer_load_dwordx4 v2, s[16:19], s73 offen lds
s_waitcnt vmcnt(16)
ds_read_b64_tr_b16 a[4:5], v10 offset:4096
ds_read_b64_tr_b16 a[6:7], v10 offset:6144
ds_read_b64_tr_b16 a[28:29], v11 offset:4096
ds_read_b64_tr_b16 a[30:31], v11 offset:6144
ds_read_b64_tr_b16 a[52:53], v12 offset:4096
ds_read_b64_tr_b16 a[54:55], v12 offset:6144
ds_read_b64_tr_b16 a[76:77], v13 offset:4096
ds_read_b64_tr_b16 a[78:79], v13 offset:6144
s_waitcnt lgkmcnt(0)
s_add_u32 s73, s70, 512
s_add_u32 m0, s72, 4096
s_nop 0
buffer_load_dwordx4 v2, s[16:19], s73 offen lds
s_add_u32 m0, s72, 5120
s_add_u32 s73, s73, s71
buffer_load_dwordx4 v2, s[16:19], s73 offen lds
s_add_u32 m0, s72, 6144
s_add_u32 s73, s73, s71
buffer_load_dwordx4 v2, s[16:19], s73 offen lds
s_add_u32 m0, s72, 7168
s_add_u32 s73, s73, s71
buffer_load_dwordx4 v2, s[16:19], s73 offen lds
s_waitcnt vmcnt(16)
ds_read_b64_tr_b16 a[8:9], v10 offset:8192
ds_read_b64_tr_b16 a[10:11], v10 offset:10240
ds_read_b64_tr_b16 a[32:33], v11 offset:8192
ds_read_b64_tr_b16 a[34:35], v11 offset:10240
ds_read_b64_tr_b16 a[56:57], v12 offset:8192
ds_read_b64_tr_b16 a[58:59], v12 offset:10240
ds_read_b64_tr_b16 a[80:81], v13 offset:8192
ds_read_b64_tr_b16 a[82:83], v13 offset:10240
s_waitcnt lgkmcnt(0)
s_add_u32 s73, s70, 41472
s_add_u32 m0, s72, 8192
s_nop 0
buffer_load_dwordx4 v2, s[16:19], s73 offen lds
s_add_u32 m0, s72, 9216
s_add_u32 s73, s73, s71
buffer_load_dwordx4 v2, s[16:19], s73 offen lds
s_add_u32 m0, s72, 10240
s_add_u32 s73, s73, s71
buffer_load_dwordx4 v2, s[16:19], s73 offen lds
s_add_u32 m0, s72, 11264
s_add_u32 s73, s73, s71
buffer_load_dwordx4 v2, s[16:19], s73 offen lds
s_waitcnt vmcnt(16)
ds_read_b64_tr_b16 a[12:13], v10 offset:12288
ds_read_b64_tr_b16 a[14:15], v10 offset:14336
ds_read_b64_tr_b16 a[36:37], v11 offset:12288
ds_read_b64_tr_b16 a[38:39], v11 offset:14336
ds_read_b64_tr_b16 a[60:61], v12 offset:12288
ds_read_b64_tr_b16 a[62:63], v12 offset:14336
ds_read_b64_tr_b16 a[84:85], v13 offset:12288
ds_read_b64_tr_b16 a[86:87], v13 offset:14336
s_waitcnt lgkmcnt(0)
s_add_u32 s73, s70, 82432
s_add_u32 m0, s72, 12288
s_nop 0
buffer_load_dwordx4 v2, s[16:19], s73 offen lds
s_add_u32 m0, s72, 13312
s_add_u32 s73, s73, s71
buffer_load_dwordx4 v2, s[16:19], s73 offen lds
s_add_u32 m0, s72, 14336
s_add_u32 s73, s73, s71
buffer_load_dwordx4 v2, s[16:19], s73 offen lds
s_add_u32 m0, s72, 15360
s_add_u32 s73, s73, s71
buffer_load_dwordx4 v2, s[16:19], s73 offen lds
s_waitcnt vmcnt(16)
ds_read_b64_tr_b16 a[16:17], v10 offset:16384
ds_read_b64_tr_b16 a[18:19], v10 offset:18432
ds_read_b64_tr_b16 a[40:41], v11 offset:16384
ds_read_b64_tr_b16 a[42:43], v11 offset:18432
ds_read_b64_tr_b16 a[64:65], v12 offset:16384
ds_read_b64_tr_b16 a[66:67], v12 offset:18432
ds_read_b64_tr_b16 a[88:89], v13 offset:16384
ds_read_b64_tr_b16 a[90:91], v13 offset:18432
s_waitcnt lgkmcnt(0)
s_add_u32 s73, s70, 123392
s_add_u32 m0, s72, 16384
s_nop 0
buffer_load_dwordx4 v2, s[16:19], s73 offen lds
s_add_u32 m0, s72, 17408
s_add_u32 s73, s73, s71
buffer_load_dwordx4 v2, s[16:19], s73 offen lds
s_add_u32 m0, s72, 18432
s_add_u32 s73, s73, s71
buffer_load_dwordx4 v2, s[16:19], s73 offen lds
s_add_u32 m0, s72, 19456
s_add_u32 s73, s73, s71
buffer_load_dwordx4 v2, s[16:19], s73 offen lds
s_waitcnt vmcnt(16)
ds_read_b64_tr_b16 a[20:21], v10 offset:0
ds_read_b64_tr_b16 a[22:23], v10 offset:2048
ds_read_b64_tr_b16 a[44:45], v11 offset:0
ds_read_b64_tr_b16 a[46:47], v11 offset:2048
ds_read_b64_tr_b16 a[68:69], v12 offset:0
ds_read_b64_tr_b16 a[70:71], v12 offset:2048
ds_read_b64_tr_b16 a[92:93], v13 offset:0
ds_read_b64_tr_b16 a[94:95], v13 offset:2048
s_waitcnt lgkmcnt(0)
s_add_u32 s73, s70, 164352
s_add_u32 m0, s72, 0
s_nop 0
buffer_load_dwordx4 v2, s[16:19], s73 offen lds
s_add_u32 m0, s72, 1024
s_add_u32 s73, s73, s71
buffer_load_dwordx4 v2, s[16:19], s73 offen lds
s_add_u32 m0, s72, 2048
s_add_u32 s73, s73, s71
buffer_load_dwordx4 v2, s[16:19], s73 offen lds
s_add_u32 m0, s72, 3072
s_add_u32 s73, s73, s71
buffer_load_dwordx4 v2, s[16:19], s73 offen lds
s_waitcnt vmcnt(16)
ds_read_b64_tr_b16 a[96:97], v10 offset:4096
ds_read_b64_tr_b16 a[98:99], v10 offset:6144
ds_read_b64_tr_b16 a[120:121], v11 offset:4096
ds_read_b64_tr_b16 a[122:123], v11 offset:6144
ds_read_b64_tr_b16 a[144:145], v12 offset:4096
ds_read_b64_tr_b16 a[146:147], v12 offset:6144
ds_read_b64_tr_b16 a[168:169], v13 offset:4096
ds_read_b64_tr_b16 a[170:171], v13 offset:6144
s_waitcnt lgkmcnt(0)
s_add_u32 s73, s70, 205312
s_add_u32 m0, s72, 4096
s_nop 0
buffer_load_dwordx4 v2, s[16:19], s73 offen lds
s_add_u32 m0, s72, 5120
s_add_u32 s73, s73, s71
buffer_load_dwordx4 v2, s[16:19], s73 offen lds
s_add_u32 m0, s72, 6144
s_add_u32 s73, s73, s71
buffer_load_dwordx4 v2, s[16:19], s73 offen lds
s_add_u32 m0, s72, 7168
s_add_u32 s73, s73, s71
buffer_load_dwordx4 v2, s[16:19], s73 offen lds
s_waitcnt vmcnt(16)
ds_read_b64_tr_b16 a[100:101], v10 offset:8192
ds_read_b64_tr_b16 a[102:103], v10 offset:10240
ds_read_b64_tr_b16 a[124:125], v11 offset:8192
ds_read_b64_tr_b16 a[126:127], v11 offset:10240
ds_read_b64_tr_b16 a[148:149], v12 offset:8192
ds_read_b64_tr_b16 a[150:151], v12 offset:10240
ds_read_b64_tr_b16 a[172:173], v13 offset:8192
ds_read_b64_tr_b16 a[174:175], v13 offset:10240
s_waitcnt lgkmcnt(0)
s_waitcnt vmcnt(12)
ds_read_b64_tr_b16 a[104:105], v10 offset:12288
ds_read_b64_tr_b16 a[106:107], v10 offset:14336
ds_read_b64_tr_b16 a[128:129], v11 offset:12288
ds_read_b64_tr_b16 a[130:131], v11 offset:14336
ds_read_b64_tr_b16 a[152:153], v12 offset:12288
ds_read_b64_tr_b16 a[154:155], v12 offset:14336
ds_read_b64_tr_b16 a[176:177], v13 offset:12288
ds_read_b64_tr_b16 a[178:179], v13 offset:14336
s_waitcnt lgkmcnt(0)
s_waitcnt vmcnt(8)
ds_read_b64_tr_b16 a[108:109], v10 offset:16384
ds_read_b64_tr_b16 a[110:111], v10 offset:18432
ds_read_b64_tr_b16 a[132:133], v11 offset:16384
ds_read_b64_tr_b16 a[134:135], v11 offset:18432
ds_read_b64_tr_b16 a[156:157], v12 offset:16384
ds_read_b64_tr_b16 a[158:159], v12 offset:18432
ds_read_b64_tr_b16 a[180:181], v13 offset:16384
ds_read_b64_tr_b16 a[182:183], v13 offset:18432
s_waitcnt lgkmcnt(0)
s_waitcnt vmcnt(4)
ds_read_b64_tr_b16 a[112:113], v10 offset:0
ds_read_b64_tr_b16 a[114:115], v10 offset:2048
ds_read_b64_tr_b16 a[136:137], v11 offset:0
ds_read_b64_tr_b16 a[138:139], v11 offset:2048
ds_read_b64_tr_b16 a[160:161], v12 offset:0
ds_read_b64_tr_b16 a[162:163], v12 offset:2048
ds_read_b64_tr_b16 a[184:185], v13 offset:0
ds_read_b64_tr_b16 a[186:187], v13 offset:2048
s_waitcnt lgkmcnt(0)
s_waitcnt vmcnt(0)
ds_read_b64_tr_b16 a[116:117], v10 offset:4096
ds_read_b64_tr_b16 a[118:119], v10 offset:6144
ds_read_b64_tr_b16 a[140:141], v11 offset:4096
ds_read_b64_tr_b16 a[142:143], v11 offset:6144
ds_read_b64_tr_b16 a[164:165], v12 offset:4096
ds_read_b64_tr_b16 a[166:167], v12 offset:6144
ds_read_b64_tr_b16 a[188:189], v13 offset:4096
ds_read_b64_tr_b16 a[190:191], v13 offset:6144
s_waitcnt lgkmcnt(0)
Lrp_475:
v_mov_b32 v6, 176
buffer_load_dword v5, v6, s[12:15], 0 offen sc1
s_waitcnt vmcnt(0)
Lrc_476:
v_readfirstlane_b32 s67, v5
s_nop 0
s_sub_u32 s67, s67, 1
s_cmp_eq_u32 s67, s34
s_cbranch_scc1 Lro_477
s_sub_u32 s65, s65, 1
s_cmp_eq_u32 s65, 0
s_cbranch_scc1 Lro_477
s_cmp_gt_u32 s67, 7
s_cbranch_scc1 Lrp_475
s_mov_b32 s34, s67
s_waitcnt vmcnt(0) lgkmcnt(0)
s_barrier
s_branch L_restart
Lro_477:
s_mov_b32 s66, -1
s_mov_b32 s94, 0
s_mov_b32 s95, 0
s_mov_b32 s85, 1
s_mov_b32 s86, 0
s_mov_b32 s87, 15
v_mov_b32 v8, 0
v_mov_b32 v17, 24576
v_min_u32 v6, 2, v0
v_lshlrev_b32 v6, 7, v6
s_mov_b32 s92, 160
Lgp_478:
buffer_load_dword v5, v3, s[12:15], s92 offen sc1
s_waitcnt vmcnt(0)
v_readfirstlane_b32 s93, v5
s_nop 0
s_cmp_ge_u32 s93, 10
s_cbranch_scc1 Lgd_479
s_sleep 8
s_cmp_eq_u32 s65, 0
s_cbranch_scc1 Lgd_479
s_sub_u32 s65, s65, 1
s_branch Lgp_478
Lgd_479:
s_cmp_gt_u32 s78, s95
s_cbranch_scc1 Lyd_481
Lyp_480:
buffer_load_dword v5, v6, s[8:11], s79 offen sc1
s_waitcnt vmcnt(0)
v_readlane_b32 s81, v5, 0
v_readlane_b32 s82, v5, 1
v_readlane_b32 s83, v5, 2
s_min_u32 s81, s81, s82
s_min_u32 s78, s81, s83
s_cmp_gt_u32 s78, s95
s_cbranch_scc1 Lyd_481
s_sleep 2
s_cmp_eq_u32 s65, 0
s_cbranch_scc1 Lyd_481
s_sub_u32 s65, s65, 1
s_branch Lyp_480
Lyd_481:
s_andn2_b32 s81, 1, s66
s_mul_i32 s81, s81, 12288
s_add_u32 s81, s81, s80
s_mul_i32 s82, s94, 491520
s_add_u32 s82, s82, s77
s_add_u32 m0, s81, 0
s_add_u32 s73, s82, 0
buffer_load_dwordx4 v1, s[8:11], s73 offen offset:0 sc1 lds
buffer_load_dwordx4 v1, s[8:11], s73 offen offset:1024 sc1 lds
buffer_load_dwordx4 v1, s[8:11], s73 offen offset:2048 sc1 lds
buffer_load_dwordx4 v1, s[8:11], s73 offen offset:3072 sc1 lds
s_add_u32 m0, s81, 4096
s_add_u32 s73, s82, 4096
buffer_load_dwordx4 v1, s[8:11], s73 offen offset:0 sc1 lds
buffer_load_dwordx4 v1, s[8:11], s73 offen offset:1024 sc1 lds
s_waitcnt vmcnt(0)
Ly_482:
s_add_u32 s66, s66, 1
s_mov_b32 s84, s94
s_mov_b32 s88, s95
s_and_b32 s81, s66, 1
s_mul_i32 s81, s81, 12288
v_add_u32 v7, s81, v1
s_mul_i32 s90, s84, 1638400
s_add_u32 s90, s90, s76
s_sub_u32 s91, s84, 64
s_mul_i32 s91, s91, 1310720
s_add_u32 s91, s91, s89
s_barrier
ds_read_b128 v[64:67], v7 offset:0
ds_read_b128 v[88:91], v7 offset:6144
ds_read_b128 v[68:71], v7 offset:1024
ds_read_b128 v[92:95], v7 offset:7168
ds_read_b128 v[72:75], v7 offset:2048
ds_read_b128 v[96:99], v7 offset:8192
ds_read_b128 v[76:79], v7 offset:3072
ds_read_b128 v[100:103], v7 offset:9216
ds_read_b128 v[80:83], v7 offset:4096
ds_read_b128 v[104:107], v7 offset:10240
ds_read_b128 v[84:87], v7 offset:5120
ds_read_b128 v[108:111], v7 offset:11264
s_add_u32 s95, s88, 1
s_cmp_lg_u32 s87, 0
s_cbranch_scc1 Lyn_488
s_add_u32 s94, s86, 64
s_add_u32 s86, s86, 1
s_cmp_lt_u32 s85, 64
s_cselect_b32 s87, 4, 0
s_cmp_lt_u32 s63, 32
s_cbranch_scc1 Lyg_489
s_mov_b32 s94, 80
s_cmp_ge_u32 s85, 64
s_cbranch_scc1 Lyg_489
s_add_u32 s95, s95, 1
Lyn_488:
s_mov_b32 s94, s85
s_add_u32 s85, s85, 1
s_sub_u32 s87, s87, 1
Lyg_489:
s_cmp_ge_u32 s84, 64
s_cbranch_scc1 Ly_483
s_waitcnt lgkmcnt(11)
v_mfma_f32_16x16x32_bf16 v[112:115], v[64:67], a[0:3], 0
s_waitcnt lgkmcnt(10)
v_mfma_f32_16x16x32_bf16 v[116:119], v[88:91], a[0:3], 0
s_waitcnt lgkmcnt(9)
v_mfma_f32_16x16x32_bf16 v[112:115], v[68:71], a[4:7], v[112:115]
s_waitcnt lgkmcnt(8)
v_mfma_f32_16x16x32_bf16 v[116:119], v[92:95], a[4:7], v[116:119]
s_waitcnt lgkmcnt(7)
v_mfma_f32_16x16x32_bf16 v[112:115], v[72:75], a[8:11], v[112:115]
s_waitcnt lgkmcnt(6)
v_mfma_f32_16x16x32_bf16 v[116:119], v[96:99], a[8:11], v[116:119]
s_waitcnt lgkmcnt(5)
v_mfma_f32_16x16x32_bf16 v[112:115], v[76:79], a[12:15], v[112:115]
s_waitcnt lgkmcnt(4)
v_mfma_f32_16x16x32_bf16 v[116:119], v[100:103], a[12:15], v[116:119]
s_waitcnt lgkmcnt(3)
v_mfma_f32_16x16x32_bf16 v[112:115], v[80:83], a[16:19], v[112:115]
s_waitcnt lgkmcnt(2)
v_mfma_f32_16x16x32_bf16 v[116:119], v[104:107], a[16:19], v[116:119]
s_waitcnt lgkmcnt(1)
v_mfma_f32_16x16x32_bf16 v[112:115], v[84:87], a[20:23], v[112:115]
s_waitcnt lgkmcnt(0)
v_mfma_f32_16x16x32_bf16 v[116:119], v[108:111], a[20:23], v[116:119]
v_mfma_f32_16x16x32_bf16 v[120:123], v[64:67], a[24:27], 0
v_mfma_f32_16x16x32_bf16 v[124:127], v[88:91], a[24:27], 0
v_mfma_f32_16x16x32_bf16 v[120:123], v[68:71], a[28:31], v[120:123]
v_mfma_f32_16x16x32_bf16 v[124:127], v[92:95], a[28:31], v[124:127]
v_mfma_f32_16x16x32_bf16 v[120:123], v[72:75], a[32:35], v[120:123]
s_add_u32 s83, s90, 0
v_mfma_f32_16x16x32_bf16 v[124:127], v[96:99], a[32:35], v[124:127]
v_cvt_pk_bf16_f32 v128, v112, v113
v_mfma_f32_16x16x32_bf16 v[120:123], v[76:79], a[36:39], v[120:123]
v_cvt_pk_bf16_f32 v129, v114, v115
v_mfma_f32_16x16x32_bf16 v[124:127], v[100:103], a[36:39], v[124:127]
v_cvt_pk_bf16_f32 v130, v116, v117
v_mfma_f32_16x16x32_bf16 v[120:123], v[80:83], a[40:43], v[120:123]
v_cvt_pk_bf16_f32 v131, v118, v119
v_mfma_f32_16x16x32_bf16 v[124:127], v[104:107], a[40:43], v[124:127]
buffer_store_dwordx4 v[128:131], v1, s[8:11], s83 offen sc1
v_mfma_f32_16x16x32_bf16 v[120:123], v[84:87], a[44:47], v[120:123]
v_mfma_f32_16x16x32_bf16 v[124:127], v[108:111], a[44:47], v[124:127]
v_mfma_f32_16x16x32_bf16 v[112:115], v[64:67], a[48:51], 0
buffer_load_dword v5, v6, s[8:11], s79 offen sc1
v_mfma_f32_16x16x32_bf16 v[116:119], v[88:91], a[48:51], 0
v_mfma_f32_16x16x32_bf16 v[112:115], v[68:71], a[52:55], v[112:115]
v_mfma_f32_16x16x32_bf16 v[116:119], v[92:95], a[52:55], v[116:119]
v_mfma_f32_16x16x32_bf16 v[112:115], v[72:75], a[56:59], v[112:115]
s_add_u32 s83, s90, 40960
v_mfma_f32_16x16x32_bf16 v[116:119], v[96:99], a[56:59], v[116:119]
v_cvt_pk_bf16_f32 v132, v120, v121
v_mfma_f32_16x16x32_bf16 v[112:115], v[76:79], a[60:63], v[112:115]
v_cvt_pk_bf16_f32 v133, v122, v123
v_mfma_f32_16x16x32_bf16 v[116:119], v[100:103], a[60:63], v[116:119]
v_cvt_pk_bf16_f32 v134, v124, v125
v_mfma_f32_16x16x32_bf16 v[112:115], v[80:83], a[64:67], v[112:115]
v_cvt_pk_bf16_f32 v135, v126, v127
v_mfma_f32_16x16x32_bf16 v[116:119], v[104:107], a[64:67], v[116:119]
buffer_store_dwordx4 v[132:135], v1, s[8:11], s83 offen sc1
v_mfma_f32_16x16x32_bf16 v[112:115], v[84:87], a[68:71], v[112:115]
v_mfma_f32_16x16x32_bf16 v[116:119], v[108:111], a[68:71], v[116:119]
v_mfma_f32_16x16x32_bf16 v[120:123], v[64:67], a[72:75], 0
v_mfma_f32_16x16x32_bf16 v[124:127], v[88:91], a[72:75], 0
v_mfma_f32_16x16x32_bf16 v[120:123], v[68:71], a[76:79], v[120:123]
v_mfma_f32_16x16x32_bf16 v[124:127], v[92:95], a[76:79], v[124:127]
v_mfma_f32_16x16x32_bf16 v[120:123], v[72:75], a[80:83], v[120:123]
s_add_u32 s83, s90, 81920
v_mfma_f32_16x16x32_bf16 v[124:127], v[96:99], a[80:83], v[124:127]
v_cvt_pk_bf16_f32 v136, v112, v113
v_mfma_f32_16x16x32_bf16 v[120:123], v[76:79], a[84:87], v[120:123]
v_cvt_pk_bf16_f32 v137, v114, v115
v_mfma_f32_16x16x32_bf16 v[124:127], v[100:103], a[84:87], v[124:127]
v_cvt_pk_bf16_f32 v138, v116, v117
v_mfma_f32_16x16x32_bf16 v[120:123], v[80:83], a[88:91], v[120:123]
v_cvt_pk_bf16_f32 v139, v118, v119
v_mfma_f32_16x16x32_bf16 v[124:127], v[104:107], a[88:91], v[124:127]
buffer_store_dwordx4 v[136:139], v1, s[8:11], s83 offen sc1
v_mfma_f32_16x16x32_bf16 v[120:123], v[84:87], a[92:95], v[120:123]
v_mfma_f32_16x16x32_bf16 v[124:127], v[108:111], a[92:95], v[124:127]
v_mfma_f32_16x16x32_bf16 v[112:115], v[64:67], a[96:99], 0
v_mfma_f32_16x16x32_bf16 v[116:119], v[88:91], a[96:99], 0
v_mfma_f32_16x16x32_bf16 v[112:115], v[68:71], a[100:103], v[112:115]
v_mfma_f32_16x16x32_bf16 v[116:119], v[92:95], a[100:103], v[116:119]
v_mfma_f32_16x16x32_bf16 v[112:115], v[72:75], a[104:107], v[112:115]
s_add_u32 s83, s90, 122880
v_mfma_f32_16x16x32_bf16 v[116:119], v[96:99], a[104:107], v[116:119]
v_cvt_pk_bf16_f32 v140, v120, v121
v_mfma_f32_16x16x32_bf16 v[112:115], v[76:79], a[108:111], v[112:115]
v_cvt_pk_bf16_f32 v141, v122, v123
v_mfma_f32_16x16x32_bf16 v[116:119], v[100:103], a[108:111], v[116:119]
v_cvt_pk_bf16_f32 v142, v124, v125
v_mfma_f32_16x16x32_bf16 v[112:115], v[80:83], a[112:115], v[112:115]
v_cvt_pk_bf16_f32 v143, v126, v127
v_mfma_f32_16x16x32_bf16 v[116:119], v[104:107], a[112:115], v[116:119]
buffer_store_dwordx4 v[140:143], v1, s[8:11], s83 offen sc1
v_mfma_f32_16x16x32_bf16 v[112:115], v[84:87], a[116:119], v[112:115]
v_mfma_f32_16x16x32_bf16 v[116:119], v[108:111], a[116:119], v[116:119]
v_mfma_f32_16x16x32_bf16 v[120:123], v[64:67], a[120:123], 0
v_mfma_f32_16x16x32_bf16 v[124:127], v[88:91], a[120:123], 0
v_mfma_f32_16x16x32_bf16 v[120:123], v[68:71], a[124:127], v[120:123]
v_mfma_f32_16x16x32_bf16 v[124:127], v[92:95], a[124:127], v[124:127]
v_mfma_f32_16x16x32_bf16 v[120:123], v[72:75], a[128:131], v[120:123]
s_add_u32 s83, s90, 655360
v_mfma_f32_16x16x32_bf16 v[124:127], v[96:99], a[128:131], v[124:127]
v_cvt_pk_bf16_f32 v128, v112, v113
v_mfma_f32_16x16x32_bf16 v[120:123], v[76:79], a[132:135], v[120:123]
v_cvt_pk_bf16_f32 v129, v114, v115
v_mfma_f32_16x16x32_bf16 v[124:127], v[100:103], a[132:135], v[124:127]
v_cvt_pk_bf16_f32 v130, v116, v117
v_mfma_f32_16x16x32_bf16 v[120:123], v[80:83], a[136:139], v[120:123]
v_cvt_pk_bf16_f32 v131, v118, v119
v_mfma_f32_16x16x32_bf16 v[124:127], v[104:107], a[136:139], v[124:127]
buffer_store_dwordx4 v[128:131], v1, s[8:11], s83 offen sc1
v_mfma_f32_16x16x32_bf16 v[120:123], v[84:87], a[140:143], v[120:123]
v_mfma_f32_16x16x32_bf16 v[124:127], v[108:111], a[140:143], v[124:127]
v_mfma_f32_16x16x32_bf16 v[112:115], v[64:67], a[144:147], 0
s_waitcnt vmcnt(4)
v_readlane_b32 s81, v5, 0
v_readlane_b32 s82, v5, 1
v_readlane_b32 s83, v5, 2
s_min_u32 s81, s81, s82
s_min_u32 s78, s81, s83
s_mov_b32 s64, 0
s_cmp_le_u32 s78, s95
s_cbranch_scc1 Lyf_490
s_cmp_ge_u32 s94, 79
s_cbranch_scc1 Lyf_490
s_andn2_b32 s81, 1, s66
s_mul_i32 s81, s81, 12288
s_add_u32 s81, s81, s80
s_mul_i32 s82, s94, 491520
s_add_u32 s82, s82, s77
s_add_u32 m0, s81, 0
s_add_u32 s73, s82, 0
buffer_load_dwordx4 v1, s[8:11], s73 offen offset:0 sc1 lds
buffer_load_dwordx4 v1, s[8:11], s73 offen offset:1024 sc1 lds
buffer_load_dwordx4 v1, s[8:11], s73 offen offset:2048 sc1 lds
buffer_load_dwordx4 v1, s[8:11], s73 offen offset:3072 sc1 lds
s_add_u32 m0, s81, 4096
s_add_u32 s73, s82, 4096
buffer_load_dwordx4 v1, s[8:11], s73 offen offset:0 sc1 lds
buffer_load_dwordx4 v1, s[8:11], s73 offen offset:1024 sc1 lds
s_mov_b32 s64, 1
Lyf_490:
v_mov_b32 v18, s64
ds_write_b32 v17, v18
v_mfma_f32_16x16x32_bf16 v[116:119], v[88:91], a[144:147], 0
v_mfma_f32_16x16x32_bf16 v[112:115], v[68:71], a[148:151], v[112:115]
v_mfma_f32_16x16x32_bf16 v[116:119], v[92:95], a[148:151], v[116:119]
v_mfma_f32_16x16x32_bf16 v[112:115], v[72:75], a[152:155], v[112:115]
s_add_u32 s83, s90, 696320
v_mfma_f32_16x16x32_bf16 v[116:119], v[96:99], a[152:155], v[116:119]
v_cvt_pk_bf16_f32 v132, v120, v121
v_mfma_f32_16x16x32_bf16 v[112:115], v[76:79], a[156:159], v[112:115]
v_cvt_pk_bf16_f32 v133, v122, v123
v_mfma_f32_16x16x32_bf16 v[116:119], v[100:103], a[156:159], v[116:119]
v_cvt_pk_bf16_f32 v134, v124, v125
v_mfma_f32_16x16x32_bf16 v[112:115], v[80:83], a[160:163], v[112:115]
v_cvt_pk_bf16_f32 v135, v126, v127
v_mfma_f32_16x16x32_bf16 v[116:119], v[104:107], a[160:163], v[116:119]
buffer_store_dwordx4 v[132:135], v1, s[8:11], s83 offen sc1
v_mfma_f32_16x16x32_bf16 v[112:115], v[84:87], a[164:167], v[112:115]
v_mfma_f32_16x16x32_bf16 v[116:119], v[108:111], a[164:167], v[116:119]
v_mfma_f32_16x16x32_bf16 v[120:123], v[64:67], a[168:171], 0
v_mfma_f32_16x16x32_bf16 v[124:127], v[88:91], a[168:171], 0
v_mfma_f32_16x16x32_bf16 v[120:123], v[68:71], a[172:175], v[120:123]
v_mfma_f32_16x16x32_bf16 v[124:127], v[92:95], a[172:175], v[124:127]
v_mfma_f32_16x16x32_bf16 v[120:123], v[72:75], a[176:179], v[120:123]
s_add_u32 s83, s90, 737280
v_mfma_f32_16x16x32_bf16 v[124:127], v[96:99], a[176:179], v[124:127]
v_cvt_pk_bf16_f32 v136, v112, v113
v_mfma_f32_16x16x32_bf16 v[120:123], v[76:79], a[180:183], v[120:123]
v_cvt_pk_bf16_f32 v137, v114, v115
v_mfma_f32_16x16x32_bf16 v[124:127], v[100:103], a[180:183], v[124:127]
v_cvt_pk_bf16_f32 v138, v116, v117
v_mfma_f32_16x16x32_bf16 v[120:123], v[80:83], a[184:187], v[120:123]
v_cvt_pk_bf16_f32 v139, v118, v119
v_mfma_f32_16x16x32_bf16 v[124:127], v[104:107], a[184:187], v[124:127]
buffer_store_dwordx4 v[136:139], v1, s[8:11], s83 offen sc1
v_mfma_f32_16x16x32_bf16 v[120:123], v[84:87], a[188:191], v[120:123]
v_mfma_f32_16x16x32_bf16 v[124:127], v[108:111], a[188:191], v[124:127]
s_add_u32 s83, s90, 778240
s_nop 2
v_cvt_pk_bf16_f32 v140, v120, v121
v_cvt_pk_bf16_f32 v141, v122, v123
s_nop 1
v_cvt_pk_bf16_f32 v142, v124, v125
v_cvt_pk_bf16_f32 v143, v126, v127
buffer_store_dwordx4 v[140:143], v1, s[8:11], s83 offen sc1
s_branch Ly_484
Ly_483:
s_waitcnt lgkmcnt(11)
v_mfma_f32_16x16x32_bf16 v[112:115], v[64:67], a[0:3], 0
s_waitcnt lgkmcnt(10)
v_mfma_f32_16x16x32_bf16 v[116:119], v[88:91], a[0:3], 0
s_waitcnt lgkmcnt(9)
v_mfma_f32_16x16x32_bf16 v[112:115], v[68:71], a[4:7], v[112:115]
s_waitcnt lgkmcnt(8)
v_mfma_f32_16x16x32_bf16 v[116:119], v[92:95], a[4:7], v[116:119]
s_waitcnt lgkmcnt(7)
v_mfma_f32_16x16x32_bf16 v[112:115], v[72:75], a[8:11], v[112:115]
s_waitcnt lgkmcnt(6)
v_mfma_f32_16x16x32_bf16 v[116:119], v[96:99], a[8:11], v[116:119]
s_waitcnt lgkmcnt(5)
v_mfma_f32_16x16x32_bf16 v[112:115], v[76:79], a[12:15], v[112:115]
s_waitcnt lgkmcnt(4)
v_mfma_f32_16x16x32_bf16 v[116:119], v[100:103], a[12:15], v[116:119]
s_waitcnt lgkmcnt(3)
v_mfma_f32_16x16x32_bf16 v[112:115], v[80:83], a[16:19], v[112:115]
s_waitcnt lgkmcnt(2)
v_mfma_f32_16x16x32_bf16 v[116:119], v[104:107], a[16:19], v[116:119]
s_waitcnt lgkmcnt(1)
v_mfma_f32_16x16x32_bf16 v[112:115], v[84:87], a[20:23], v[112:115]
s_waitcnt lgkmcnt(0)
v_mfma_f32_16x16x32_bf16 v[116:119], v[108:111], a[20:23], v[116:119]
v_mfma_f32_16x16x32_bf16 v[120:123], v[64:67], a[24:27], 0
v_mfma_f32_16x16x32_bf16 v[124:127], v[88:91], a[24:27], 0
v_mfma_f32_16x16x32_bf16 v[120:123], v[68:71], a[28:31], v[120:123]
v_mfma_f32_16x16x32_bf16 v[124:127], v[92:95], a[28:31], v[124:127]
v_mfma_f32_16x16x32_bf16 v[120:123], v[72:75], a[32:35], v[120:123]
s_add_u32 s82, s91, 0
v_mfma_f32_16x16x32_bf16 v[124:127], v[96:99], a[32:35], v[124:127]
s_add_u32 s83, s91, 655360
v_mfma_f32_16x16x32_bf16 v[120:123], v[76:79], a[36:39], v[120:123]
v_cvt_pk_bf16_f32 v128, v112, v113
v_mfma_f32_16x16x32_bf16 v[124:127], v[100:103], a[36:39], v[124:127]
v_cvt_pk_bf16_f32 v129, v114, v115
v_mfma_f32_16x16x32_bf16 v[120:123], v[80:83], a[40:43], v[120:123]
v_cvt_pk_bf16_f32 v130, v116, v117
v_mfma_f32_16x16x32_bf16 v[124:127], v[104:107], a[40:43], v[124:127]
v_cvt_pk_bf16_f32 v131, v118, v119
v_mfma_f32_16x16x32_bf16 v[120:123], v[84:87], a[44:47], v[120:123]
buffer_store_dwordx2 v[128:129], v16, s[8:11], s82 offen offset:0 sc1
v_mfma_f32_16x16x32_bf16 v[124:127], v[108:111], a[44:47], v[124:127]
buffer_store_dwordx2 v[130:131], v16, s[8:11], s83 offen offset:0 sc1
v_mfma_f32_16x16x32_bf16 v[112:115], v[64:67], a[48:51], 0
buffer_load_dword v5, v6, s[8:11], s79 offen sc1
v_mfma_f32_16x16x32_bf16 v[116:119], v[88:91], a[48:51], 0
v_mfma_f32_16x16x32_bf16 v[112:115], v[68:71], a[52:55], v[112:115]
v_mfma_f32_16x16x32_bf16 v[116:119], v[92:95], a[52:55], v[116:119]
v_mfma_f32_16x16x32_bf16 v[112:115], v[72:75], a[56:59], v[112:115]
v_cvt_pk_bf16_f32 v132, v120, v121
v_mfma_f32_16x16x32_bf16 v[116:119], v[96:99], a[56:59], v[116:119]
v_cvt_pk_bf16_f32 v133, v122, v123
v_mfma_f32_16x16x32_bf16 v[112:115], v[76:79], a[60:63], v[112:115]
v_cvt_pk_bf16_f32 v134, v124, v125
v_mfma_f32_16x16x32_bf16 v[116:119], v[100:103], a[60:63], v[116:119]
v_cvt_pk_bf16_f32 v135, v126, v127
v_mfma_f32_16x16x32_bf16 v[112:115], v[80:83], a[64:67], v[112:115]
buffer_store_dwordx2 v[132:133], v16, s[8:11], s82 offen offset:256 sc1
v_mfma_f32_16x16x32_bf16 v[116:119], v[104:107], a[64:67], v[116:119]
buffer_store_dwordx2 v[134:135], v16, s[8:11], s83 offen offset:256 sc1
v_mfma_f32_16x16x32_bf16 v[112:115], v[84:87], a[68:71], v[112:115]
v_mfma_f32_16x16x32_bf16 v[116:119], v[108:111], a[68:71], v[116:119]
v_mfma_f32_16x16x32_bf16 v[120:123], v[64:67], a[72:75], 0
v_mfma_f32_16x16x32_bf16 v[124:127], v[88:91], a[72:75], 0
v_mfma_f32_16x16x32_bf16 v[120:123], v[68:71], a[76:79], v[120:123]
v_mfma_f32_16x16x32_bf16 v[124:127], v[92:95], a[76:79], v[124:127]
v_mfma_f32_16x16x32_bf16 v[120:123], v[72:75], a[80:83], v[120:123]
v_cvt_pk_bf16_f32 v136, v112, v113
v_mfma_f32_16x16x32_bf16 v[124:127], v[96:99], a[80:83], v[124:127]
v_cvt_pk_bf16_f32 v137, v114, v115
v_mfma_f32_16x16x32_bf16 v[120:123], v[76:79], a[84:87], v[120:123]
v_cvt_pk_bf16_f32 v138, v116, v117
v_mfma_f32_16x16x32_bf16 v[124:127], v[100:103], a[84:87], v[124:127]
v_cvt_pk_bf16_f32 v139, v118, v119
v_mfma_f32_16x16x32_bf16 v[120:123], v[80:83], a[88:91], v[120:123]
buffer_store_dwordx2 v[136:137], v16, s[8:11], s82 offen offset:512 sc1
v_mfma_f32_16x16x32_bf16 v[124:127], v[104:107], a[88:91], v[124:127]
buffer_store_dwordx2 v[138:139], v16, s[8:11], s83 offen offset:512 sc1
v_mfma_f32_16x16x32_bf16 v[120:123], v[84:87], a[92:95], v[120:123]
v_mfma_f32_16x16x32_bf16 v[124:127], v[108:111], a[92:95], v[124:127]
v_mfma_f32_16x16x32_bf16 v[112:115], v[64:67], a[96:99], 0
v_mfma_f32_16x16x32_bf16 v[116:119], v[88:91], a[96:99], 0
v_mfma_f32_16x16x32_bf16 v[112:115], v[68:71], a[100:103], v[112:115]
v_mfma_f32_16x16x32_bf16 v[116:119], v[92:95], a[100:103], v[116:119]
v_mfma_f32_16x16x32_bf16 v[112:115], v[72:75], a[104:107], v[112:115]
v_cvt_pk_bf16_f32 v140, v120, v121
v_mfma_f32_16x16x32_bf16 v[116:119], v[96:99], a[104:107], v[116:119]
v_cvt_pk_bf16_f32 v141, v122, v123
v_mfma_f32_16x16x32_bf16 v[112:115], v[76:79], a[108:111], v[112:115]
v_cvt_pk_bf16_f32 v142, v124, v125
v_mfma_f32_16x16x32_bf16 v[116:119], v[100:103], a[108:111], v[116:119]
v_cvt_pk_bf16_f32 v143, v126, v127
v_mfma_f32_16x16x32_bf16 v[112:115], v[80:83], a[112:115], v[112:115]
buffer_store_dwordx2 v[140:141], v16, s[8:11], s82 offen offset:768 sc1
v_mfma_f32_16x16x32_bf16 v[116:119], v[104:107], a[112:115], v[116:119]
buffer_store_dwordx2 v[142:143], v16, s[8:11], s83 offen offset:768 sc1
v_mfma_f32_16x16x32_bf16 v[112:115], v[84:87], a[116:119], v[112:115]
v_mfma_f32_16x16x32_bf16 v[116:119], v[108:111], a[116:119], v[116:119]
v_mfma_f32_16x16x32_bf16 v[120:123], v[64:67], a[120:123], 0
v_mfma_f32_16x16x32_bf16 v[124:127], v[88:91], a[120:123], 0
v_mfma_f32_16x16x32_bf16 v[120:123], v[68:71], a[124:127], v[120:123]
v_mfma_f32_16x16x32_bf16 v[124:127], v[92:95], a[124:127], v[124:127]
v_mfma_f32_16x16x32_bf16 v[120:123], v[72:75], a[128:131], v[120:123]
s_add_u32 s82, s91, 4096
v_mfma_f32_16x16x32_bf16 v[124:127], v[96:99], a[128:131], v[124:127]
s_add_u32 s83, s91, 659456
v_mfma_f32_16x16x32_bf16 v[120:123], v[76:79], a[132:135], v[120:123]
v_cvt_pk_bf16_f32 v128, v112, v113
v_mfma_f32_16x16x32_bf16 v[124:127], v[100:103], a[132:135], v[124:127]
v_cvt_pk_bf16_f32 v129, v114, v115
v_mfma_f32_16x16x32_bf16 v[120:123], v[80:83], a[136:139], v[120:123]
v_cvt_pk_bf16_f32 v130, v116, v117
v_mfma_f32_16x16x32_bf16 v[124:127], v[104:107], a[136:139], v[124:127]
v_cvt_pk_bf16_f32 v131, v118, v119
v_mfma_f32_16x16x32_bf16 v[120:123], v[84:87], a[140:143], v[120:123]
buffer_store_dwordx2 v[128:129], v16, s[8:11], s82 offen offset:0 sc1
v_mfma_f32_16x16x32_bf16 v[124:127], v[108:111], a[140:143], v[124:127]
buffer_store_dwordx2 v[130:131], v16, s[8:11], s83 offen offset:0 sc1
v_mfma_f32_16x16x32_bf16 v[112:115], v[64:67], a[144:147], 0
s_waitcnt vmcnt(8)
v_readlane_b32 s81, v5, 0
v_readlane_b32 s82, v5, 1
v_readlane_b32 s83, v5, 2
s_min_u32 s81, s81, s82
s_min_u32 s78, s81, s83
s_mov_b32 s64, 0
s_cmp_le_u32 s78, s95
s_cbranch_scc1 Lyf_491
s_cmp_ge_u32 s94, 79
s_cbranch_scc1 Lyf_491
s_andn2_b32 s81, 1, s66
s_mul_i32 s81, s81, 12288
s_add_u32 s81, s81, s80
s_mul_i32 s82, s94, 491520
s_add_u32 s82, s82, s77
s_add_u32 m0, s81, 0
s_add_u32 s73, s82, 0
buffer_load_dwordx4 v1, s[8:11], s73 offen offset:0 sc1 lds
buffer_load_dwordx4 v1, s[8:11], s73 offen offset:1024 sc1 lds
buffer_load_dwordx4 v1, s[8:11], s73 offen offset:2048 sc1 lds
buffer_load_dwordx4 v1, s[8:11], s73 offen offset:3072 sc1 lds
s_add_u32 m0, s81, 4096
s_add_u32 s73, s82, 4096
buffer_load_dwordx4 v1, s[8:11], s73 offen offset:0 sc1 lds
buffer_load_dwordx4 v1, s[8:11], s73 offen offset:1024 sc1 lds
s_mov_b32 s64, 1
Lyf_491:
v_mov_b32 v18, s64
ds_write_b32 v17, v18
s_add_u32 s82, s91, 4096
s_add_u32 s83, s91, 659456
v_mfma_f32_16x16x32_bf16 v[116:119], v[88:91], a[144:147], 0
v_mfma_f32_16x16x32_bf16 v[112:115], v[68:71], a[148:151], v[112:115]
v_mfma_f32_16x16x32_bf16 v[116:119], v[92:95], a[148:151], v[116:119]
v_mfma_f32_16x16x32_bf16 v[112:115], v[72:75], a[152:155], v[112:115]
v_cvt_pk_bf16_f32 v132, v120, v121
v_mfma_f32_16x16x32_bf16 v[116:119], v[96:99], a[152:155], v[116:119]
v_cvt_pk_bf16_f32 v133, v122, v123
v_mfma_f32_16x16x32_bf16 v[112:115], v[76:79], a[156:159], v[112:115]
v_cvt_pk_bf16_f32 v134, v124, v125
v_mfma_f32_16x16x32_bf16 v[116:119], v[100:103], a[156:159], v[116:119]
v_cvt_pk_bf16_f32 v135, v126, v127
v_mfma_f32_16x16x32_bf16 v[112:115], v[80:83], a[160:163], v[112:115]
buffer_store_dwordx2 v[132:133], v16, s[8:11], s82 offen offset:256 sc1
v_mfma_f32_16x16x32_bf16 v[116:119], v[104:107], a[160:163], v[116:119]
buffer_store_dwordx2 v[134:135], v16, s[8:11], s83 offen offset:256 sc1
v_mfma_f32_16x16x32_bf16 v[112:115], v[84:87], a[164:167], v[112:115]
v_mfma_f32_16x16x32_bf16 v[116:119], v[108:111], a[164:167], v[116:119]
v_mfma_f32_16x16x32_bf16 v[120:123], v[64:67], a[168:171], 0
v_mfma_f32_16x16x32_bf16 v[124:127], v[88:91], a[168:171], 0
v_mfma_f32_16x16x32_bf16 v[120:123], v[68:71], a[172:175], v[120:123]
v_mfma_f32_16x16x32_bf16 v[124:127], v[92:95], a[172:175], v[124:127]
v_mfma_f32_16x16x32_bf16 v[120:123], v[72:75], a[176:179], v[120:123]
v_cvt_pk_bf16_f32 v136, v112, v113
v_mfma_f32_16x16x32_bf16 v[124:127], v[96:99], a[176:179], v[124:127]
v_cvt_pk_bf16_f32 v137, v114, v115
v_mfma_f32_16x16x32_bf16 v[120:123], v[76:79], a[180:183], v[120:123]
v_cvt_pk_bf16_f32 v138, v116, v117
v_mfma_f32_16x16x32_bf16 v[124:127], v[100:103], a[180:183], v[124:127]
v_cvt_pk_bf16_f32 v139, v118, v119
v_mfma_f32_16x16x32_bf16 v[120:123], v[80:83], a[184:187], v[120:123]
buffer_store_dwordx2 v[136:137], v16, s[8:11], s82 offen offset:512 sc1
v_mfma_f32_16x16x32_bf16 v[124:127], v[104:107], a[184:187], v[124:127]
buffer_store_dwordx2 v[138:139], v16, s[8:11], s83 offen offset:512 sc1
v_mfma_f32_16x16x32_bf16 v[120:123], v[84:87], a[188:191], v[120:123]
v_mfma_f32_16x16x32_bf16 v[124:127], v[108:111], a[188:191], v[124:127]
s_nop 3
v_cvt_pk_bf16_f32 v140, v120, v121
v_cvt_pk_bf16_f32 v141, v122, v123
s_nop 1
v_cvt_pk_bf16_f32 v142, v124, v125
v_cvt_pk_bf16_f32 v143, v126, v127
buffer_store_dwordx2 v[140:141], v16, s[8:11], s82 offen offset:768 sc1
buffer_store_dwordx2 v[142:143], v16, s[8:11], s83 offen offset:768 sc1
Ly_484:
s_add_u32 s81, s88, 1
v_mov_b32 v8, s81
s_cmp_ge_u32 s94, 79
s_cbranch_scc1 Ly_485
s_waitcnt vmcnt(0)
buffer_store_dword v8, v3, s[8:11], s75 offen sc1
s_cmp_lg_u32 s64, 0
s_cbranch_scc1 Ly_482
s_cmp_gt_u32 s78, s95
s_cbranch_scc1 Lyd_493
Lyp_492:
buffer_load_dword v5, v6, s[8:11], s79 offen sc1
s_waitcnt vmcnt(0)
v_readlane_b32 s81, v5, 0
v_readlane_b32 s82, v5, 1
v_readlane_b32 s83, v5, 2
s_min_u32 s81, s81, s82
s_min_u32 s78, s81, s83
s_cmp_gt_u32 s78, s95
s_cbranch_scc1 Lyd_493
s_sleep 2
s_cmp_eq_u32 s65, 0
s_cbranch_scc1 Lyd_493
s_sub_u32 s65, s65, 1
s_branch Lyp_492
Lyd_493:
s_andn2_b32 s81, 1, s66
s_mul_i32 s81, s81, 12288
s_add_u32 s81, s81, s80
s_mul_i32 s82, s94, 491520
s_add_u32 s82, s82, s77
s_add_u32 m0, s81, 0
s_add_u32 s73, s82, 0
buffer_load_dwordx4 v1, s[8:11], s73 offen offset:0 sc1 lds
buffer_load_dwordx4 v1, s[8:11], s73 offen offset:1024 sc1 lds
buffer_load_dwordx4 v1, s[8:11], s73 offen offset:2048 sc1 lds
buffer_load_dwordx4 v1, s[8:11], s73 offen offset:3072 sc1 lds
s_add_u32 m0, s81, 4096
s_add_u32 s73, s82, 4096
buffer_load_dwordx4 v1, s[8:11], s73 offen offset:0 sc1 lds
buffer_load_dwordx4 v1, s[8:11], s73 offen offset:1024 sc1 lds
s_waitcnt vmcnt(0)
s_branch Ly_482
Ly_485:
s_waitcnt vmcnt(0)
buffer_store_dword v8, v3, s[8:11], s75 offen sc1
s_sub_u32 s68, s63, 2
s_cmp_ge_u32 s63, 32
s_cbranch_scc1 L_f2
s_waitcnt vmcnt(0)
s_endpgm
Lfu_411:
s_mul_i32 s63, s67, 13
s_sub_u32 s63, s63, s69
s_add_u32 s63, s63, s68
s_sub_u32 s63, s63, s70
s_cmp_ge_u32 s63, 64
s_cbranch_scc1 Lz_495
s_mul_i32 s67, s3, 320
s_add_u32 s67, s67, 0
v_mov_b32 v5, s67
v_bfe_u32 v6, v0, 0, 4
s_mov_b32 s67, 1280
v_mad_i32_i24 v5, v6, s67, v5
v_bfe_u32 v6, v0, 4, 2
s_mov_b32 s67, 8
v_mad_i32_i24 v5, v6, s67, v5
s_mul_i32 s68, s63, 40960
s_add_u32 s69, s68, 20480
buffer_load_dwordx2 v[16:17], v5, s[20:23], s68 offen offset:0
buffer_load_dwordx2 v[18:19], v5, s[20:23], s68 offen offset:32
buffer_load_dwordx2 v[20:21], v5, s[20:23], s68 offen offset:64
buffer_load_dwordx2 v[22:23], v5, s[20:23], s68 offen offset:96
buffer_load_dwordx2 v[24:25], v5, s[20:23], s68 offen offset:128
buffer_load_dwordx2 v[26:27], v5, s[20:23], s68 offen offset:160
buffer_load_dwordx2 v[28:29], v5, s[20:23], s68 offen offset:192
buffer_load_dwordx2 v[30:31], v5, s[20:23], s68 offen offset:224
buffer_load_dwordx2 v[32:33], v5, s[20:23], s68 offen offset:256
buffer_load_dwordx2 v[34:35], v5, s[20:23], s68 offen offset:288
buffer_load_dwordx2 v[36:37], v5, s[20:23], s69 offen offset:0
buffer_load_dwordx2 v[38:39], v5, s[20:23], s69 offen offset:32
buffer_load_dwordx2 v[40:41], v5, s[20:23], s69 offen offset:64
buffer_load_dwordx2 v[42:43], v5, s[20:23], s69 offen offset:96
buffer_load_dwordx2 v[44:45], v5, s[20:23], s69 offen offset:128
buffer_load_dwordx2 v[46:47], v5, s[20:23], s69 offen offset:160
buffer_load_dwordx2 v[48:49], v5, s[20:23], s69 offen offset:192
buffer_load_dwordx2 v[50:51], v5, s[20:23], s69 offen offset:224
buffer_load_dwordx2 v[52:53], v5, s[20:23], s69 offen offset:256
buffer_load_dwordx2 v[54:55], v5, s[20:23], s69 offen offset:288
v_mov_b32 v241, 0
v_bfe_u32 v242, v0, 0, 4
s_mov_b32 s67, 16
v_mad_i32_i24 v241, v242, s67, v241
s_lshl_b32 s67, s3, 2
v_add_u32 v240, s67, v241
s_waitcnt vmcnt(10)
v_lshlrev_b32 v64, 16, v16
v_and_b32 v65, 0xffff0000, v16
v_lshlrev_b32 v66, 16, v17
v_and_b32 v67, 0xffff0000, v17
v_lshlrev_b32 v68, 16, v18
v_and_b32 v69, 0xffff0000, v18
v_lshlrev_b32 v70, 16, v19
v_and_b32 v71, 0xffff0000, v19
v_lshlrev_b32 v72, 16, v20
v_and_b32 v73, 0xffff0000, v20
v_lshlrev_b32 v74, 16, v21
v_and_b32 v75, 0xffff0000, v21
v_lshlrev_b32 v76, 16, v22
v_and_b32 v77, 0xffff0000, v22
v_lshlrev_b32 v78, 16, v23
v_and_b32 v79, 0xffff0000, v23
v_lshlrev_b32 v80, 16, v24
v_and_b32 v81, 0xffff0000, v24
v_lshlrev_b32 v82, 16, v25
v_and_b32 v83, 0xffff0000, v25
v_lshlrev_b32 v84, 16, v26
v_and_b32 v85, 0xffff0000, v26
v_lshlrev_b32 v86, 16, v27
v_and_b32 v87, 0xffff0000, v27
v_lshlrev_b32 v88, 16, v28
v_and_b32 v89, 0xffff0000, v28
v_lshlrev_b32 v90, 16, v29
v_and_b32 v91, 0xffff0000, v29
v_lshlrev_b32 v92, 16, v30
v_and_b32 v93, 0xffff0000, v30
v_lshlrev_b32 v94, 16, v31
v_and_b32 v95, 0xffff0000, v31
v_lshlrev_b32 v96, 16, v32
v_and_b32 v97, 0xffff0000, v32
v_lshlrev_b32 v98, 16, v33
v_and_b32 v99, 0xffff0000, v33
v_lshlrev_b32 v100, 16, v34
v_and_b32 v101, 0xffff0000, v34
v_lshlrev_b32 v102, 16, v35
v_and_b32 v103, 0xffff0000, v35
v_pk_add_f32 v[224:225], v[64:65], v[66:67]
v_pk_add_f32 v[224:225], v[224:225], v[68:69]
v_pk_add_f32 v[224:225], v[224:225], v[70:71]
v_pk_add_f32 v[224:225], v[224:225], v[72:73]
v_pk_add_f32 v[224:225], v[224:225], v[74:75]
v_pk_add_f32 v[224:225], v[224:225], v[76:77]
v_pk_add_f32 v[224:225], v[224:225], v[78:79]
v_pk_add_f32 v[224:225], v[224:225], v[80:81]
v_pk_add_f32 v[224:225], v[224:225], v[82:83]
v_pk_add_f32 v[224:225], v[224:225], v[84:85]
v_pk_add_f32 v[224:225], v[224:225], v[86:87]
v_pk_add_f32 v[224:225], v[224:225], v[88:89]
v_pk_add_f32 v[224:225], v[224:225], v[90:91]
v_pk_add_f32 v[224:225], v[224:225], v[92:93]
v_pk_add_f32 v[224:225], v[224:225], v[94:95]
v_pk_add_f32 v[224:225], v[224:225], v[96:97]
v_pk_add_f32 v[224:225], v[224:225], v[98:99]
v_pk_add_f32 v[224:225], v[224:225], v[100:101]
v_pk_add_f32 v[224:225], v[224:225], v[102:103]
s_waitcnt vmcnt(0)
v_lshlrev_b32 v104, 16, v36
v_and_b32 v105, 0xffff0000, v36
v_lshlrev_b32 v106, 16, v37
v_and_b32 v107, 0xffff0000, v37
v_lshlrev_b32 v108, 16, v38
v_and_b32 v109, 0xffff0000, v38
v_lshlrev_b32 v110, 16, v39
v_and_b32 v111, 0xffff0000, v39
v_lshlrev_b32 v112, 16, v40
v_and_b32 v113, 0xffff0000, v40
v_lshlrev_b32 v114, 16, v41
v_and_b32 v115, 0xffff0000, v41
v_lshlrev_b32 v116, 16, v42
v_and_b32 v117, 0xffff0000, v42
v_lshlrev_b32 v118, 16, v43
v_and_b32 v119, 0xffff0000, v43
v_lshlrev_b32 v120, 16, v44
v_and_b32 v121, 0xffff0000, v44
v_lshlrev_b32 v122, 16, v45
v_and_b32 v123, 0xffff0000, v45
v_lshlrev_b32 v124, 16, v46
v_and_b32 v125, 0xffff0000, v46
v_lshlrev_b32 v126, 16, v47
v_and_b32 v127, 0xffff0000, v47
v_lshlrev_b32 v128, 16, v48
v_and_b32 v129, 0xffff0000, v48
v_lshlrev_b32 v130, 16, v49
v_and_b32 v131, 0xffff0000, v49
v_lshlrev_b32 v132, 16, v50
v_and_b32 v133, 0xffff0000, v50
v_lshlrev_b32 v134, 16, v51
v_and_b32 v135, 0xffff0000, v51
v_lshlrev_b32 v136, 16, v52
v_and_b32 v137, 0xffff0000, v52
v_lshlrev_b32 v138, 16, v53
v_and_b32 v139, 0xffff0000, v53
v_lshlrev_b32 v140, 16, v54
v_and_b32 v141, 0xffff0000, v54
v_lshlrev_b32 v142, 16, v55
v_and_b32 v143, 0xffff0000, v55
v_pk_add_f32 v[232:233], v[104:105], v[106:107]
v_pk_add_f32 v[232:233], v[232:233], v[108:109]
v_pk_add_f32 v[232:233], v[232:233], v[110:111]
v_pk_add_f32 v[232:233], v[232:233], v[112:113]
v_pk_add_f32 v[232:233], v[232:233], v[114:115]
v_pk_add_f32 v[232:233], v[232:233], v[116:117]
v_pk_add_f32 v[232:233], v[232:233], v[118:119]
v_pk_add_f32 v[232:233], v[232:233], v[120:121]
v_pk_add_f32 v[232:233], v[232:233], v[122:123]
v_pk_add_f32 v[232:233], v[232:233], v[124:125]
v_pk_add_f32 v[232:233], v[232:233], v[126:127]
v_pk_add_f32 v[232:233], v[232:233], v[128:129]
v_pk_add_f32 v[232:233], v[232:233], v[130:131]
v_pk_add_f32 v[232:233], v[232:233], v[132:133]
v_pk_add_f32 v[232:233], v[232:233], v[134:135]
v_pk_add_f32 v[232:233], v[232:233], v[136:137]
v_pk_add_f32 v[232:233], v[232:233], v[138:139]
v_pk_add_f32 v[232:233], v[232:233], v[140:141]
v_pk_add_f32 v[232:233], v[232:233], v[142:143]
v_add_f32 v224, v224, v225
v_mov_b32 v242, v224
s_nop 1
v_permlane16_swap_b32 v224, v242
v_add_f32 v224, v224, v242
v_mov_b32 v242, v224
s_nop 1
v_permlane32_swap_b32 v224, v242
v_add_f32 v224, v224, v242
ds_write_b32 v240, v224 offset:0
v_add_f32 v232, v232, v233
v_mov_b32 v242, v232
s_nop 1
v_permlane16_swap_b32 v232, v242
v_add_f32 v232, v232, v242
v_mov_b32 v242, v232
s_nop 1
v_permlane32_swap_b32 v232, v242
v_add_f32 v232, v232, v242
ds_write_b32 v240, v232 offset:256
s_waitcnt lgkmcnt(0)
s_barrier
ds_read_b128 v[228:231], v241 offset:0
ds_read_b128 v[236:239], v241 offset:256
s_waitcnt lgkmcnt(0)
v_add_f32 v228, v228, v229
v_add_f32 v230, v230, v231
v_add_f32 v224, v228, v230
v_add_f32 v236, v236, v237
v_add_f32 v238, v238, v239
v_add_f32 v232, v236, v238
s_mov_b32 s67, 0xbacccccd
v_mul_f32 v224, s67, v224
v_mov_b32 v225, v224
v_pk_add_f32 v[144:145], v[64:65], v[224:225]
v_pk_add_f32 v[146:147], v[66:67], v[224:225]
v_pk_add_f32 v[148:149], v[68:69], v[224:225]
v_pk_add_f32 v[150:151], v[70:71], v[224:225]
v_pk_add_f32 v[152:153], v[72:73], v[224:225]
v_pk_add_f32 v[154:155], v[74:75], v[224:225]
v_pk_add_f32 v[156:157], v[76:77], v[224:225]
v_pk_add_f32 v[158:159], v[78:79], v[224:225]
v_pk_add_f32 v[160:161], v[80:81], v[224:225]
v_pk_add_f32 v[162:163], v[82:83], v[224:225]
v_pk_add_f32 v[164:165], v[84:85], v[224:225]
v_pk_add_f32 v[166:167], v[86:87], v[224:225]
v_pk_add_f32 v[168:169], v[88:89], v[224:225]
v_pk_add_f32 v[170:171], v[90:91], v[224:225]
v_pk_add_f32 v[172:173], v[92:93], v[224:225]
v_pk_add_f32 v[174:175], v[94:95], v[224:225]
v_pk_add_f32 v[176:177], v[96:97], v[224:225]
v_pk_add_f32 v[178:179], v[98:99], v[224:225]
v_pk_add_f32 v[180:181], v[100:101], v[224:225]
v_pk_add_f32 v[182:183], v[102:103], v[224:225]
v_pk_mul_f32 v[226:227], v[144:145], v[144:145]
v_pk_fma_f32 v[226:227], v[146:147], v[146:147], v[226:227]
v_pk_fma_f32 v[226:227], v[148:149], v[148:149], v[226:227]
v_pk_fma_f32 v[226:227], v[150:151], v[150:151], v[226:227]
v_pk_fma_f32 v[226:227], v[152:153], v[152:153], v[226:227]
v_pk_fma_f32 v[226:227], v[154:155], v[154:155], v[226:227]
v_pk_fma_f32 v[226:227], v[156:157], v[156:157], v[226:227]
v_pk_fma_f32 v[226:227], v[158:159], v[158:159], v[226:227]
v_pk_fma_f32 v[226:227], v[160:161], v[160:161], v[226:227]
v_pk_fma_f32 v[226:227], v[162:163], v[162:163], v[226:227]
v_pk_fma_f32 v[226:227], v[164:165], v[164:165], v[226:227]
v_pk_fma_f32 v[226:227], v[166:167], v[166:167], v[226:227]
v_pk_fma_f32 v[226:227], v[168:169], v[168:169], v[226:227]
v_pk_fma_f32 v[226:227], v[170:171], v[170:171], v[226:227]
v_pk_fma_f32 v[226:227], v[172:173], v[172:173], v[226:227]
v_pk_fma_f32 v[226:227], v[174:175], v[174:175], v[226:227]
v_pk_fma_f32 v[226:227], v[176:177], v[176:177], v[226:227]
v_pk_fma_f32 v[226:227], v[178:179], v[178:179], v[226:227]
v_pk_fma_f32 v[226:227], v[180:181], v[180:181], v[226:227]
v_pk_fma_f32 v[226:227], v[182:183], v[182:183], v[226:227]
v_mul_f32 v232, s67, v232
v_mov_b32 v233, v232
v_pk_add_f32 v[184:185], v[104:105], v[232:233]
v_pk_add_f32 v[186:187], v[106:107], v[232:233]
v_pk_add_f32 v[188:189], v[108:109], v[232:233]
v_pk_add_f32 v[190:191], v[110:111], v[232:233]
v_pk_add_f32 v[192:193], v[112:113], v[232:233]
v_pk_add_f32 v[194:195], v[114:115], v[232:233]
v_pk_add_f32 v[196:197], v[116:117], v[232:233]
v_pk_add_f32 v[198:199], v[118:119], v[232:233]
v_pk_add_f32 v[200:201], v[120:121], v[232:233]
v_pk_add_f32 v[202:203], v[122:123], v[232:233]
v_pk_add_f32 v[204:205], v[124:125], v[232:233]
v_pk_add_f32 v[206:207], v[126:127], v[232:233]
v_pk_add_f32 v[208:209], v[128:129], v[232:233]
v_pk_add_f32 v[210:211], v[130:131], v[232:233]
v_pk_add_f32 v[212:213], v[132:133], v[232:233]
v_pk_add_f32 v[214:215], v[134:135], v[232:233]
v_pk_add_f32 v[216:217], v[136:137], v[232:233]
v_pk_add_f32 v[218:219], v[138:139], v[232:233]
v_pk_add_f32 v[220:221], v[140:141], v[232:233]
v_pk_add_f32 v[222:223], v[142:143], v[232:233]
v_pk_mul_f32 v[234:235], v[184:185], v[184:185]
v_pk_fma_f32 v[234:235], v[186:187], v[186:187], v[234:235]
v_pk_fma_f32 v[234:235], v[188:189], v[188:189], v[234:235]
v_pk_fma_f32 v[234:235], v[190:191], v[190:191], v[234:235]
v_pk_fma_f32 v[234:235], v[192:193], v[192:193], v[234:235]
v_pk_fma_f32 v[234:235], v[194:195], v[194:195], v[234:235]
v_pk_fma_f32 v[234:235], v[196:197], v[196:197], v[234:235]
v_pk_fma_f32 v[234:235], v[198:199], v[198:199], v[234:235]
v_pk_fma_f32 v[234:235], v[200:201], v[200:201], v[234:235]
v_pk_fma_f32 v[234:235], v[202:203], v[202:203], v[234:235]
v_pk_fma_f32 v[234:235], v[204:205], v[204:205], v[234:235]
v_pk_fma_f32 v[234:235], v[206:207], v[206:207], v[234:235]
v_pk_fma_f32 v[234:235], v[208:209], v[208:209], v[234:235]
v_pk_fma_f32 v[234:235], v[210:211], v[210:211], v[234:235]
v_pk_fma_f32 v[234:235], v[212:213], v[212:213], v[234:235]
v_pk_fma_f32 v[234:235], v[214:215], v[214:215], v[234:235]
v_pk_fma_f32 v[234:235], v[216:217], v[216:217], v[234:235]
v_pk_fma_f32 v[234:235], v[218:219], v[218:219], v[234:235]
v_pk_fma_f32 v[234:235], v[220:221], v[220:221], v[234:235]
v_pk_fma_f32 v[234:235], v[222:223], v[222:223], v[234:235]
v_add_f32 v226, v226, v227
v_mov_b32 v242, v226
s_nop 1
v_permlane16_swap_b32 v226, v242
v_add_f32 v226, v226, v242
v_mov_b32 v242, v226
s_nop 1
v_permlane32_swap_b32 v226, v242
v_add_f32 v226, v226, v242
ds_write_b32 v240, v226 offset:512
v_add_f32 v234, v234, v235
v_mov_b32 v242, v234
s_nop 1
v_permlane16_swap_b32 v234, v242
v_add_f32 v234, v234, v242
v_mov_b32 v242, v234
s_nop 1
v_permlane32_swap_b32 v234, v242
v_add_f32 v234, v234, v242
ds_write_b32 v240, v234 offset:768
s_waitcnt lgkmcnt(0)
s_barrier
ds_read_b128 v[228:231], v241 offset:512
ds_read_b128 v[236:239], v241 offset:768
s_waitcnt lgkmcnt(0)
v_add_f32 v228, v228, v229
v_add_f32 v230, v230, v231
v_add_f32 v226, v228, v230
v_add_f32 v236, v236, v237
v_add_f32 v238, v238, v239
v_add_f32 v234, v236, v238
Lrp_498:
v_mov_b32 v6, 176
buffer_load_dword v5, v6, s[12:15], 0 offen sc1
s_waitcnt vmcnt(0)
Lrc_499:
v_readfirstlane_b32 s67, v5
s_nop 0
s_sub_u32 s67, s67, 1
s_cmp_eq_u32 s67, s34
s_cbranch_scc1 Lro_500
s_sub_u32 s65, s65, 1
s_cmp_eq_u32 s65, 0
s_cbranch_scc1 Lro_500
s_cmp_gt_u32 s67, 7
s_cbranch_scc1 Lrp_498
s_mov_b32 s34, s67
s_waitcnt vmcnt(0) lgkmcnt(0)
s_barrier
s_branch L_restart
Lro_500:
s_mov_b32 s67, 0x3acccccd
s_mul_i32 s68, s63, 40960
s_mul_i32 s69, s3, 5120
s_add_u32 s68, s68, s69
v_mul_f32 v226, s67, v226
v_cvt_pk_bf16_f32 v226, v226, v226
v_lshlrev_b32 v226, 16, v226
v_add_f32 v226, 0x3727c5ac, v226
v_cvt_pk_bf16_f32 v226, v226, v226
v_lshlrev_b32 v226, 16, v226
v_sqrt_f32 v226, v226
s_nop 0
v_cvt_pk_bf16_f32 v226, v226, v226
v_lshlrev_b32 v226, 16, v226
v_rcp_f32 v226, v226
v_cvt_pk_bf16_f32 v224, v224, v224
v_lshlrev_b32 v224, 16, v224
v_mov_b32 v227, v226
v_mov_b32 v225, v224
v_pk_add_f32 v[64:65], v[64:65], v[224:225]
v_pk_add_f32 v[66:67], v[66:67], v[224:225]
v_pk_add_f32 v[68:69], v[68:69], v[224:225]
v_pk_add_f32 v[70:71], v[70:71], v[224:225]
v_pk_add_f32 v[72:73], v[72:73], v[224:225]
v_pk_add_f32 v[74:75], v[74:75], v[224:225]
v_pk_add_f32 v[76:77], v[76:77], v[224:225]
v_pk_add_f32 v[78:79], v[78:79], v[224:225]
v_pk_add_f32 v[80:81], v[80:81], v[224:225]
v_pk_add_f32 v[82:83], v[82:83], v[224:225]
v_pk_add_f32 v[84:85], v[84:85], v[224:225]
v_pk_add_f32 v[86:87], v[86:87], v[224:225]
v_pk_add_f32 v[88:89], v[88:89], v[224:225]
v_pk_add_f32 v[90:91], v[90:91], v[224:225]
v_pk_add_f32 v[92:93], v[92:93], v[224:225]
v_pk_add_f32 v[94:95], v[94:95], v[224:225]
v_pk_add_f32 v[96:97], v[96:97], v[224:225]
v_pk_add_f32 v[98:99], v[98:99], v[224:225]
v_pk_add_f32 v[100:101], v[100:101], v[224:225]
v_pk_add_f32 v[102:103], v[102:103], v[224:225]
v_cvt_pk_bf16_f32 v16, v64, v65
v_cvt_pk_bf16_f32 v17, v66, v67
v_cvt_pk_bf16_f32 v18, v68, v69
v_cvt_pk_bf16_f32 v19, v70, v71
v_cvt_pk_bf16_f32 v20, v72, v73
v_cvt_pk_bf16_f32 v21, v74, v75
v_cvt_pk_bf16_f32 v22, v76, v77
v_cvt_pk_bf16_f32 v23, v78, v79
v_cvt_pk_bf16_f32 v24, v80, v81
v_cvt_pk_bf16_f32 v25, v82, v83
v_cvt_pk_bf16_f32 v26, v84, v85
v_cvt_pk_bf16_f32 v27, v86, v87
v_cvt_pk_bf16_f32 v28, v88, v89
v_cvt_pk_bf16_f32 v29, v90, v91
v_cvt_pk_bf16_f32 v30, v92, v93
v_cvt_pk_bf16_f32 v31, v94, v95
v_cvt_pk_bf16_f32 v32, v96, v97
v_cvt_pk_bf16_f32 v33, v98, v99
v_cvt_pk_bf16_f32 v34, v100, v101
v_cvt_pk_bf16_f32 v35, v102, v103
v_lshlrev_b32 v64, 16, v16
v_and_b32 v65, 0xffff0000, v16
v_lshlrev_b32 v66, 16, v17
v_and_b32 v67, 0xffff0000, v17
v_lshlrev_b32 v68, 16, v18
v_and_b32 v69, 0xffff0000, v18
v_lshlrev_b32 v70, 16, v19
v_and_b32 v71, 0xffff0000, v19
v_lshlrev_b32 v72, 16, v20
v_and_b32 v73, 0xffff0000, v20
v_lshlrev_b32 v74, 16, v21
v_and_b32 v75, 0xffff0000, v21
v_lshlrev_b32 v76, 16, v22
v_and_b32 v77, 0xffff0000, v22
v_lshlrev_b32 v78, 16, v23
v_and_b32 v79, 0xffff0000, v23
v_lshlrev_b32 v80, 16, v24
v_and_b32 v81, 0xffff0000, v24
v_lshlrev_b32 v82, 16, v25
v_and_b32 v83, 0xffff0000, v25
v_lshlrev_b32 v84, 16, v26
v_and_b32 v85, 0xffff0000, v26
v_lshlrev_b32 v86, 16, v27
v_and_b32 v87, 0xffff0000, v27
v_lshlrev_b32 v88, 16, v28
v_and_b32 v89, 0xffff0000, v28
v_lshlrev_b32 v90, 16, v29
v_and_b32 v91, 0xffff0000, v29
v_lshlrev_b32 v92, 16, v30
v_and_b32 v93, 0xffff0000, v30
v_lshlrev_b32 v94, 16, v31
v_and_b32 v95, 0xffff0000, v31
v_lshlrev_b32 v96, 16, v32
v_and_b32 v97, 0xffff0000, v32
v_lshlrev_b32 v98, 16, v33
v_and_b32 v99, 0xffff0000, v33
v_lshlrev_b32 v100, 16, v34
v_and_b32 v101, 0xffff0000, v34
v_lshlrev_b32 v102, 16, v35
v_and_b32 v103, 0xffff0000, v35
v_pk_mul_f32 v[64:65], v[64:65], v[226:227]
v_pk_mul_f32 v[66:67], v[66:67], v[226:227]
v_pk_mul_f32 v[68:69], v[68:69], v[226:227]
v_pk_mul_f32 v[70:71], v[70:71], v[226:227]
v_pk_mul_f32 v[72:73], v[72:73], v[226:227]
v_pk_mul_f32 v[74:75], v[74:75], v[226:227]
v_pk_mul_f32 v[76:77], v[76:77], v[226:227]
v_pk_mul_f32 v[78:79], v[78:79], v[226:227]
v_pk_mul_f32 v[80:81], v[80:81], v[226:227]
v_pk_mul_f32 v[82:83], v[82:83], v[226:227]
v_pk_mul_f32 v[84:85], v[84:85], v[226:227]
v_pk_mul_f32 v[86:87], v[86:87], v[226:227]
v_pk_mul_f32 v[88:89], v[88:89], v[226:227]
v_pk_mul_f32 v[90:91], v[90:91], v[226:227]
v_pk_mul_f32 v[92:93], v[92:93], v[226:227]
v_pk_mul_f32 v[94:95], v[94:95], v[226:227]
v_pk_mul_f32 v[96:97], v[96:97], v[226:227]
v_pk_mul_f32 v[98:99], v[98:99], v[226:227]
v_pk_mul_f32 v[100:101], v[100:101], v[226:227]
v_pk_mul_f32 v[102:103], v[102:103], v[226:227]
v_cvt_pk_bf16_f32 v16, v64, v65
v_cvt_pk_bf16_f32 v17, v66, v67
v_cvt_pk_bf16_f32 v18, v68, v69
v_cvt_pk_bf16_f32 v19, v70, v71
v_cvt_pk_bf16_f32 v20, v72, v73
v_cvt_pk_bf16_f32 v21, v74, v75
v_cvt_pk_bf16_f32 v22, v76, v77
v_cvt_pk_bf16_f32 v23, v78, v79
v_cvt_pk_bf16_f32 v24, v80, v81
v_cvt_pk_bf16_f32 v25, v82, v83
v_cvt_pk_bf16_f32 v26, v84, v85
v_cvt_pk_bf16_f32 v27, v86, v87
v_cvt_pk_bf16_f32 v28, v88, v89
v_cvt_pk_bf16_f32 v29, v90, v91
v_cvt_pk_bf16_f32 v30, v92, v93
v_cvt_pk_bf16_f32 v31, v94, v95
v_cvt_pk_bf16_f32 v32, v96, v97
v_cvt_pk_bf16_f32 v33, v98, v99
v_cvt_pk_bf16_f32 v34, v100, v101
v_cvt_pk_bf16_f32 v35, v102, v103
s_add_u32 s69, s68, 4096
buffer_store_dwordx4 v[16:19], v1, s[8:11], s68 offen offset:0 sc1
buffer_store_dwordx4 v[20:23], v1, s[8:11], s68 offen offset:1024 sc1
buffer_store_dwordx4 v[24:27], v1, s[8:11], s68 offen offset:2048 sc1
buffer_store_dwordx4 v[28:31], v1, s[8:11], s68 offen offset:3072 sc1
buffer_store_dwordx4 v[32:35], v1, s[8:11], s69 offen offset:0 sc1
s_add_u32 s68, s68, 20480
v_mul_f32 v234, s67, v234
v_cvt_pk_bf16_f32 v234, v234, v234
v_lshlrev_b32 v234, 16, v234
v_add_f32 v234, 0x3727c5ac, v234
v_cvt_pk_bf16_f32 v234, v234, v234
v_lshlrev_b32 v234, 16, v234
v_sqrt_f32 v234, v234
s_nop 0
v_cvt_pk_bf16_f32 v234, v234, v234
v_lshlrev_b32 v234, 16, v234
v_rcp_f32 v234, v234
v_cvt_pk_bf16_f32 v232, v232, v232
v_lshlrev_b32 v232, 16, v232
v_mov_b32 v235, v234
v_mov_b32 v233, v232
v_pk_add_f32 v[104:105], v[104:105], v[232:233]
v_pk_add_f32 v[106:107], v[106:107], v[232:233]
v_pk_add_f32 v[108:109], v[108:109], v[232:233]
v_pk_add_f32 v[110:111], v[110:111], v[232:233]
v_pk_add_f32 v[112:113], v[112:113], v[232:233]
v_pk_add_f32 v[114:115], v[114:115], v[232:233]
v_pk_add_f32 v[116:117], v[116:117], v[232:233]
v_pk_add_f32 v[118:119], v[118:119], v[232:233]
v_pk_add_f32 v[120:121], v[120:121], v[232:233]
v_pk_add_f32 v[122:123], v[122:123], v[232:233]
v_pk_add_f32 v[124:125], v[124:125], v[232:233]
v_pk_add_f32 v[126:127], v[126:127], v[232:233]
v_pk_add_f32 v[128:129], v[128:129], v[232:233]
v_pk_add_f32 v[130:131], v[130:131], v[232:233]
v_pk_add_f32 v[132:133], v[132:133], v[232:233]
v_pk_add_f32 v[134:135], v[134:135], v[232:233]
v_pk_add_f32 v[136:137], v[136:137], v[232:233]
v_pk_add_f32 v[138:139], v[138:139], v[232:233]
v_pk_add_f32 v[140:141], v[140:141], v[232:233]
v_pk_add_f32 v[142:143], v[142:143], v[232:233]
v_cvt_pk_bf16_f32 v36, v104, v105
v_cvt_pk_bf16_f32 v37, v106, v107
v_cvt_pk_bf16_f32 v38, v108, v109
v_cvt_pk_bf16_f32 v39, v110, v111
v_cvt_pk_bf16_f32 v40, v112, v113
v_cvt_pk_bf16_f32 v41, v114, v115
v_cvt_pk_bf16_f32 v42, v116, v117
v_cvt_pk_bf16_f32 v43, v118, v119
v_cvt_pk_bf16_f32 v44, v120, v121
v_cvt_pk_bf16_f32 v45, v122, v123
v_cvt_pk_bf16_f32 v46, v124, v125
v_cvt_pk_bf16_f32 v47, v126, v127
v_cvt_pk_bf16_f32 v48, v128, v129
v_cvt_pk_bf16_f32 v49, v130, v131
v_cvt_pk_bf16_f32 v50, v132, v133
v_cvt_pk_bf16_f32 v51, v134, v135
v_cvt_pk_bf16_f32 v52, v136, v137
v_cvt_pk_bf16_f32 v53, v138, v139
v_cvt_pk_bf16_f32 v54, v140, v141
v_cvt_pk_bf16_f32 v55, v142, v143
v_lshlrev_b32 v104, 16, v36
v_and_b32 v105, 0xffff0000, v36
v_lshlrev_b32 v106, 16, v37
v_and_b32 v107, 0xffff0000, v37
v_lshlrev_b32 v108, 16, v38
v_and_b32 v109, 0xffff0000, v38
v_lshlrev_b32 v110, 16, v39
v_and_b32 v111, 0xffff0000, v39
v_lshlrev_b32 v112, 16, v40
v_and_b32 v113, 0xffff0000, v40
v_lshlrev_b32 v114, 16, v41
v_and_b32 v115, 0xffff0000, v41
v_lshlrev_b32 v116, 16, v42
v_and_b32 v117, 0xffff0000, v42
v_lshlrev_b32 v118, 16, v43
v_and_b32 v119, 0xffff0000, v43
v_lshlrev_b32 v120, 16, v44
v_and_b32 v121, 0xffff0000, v44
v_lshlrev_b32 v122, 16, v45
v_and_b32 v123, 0xffff0000, v45
v_lshlrev_b32 v124, 16, v46
v_and_b32 v125, 0xffff0000, v46
v_lshlrev_b32 v126, 16, v47
v_and_b32 v127, 0xffff0000, v47
v_lshlrev_b32 v128, 16, v48
v_and_b32 v129, 0xffff0000, v48
v_lshlrev_b32 v130, 16, v49
v_and_b32 v131, 0xffff0000, v49
v_lshlrev_b32 v132, 16, v50
v_and_b32 v133, 0xffff0000, v50
v_lshlrev_b32 v134, 16, v51
v_and_b32 v135, 0xffff0000, v51
v_lshlrev_b32 v136, 16, v52
v_and_b32 v137, 0xffff0000, v52
v_lshlrev_b32 v138, 16, v53
v_and_b32 v139, 0xffff0000, v53
v_lshlrev_b32 v140, 16, v54
v_and_b32 v141, 0xffff0000, v54
v_lshlrev_b32 v142, 16, v55
v_and_b32 v143, 0xffff0000, v55
v_pk_mul_f32 v[104:105], v[104:105], v[234:235]
v_pk_mul_f32 v[106:107], v[106:107], v[234:235]
v_pk_mul_f32 v[108:109], v[108:109], v[234:235]
v_pk_mul_f32 v[110:111], v[110:111], v[234:235]
v_pk_mul_f32 v[112:113], v[112:113], v[234:235]
v_pk_mul_f32 v[114:115], v[114:115], v[234:235]
v_pk_mul_f32 v[116:117], v[116:117], v[234:235]
v_pk_mul_f32 v[118:119], v[118:119], v[234:235]
v_pk_mul_f32 v[120:121], v[120:121], v[234:235]
v_pk_mul_f32 v[122:123], v[122:123], v[234:235]
v_pk_mul_f32 v[124:125], v[124:125], v[234:235]
v_pk_mul_f32 v[126:127], v[126:127], v[234:235]
v_pk_mul_f32 v[128:129], v[128:129], v[234:235]
v_pk_mul_f32 v[130:131], v[130:131], v[234:235]
v_pk_mul_f32 v[132:133], v[132:133], v[234:235]
v_pk_mul_f32 v[134:135], v[134:135], v[234:235]
v_pk_mul_f32 v[136:137], v[136:137], v[234:235]
v_pk_mul_f32 v[138:139], v[138:139], v[234:235]
v_pk_mul_f32 v[140:141], v[140:141], v[234:235]
v_pk_mul_f32 v[142:143], v[142:143], v[234:235]
v_cvt_pk_bf16_f32 v36, v104, v105
v_cvt_pk_bf16_f32 v37, v106, v107
v_cvt_pk_bf16_f32 v38, v108, v109
v_cvt_pk_bf16_f32 v39, v110, v111
v_cvt_pk_bf16_f32 v40, v112, v113
v_cvt_pk_bf16_f32 v41, v114, v115
v_cvt_pk_bf16_f32 v42, v116, v117
v_cvt_pk_bf16_f32 v43, v118, v119
v_cvt_pk_bf16_f32 v44, v120, v121
v_cvt_pk_bf16_f32 v45, v122, v123
v_cvt_pk_bf16_f32 v46, v124, v125
v_cvt_pk_bf16_f32 v47, v126, v127
v_cvt_pk_bf16_f32 v48, v128, v129
v_cvt_pk_bf16_f32 v49, v130, v131
v_cvt_pk_bf16_f32 v50, v132, v133
v_cvt_pk_bf16_f32 v51, v134, v135
v_cvt_pk_bf16_f32 v52, v136, v137
v_cvt_pk_bf16_f32 v53, v138, v139
v_cvt_pk_bf16_f32 v54, v140, v141
v_cvt_pk_bf16_f32 v55, v142, v143
s_add_u32 s69, s68, 4096
buffer_store_dwordx4 v[36:39], v1, s[8:11], s68 offen offset:0 sc1
buffer_store_dwordx4 v[40:43], v1, s[8:11], s68 offen offset:1024 sc1
buffer_store_dwordx4 v[44:47], v1, s[8:11], s68 offen offset:2048 sc1
buffer_store_dwordx4 v[48:51], v1, s[8:11], s68 offen offset:3072 sc1
buffer_store_dwordx4 v[52:55], v1, s[8:11], s69 offen offset:0 sc1
s_add_u32 s68, s68, 20480
s_mov_b32 s92, 160
Lgp_501:
buffer_load_dword v5, v3, s[12:15], s92 offen sc1
s_waitcnt vmcnt(0)
v_readfirstlane_b32 s93, v5
s_nop 0
s_cmp_ge_u32 s93, 10
s_cbranch_scc1 Lgd_502
s_sleep 8
s_cmp_eq_u32 s65, 0
s_cbranch_scc1 Lgd_502
s_sub_u32 s65, s65, 1
s_branch Lgp_501
Lgd_502:
s_barrier
s_lshl_b32 s68, s63, 7
s_add_u32 s68, s68, 193015808
buffer_store_dword v4, v3, s[8:11], s68 offen sc1
s_branch Lnoln_494
Lz_495:
Lrp_503:
v_mov_b32 v6, 176
buffer_load_dword v5, v6, s[12:15], 0 offen sc1
s_waitcnt vmcnt(0)
Lrc_504:
v_readfirstlane_b32 s67, v5
s_nop 0
s_sub_u32 s67, s67, 1
s_cmp_eq_u32 s67, s34
s_cbranch_scc1 Lro_505
s_sub_u32 s65, s65, 1
s_cmp_eq_u32 s65, 0
s_cbranch_scc1 Lro_505
s_cmp_gt_u32 s67, 7
s_cbranch_scc1 Lrp_503
s_mov_b32 s34, s67
s_waitcnt vmcnt(0) lgkmcnt(0)
s_barrier
s_branch L_restart
Lro_505:
v_mov_b32 v16, 0
v_mov_b32 v17, 0
v_mov_b32 v18, 0
v_mov_b32 v19, 0
s_sub_u32 s69, s63, 64
s_mul_i32 s68, s69, 12288
s_mul_i32 s67, s3, 3072
s_add_u32 s68, s68, s67
s_add_u32 s68, s68, 192937984
buffer_store_dwordx4 v[16:19], v1, s[8:11], s68 offen offset:0 sc1
buffer_store_dwordx4 v[16:19], v1, s[8:11], s68 offen offset:1024 sc1
buffer_store_dwordx4 v[16:19], v1, s[8:11], s68 offen offset:2048 sc1
s_waitcnt vmcnt(0)
s_barrier
s_cmp_lg_u32 s3, 0
s_cbranch_scc1 Lz_496
s_mov_b32 s68, 160
buffer_atomic_add v4, v3, s[12:15], s68 offen sc1
Lz_496:
s_cmp_lg_u32 s3, 0
s_cbranch_scc1 Lcal_506
s_add_u32 s70, s60, 237502463
s_and_b32 s70, s70, 0xfff80000
s_sub_u32 s70, s70, s60
s_lshl_b32 s71, s69, 7
s_add_u32 s70, s70, s71
s_add_u32 s70, s70, 6144
v_mov_b32 v16, 0
s_mov_b64 exec, 1
s_mov_b32 s80, -1
s_mov_b32 s81, -1
s_mov_b32 s82, -1
s_mov_b32 s83, -1
s_waitcnt vmcnt(0)
s_memtime s[74:75]
buffer_store_dword v16, v16, s[8:11], s70 offen sc1
s_waitcnt vmcnt(0)
s_memtime s[76:77]
s_add_u32 s70, s70, 8192
s_waitcnt lgkmcnt(0)
s_sub_u32 s76, s76, s74
s_min_u32 s80, s80, s76
s_memtime s[74:75]
buffer_store_dword v16, v16, s[8:11], s70 offen sc1
s_waitcnt vmcnt(0)
s_memtime s[76:77]
s_add_u32 s70, s70, 8192
s_waitcnt lgkmcnt(0)
s_sub_u32 s76, s76, s74
s_min_u32 s81, s81, s76
s_memtime s[74:75]
buffer_store_dword v16, v16, s[8:11], s70 offen sc1
s_waitcnt vmcnt(0)
s_memtime s[76:77]
s_add_u32 s70, s70, 8192
s_waitcnt lgkmcnt(0)
s_sub_u32 s76, s76, s74
s_min_u32 s82, s82, s76
s_memtime s[74:75]
buffer_store_dword v16, v16, s[8:11], s70 offen sc1
s_waitcnt vmcnt(0)
s_memtime s[76:77]
s_add_u32 s70, s70, 8192
s_waitcnt lgkmcnt(0)
s_sub_u32 s76, s76, s74
s_min_u32 s83, s83, s76
s_memtime s[74:75]
buffer_store_dword v16, v16, s[8:11], s70 offen sc1
s_waitcnt vmcnt(0)
s_memtime s[76:77]
s_add_u32 s70, s70, 8192
s_waitcnt lgkmcnt(0)
s_sub_u32 s76, s76, s74
s_min_u32 s80, s80, s76
s_memtime s[74:75]
buffer_store_dword v16, v16, s[8:11], s70 offen sc1
s_waitcnt vmcnt(0)
s_memtime s[76:77]
s_add_u32 s70, s70, 8192
s_waitcnt lgkmcnt(0)
s_sub_u32 s76, s76, s74
s_min_u32 s81, s81, s76
s_memtime s[74:75]
buffer_store_dword v16, v16, s[8:11], s70 offen sc1
s_waitcnt vmcnt(0)
s_memtime s[76:77]
s_add_u32 s70, s70, 8192
s_waitcnt lgkmcnt(0)
s_sub_u32 s76, s76, s74
s_min_u32 s82, s82, s76
s_memtime s[74:75]
buffer_store_dword v16, v16, s[8:11], s70 offen sc1
s_waitcnt vmcnt(0)
s_memtime s[76:77]
s_add_u32 s70, s70, 8192
s_waitcnt lgkmcnt(0)
s_sub_u32 s76, s76, s74
s_min_u32 s83, s83, s76
s_memtime s[74:75]
buffer_store_dword v16, v16, s[8:11], s70 offen sc1
s_waitcnt vmcnt(0)
s_memtime s[76:77]
s_add_u32 s70, s70, 8192
s_waitcnt lgkmcnt(0)
s_sub_u32 s76, s76, s74
s_min_u32 s80, s80, s76
s_memtime s[74:75]
buffer_store_dword v16, v16, s[8:11], s70 offen sc1
s_waitcnt vmcnt(0)
s_memtime s[76:77]
s_add_u32 s70, s70, 8192
s_waitcnt lgkmcnt(0)
s_sub_u32 s76, s76, s74
s_min_u32 s81, s81, s76
s_memtime s[74:75]
buffer_store_dword v16, v16, s[8:11], s70 offen sc1
s_waitcnt vmcnt(0)
s_memtime s[76:77]
s_add_u32 s70, s70, 8192
s_waitcnt lgkmcnt(0)
s_sub_u32 s76, s76, s74
s_min_u32 s82, s82, s76
s_memtime s[74:75]
buffer_store_dword v16, v16, s[8:11], s70 offen sc1
s_waitcnt vmcnt(0)
s_memtime s[76:77]
s_add_u32 s70, s70, 8192
s_waitcnt lgkmcnt(0)
s_sub_u32 s76, s76, s74
s_min_u32 s83, s83, s76
s_memtime s[74:75]
buffer_store_dword v16, v16, s[8:11], s70 offen sc1
s_waitcnt vmcnt(0)
s_memtime s[76:77]
s_add_u32 s70, s70, 8192
s_waitcnt lgkmcnt(0)
s_sub_u32 s76, s76, s74
s_min_u32 s80, s80, s76
s_memtime s[74:75]
buffer_store_dword v16, v16, s[8:11], s70 offen sc1
s_waitcnt vmcnt(0)
s_memtime s[76:77]
s_add_u32 s70, s70, 8192
s_waitcnt lgkmcnt(0)
s_sub_u32 s76, s76, s74
s_min_u32 s81, s81, s76
s_memtime s[74:75]
buffer_store_dword v16, v16, s[8:11], s70 offen sc1
s_waitcnt vmcnt(0)
s_memtime s[76:77]
s_add_u32 s70, s70, 8192
s_waitcnt lgkmcnt(0)
s_sub_u32 s76, s76, s74
s_min_u32 s82, s82, s76
s_memtime s[74:75]
buffer_store_dword v16, v16, s[8:11], s70 offen sc1
s_waitcnt vmcnt(0)
s_memtime s[76:77]
s_add_u32 s70, s70, 8192
s_waitcnt lgkmcnt(0)
s_sub_u32 s76, s76, s74
s_min_u32 s83, s83, s76
s_memtime s[74:75]
buffer_store_dword v16, v16, s[8:11], s70 offen sc1
s_waitcnt vmcnt(0)
s_memtime s[76:77]
s_add_u32 s70, s70, 8192
s_waitcnt lgkmcnt(0)
s_sub_u32 s76, s76, s74
s_min_u32 s80, s80, s76
s_memtime s[74:75]
buffer_store_dword v16, v16, s[8:11], s70 offen sc1
s_waitcnt vmcnt(0)
s_memtime s[76:77]
s_add_u32 s70, s70, 8192
s_waitcnt lgkmcnt(0)
s_sub_u32 s76, s76, s74
s_min_u32 s81, s81, s76
s_memtime s[74:75]
buffer_store_dword v16, v16, s[8:11], s70 offen sc1
s_waitcnt vmcnt(0)
s_memtime s[76:77]
s_add_u32 s70, s70, 8192
s_waitcnt lgkmcnt(0)
s_sub_u32 s76, s76, s74
s_min_u32 s82, s82, s76
s_memtime s[74:75]
buffer_store_dword v16, v16, s[8:11], s70 offen sc1
s_waitcnt vmcnt(0)
s_memtime s[76:77]
s_add_u32 s70, s70, 8192
s_waitcnt lgkmcnt(0)
s_sub_u32 s76, s76, s74
s_min_u32 s83, s83, s76
s_memtime s[74:75]
buffer_store_dword v16, v16, s[8:11], s70 offen sc1
s_waitcnt vmcnt(0)
s_memtime s[76:77]
s_add_u32 s70, s70, 8192
s_waitcnt lgkmcnt(0)
s_sub_u32 s76, s76, s74
s_min_u32 s80, s80, s76
s_memtime s[74:75]
buffer_store_dword v16, v16, s[8:11], s70 offen sc1
s_waitcnt vmcnt(0)
s_memtime s[76:77]
s_add_u32 s70, s70, 8192
s_waitcnt lgkmcnt(0)
s_sub_u32 s76, s76, s74
s_min_u32 s81, s81, s76
s_memtime s[74:75]
buffer_store_dword v16, v16, s[8:11], s70 offen sc1
s_waitcnt vmcnt(0)
s_memtime s[76:77]
s_add_u32 s70, s70, 8192
s_waitcnt lgkmcnt(0)
s_sub_u32 s76, s76, s74
s_min_u32 s82, s82, s76
s_memtime s[74:75]
buffer_store_dword v16, v16, s[8:11], s70 offen sc1
s_waitcnt vmcnt(0)
s_memtime s[76:77]
s_add_u32 s70, s70, 8192
s_waitcnt lgkmcnt(0)
s_sub_u32 s76, s76, s74
s_min_u32 s83, s83, s76
s_add_u32 s72, s80, s82
s_add_u32 s73, s81, s83
s_cmp_lt_u32 s73, s72
s_cselect_b32 s72, 1, 0
s_cselect_b32 s80, s81, s80
s_cselect_b32 s82, s83, s82
s_lshr_b32 s73, s4, 2
s_xor_b32 s72, s72, s73
s_cmp_lt_u32 s82, s80
s_cselect_b32 s73, 1, 0
s_xor_b32 s73, s73, s4
s_and_b32 s73, s73, 1
s_lshl_b32 s73, s73, 4
s_add_u32 s72, s72, s73
s_add_u32 s72, s72, 256
v_mov_b32 v17, s72
v_mov_b32 v16, 40
buffer_atomic_add v17, v16, s[12:15], 0 offen sc1
s_mov_b64 exec, -1
Lcal_506:
s_barrier
s_mov_b32 s92, 160
Lgp_507:
buffer_load_dword v5, v3, s[12:15], s92 offen sc1
s_waitcnt vmcnt(0)
v_readfirstlane_b32 s93, v5
s_nop 0
s_cmp_ge_u32 s93, 10
s_cbranch_scc1 Lgd_508
s_sleep 8
s_cmp_eq_u32 s65, 0
s_cbranch_scc1 Lgd_508
s_sub_u32 s65, s65, 1
s_branch Lgp_507
Lgd_508:
Lnoln_494:
s_sub_u32 s68, s63, 34
s_cmp_ge_u32 s63, 72
s_cbranch_scc1 L_f2
s_cmp_ge_u32 s63, 32
s_cbranch_scc1 Lfu_497
s_and_b32 s71, s63, 7
s_lshl_b32 s71, s71, 2
s_add_u32 s71, s71, s3
s_lshl_b32 s72, s63, 9
s_lshl_b32 s67, s3, 7
s_add_u32 s72, s72, s67
s_add_u32 s72, s72, 192999424
v_min_u32 v156, 5, v0
v_cmp_lt_u32 vcc, 2, v156
v_add_u32 v158, 93, v156
s_nop 0
v_cndmask_b32 v156, v156, v158, vcc
v_lshlrev_b32 v156, 7, v156
v_min_u32 v6, 2, v0
v_lshlrev_b32 v6, 7, v6
v_mov_b32 v157, 0
v_bfe_u32 v158, v0, 0, 4
s_mov_b32 s67, 16
v_mad_i32_i24 v157, v158, s67, v157
v_bfe_u32 v158, v0, 4, 1
s_mov_b32 s67, 8
v_mad_i32_i24 v157, v158, s67, v157
v_and_b32 v161, 15, v0
v_mov_b32 v159, 0
v_bfe_u32 v158, v0, 4, 2
s_mov_b32 s67, 4
v_mad_i32_i24 v159, v158, s67, v159
v_cmp_le_u32 s[76:77], v159, v161
v_mov_b32 v159, 1
v_bfe_u32 v158, v0, 4, 2
s_mov_b32 s67, 4
v_mad_i32_i24 v159, v158, s67, v159
v_cmp_le_u32 s[78:79], v159, v161
v_mov_b32 v159, 2
v_bfe_u32 v158, v0, 4, 2
s_mov_b32 s67, 4
v_mad_i32_i24 v159, v158, s67, v159
v_cmp_le_u32 s[80:81], v159, v161
v_mov_b32 v159, 3
v_bfe_u32 v158, v0, 4, 2
s_mov_b32 s67, 4
v_mad_i32_i24 v159, v158, s67, v159
v_cmp_le_u32 s[82:83], v159, v161
s_bitcmp1_b32 s63, 3
s_cselect_b32 s74, 0, -1
s_cselect_b32 s75, -1, 0
s_mul_i32 s73, s71, 384
s_add_u32 s73, s73, 192937984
s_add_u32 s88, s73, 12288
s_mov_b32 s84, 0x3dd53b95
s_mov_b32 s70, 0
Lp_509:
s_lshl_b32 s66, s70, 2
s_lshr_b32 s67, s63, 3
s_add_u32 s66, s66, s67
s_sub_u32 s85, s66, 12
s_max_i32 s85, s85, 0
s_lshr_b32 s85, s85, 2
s_add_u32 s85, s85, s66
Lq_510:
buffer_load_dword v158, v156, s[8:11], s73 offen sc1
s_waitcnt vmcnt(0)
v_cmp_ge_u32 vcc, s85, v158
s_cbranch_vccz Lqd_511
s_sleep 16
s_cmp_eq_u32 s65, 0
s_cbranch_scc1 Lqd_511
s_sub_u32 s65, s65, 1
s_branch Lq_510
Lqd_511:
s_lshl_b32 s86, s66, 5
s_add_u32 s86, s86, s71
s_mul_i32 s86, s86, 12288
s_add_u32 s87, s86, 4194304
buffer_load_dwordx4 v[16:19], v1, s[8:11], s87 offen offset:0 sc1
buffer_load_dwordx4 v[20:23], v1, s[8:11], s87 offen offset:1024 sc1
buffer_load_dwordx4 v[24:27], v1, s[8:11], s87 offen offset:2048 sc1
buffer_load_dwordx4 v[28:31], v1, s[8:11], s87 offen offset:3072 sc1
s_add_u32 s87, s86, 4198400
buffer_load_dwordx4 v[32:35], v1, s[8:11], s87 offen offset:0 sc1
buffer_load_dwordx4 v[36:39], v1, s[8:11], s87 offen offset:1024 sc1
buffer_load_dwordx4 v[40:43], v1, s[8:11], s87 offen offset:2048 sc1
buffer_load_dwordx4 v[44:47], v1, s[8:11], s87 offen offset:3072 sc1
s_add_u32 s87, s86, 4202496
buffer_load_dwordx4 v[48:51], v1, s[8:11], s87 offen offset:0 sc1
buffer_load_dwordx4 v[52:55], v1, s[8:11], s87 offen offset:1024 sc1
buffer_load_dwordx4 v[56:59], v1, s[8:11], s87 offen offset:2048 sc1
buffer_load_dwordx4 v[60:63], v1, s[8:11], s87 offen offset:3072 sc1
s_add_u32 s87, s86, 29360128
buffer_load_dwordx4 v[64:67], v1, s[8:11], s87 offen offset:0 sc1
buffer_load_dwordx4 v[68:71], v1, s[8:11], s87 offen offset:1024 sc1
buffer_load_dwordx4 v[72:75], v1, s[8:11], s87 offen offset:2048 sc1
buffer_load_dwordx4 v[76:79], v1, s[8:11], s87 offen offset:3072 sc1
s_add_u32 s87, s86, 29364224
buffer_load_dwordx4 v[80:83], v1, s[8:11], s87 offen offset:0 sc1
buffer_load_dwordx4 v[84:87], v1, s[8:11], s87 offen offset:1024 sc1
buffer_load_dwordx4 v[88:91], v1, s[8:11], s87 offen offset:2048 sc1
buffer_load_dwordx4 v[92:95], v1, s[8:11], s87 offen offset:3072 sc1
s_add_u32 s87, s86, 29368320
buffer_load_dwordx4 v[96:99], v1, s[8:11], s87 offen offset:0 sc1
buffer_load_dwordx4 v[100:103], v1, s[8:11], s87 offen offset:1024 sc1
buffer_load_dwordx4 v[104:107], v1, s[8:11], s87 offen offset:2048 sc1
buffer_load_dwordx4 v[108:111], v1, s[8:11], s87 offen offset:3072 sc1
s_waitcnt vmcnt(6)
v_mfma_f32_16x16x32_bf16 v[136:139], v[64:67], v[16:19], 0
v_mfma_f32_16x16x32_bf16 v[140:143], v[64:67], v[40:43], 0
v_mfma_f32_16x16x32_bf16 v[136:139], v[68:71], v[20:23], v[136:139]
v_mfma_f32_16x16x32_bf16 v[140:143], v[68:71], v[44:47], v[140:143]
v_mfma_f32_16x16x32_bf16 v[136:139], v[72:75], v[24:27], v[136:139]
v_mfma_f32_16x16x32_bf16 v[140:143], v[72:75], v[48:51], v[140:143]
v_mfma_f32_16x16x32_bf16 v[136:139], v[76:79], v[28:31], v[136:139]
v_mfma_f32_16x16x32_bf16 v[140:143], v[76:79], v[52:55], v[140:143]
v_mfma_f32_16x16x32_bf16 v[136:139], v[80:83], v[32:35], v[136:139]
v_mfma_f32_16x16x32_bf16 v[140:143], v[80:83], v[56:59], v[140:143]
v_mfma_f32_16x16x32_bf16 v[136:139], v[84:87], v[36:39], v[136:139]
v_mfma_f32_16x16x32_bf16 v[140:143], v[84:87], v[60:63], v[140:143]
s_waitcnt vmcnt(0)
v_mfma_f32_16x16x32_bf16 v[144:147], v[88:91], v[40:43], 0
v_mfma_f32_16x16x32_bf16 v[144:147], v[92:95], v[44:47], v[144:147]
v_mfma_f32_16x16x32_bf16 v[144:147], v[96:99], v[48:51], v[144:147]
v_mfma_f32_16x16x32_bf16 v[144:147], v[100:103], v[52:55], v[144:147]
v_mfma_f32_16x16x32_bf16 v[144:147], v[104:107], v[56:59], v[144:147]
v_mfma_f32_16x16x32_bf16 v[144:147], v[108:111], v[60:63], v[144:147]
v_mov_b32 v161, 0xff7fffff
v_cndmask_b32 v136, v161, v136, s[76:77]
v_cndmask_b32 v137, v161, v137, s[78:79]
v_cndmask_b32 v138, v161, v138, s[80:81]
v_cndmask_b32 v139, v161, v139, s[82:83]
s_nop 2
v_cndmask_b32 v144, v161, v144, s[76:77]
v_cndmask_b32 v145, v161, v145, s[78:79]
v_cndmask_b32 v146, v161, v146, s[80:81]
v_cndmask_b32 v147, v161, v147, s[82:83]
s_mul_i32 s85, s70, 5
s_add_u32 s85, s85, 16
s_add_u32 s67, s70, 64
s_min_u32 s85, s85, s67
s_cmp_lt_u32 s70, 15
s_cbranch_scc1 Lpk_512
s_lshr_b32 s88, s71, 4
s_lshl_b32 s88, s88, 4
s_add_u32 s88, s88, s71
s_lshl_b32 s88, s88, 7
s_add_u32 s88, s88, 193026048
v_mov_b32 v6, 0
s_mov_b32 s85, s66
Lpk_512:
Lq_513:
buffer_load_dword v158, v6, s[8:11], s88 offen sc1
s_waitcnt vmcnt(0)
v_cmp_ge_u32 vcc, s85, v158
s_cbranch_vccz Lqd_514
s_sleep 1
s_cmp_eq_u32 s65, 0
s_cbranch_scc1 Lqd_514
s_sub_u32 s65, s65, 1
s_branch Lq_513
Lqd_514:
s_add_u32 s86, s70, 64
s_lshl_b32 s86, s86, 5
s_add_u32 s86, s86, s71
s_mul_i32 s86, s86, 12288
s_bitcmp1_b32 s63, 4
s_cselect_b32 s67, 6144, 0
s_add_u32 s86, s86, s67
s_add_u32 s87, s86, 29360128
buffer_load_dwordx4 v[112:115], v1, s[8:11], s87 offen offset:0 sc1
buffer_load_dwordx4 v[116:119], v1, s[8:11], s87 offen offset:1024 sc1
buffer_load_dwordx4 v[120:123], v1, s[8:11], s87 offen offset:2048 sc1
buffer_load_dwordx4 v[124:127], v1, s[8:11], s87 offen offset:3072 sc1
s_add_u32 s87, s86, 29364224
buffer_load_dwordx4 v[128:131], v1, s[8:11], s87 offen offset:0 sc1
buffer_load_dwordx4 v[132:135], v1, s[8:11], s87 offen offset:1024 sc1
s_waitcnt vmcnt(5)
v_mfma_f32_16x16x32_bf16 v[148:151], v[112:115], v[16:19], 0
v_mfma_f32_16x16x32_bf16 v[152:155], v[112:115], v[40:43], 0
s_waitcnt vmcnt(4)
v_mfma_f32_16x16x32_bf16 v[148:151], v[116:119], v[20:23], v[148:151]
v_mfma_f32_16x16x32_bf16 v[152:155], v[116:119], v[44:47], v[152:155]
s_waitcnt vmcnt(3)
v_mfma_f32_16x16x32_bf16 v[148:151], v[120:123], v[24:27], v[148:151]
v_mfma_f32_16x16x32_bf16 v[152:155], v[120:123], v[48:51], v[152:155]
s_waitcnt vmcnt(2)
v_mfma_f32_16x16x32_bf16 v[148:151], v[124:127], v[28:31], v[148:151]
v_mfma_f32_16x16x32_bf16 v[152:155], v[124:127], v[52:55], v[152:155]
s_waitcnt vmcnt(1)
v_mfma_f32_16x16x32_bf16 v[148:151], v[128:131], v[32:35], v[148:151]
v_mfma_f32_16x16x32_bf16 v[152:155], v[128:131], v[56:59], v[152:155]
s_waitcnt vmcnt(0)
v_mfma_f32_16x16x32_bf16 v[148:151], v[132:135], v[36:39], v[148:151]
v_mfma_f32_16x16x32_bf16 v[152:155], v[132:135], v[60:63], v[152:155]
s_lshl_b32 s86, s66, 5
s_add_u32 s86, s86, s71
s_lshl_b32 s86, s86, 11
s_add_u32 s86, s86, 186646528
s_lshl_b32 s87, s66, 3
s_lshr_b32 s67, s71, 2
s_add_u32 s87, s87, s67
s_lshl_b32 s87, s87, 11
s_and_b32 s67, s71, 3
s_lshl_b32 s67, s67, 8
s_add_u32 s87, s87, s67
s_add_u32 s87, s87, 190840832
v_mov_b32 v161, 0xff7fffff
v_cndmask_b32 v148, v161, v148, s[74:75]
v_cndmask_b32 v149, v161, v149, s[74:75]
v_cndmask_b32 v150, v161, v150, s[74:75]
v_cndmask_b32 v151, v161, v151, s[74:75]
v_cndmask_b32 v152, v161, v152, s[74:75]
v_cndmask_b32 v153, v161, v153, s[74:75]
v_cndmask_b32 v154, v161, v154, s[74:75]
v_cndmask_b32 v155, v161, v155, s[74:75]
v_max3_f32 v159, v136, v137, v138
v_max3_f32 v159, v159, v139, v148
v_max3_f32 v159, v159, v149, v150
v_max_f32 v159, v159, v151
v_mov_b32 v161, v159
s_nop 1
v_permlane16_swap_b32 v159, v161
v_max_f32 v159, v159, v161
v_mov_b32 v161, v159
s_nop 1
v_permlane32_swap_b32 v159, v161
v_max_f32 v159, v159, v161
v_mul_f32 v159, s84, v159
v_fma_f32 v136, v136, s84, -v159
v_fma_f32 v137, v137, s84, -v159
v_fma_f32 v138, v138, s84, -v159
v_fma_f32 v139, v139, s84, -v159
v_fma_f32 v148, v148, s84, -v159
v_fma_f32 v149, v149, s84, -v159
v_fma_f32 v150, v150, s84, -v159
v_fma_f32 v151, v151, s84, -v159
v_exp_f32 v136, v136
v_exp_f32 v137, v137
v_exp_f32 v138, v138
v_exp_f32 v139, v139
v_exp_f32 v148, v148
v_exp_f32 v149, v149
v_exp_f32 v150, v150
v_exp_f32 v151, v151
v_add_f32 v160, v136, v137
v_add_f32 v160, v160, v138
v_add_f32 v160, v160, v139
v_add_f32 v160, v160, v148
v_add_f32 v160, v160, v149
v_add_f32 v160, v160, v150
v_add_f32 v160, v160, v151
v_mov_b32 v161, v160
s_nop 1
v_permlane16_swap_b32 v160, v161
v_add_f32 v160, v160, v161
v_mov_b32 v161, v160
s_nop 1
v_permlane32_swap_b32 v160, v161
v_add_f32 v160, v160, v161
v_rcp_f32 v160, v160
s_nop 0
v_mul_f32 v136, v136, v160
v_mul_f32 v137, v137, v160
v_mul_f32 v138, v138, v160
v_mul_f32 v139, v139, v160
v_mul_f32 v148, v148, v160
v_mul_f32 v149, v149, v160
v_mul_f32 v150, v150, v160
v_mul_f32 v151, v151, v160
v_cvt_pk_bf16_f32 v136, v136, v137
v_cvt_pk_bf16_f32 v137, v138, v139
v_mov_b32 v138, 0
v_mov_b32 v139, 0
v_cvt_pk_bf16_f32 v148, v148, v149
v_cvt_pk_bf16_f32 v149, v150, v151
buffer_store_dwordx4 v[136:139], v1, s[8:11], s86 offen offset:0 sc1
s_mov_b64 exec, s[74:75]
buffer_store_dwordx2 v[148:149], v157, s[8:11], s87 offen offset:0 sc1
s_mov_b64 exec, -1
v_max3_f32 v159, v140, v141, v142
v_max3_f32 v159, v159, v143, v144
v_max3_f32 v159, v159, v145, v146
v_max3_f32 v159, v159, v147, v152
v_max3_f32 v159, v159, v153, v154
v_max_f32 v159, v159, v155
v_mov_b32 v161, v159
s_nop 1
v_permlane16_swap_b32 v159, v161
v_max_f32 v159, v159, v161
v_mov_b32 v161, v159
s_nop 1
v_permlane32_swap_b32 v159, v161
v_max_f32 v159, v159, v161
v_mul_f32 v159, s84, v159
v_fma_f32 v140, v140, s84, -v159
v_fma_f32 v141, v141, s84, -v159
v_fma_f32 v142, v142, s84, -v159
v_fma_f32 v143, v143, s84, -v159
v_fma_f32 v144, v144, s84, -v159
v_fma_f32 v145, v145, s84, -v159
v_fma_f32 v146, v146, s84, -v159
v_fma_f32 v147, v147, s84, -v159
v_fma_f32 v152, v152, s84, -v159
v_fma_f32 v153, v153, s84, -v159
v_fma_f32 v154, v154, s84, -v159
v_fma_f32 v155, v155, s84, -v159
v_exp_f32 v140, v140
v_exp_f32 v141, v141
v_exp_f32 v142, v142
v_exp_f32 v143, v143
v_exp_f32 v144, v144
v_exp_f32 v145, v145
v_exp_f32 v146, v146
v_exp_f32 v147, v147
v_exp_f32 v152, v152
v_exp_f32 v153, v153
v_exp_f32 v154, v154
v_exp_f32 v155, v155
v_add_f32 v160, v140, v141
v_add_f32 v160, v160, v142
v_add_f32 v160, v160, v143
v_add_f32 v160, v160, v144
v_add_f32 v160, v160, v145
v_add_f32 v160, v160, v146
v_add_f32 v160, v160, v147
v_add_f32 v160, v160, v152
v_add_f32 v160, v160, v153
v_add_f32 v160, v160, v154
v_add_f32 v160, v160, v155
v_mov_b32 v161, v160
s_nop 1
v_permlane16_swap_b32 v160, v161
v_add_f32 v160, v160, v161
v_mov_b32 v161, v160
s_nop 1
v_permlane32_swap_b32 v160, v161
v_add_f32 v160, v160, v161
v_rcp_f32 v160, v160
s_nop 0
v_mul_f32 v140, v140, v160
v_mul_f32 v141, v141, v160
v_mul_f32 v142, v142, v160
v_mul_f32 v143, v143, v160
v_mul_f32 v144, v144, v160
v_mul_f32 v145, v145, v160
v_mul_f32 v146, v146, v160
v_mul_f32 v147, v147, v160
v_mul_f32 v152, v152, v160
v_mul_f32 v153, v153, v160
v_mul_f32 v154, v154, v160
v_mul_f32 v155, v155, v160
v_cvt_pk_bf16_f32 v140, v140, v141
v_cvt_pk_bf16_f32 v141, v142, v143
v_cvt_pk_bf16_f32 v142, v144, v145
v_cvt_pk_bf16_f32 v143, v146, v147
v_cvt_pk_bf16_f32 v152, v152, v153
v_cvt_pk_bf16_f32 v153, v154, v155
buffer_store_dwordx4 v[140:143], v1, s[8:11], s86 offen offset:1024 sc1
s_mov_b64 exec, s[74:75]
buffer_store_dwordx2 v[152:153], v157, s[8:11], s87 offen offset:1024 sc1
s_mov_b64 exec, -1
s_add_u32 s70, s70, 1
v_mov_b32 v8, s70
s_waitcnt vmcnt(0)
buffer_store_dword v8, v3, s[8:11], s72 offen sc1
s_cmp_lt_u32 s70, 16
s_cbranch_scc1 Lp_509
s_waitcnt vmcnt(0)
s_endpgm
Lfu_497:
s_sub_u32 s68, s63, 32
s_mov_b32 s70, 0
s_mov_b32 s82, 15
s_branch Lfg_515
L_f2:
s_waitcnt vmcnt(0) lgkmcnt(0)
s_barrier
s_mov_b32 s70, 15
s_mov_b32 s82, 16
Lfg_515:
s_mov_b32 s83, s68
v_and_b32 v156, 15, v0
v_lshrrev_b32 v157, 4, v0
v_lshlrev_b32 v157, 2, v157
v_sub_u32 v156, v156, v157
v_mov_b32 v128, 0
v_mov_b32 v129, 0
v_mov_b32 v132, 0
v_mov_b32 v133, 0
v_mov_b32 v157, 0x3f80
v_mov_b32 v140, 0x3f800000
v_cmp_eq_u32 vcc, 0, v156
s_nop 1
v_cndmask_b32 v130, 0, v157, vcc
v_cmp_eq_u32 vcc, 1, v156
s_nop 1
v_cndmask_b32 v130, v130, v140, vcc
v_cmp_eq_u32 vcc, 2, v156
s_nop 1
v_cndmask_b32 v131, 0, v157, vcc
v_cmp_eq_u32 vcc, 3, v156
s_nop 1
v_cndmask_b32 v131, v131, v140, vcc
v_mov_b32 v150, 0
v_bfe_u32 v156, v0, 0, 4
s_mov_b32 s67, 16
v_mad_i32_i24 v150, v156, s67, v150
v_bfe_u32 v156, v0, 4, 2
s_mov_b32 s67, 10240
v_mad_i32_i24 v150, v156, s67, v150
v_mov_b32 v151, 0
v_bfe_u32 v156, v0, 0, 4
s_mov_b32 s67, 1280
v_mad_i32_i24 v151, v156, s67, v151
v_bfe_u32 v156, v0, 4, 2
s_mov_b32 s67, 8
v_mad_i32_i24 v151, v156, s67, v151
s_mov_b32 s68, s83
s_mul_i32 s71, s68, 205
s_lshr_b32 s71, s71, 11
s_mul_i32 s67, s71, 10
s_sub_u32 s72, s68, s67
s_and_b32 s79, s72, 3
s_mul_i32 s79, s79, 5120
s_add_u32 s79, s79, 192978944
s_lshl_b32 s72, s72, 2
s_add_u32 s72, s72, s3
v_min_u32 v153, 39, v0
v_lshlrev_b32 v153, 7, v153
v_lshlrev_b32 v154, 7, v0
s_lshl_b32 s67, s71, 12
s_add_u32 s67, s67, 192995328
s_sub_u32 s67, s67, s79
v_add_u32 v156, s67, v154
s_mov_b32 s80, 0
s_mov_b32 s81, -1
v_cndmask_b32 v154, v154, v156, s[80:81]
Lfb_516:
s_lshl_b32 s66, s70, 2
s_add_u32 s66, s66, s71
s_cmp_lg_u32 s3, 0
s_cbranch_scc1 Lfb_517
s_sub_u32 s73, s66, 12
s_max_i32 s73, s73, 0
s_lshr_b32 s73, s73, 2
s_add_u32 s73, s73, s66
Lq_519:
buffer_load_dword v156, v153, s[8:11], s79 offen sc1
s_waitcnt vmcnt(0)
v_cmp_ge_u32 vcc, s73, v156
s_cbranch_vccz Lqd_520
s_sleep 16
s_cmp_eq_u32 s65, 0
s_cbranch_scc1 Lqd_520
s_sub_u32 s65, s65, 1
s_branch Lq_519
Lqd_520:
Lfb_517:
s_barrier
s_mul_i32 s73, s66, 40
s_add_u32 s73, s73, s72
s_mul_i32 s73, s73, 40960
s_add_u32 s73, s73, 60817408
s_add_u32 s74, s73, 32768
buffer_load_dwordx4 a[128:131], v1, s[8:11], s74 offen offset:0 sc1
buffer_load_dwordx4 a[132:135], v1, s[8:11], s74 offen offset:1024 sc1
buffer_load_dwordx4 a[136:139], v1, s[8:11], s74 offen offset:2048 sc1
buffer_load_dwordx4 a[140:143], v1, s[8:11], s74 offen offset:3072 sc1
s_add_u32 s74, s73, 36864
buffer_load_dwordx4 a[144:147], v1, s[8:11], s74 offen offset:0 sc1
buffer_load_dwordx4 a[148:151], v1, s[8:11], s74 offen offset:1024 sc1
buffer_load_dwordx4 a[152:155], v1, s[8:11], s74 offen offset:2048 sc1
buffer_load_dwordx4 a[156:159], v1, s[8:11], s74 offen offset:3072 sc1
s_mul_i32 s75, s66, 40960
s_lshl_b32 s67, s72, 5
s_add_u32 s75, s75, s67
s_add_u32 s76, s75, 20480
buffer_load_dwordx2 v[136:137], v151, s[20:23], s75 offen
buffer_load_dwordx2 v[138:139], v151, s[20:23], s76 offen
s_add_u32 s74, s73, 0
buffer_load_dwordx4 a[0:3], v1, s[8:11], s74 offen offset:0 sc1
buffer_load_dwordx4 a[4:7], v1, s[8:11], s74 offen offset:1024 sc1
buffer_load_dwordx4 a[8:11], v1, s[8:11], s74 offen offset:2048 sc1
buffer_load_dwordx4 a[12:15], v1, s[8:11], s74 offen offset:3072 sc1
s_add_u32 s74, s73, 4096
buffer_load_dwordx4 a[16:19], v1, s[8:11], s74 offen offset:0 sc1
buffer_load_dwordx4 a[20:23], v1, s[8:11], s74 offen offset:1024 sc1
buffer_load_dwordx4 a[24:27], v1, s[8:11], s74 offen offset:2048 sc1
buffer_load_dwordx4 a[28:31], v1, s[8:11], s74 offen offset:3072 sc1
s_add_u32 s74, s73, 8192
buffer_load_dwordx4 a[32:35], v1, s[8:11], s74 offen offset:0 sc1
buffer_load_dwordx4 a[36:39], v1, s[8:11], s74 offen offset:1024 sc1
buffer_load_dwordx4 a[40:43], v1, s[8:11], s74 offen offset:2048 sc1
buffer_load_dwordx4 a[44:47], v1, s[8:11], s74 offen offset:3072 sc1
s_add_u32 s74, s73, 12288
buffer_load_dwordx4 a[48:51], v1, s[8:11], s74 offen offset:0 sc1
buffer_load_dwordx4 a[52:55], v1, s[8:11], s74 offen offset:1024 sc1
buffer_load_dwordx4 a[56:59], v1, s[8:11], s74 offen offset:2048 sc1
buffer_load_dwordx4 a[60:63], v1, s[8:11], s74 offen offset:3072 sc1
s_add_u32 s74, s73, 16384
buffer_load_dwordx4 a[64:67], v1, s[8:11], s74 offen offset:0 sc1
buffer_load_dwordx4 a[68:71], v1, s[8:11], s74 offen offset:1024 sc1
buffer_load_dwordx4 a[72:75], v1, s[8:11], s74 offen offset:2048 sc1
buffer_load_dwordx4 a[76:79], v1, s[8:11], s74 offen offset:3072 sc1
s_add_u32 s74, s73, 20480
buffer_load_dwordx4 a[80:83], v1, s[8:11], s74 offen offset:0 sc1
buffer_load_dwordx4 a[84:87], v1, s[8:11], s74 offen offset:1024 sc1
buffer_load_dwordx4 a[88:91], v1, s[8:11], s74 offen offset:2048 sc1
buffer_load_dwordx4 a[92:95], v1, s[8:11], s74 offen offset:3072 sc1
s_add_u32 s74, s73, 24576
buffer_load_dwordx4 a[96:99], v1, s[8:11], s74 offen offset:0 sc1
buffer_load_dwordx4 a[100:103], v1, s[8:11], s74 offen offset:1024 sc1
buffer_load_dwordx4 a[104:107], v1, s[8:11], s74 offen offset:2048 sc1
buffer_load_dwordx4 a[108:111], v1, s[8:11], s74 offen offset:3072 sc1
s_add_u32 s74, s73, 28672
buffer_load_dwordx4 a[112:115], v1, s[8:11], s74 offen offset:0 sc1
buffer_load_dwordx4 a[116:119], v1, s[8:11], s74 offen offset:1024 sc1
buffer_load_dwordx4 a[120:123], v1, s[8:11], s74 offen offset:2048 sc1
buffer_load_dwordx4 a[124:127], v1, s[8:11], s74 offen offset:3072 sc1
s_waitcnt vmcnt(41)
v_mfma_f32_16x16x32_bf16 v[56:59], a[128:131], v[130:133], 0
v_mfma_f32_16x16x32_bf16 v[60:63], a[128:131], v[128:131], 0
s_waitcnt vmcnt(40)
v_mfma_f32_16x16x32_bf16 v[56:59], a[132:135], v[130:133], v[56:59]
v_mfma_f32_16x16x32_bf16 v[60:63], a[132:135], v[128:131], v[60:63]
s_waitcnt vmcnt(39)
v_mfma_f32_16x16x32_bf16 v[56:59], a[136:139], v[130:133], v[56:59]
v_mfma_f32_16x16x32_bf16 v[60:63], a[136:139], v[128:131], v[60:63]
s_waitcnt vmcnt(38)
v_mfma_f32_16x16x32_bf16 v[56:59], a[140:143], v[130:133], v[56:59]
v_mfma_f32_16x16x32_bf16 v[60:63], a[140:143], v[128:131], v[60:63]
s_waitcnt vmcnt(37)
v_mfma_f32_16x16x32_bf16 v[56:59], a[144:147], v[130:133], v[56:59]
v_mfma_f32_16x16x32_bf16 v[60:63], a[144:147], v[128:131], v[60:63]
s_waitcnt vmcnt(36)
v_mfma_f32_16x16x32_bf16 v[56:59], a[148:151], v[130:133], v[56:59]
v_mfma_f32_16x16x32_bf16 v[60:63], a[148:151], v[128:131], v[60:63]
s_waitcnt vmcnt(35)
v_mfma_f32_16x16x32_bf16 v[56:59], a[152:155], v[130:133], v[56:59]
v_mfma_f32_16x16x32_bf16 v[60:63], a[152:155], v[128:131], v[60:63]
s_waitcnt vmcnt(34)
v_mfma_f32_16x16x32_bf16 v[56:59], a[156:159], v[130:133], v[56:59]
v_mfma_f32_16x16x32_bf16 v[60:63], a[156:159], v[128:131], v[60:63]
s_nop 3
v_cvt_pk_bf16_f32 v64, v56, v57
v_cvt_pk_bf16_f32 v65, v58, v59
s_nop 1
v_cvt_pk_bf16_f32 v66, v60, v61
v_cvt_pk_bf16_f32 v67, v62, v63
v_lshlrev_b32 v56, 16, v64
v_and_b32 v57, 0xffff0000, v64
v_lshlrev_b32 v58, 16, v65
v_and_b32 v59, 0xffff0000, v65
v_lshlrev_b32 v60, 16, v66
v_and_b32 v61, 0xffff0000, v66
v_lshlrev_b32 v62, 16, v67
v_and_b32 v63, 0xffff0000, v67
s_mov_b32 s67, 0xbfb8aa3b
v_mul_f32 v140, s67, v56
v_mul_f32 v141, s67, v57
v_mul_f32 v142, s67, v58
v_mul_f32 v143, s67, v59
v_mul_f32 v144, s67, v60
v_mul_f32 v145, s67, v61
v_mul_f32 v146, s67, v62
v_mul_f32 v147, s67, v63
v_exp_f32 v140, v140
v_exp_f32 v141, v141
v_exp_f32 v142, v142
v_exp_f32 v143, v143
v_exp_f32 v144, v144
v_exp_f32 v145, v145
v_exp_f32 v146, v146
v_exp_f32 v147, v147
v_add_f32 v140, 1.0, v140
v_add_f32 v141, 1.0, v141
v_add_f32 v142, 1.0, v142
v_add_f32 v143, 1.0, v143
v_add_f32 v144, 1.0, v144
v_add_f32 v145, 1.0, v145
v_add_f32 v146, 1.0, v146
v_add_f32 v147, 1.0, v147
v_rcp_f32 v140, v140
v_rcp_f32 v141, v141
v_rcp_f32 v142, v142
v_rcp_f32 v143, v143
v_rcp_f32 v144, v144
v_rcp_f32 v145, v145
v_rcp_f32 v146, v146
v_rcp_f32 v147, v147
v_mul_f32 v140, v140, v56
v_mul_f32 v141, v141, v57
v_mul_f32 v142, v142, v58
v_mul_f32 v143, v143, v59
v_mul_f32 v144, v144, v60
v_mul_f32 v145, v145, v61
v_mul_f32 v146, v146, v62
v_mul_f32 v147, v147, v63
v_cvt_pk_bf16_f32 v64, v140, v141
v_cvt_pk_bf16_f32 v65, v142, v143
v_cvt_pk_bf16_f32 v66, v144, v145
v_cvt_pk_bf16_f32 v67, v146, v147
v_lshlrev_b32 v140, 16, v64
v_and_b32 v141, 0xffff0000, v64
v_lshlrev_b32 v142, 16, v65
v_and_b32 v143, 0xffff0000, v65
v_lshlrev_b32 v144, 16, v66
v_and_b32 v145, 0xffff0000, v66
v_lshlrev_b32 v146, 16, v67
v_and_b32 v147, 0xffff0000, v67
s_cmp_lg_u32 s3, 0
s_cbranch_scc1 Lfb_518
s_mul_i32 s73, s70, 5
s_add_u32 s73, s73, 16
s_add_u32 s67, s70, 64
s_min_u32 s73, s73, s67
s_cmp_lt_u32 s70, 15
s_cbranch_scc1 Lfk_521
v_and_b32 v156, 16, v0
v_add_u32 v156, v156, v0
v_lshlrev_b32 v156, 7, v156
s_sub_u32 s73, 193028096, s79
v_add_u32 v156, s73, v156
v_cndmask_b32 v154, v156, v154, s[80:81]
s_mov_b32 s73, s66
Lfk_521:
v_mov_b32 v155, s73
v_mov_b32 v156, s70
v_cndmask_b32 v155, v155, v156, s[80:81]
Lq_522:
buffer_load_dword v64, v154, s[8:11], s79 offen sc1
s_waitcnt vmcnt(0)
v_cmp_ge_u32 vcc, v155, v64
s_cbranch_vccz Lqd_523
s_sleep 1
s_cmp_eq_u32 s65, 0
s_cbranch_scc1 Lqd_523
s_sub_u32 s65, s65, 1
s_branch Lq_522
Lqd_523:
Lfb_518:
s_barrier
s_mul_i32 s73, s66, 327680
s_lshl_b32 s67, s72, 8
s_add_u32 s73, s73, s67
s_add_u32 s73, s73, 165675008
s_lshl_b32 s74, s3, 10
s_lshl_b32 s77, s66, 16
s_add_u32 s77, s77, s74
s_add_u32 s77, s77, 186646528
s_lshl_b32 s78, s66, 14
s_add_u32 s78, s78, s74
s_add_u32 s78, s78, 190840832
s_add_u32 m0, s74, 0
s_nop 0
buffer_load_dwordx4 v1, s[8:11], s77 offen sc1 lds
s_add_u32 m0, s74, 4096
s_add_u32 s77, s77, 4096
buffer_load_dwordx4 v1, s[8:11], s77 offen sc1 lds
s_add_u32 m0, s74, 8192
s_add_u32 s77, s77, 4096
buffer_load_dwordx4 v1, s[8:11], s77 offen sc1 lds
s_add_u32 m0, s74, 12288
s_add_u32 s77, s77, 4096
buffer_load_dwordx4 v1, s[8:11], s77 offen sc1 lds
s_add_u32 m0, s74, 16384
s_add_u32 s77, s77, 4096
buffer_load_dwordx4 v1, s[8:11], s77 offen sc1 lds
buffer_load_dwordx4 v[16:19], v150, s[8:11], s73 offen sc1
s_add_u32 s73, s73, 40960
buffer_load_dwordx4 v[20:23], v150, s[8:11], s73 offen sc1
s_add_u32 s73, s73, 40960
buffer_load_dwordx4 v[24:27], v150, s[8:11], s73 offen sc1
s_add_u32 s73, s73, 40960
buffer_load_dwordx4 v[28:31], v150, s[8:11], s73 offen sc1
s_add_u32 s73, s73, 40960
buffer_load_dwordx4 v[32:35], v150, s[8:11], s73 offen sc1
s_add_u32 s73, s73, 40960
buffer_load_dwordx4 v[36:39], v150, s[8:11], s73 offen sc1
s_add_u32 s73, s73, 40960
buffer_load_dwordx4 v[40:43], v150, s[8:11], s73 offen sc1
s_add_u32 s73, s73, 40960
buffer_load_dwordx4 v[44:47], v150, s[8:11], s73 offen sc1
s_add_u32 s73, s73, 40960
s_add_u32 m0, s74, 20480
s_add_u32 s77, s77, 4096
buffer_load_dwordx4 v1, s[8:11], s77 offen sc1 lds
s_add_u32 m0, s74, 24576
s_add_u32 s77, s77, 4096
buffer_load_dwordx4 v1, s[8:11], s77 offen sc1 lds
s_add_u32 m0, s74, 28672
s_add_u32 s77, s77, 4096
buffer_load_dwordx4 v1, s[8:11], s77 offen sc1 lds
s_add_u32 m0, s74, 32768
s_add_u32 s77, s77, 4096
buffer_load_dwordx4 v1, s[8:11], s77 offen sc1 lds
s_add_u32 m0, s74, 36864
s_add_u32 s77, s77, 4096
buffer_load_dwordx4 v1, s[8:11], s77 offen sc1 lds
s_add_u32 m0, s74, 40960
s_add_u32 s77, s77, 4096
buffer_load_dwordx4 v1, s[8:11], s77 offen sc1 lds
s_add_u32 m0, s74, 45056
s_add_u32 s77, s77, 4096
buffer_load_dwordx4 v1, s[8:11], s77 offen sc1 lds
s_add_u32 m0, s74, 49152
s_add_u32 s77, s77, 4096
buffer_load_dwordx4 v1, s[8:11], s77 offen sc1 lds
s_add_u32 m0, s74, 53248
s_add_u32 s77, s77, 4096
buffer_load_dwordx4 v1, s[8:11], s77 offen sc1 lds
s_add_u32 m0, s74, 57344
s_add_u32 s77, s77, 4096
buffer_load_dwordx4 v1, s[8:11], s77 offen sc1 lds
s_add_u32 m0, s74, 61440
s_add_u32 s77, s77, 4096
buffer_load_dwordx4 v1, s[8:11], s77 offen sc1 lds
s_add_u32 m0, s74, 65536
s_nop 0
buffer_load_dwordx4 v1, s[8:11], s78 offen sc1 lds
s_add_u32 m0, s74, 69632
s_add_u32 s78, s78, 4096
buffer_load_dwordx4 v1, s[8:11], s78 offen sc1 lds
s_add_u32 m0, s74, 73728
s_add_u32 s78, s78, 4096
buffer_load_dwordx4 v1, s[8:11], s78 offen sc1 lds
s_add_u32 m0, s74, 77824
s_add_u32 s78, s78, 4096
buffer_load_dwordx4 v1, s[8:11], s78 offen sc1 lds
v_add_u32 v152, 32768, v1
s_waitcnt vmcnt(23)
s_barrier
ds_read_b128 v[64:67], v1 offset:0
ds_read_b128 v[68:71], v1 offset:1024
ds_read_b128 v[72:75], v1 offset:2048
ds_read_b128 v[76:79], v1 offset:3072
ds_read_b128 v[80:83], v1 offset:4096
ds_read_b128 v[84:87], v1 offset:5120
ds_read_b128 v[88:91], v1 offset:6144
ds_read_b128 v[92:95], v1 offset:7168
s_waitcnt lgkmcnt(7)
v_mfma_f32_16x16x32_bf16 v[48:51], a[0:3], v[64:67], 0
ds_read_b128 v[96:99], v1 offset:8192
s_waitcnt lgkmcnt(7)
v_mfma_f32_16x16x32_bf16 v[52:55], a[0:3], v[68:71], 0
ds_read_b128 v[100:103], v1 offset:9216
s_waitcnt lgkmcnt(7)
v_mfma_f32_16x16x32_bf16 v[48:51], a[4:7], v[72:75], v[48:51]
ds_read_b128 v[104:107], v1 offset:10240
s_waitcnt lgkmcnt(7)
v_mfma_f32_16x16x32_bf16 v[52:55], a[4:7], v[76:79], v[52:55]
ds_read_b128 v[108:111], v1 offset:11264
s_waitcnt lgkmcnt(7)
v_mfma_f32_16x16x32_bf16 v[48:51], a[8:11], v[80:83], v[48:51]
ds_read_b128 v[112:115], v1 offset:12288
s_waitcnt lgkmcnt(7)
v_mfma_f32_16x16x32_bf16 v[52:55], a[8:11], v[84:87], v[52:55]
ds_read_b128 v[116:119], v1 offset:13312
s_waitcnt lgkmcnt(7)
v_mfma_f32_16x16x32_bf16 v[48:51], a[12:15], v[88:91], v[48:51]
ds_read_b128 v[120:123], v1 offset:14336
s_waitcnt lgkmcnt(7)
v_mfma_f32_16x16x32_bf16 v[52:55], a[12:15], v[92:95], v[52:55]
ds_read_b128 v[124:127], v1 offset:15360
s_waitcnt lgkmcnt(7)
v_mfma_f32_16x16x32_bf16 v[48:51], a[16:19], v[96:99], v[48:51]
ds_read_b128 v[64:67], v1 offset:16384
s_waitcnt lgkmcnt(7)
v_mfma_f32_16x16x32_bf16 v[52:55], a[16:19], v[100:103], v[52:55]
ds_read_b128 v[68:71], v1 offset:17408
s_waitcnt lgkmcnt(7)
v_mfma_f32_16x16x32_bf16 v[48:51], a[20:23], v[104:107], v[48:51]
ds_read_b128 v[72:75], v1 offset:18432
s_waitcnt lgkmcnt(7)
v_mfma_f32_16x16x32_bf16 v[52:55], a[20:23], v[108:111], v[52:55]
ds_read_b128 v[76:79], v1 offset:19456
s_waitcnt lgkmcnt(7)
v_mfma_f32_16x16x32_bf16 v[48:51], a[24:27], v[112:115], v[48:51]
s_waitcnt lgkmcnt(6)
v_mfma_f32_16x16x32_bf16 v[52:55], a[24:27], v[116:119], v[52:55]
s_waitcnt lgkmcnt(5)
v_mfma_f32_16x16x32_bf16 v[48:51], a[28:31], v[120:123], v[48:51]
s_waitcnt lgkmcnt(4)
v_mfma_f32_16x16x32_bf16 v[52:55], a[28:31], v[124:127], v[52:55]
s_waitcnt lgkmcnt(3)
v_mfma_f32_16x16x32_bf16 v[48:51], a[32:35], v[64:67], v[48:51]
s_waitcnt lgkmcnt(2)
v_mfma_f32_16x16x32_bf16 v[52:55], a[32:35], v[68:71], v[52:55]
s_waitcnt lgkmcnt(1)
v_mfma_f32_16x16x32_bf16 v[48:51], a[36:39], v[72:75], v[48:51]
s_waitcnt lgkmcnt(0)
v_mfma_f32_16x16x32_bf16 v[52:55], a[36:39], v[76:79], v[52:55]
s_waitcnt vmcnt(10)
s_barrier
ds_read_b128 v[80:83], v1 offset:20480
ds_read_b128 v[84:87], v1 offset:21504
ds_read_b128 v[88:91], v1 offset:22528
ds_read_b128 v[92:95], v1 offset:23552
ds_read_b128 v[96:99], v1 offset:24576
ds_read_b128 v[100:103], v1 offset:25600
ds_read_b128 v[104:107], v1 offset:26624
ds_read_b128 v[108:111], v1 offset:27648
s_waitcnt lgkmcnt(7)
v_mfma_f32_16x16x32_bf16 v[48:51], a[40:43], v[80:83], v[48:51]
ds_read_b128 v[112:115], v1 offset:28672
s_waitcnt lgkmcnt(7)
v_mfma_f32_16x16x32_bf16 v[52:55], a[40:43], v[84:87], v[52:55]
ds_read_b128 v[116:119], v1 offset:29696
s_waitcnt lgkmcnt(7)
v_mfma_f32_16x16x32_bf16 v[48:51], a[44:47], v[88:91], v[48:51]
ds_read_b128 v[120:123], v1 offset:30720
s_waitcnt lgkmcnt(7)
v_mfma_f32_16x16x32_bf16 v[52:55], a[44:47], v[92:95], v[52:55]
ds_read_b128 v[124:127], v1 offset:31744
s_waitcnt lgkmcnt(7)
v_mfma_f32_16x16x32_bf16 v[48:51], a[48:51], v[96:99], v[48:51]
ds_read_b128 v[64:67], v152 offset:0
s_waitcnt lgkmcnt(7)
v_mfma_f32_16x16x32_bf16 v[52:55], a[48:51], v[100:103], v[52:55]
ds_read_b128 v[68:71], v152 offset:1024
s_waitcnt lgkmcnt(7)
v_mfma_f32_16x16x32_bf16 v[48:51], a[52:55], v[104:107], v[48:51]
ds_read_b128 v[72:75], v152 offset:2048
s_waitcnt lgkmcnt(7)
v_mfma_f32_16x16x32_bf16 v[52:55], a[52:55], v[108:111], v[52:55]
ds_read_b128 v[76:79], v152 offset:3072
s_waitcnt lgkmcnt(7)
v_mfma_f32_16x16x32_bf16 v[48:51], a[56:59], v[112:115], v[48:51]
ds_read_b128 v[80:83], v152 offset:4096
s_waitcnt lgkmcnt(7)
v_mfma_f32_16x16x32_bf16 v[52:55], a[56:59], v[116:119], v[52:55]
ds_read_b128 v[84:87], v152 offset:5120
s_waitcnt lgkmcnt(7)
v_mfma_f32_16x16x32_bf16 v[48:51], a[60:63], v[120:123], v[48:51]
ds_read_b128 v[88:91], v152 offset:6144
s_waitcnt lgkmcnt(7)
v_mfma_f32_16x16x32_bf16 v[52:55], a[60:63], v[124:127], v[52:55]
ds_read_b128 v[92:95], v152 offset:7168
s_waitcnt lgkmcnt(7)
v_mfma_f32_16x16x32_bf16 v[48:51], a[64:67], v[64:67], v[48:51]
s_waitcnt lgkmcnt(6)
v_mfma_f32_16x16x32_bf16 v[52:55], a[64:67], v[68:71], v[52:55]
s_waitcnt lgkmcnt(5)
v_mfma_f32_16x16x32_bf16 v[48:51], a[68:71], v[72:75], v[48:51]
s_waitcnt lgkmcnt(4)
v_mfma_f32_16x16x32_bf16 v[52:55], a[68:71], v[76:79], v[52:55]
s_waitcnt lgkmcnt(3)
v_mfma_f32_16x16x32_bf16 v[48:51], a[72:75], v[80:83], v[48:51]
s_waitcnt lgkmcnt(2)
v_mfma_f32_16x16x32_bf16 v[52:55], a[72:75], v[84:87], v[52:55]
s_waitcnt lgkmcnt(1)
v_mfma_f32_16x16x32_bf16 v[48:51], a[76:79], v[88:91], v[48:51]
s_waitcnt lgkmcnt(0)
v_mfma_f32_16x16x32_bf16 v[52:55], a[76:79], v[92:95], v[52:55]
s_waitcnt vmcnt(5)
s_barrier
ds_read_b128 v[96:99], v152 offset:8192
ds_read_b128 v[100:103], v152 offset:9216
ds_read_b128 v[104:107], v152 offset:10240
ds_read_b128 v[108:111], v152 offset:11264
ds_read_b128 v[112:115], v152 offset:12288
ds_read_b128 v[116:119], v152 offset:13312
ds_read_b128 v[120:123], v152 offset:14336
ds_read_b128 v[124:127], v152 offset:15360
s_waitcnt lgkmcnt(7)
v_mfma_f32_16x16x32_bf16 v[48:51], a[80:83], v[96:99], v[48:51]
ds_read_b128 v[64:67], v152 offset:16384
s_waitcnt lgkmcnt(7)
v_mfma_f32_16x16x32_bf16 v[52:55], a[80:83], v[100:103], v[52:55]
ds_read_b128 v[68:71], v152 offset:17408
s_waitcnt lgkmcnt(7)
v_mfma_f32_16x16x32_bf16 v[48:51], a[84:87], v[104:107], v[48:51]
ds_read_b128 v[72:75], v152 offset:18432
s_waitcnt lgkmcnt(7)
v_mfma_f32_16x16x32_bf16 v[52:55], a[84:87], v[108:111], v[52:55]
ds_read_b128 v[76:79], v152 offset:19456
s_waitcnt lgkmcnt(7)
v_mfma_f32_16x16x32_bf16 v[48:51], a[88:91], v[112:115], v[48:51]
ds_read_b128 v[80:83], v152 offset:20480
s_waitcnt lgkmcnt(7)
v_mfma_f32_16x16x32_bf16 v[52:55], a[88:91], v[116:119], v[52:55]
ds_read_b128 v[84:87], v152 offset:21504
s_waitcnt lgkmcnt(7)
v_mfma_f32_16x16x32_bf16 v[48:51], a[92:95], v[120:123], v[48:51]
ds_read_b128 v[88:91], v152 offset:22528
s_waitcnt lgkmcnt(7)
v_mfma_f32_16x16x32_bf16 v[52:55], a[92:95], v[124:127], v[52:55]
ds_read_b128 v[92:95], v152 offset:23552
s_waitcnt lgkmcnt(7)
v_mfma_f32_16x16x32_bf16 v[48:51], a[96:99], v[64:67], v[48:51]
ds_read_b128 v[96:99], v152 offset:24576
s_waitcnt lgkmcnt(7)
v_mfma_f32_16x16x32_bf16 v[52:55], a[96:99], v[68:71], v[52:55]
ds_read_b128 v[100:103], v152 offset:25600
s_waitcnt lgkmcnt(7)
v_mfma_f32_16x16x32_bf16 v[48:51], a[100:103], v[72:75], v[48:51]
ds_read_b128 v[104:107], v152 offset:26624
s_waitcnt lgkmcnt(7)
v_mfma_f32_16x16x32_bf16 v[52:55], a[100:103], v[76:79], v[52:55]
ds_read_b128 v[108:111], v152 offset:27648
s_waitcnt lgkmcnt(7)
v_mfma_f32_16x16x32_bf16 v[48:51], a[104:107], v[80:83], v[48:51]
s_waitcnt lgkmcnt(6)
v_mfma_f32_16x16x32_bf16 v[52:55], a[104:107], v[84:87], v[52:55]
s_waitcnt lgkmcnt(5)
v_mfma_f32_16x16x32_bf16 v[48:51], a[108:111], v[88:91], v[48:51]
s_waitcnt lgkmcnt(4)
v_mfma_f32_16x16x32_bf16 v[52:55], a[108:111], v[92:95], v[52:55]
s_waitcnt lgkmcnt(3)
v_mfma_f32_16x16x32_bf16 v[48:51], a[112:115], v[96:99], v[48:51]
s_waitcnt lgkmcnt(2)
v_mfma_f32_16x16x32_bf16 v[52:55], a[112:115], v[100:103], v[52:55]
s_waitcnt lgkmcnt(1)
v_mfma_f32_16x16x32_bf16 v[48:51], a[116:119], v[104:107], v[48:51]
s_waitcnt lgkmcnt(0)
v_mfma_f32_16x16x32_bf16 v[52:55], a[116:119], v[108:111], v[52:55]
s_waitcnt vmcnt(0)
s_barrier
ds_read_b128 v[112:115], v152 offset:28672
ds_read_b128 v[116:119], v152 offset:29696
ds_read_b128 v[120:123], v152 offset:30720
ds_read_b128 v[124:127], v152 offset:31744
ds_read_b128 v[64:67], v152 offset:32768
ds_read_b128 v[68:71], v152 offset:33792
ds_read_b128 v[72:75], v152 offset:34816
ds_read_b128 v[76:79], v152 offset:35840
s_waitcnt lgkmcnt(7)
v_mfma_f32_16x16x32_bf16 v[48:51], a[120:123], v[112:115], v[48:51]
ds_read_b128 v[80:83], v152 offset:36864
s_waitcnt lgkmcnt(7)
v_mfma_f32_16x16x32_bf16 v[52:55], a[120:123], v[116:119], v[52:55]
ds_read_b128 v[84:87], v152 offset:37888
s_waitcnt lgkmcnt(7)
v_mfma_f32_16x16x32_bf16 v[48:51], a[124:127], v[120:123], v[48:51]
ds_read_b128 v[88:91], v152 offset:38912
s_waitcnt lgkmcnt(7)
v_mfma_f32_16x16x32_bf16 v[52:55], a[124:127], v[124:127], v[52:55]
ds_read_b128 v[92:95], v152 offset:39936
s_waitcnt lgkmcnt(7)
v_mfma_f32_16x16x32_bf16 v[48:51], v[16:19], v[64:67], v[48:51]
ds_read_b128 v[96:99], v152 offset:40960
s_waitcnt lgkmcnt(7)
v_mfma_f32_16x16x32_bf16 v[52:55], v[16:19], v[68:71], v[52:55]
ds_read_b128 v[100:103], v152 offset:41984
s_waitcnt lgkmcnt(7)
v_mfma_f32_16x16x32_bf16 v[48:51], v[20:23], v[72:75], v[48:51]
ds_read_b128 v[104:107], v152 offset:43008
s_waitcnt lgkmcnt(7)
v_mfma_f32_16x16x32_bf16 v[52:55], v[20:23], v[76:79], v[52:55]
ds_read_b128 v[108:111], v152 offset:44032
s_waitcnt lgkmcnt(7)
v_mfma_f32_16x16x32_bf16 v[48:51], v[24:27], v[80:83], v[48:51]
ds_read_b128 v[112:115], v152 offset:45056
s_waitcnt lgkmcnt(7)
v_mfma_f32_16x16x32_bf16 v[52:55], v[24:27], v[84:87], v[52:55]
ds_read_b128 v[116:119], v152 offset:46080
s_waitcnt lgkmcnt(7)
v_mfma_f32_16x16x32_bf16 v[48:51], v[28:31], v[88:91], v[48:51]
ds_read_b128 v[120:123], v152 offset:47104
s_waitcnt lgkmcnt(7)
v_mfma_f32_16x16x32_bf16 v[52:55], v[28:31], v[92:95], v[52:55]
ds_read_b128 v[124:127], v152 offset:48128
s_waitcnt lgkmcnt(7)
v_mfma_f32_16x16x32_bf16 v[48:51], v[32:35], v[96:99], v[48:51]
s_waitcnt lgkmcnt(6)
v_mfma_f32_16x16x32_bf16 v[52:55], v[32:35], v[100:103], v[52:55]
s_waitcnt lgkmcnt(5)
v_mfma_f32_16x16x32_bf16 v[48:51], v[36:39], v[104:107], v[48:51]
s_waitcnt lgkmcnt(4)
v_mfma_f32_16x16x32_bf16 v[52:55], v[36:39], v[108:111], v[52:55]
s_waitcnt lgkmcnt(3)
v_mfma_f32_16x16x32_bf16 v[48:51], v[40:43], v[112:115], v[48:51]
s_waitcnt lgkmcnt(2)
v_mfma_f32_16x16x32_bf16 v[52:55], v[40:43], v[116:119], v[52:55]
s_waitcnt lgkmcnt(1)
v_mfma_f32_16x16x32_bf16 v[48:51], v[44:47], v[120:123], v[48:51]
s_waitcnt lgkmcnt(0)
v_mfma_f32_16x16x32_bf16 v[52:55], v[44:47], v[124:127], v[52:55]
s_nop 3
v_cvt_pk_bf16_f32 v64, v48, v49
v_cvt_pk_bf16_f32 v65, v50, v51
s_nop 1
v_cvt_pk_bf16_f32 v66, v52, v53
v_cvt_pk_bf16_f32 v67, v54, v55
v_lshlrev_b32 v48, 16, v64
v_and_b32 v49, 0xffff0000, v64
v_lshlrev_b32 v50, 16, v65
v_and_b32 v51, 0xffff0000, v65
v_lshlrev_b32 v52, 16, v66
v_and_b32 v53, 0xffff0000, v66
v_lshlrev_b32 v54, 16, v67
v_and_b32 v55, 0xffff0000, v67
v_mul_f32 v48, v48, v140
v_mul_f32 v49, v49, v141
v_mul_f32 v50, v50, v142
v_mul_f32 v51, v51, v143
v_mul_f32 v52, v52, v144
v_mul_f32 v53, v53, v145
v_mul_f32 v54, v54, v146
v_mul_f32 v55, v55, v147
v_cvt_pk_bf16_f32 v64, v48, v49
v_cvt_pk_bf16_f32 v65, v50, v51
v_cvt_pk_bf16_f32 v66, v52, v53
v_cvt_pk_bf16_f32 v67, v54, v55
v_lshlrev_b32 v48, 16, v64
v_and_b32 v49, 0xffff0000, v64
v_lshlrev_b32 v50, 16, v65
v_and_b32 v51, 0xffff0000, v65
v_lshlrev_b32 v52, 16, v66
v_and_b32 v53, 0xffff0000, v66
v_lshlrev_b32 v54, 16, v67
v_and_b32 v55, 0xffff0000, v67
v_lshlrev_b32 v56, 16, v136
v_and_b32 v57, 0xffff0000, v136
v_lshlrev_b32 v58, 16, v137
v_and_b32 v59, 0xffff0000, v137
v_lshlrev_b32 v60, 16, v138
v_and_b32 v61, 0xffff0000, v138
v_lshlrev_b32 v62, 16, v139
v_and_b32 v63, 0xffff0000, v139
v_add_f32 v48, v48, v56
v_add_f32 v49, v49, v57
v_add_f32 v50, v50, v58
v_add_f32 v51, v51, v59
v_add_f32 v52, v52, v60
v_add_f32 v53, v53, v61
v_add_f32 v54, v54, v62
v_add_f32 v55, v55, v63
v_cvt_pk_bf16_f32 v48, v48, v49
v_cvt_pk_bf16_f32 v49, v50, v51
v_cvt_pk_bf16_f32 v50, v52, v53
v_cvt_pk_bf16_f32 v51, v54, v55
buffer_store_dwordx2 v[48:49], v151, s[28:31], s75 offen
buffer_store_dwordx2 v[50:51], v151, s[28:31], s76 offen
s_add_u32 s70, s70, 1
s_cmp_lt_u32 s70, s82
s_cbranch_scc1 Lfb_516
s_waitcnt vmcnt(0)
s_endpgm
L_wend:
s_waitcnt vmcnt(0)
L_end:
s_endpgm
.section .rodata,"a"
.p2align 6
.amdhsa_kernel recurrent_scan__memory_aug_recurrent_mem_tr__dense_activation_relu__prompt_kernel
  .amdhsa_next_free_vgpr 512
  .amdhsa_next_free_sgpr 102
  .amdhsa_accum_offset 256
  .amdhsa_group_segment_fixed_size 0
  .amdhsa_kernarg_size 104
  .amdhsa_user_sgpr_count 2
  .amdhsa_user_sgpr_kernarg_segment_ptr 1
  .amdhsa_system_sgpr_workgroup_id_x 1
.end_amdhsa_kernel
```
